```python
import torch

def _softmax(x, axis=-1):
    return torch.softmax(x, dim=axis)

def _gelu(x):
    return torch.nn.functional.gelu(x, approximate='tanh')

def _silu(x):
    return torch.nn.functional.silu(x)

def _sigmoid(x):
    return torch.sigmoid(x)

def _layernorm(x, axis=-1, eps=1e-05):
    m = x.mean(dim=axis, keepdim=True)
    v = x.var(dim=axis, keepdim=True, unbiased=False)
    return (x - m) / torch.sqrt(v + eps)

def _scatter_add(tgt, idx, src, axis=0):
    return tgt.clone().index_add_(axis, idx, src)

def _segment_sum(src, seg, n):
    out = torch.zeros((n,) + src.shape[1:], dtype=src.dtype)
    return out.index_add_(0, seg, src)

def _pad(x, pw):
    flat = tuple((v for pair in reversed(pw) for v in pair))
    return torch.nn.functional.pad(x, flat)
kernel_name = 'adaLN_cond__mha_block_cached__swiglu_ffn__prompt'

def setup_inputs():

    _w = lambda a: (lambda t: t.to(torch.bfloat16) if t.is_floating_point() else t)(torch.as_tensor(a))

    def _A_setup():
        B, Sq, D = (1, 2048, 512)
        H, Sk, Dh = (32, 2048, 128)
        return {'x': _w((lambda *s: torch.randn(*s, dtype=torch.bfloat16) * 0.1)(B, Sq, D)), 'k_cache': _w((lambda *s: torch.randn(*s, dtype=torch.bfloat16) * 0.8)(B, H, Sk, Dh)), 'v_cache': _w((lambda *s: torch.randn(*s, dtype=torch.bfloat16) * 1.6)(B, H, Sk, Dh)), 'wq': _w((lambda *s: torch.randn(*s, dtype=torch.bfloat16) * 0.8)(D, H * Dh) * D ** (-0.5)), 'wo': _w((lambda *s: torch.randn(*s, dtype=torch.bfloat16) * 1.6)(H * Dh, D) * (H * Dh) ** (-0.5))}
    _A_in = _A_setup()

    def _B_setup():
        B, S, D, F = (1, 2048, 512, 1792)
        return {'x': _w((lambda *s: torch.randn(*s, dtype=torch.bfloat16) * 0.1)(B, S, D)), 'w_gate': _w((lambda *s: torch.randn(*s, dtype=torch.bfloat16) * 0.1)(D, F)), 'w_up': _w((lambda *s: torch.randn(*s, dtype=torch.bfloat16) * 0.1)(D, F)), 'w_down': _w((lambda *s: torch.randn(*s, dtype=torch.bfloat16) * 0.1)(F, D))}
    _B_in = _B_setup()
    return {'A_x': _A_in['x'], 'A_k_cache': _A_in['k_cache'], 'A_v_cache': _A_in['v_cache'], 'A_wq': _A_in['wq'], 'A_wo': _A_in['wo'], 'B_x': _B_in['x'], 'B_w_gate': _B_in['w_gate'], 'B_w_up': _B_in['w_up'], 'B_w_down': _B_in['w_down'], 'c': _w((lambda *s: torch.randn(*s, dtype=torch.bfloat16) * 0.8)(1, 512) * 8.0), 'w_mod': _w((lambda *s: torch.randn(*s, dtype=torch.bfloat16) * 0.8)(512, 6 * 512) * 512 ** (-0.5) * 8.0)}

def reference(A_x, A_k_cache, A_v_cache, A_wq, A_wo, B_x, B_w_gate, B_w_up, B_w_down, c, w_mod):

    def _A_ref(x, k_cache, v_cache, wq, wo):
        B, Sq, D = x.shape
        H, Dh = (32, 128)
        q = (lambda x, *d: x.permute(*d))((x @ wq).reshape(B, Sq, H, Dh), 0, 2, 1, 3)
        scores = torch.einsum('bhqd,bhkd->bhqk', q, k_cache) * Dh ** (-0.5)
        p = _softmax(scores, axis=-1)
        o = torch.einsum('bhqk,bhkd->bhqd', p, v_cache)
        return (lambda x, *d: x.permute(*d))(o, 0, 2, 1, 3).reshape(B, Sq, H * Dh) @ wo

    def _B_ref(x, w_gate, w_up, w_down):
        g = _silu(x @ w_gate)
        u = x @ w_up
        return g * u @ w_down
    x = A_x
    mod = (_silu(c) @ w_mod).reshape(c.shape[0], 6, 1, -1)
    sa, ca, ga, sb, cb, gb = (mod[:, 0].clone(), mod[:, 1].clone(), mod[:, 2].clone(), mod[:, 3].clone(), mod[:, 4].clone(), mod[:, 5].clone())
    h = _layernorm(x, axis=-1) * (1 + ca) + sa
    x = x + ga * _A_ref(h, A_k_cache, A_v_cache, A_wq, A_wo)
    h = _layernorm(x, axis=-1) * (1 + cb) + sb
    x = x + gb * _B_ref(h, B_w_gate, B_w_up, B_w_down)
    return x
```

```asm
; @launch grid=(256,1,1) block=(256,1,1) lds=163840
.amdgcn_target "amdgcn-amd-amdhsa--gfx950"
.text
.globl adaLN_cond__mha_block_cached__swiglu_ffn__prompt_kernel
.p2align 8
.type adaLN_cond__mha_block_cached__swiglu_ffn__prompt_kernel,@function
adaLN_cond__mha_block_cached__swiglu_ffn__prompt_kernel:
    s_cmp_ge_u32 s2, 256
    s_cbranch_scc1 fused_exit
    s_load_dwordx2 s[34:35], s[0:1], 104
    s_load_dwordx2 s[48:49], s[0:1], 96
    s_load_dwordx2 s[4:5], s[0:1], 72
    s_load_dwordx2 s[8:9], s[0:1], 80
    s_load_dwordx2 s[12:13], s[0:1], 0
    s_load_dwordx2 s[52:53], s[0:1], 24
    v_lshrrev_b32 v1, 6, v0
    s_nop 0
    v_readfirstlane_b32 s24, v1
    s_mov_b32 s33, 0
    s_waitcnt lgkmcnt(0)
    s_cmp_lg_u32 s2, 0
    s_cbranch_scc1 no_nonce
    s_cmp_lg_u32 s24, 0
    s_cbranch_scc1 no_nonce
    s_memrealtime s[40:41]
    s_waitcnt lgkmcnt(0)
    s_or_b32 s40, s40, 1
    v_mov_b32 v3, s40
    v_mov_b32 v4, 0
    s_mov_b64 exec, 1
    global_store_dword v4, v3, s[48:49] sc1
    s_mov_b64 exec, -1
no_nonce:
    s_mov_b32 s65, s2
    s_cmp_ge_u32 s65, 192
    s_cbranch_scc1 p0_ln
    s_mul_hi_u32 s20, s65, 0x5555556
    s_mul_i32 s21, s20, 48
    s_sub_u32 s21, s65, s21
    v_mbcnt_lo_u32_b32 v2, -1, 0
    v_mbcnt_hi_u32_b32 v2, -1, v2
    s_lshl_b32 s22, s20, 7
    s_lshl_b32 s23, s24, 5
    s_add_u32 s22, s22, s23
    v_lshrrev_b32 v3, 3, v2
    v_add_u32 v3, s22, v3
    v_and_b32 v4, 7, v2
    s_mov_b32 s23, 6144
    v_mul_lo_u32 v5, v3, s23
    s_lshl_b32 s25, s21, 7
    v_lshl_add_u32 v5, v4, 4, v5
    v_add_u32 v5, s25, v5
    v_lshlrev_b32 v6, 1, v3
    s_and_b32 s5, s5, 0xffff
    s_mov_b32 s6, 1024
    s_mov_b32 s7, 0x00020000
    s_and_b32 s9, s9, 0xffff
    s_mov_b32 s10, 3145728
    s_mov_b32 s11, 0x00020000
    s_mov_b32 s26, 0
    buffer_load_dwordx4 v[8:11], v5, s[8:11], s26 offen
    buffer_load_ushort v24, v6, s[4:7], 0 offen offset:0
    s_mov_b32 s26, 49152
    buffer_load_dwordx4 v[12:15], v5, s[8:11], s26 offen
    buffer_load_ushort v25, v6, s[4:7], 0 offen offset:16
    s_mov_b32 s26, 98304
    buffer_load_dwordx4 v[16:19], v5, s[8:11], s26 offen
    buffer_load_ushort v26, v6, s[4:7], 0 offen offset:32
    s_mov_b32 s26, 147456
    buffer_load_dwordx4 v[20:23], v5, s[8:11], s26 offen
    buffer_load_ushort v27, v6, s[4:7], 0 offen offset:48
    s_getpc_b64 s[40:41]
code_here_m:
    s_sub_u32 s40, s40, code_here_m-adaLN_cond__mha_block_cached__swiglu_ffn__prompt_kernel
    s_subb_u32 s41, s41, 0
    s_lshr_b32 s42, s2, 3
    s_lshl_b32 s42, s42, 2
    s_add_u32 s42, s42, s24
    s_lshl_b32 s42, s42, 3
    v_and_b32 v126, 7, v0
    v_add_u32 v126, s42, v126
    s_mov_b32 s42, ((code_end-adaLN_cond__mha_block_cached__swiglu_ffn__prompt_kernel)>>7)
    v_cmp_gt_u32 vcc, s42, v126
    v_lshlrev_b32 v126, 7, v126
    s_and_saveexec_b64 s[42:43], vcc
    s_cbranch_execz ctouch_done_m
    global_load_dword v255, v126, s[40:41]
ctouch_done_m:
    s_mov_b64 exec, s[42:43]
    s_waitcnt vmcnt(6)
    v_lshlrev_b32 v24, 16, v24
    v_mul_f32 v28, 0xbfb8aa3b, v24
    v_exp_f32 v28, v28
    s_nop 0
    v_add_f32 v28, 1.0, v28
    v_rcp_f32 v28, v28
    s_nop 0
    v_mul_f32 v24, v24, v28
    v_cvt_pk_bf16_f32 v24, v24, v24
    v_and_b32 v24, 0xffff0000, v24
    s_waitcnt vmcnt(4)
    v_lshlrev_b32 v25, 16, v25
    v_mul_f32 v28, 0xbfb8aa3b, v25
    v_exp_f32 v28, v28
    s_nop 0
    v_add_f32 v28, 1.0, v28
    v_rcp_f32 v28, v28
    s_nop 0
    v_mul_f32 v25, v25, v28
    v_cvt_pk_bf16_f32 v25, v25, v25
    v_and_b32 v25, 0xffff0000, v25
    s_waitcnt vmcnt(2)
    v_lshlrev_b32 v26, 16, v26
    v_mul_f32 v28, 0xbfb8aa3b, v26
    v_exp_f32 v28, v28
    s_nop 0
    v_add_f32 v28, 1.0, v28
    v_rcp_f32 v28, v28
    s_nop 0
    v_mul_f32 v26, v26, v28
    v_cvt_pk_bf16_f32 v26, v26, v26
    v_and_b32 v26, 0xffff0000, v26
    s_waitcnt vmcnt(0)
    v_lshlrev_b32 v27, 16, v27
    v_mul_f32 v28, 0xbfb8aa3b, v27
    v_exp_f32 v28, v28
    s_nop 0
    v_add_f32 v28, 1.0, v28
    v_rcp_f32 v28, v28
    s_nop 0
    v_mul_f32 v27, v27, v28
    v_cvt_pk_bf16_f32 v27, v27, v27
    v_and_b32 v27, 0xffff0000, v27
    v_mov_b32 v32, 0
    v_mov_b32 v33, 0
    v_mov_b32 v34, 0
    v_mov_b32 v35, 0
    v_mov_b32 v36, 0
    v_mov_b32 v37, 0
    v_mov_b32 v38, 0
    v_mov_b32 v39, 0
    v_lshlrev_b32 v28, 16, v8
    v_and_b32 v29, 0xffff0000, v8
    v_fmac_f32 v32, v28, v24
    v_fmac_f32 v33, v29, v24
    v_lshlrev_b32 v28, 16, v9
    v_and_b32 v29, 0xffff0000, v9
    v_fmac_f32 v34, v28, v24
    v_fmac_f32 v35, v29, v24
    v_lshlrev_b32 v28, 16, v10
    v_and_b32 v29, 0xffff0000, v10
    v_fmac_f32 v36, v28, v24
    v_fmac_f32 v37, v29, v24
    v_lshlrev_b32 v28, 16, v11
    v_and_b32 v29, 0xffff0000, v11
    v_fmac_f32 v38, v28, v24
    v_fmac_f32 v39, v29, v24
    v_lshlrev_b32 v28, 16, v12
    v_and_b32 v29, 0xffff0000, v12
    v_fmac_f32 v32, v28, v25
    v_fmac_f32 v33, v29, v25
    v_lshlrev_b32 v28, 16, v13
    v_and_b32 v29, 0xffff0000, v13
    v_fmac_f32 v34, v28, v25
    v_fmac_f32 v35, v29, v25
    v_lshlrev_b32 v28, 16, v14
    v_and_b32 v29, 0xffff0000, v14
    v_fmac_f32 v36, v28, v25
    v_fmac_f32 v37, v29, v25
    v_lshlrev_b32 v28, 16, v15
    v_and_b32 v29, 0xffff0000, v15
    v_fmac_f32 v38, v28, v25
    v_fmac_f32 v39, v29, v25
    v_lshlrev_b32 v28, 16, v16
    v_and_b32 v29, 0xffff0000, v16
    v_fmac_f32 v32, v28, v26
    v_fmac_f32 v33, v29, v26
    v_lshlrev_b32 v28, 16, v17
    v_and_b32 v29, 0xffff0000, v17
    v_fmac_f32 v34, v28, v26
    v_fmac_f32 v35, v29, v26
    v_lshlrev_b32 v28, 16, v18
    v_and_b32 v29, 0xffff0000, v18
    v_fmac_f32 v36, v28, v26
    v_fmac_f32 v37, v29, v26
    v_lshlrev_b32 v28, 16, v19
    v_and_b32 v29, 0xffff0000, v19
    v_fmac_f32 v38, v28, v26
    v_fmac_f32 v39, v29, v26
    v_lshlrev_b32 v28, 16, v20
    v_and_b32 v29, 0xffff0000, v20
    v_fmac_f32 v32, v28, v27
    v_fmac_f32 v33, v29, v27
    v_lshlrev_b32 v28, 16, v21
    v_and_b32 v29, 0xffff0000, v21
    v_fmac_f32 v34, v28, v27
    v_fmac_f32 v35, v29, v27
    v_lshlrev_b32 v28, 16, v22
    v_and_b32 v29, 0xffff0000, v22
    v_fmac_f32 v36, v28, v27
    v_fmac_f32 v37, v29, v27
    v_lshlrev_b32 v28, 16, v23
    v_and_b32 v29, 0xffff0000, v23
    v_fmac_f32 v38, v28, v27
    v_fmac_f32 v39, v29, v27
    v_mov_b32 v125, 0
    global_load_dword v124, v125, s[48:49] sc1
    s_and_b32 s56, s2, 7
    s_lshr_b32 s57, s2, 3
    s_lshr_b32 s59, s57, 2
    s_and_b32 s57, s57, 3
    s_lshl_b32 s56, s56, 2
    s_add_u32 s56, s56, s57
    s_lshl_b32 s56, s56, 8
    v_mbcnt_lo_u32_b32 v250, -1, 0
    v_mbcnt_hi_u32_b32 v250, -1, v250
    v_lshrrev_b32 v251, 1, v250
    v_and_b32 v251, 15, v251
    s_lshl_b32 s59, s59, 6
    s_lshl_b32 s57, s24, 4
    s_add_u32 s59, s59, s57
    v_add_u32 v251, s59, v251
    v_lshlrev_b32 v251, 13, v251
    v_and_b32 v252, 1, v250
    v_lshl_add_u32 v251, v252, 7, v251
    s_add_u32 s52, s52, s56
    s_addc_u32 s53, s53, 0
    s_and_b32 s53, s53, 0xffff
    s_sub_u32 s54, 0x400000, s56
    s_mov_b32 s55, 0x00020000
    buffer_load_dword v255, v251, s[52:55], 0 offen
    v_lshrrev_b32 v3, 3, v2
    s_lshl_b32 s22, s24, 3
    v_add_u32 v3, s22, v3
    v_lshlrev_b32 v3, 8, v3
    v_lshl_add_u32 v3, v4, 5, v3
    v_add_u32 v3, 131072, v3
    ds_write_b128 v3, v[32:35]
    ds_write_b128 v3, v[36:39] offset:16
    s_waitcnt lgkmcnt(0)
    s_barrier
    s_cmp_lg_u32 s24, 0
    s_cbranch_scc1 p0_mod_done
    v_lshlrev_b32 v3, 2, v2
    v_add_u32 v7, 131072, v3
    ds_read_b32 v8, v7 offset:0
    ds_read_b32 v9, v7 offset:256
    ds_read_b32 v10, v7 offset:512
    ds_read_b32 v11, v7 offset:768
    ds_read_b32 v12, v7 offset:1024
    ds_read_b32 v13, v7 offset:1280
    ds_read_b32 v14, v7 offset:1536
    ds_read_b32 v15, v7 offset:1792
    ds_read_b32 v16, v7 offset:2048
    ds_read_b32 v17, v7 offset:2304
    ds_read_b32 v18, v7 offset:2560
    ds_read_b32 v19, v7 offset:2816
    ds_read_b32 v20, v7 offset:3072
    ds_read_b32 v21, v7 offset:3328
    ds_read_b32 v22, v7 offset:3584
    ds_read_b32 v23, v7 offset:3840
    v_mov_b32 v40, 0
    v_mov_b32 v41, 0
    s_waitcnt lgkmcnt(15)
    v_add_f32 v40, v40, v8
    s_waitcnt lgkmcnt(14)
    v_add_f32 v41, v41, v9
    s_waitcnt lgkmcnt(13)
    v_add_f32 v40, v40, v10
    s_waitcnt lgkmcnt(12)
    v_add_f32 v41, v41, v11
    s_waitcnt lgkmcnt(11)
    v_add_f32 v40, v40, v12
    s_waitcnt lgkmcnt(10)
    v_add_f32 v41, v41, v13
    s_waitcnt lgkmcnt(9)
    v_add_f32 v40, v40, v14
    s_waitcnt lgkmcnt(8)
    v_add_f32 v41, v41, v15
    s_waitcnt lgkmcnt(7)
    v_add_f32 v40, v40, v16
    s_waitcnt lgkmcnt(6)
    v_add_f32 v41, v41, v17
    s_waitcnt lgkmcnt(5)
    v_add_f32 v40, v40, v18
    s_waitcnt lgkmcnt(4)
    v_add_f32 v41, v41, v19
    s_waitcnt lgkmcnt(3)
    v_add_f32 v40, v40, v20
    s_waitcnt lgkmcnt(2)
    v_add_f32 v41, v41, v21
    s_waitcnt lgkmcnt(1)
    v_add_f32 v40, v40, v22
    s_waitcnt lgkmcnt(0)
    v_add_f32 v41, v41, v23
    ds_read_b32 v8, v7 offset:4096
    ds_read_b32 v9, v7 offset:4352
    ds_read_b32 v10, v7 offset:4608
    ds_read_b32 v11, v7 offset:4864
    ds_read_b32 v12, v7 offset:5120
    ds_read_b32 v13, v7 offset:5376
    ds_read_b32 v14, v7 offset:5632
    ds_read_b32 v15, v7 offset:5888
    ds_read_b32 v16, v7 offset:6144
    ds_read_b32 v17, v7 offset:6400
    ds_read_b32 v18, v7 offset:6656
    ds_read_b32 v19, v7 offset:6912
    ds_read_b32 v20, v7 offset:7168
    ds_read_b32 v21, v7 offset:7424
    ds_read_b32 v22, v7 offset:7680
    ds_read_b32 v23, v7 offset:7936
    s_waitcnt lgkmcnt(15)
    v_add_f32 v40, v40, v8
    s_waitcnt lgkmcnt(14)
    v_add_f32 v41, v41, v9
    s_waitcnt lgkmcnt(13)
    v_add_f32 v40, v40, v10
    s_waitcnt lgkmcnt(12)
    v_add_f32 v41, v41, v11
    s_waitcnt lgkmcnt(11)
    v_add_f32 v40, v40, v12
    s_waitcnt lgkmcnt(10)
    v_add_f32 v41, v41, v13
    s_waitcnt lgkmcnt(9)
    v_add_f32 v40, v40, v14
    s_waitcnt lgkmcnt(8)
    v_add_f32 v41, v41, v15
    s_waitcnt lgkmcnt(7)
    v_add_f32 v40, v40, v16
    s_waitcnt lgkmcnt(6)
    v_add_f32 v41, v41, v17
    s_waitcnt lgkmcnt(5)
    v_add_f32 v40, v40, v18
    s_waitcnt lgkmcnt(4)
    v_add_f32 v41, v41, v19
    s_waitcnt lgkmcnt(3)
    v_add_f32 v40, v40, v20
    s_waitcnt lgkmcnt(2)
    v_add_f32 v41, v41, v21
    s_waitcnt lgkmcnt(1)
    v_add_f32 v40, v40, v22
    s_waitcnt lgkmcnt(0)
    v_add_f32 v41, v41, v23
    v_add_f32 v40, v40, v41
    s_mul_i32 s22, s20, 12288
    s_lshl_b32 s23, s21, 8
    s_add_u32 s22, s22, s23
    s_add_u32 s22, s22, 0
    v_add_u32 v3, s22, v3
    s_waitcnt vmcnt(1)
    v_readfirstlane_b32 s33, v124
    s_cmp_lg_u32 s24, 0
    s_cbranch_scc1 nskip_1
    s_cmp_lg_u32 s33, 0
    s_cbranch_scc1 nskip_1
    s_mov_b32 s47, 400000
    v_mov_b32 v45, 0
nloop_1:
    global_load_dword v44, v45, s[48:49] sc1
    s_waitcnt vmcnt(0)
    v_readfirstlane_b32 s33, v44
    s_cmp_lg_u32 s33, 0
    s_cbranch_scc1 nskip_1
    s_sub_u32 s47, s47, 1
    s_cmp_lg_u32 s47, 0
    s_cbranch_scc1 nloop_1
nskip_1:
    s_cmp_ge_u32 s21, 16
    s_cbranch_scc1 mod_notag
    s_lshl_b32 s22, s20, 13
    s_lshl_b32 s23, s21, 9
    s_add_u32 s22, s22, s23
    s_add_u32 s22, s22, 655360
    v_lshlrev_b32 v5, 3, v2
    v_add_u32 v5, s22, v5
    v_mov_b32 v41, s33
    global_store_dwordx2 v5, v[40:41], s[34:35] sc1
mod_notag:
    global_store_dword v3, v40, s[34:35] sc1
    s_lshl_b32 s22, s65, 2
    s_add_u32 s22, s22, 0x3000000
    s_waitcnt vmcnt(0)
    s_cmp_lg_u32 s24, 0
    s_cbranch_scc1 fskip_mod_2
    v_mov_b32 v44, s33
    v_mov_b32 v45, s22
    s_mov_b64 exec, 1
    global_store_dword v45, v44, s[34:35] sc1
    s_mov_b64 exec, -1
fskip_mod_2:
p0_mod_done:
    v_mbcnt_lo_u32_b32 v250, -1, 0
    v_mbcnt_hi_u32_b32 v250, -1, v250
    v_lshrrev_b32 v251, 4, v250
    v_and_b32 v252, 15, v250
    v_lshlrev_b32 v253, 2, v251
    v_xor_b32 v253, v252, v253
    v_lshlrev_b32 v253, 4, v253
    s_lshl_b32 s57, s24, 3
    v_add_u32 v254, s57, v251
    v_lshl_add_u32 v203, v254, 13, v253
    v_add_u32 v200, 31744, v203
    s_lshl_b32 s58, s24, 11
    s_add_u32 m0, s58, 0x0
    s_mov_b32 s59, 0x0
    buffer_load_dwordx4 v203, s[52:55], s59 offen lds
    buffer_load_dwordx4 v200, s[52:55], s59 offen offset:1024 lds
    s_add_u32 m0, s58, 0x2000
    s_mov_b32 s59, 0x40000
    buffer_load_dwordx4 v203, s[52:55], s59 offen lds
    buffer_load_dwordx4 v200, s[52:55], s59 offen offset:1024 lds
    s_add_u32 m0, s58, 0x4000
    s_mov_b32 s59, 0x80000
    buffer_load_dwordx4 v203, s[52:55], s59 offen lds
    buffer_load_dwordx4 v200, s[52:55], s59 offen offset:1024 lds
    s_add_u32 m0, s58, 0x6000
    s_mov_b32 s59, 0xc0000
    buffer_load_dwordx4 v203, s[52:55], s59 offen lds
    buffer_load_dwordx4 v200, s[52:55], s59 offen offset:1024 lds
    s_add_u32 m0, s58, 0x10000
    s_mov_b32 s59, 0x100000
    buffer_load_dwordx4 v203, s[52:55], s59 offen lds
    buffer_load_dwordx4 v200, s[52:55], s59 offen offset:1024 lds
    s_add_u32 m0, s58, 0x12000
    s_mov_b32 s59, 0x140000
    buffer_load_dwordx4 v203, s[52:55], s59 offen lds
    buffer_load_dwordx4 v200, s[52:55], s59 offen offset:1024 lds
    s_add_u32 m0, s58, 0x8000
    s_mov_b32 s59, 0x180000
    buffer_load_dwordx4 v203, s[52:55], s59 offen lds
    buffer_load_dwordx4 v200, s[52:55], s59 offen offset:1024 lds
    s_add_u32 m0, s58, 0xa000
    s_mov_b32 s59, 0x1c0000
    buffer_load_dwordx4 v203, s[52:55], s59 offen lds
    buffer_load_dwordx4 v200, s[52:55], s59 offen offset:1024 lds
    s_add_u32 m0, s58, 0xc000
    s_mov_b32 s59, 0x200000
    buffer_load_dwordx4 v203, s[52:55], s59 offen lds
    buffer_load_dwordx4 v200, s[52:55], s59 offen offset:1024 lds
    s_add_u32 m0, s58, 0x14000
    s_mov_b32 s59, 0x240000
    buffer_load_dwordx4 v203, s[52:55], s59 offen lds
    buffer_load_dwordx4 v200, s[52:55], s59 offen offset:1024 lds
    s_add_u32 m0, s58, 0x16000
    s_mov_b32 s59, 0x280000
    buffer_load_dwordx4 v203, s[52:55], s59 offen lds
    buffer_load_dwordx4 v200, s[52:55], s59 offen offset:1024 lds
    s_add_u32 m0, s58, 0x18000
    s_mov_b32 s59, 0x2c0000
    buffer_load_dwordx4 v203, s[52:55], s59 offen lds
    buffer_load_dwordx4 v200, s[52:55], s59 offen offset:1024 lds
    s_add_u32 m0, s58, 0xe000
    s_mov_b32 s59, 0x300000
    buffer_load_dwordx4 v203, s[52:55], s59 offen lds
    buffer_load_dwordx4 v200, s[52:55], s59 offen offset:1024 lds
    s_add_u32 m0, s58, 0x1a000
    s_mov_b32 s59, 0x340000
    buffer_load_dwordx4 v203, s[52:55], s59 offen lds
    buffer_load_dwordx4 v200, s[52:55], s59 offen offset:1024 lds
    s_add_u32 m0, s58, 0x1c000
    s_mov_b32 s59, 0x380000
    buffer_load_dwordx4 v203, s[52:55], s59 offen lds
    buffer_load_dwordx4 v200, s[52:55], s59 offen offset:1024 lds
    s_add_u32 m0, s58, 0x1e000
    s_mov_b32 s59, 0x3c0000
    buffer_load_dwordx4 v203, s[52:55], s59 offen lds
    buffer_load_dwordx4 v200, s[52:55], s59 offen offset:1024 lds
    s_waitcnt vmcnt(0)
    s_load_dwordx2 s[4:5], s[0:1], 32
    s_load_dwordx2 s[8:9], s[0:1], 64
    s_lshl_b32 s20, s65, 2
    s_add_u32 s20, s20, s24
    s_sub_u32 s21, s20, 512
    v_mbcnt_lo_u32_b32 v2, -1, 0
    v_mbcnt_hi_u32_b32 v2, -1, v2
    v_lshrrev_b32 v3, 3, v2
    v_and_b32 v2, 7, v2
    v_lshlrev_b32 v3, 10, v3
    v_lshl_add_u32 v2, v2, 4, v3
    s_waitcnt lgkmcnt(0)
    s_cmp_lt_u32 s20, 512
    s_cselect_b32 s4, s4, s8
    s_cselect_b32 s5, s5, s9
    s_cselect_b32 s22, s20, s21
    s_mov_b32 s21, 0x1c0000
    s_cselect_b32 s6, 0x400000, s21
    s_cmp_lt_u32 s20, 736
    s_cselect_b32 s6, s6, 0
    s_lshr_b32 s21, s4, 7
    s_sub_u32 s21, 3, s21
    s_and_b32 s21, s21, 7
    s_lshl_b32 s21, s21, 7
    s_and_b32 s5, s5, 0xffff
    s_mov_b32 s7, 0x00020000
    s_lshl_b32 s22, s22, 13
    s_add_u32 s22, s22, s21
    buffer_load_dwordx4 a[208:211], v2, s[4:7], s22 offen
    s_load_dwordx2 s[4:5], s[0:1], 8
    s_load_dwordx2 s[8:9], s[0:1], 16
    s_and_b32 s36, s2, 7
    s_lshr_b32 s37, s2, 3
    s_and_b32 s38, s37, 3
    s_lshl_b32 s29, s36, 2
    s_add_u32 s29, s29, s38
    s_lshr_b32 s32, s37, 2
    s_lshl_b32 s25, s24, 11
    v_mbcnt_lo_u32_b32 v2, -1, 0
    v_mbcnt_hi_u32_b32 v2, -1, v2
    s_waitcnt lgkmcnt(0)
    s_lshl_b32 s36, s29, 19
    s_add_u32 s4, s4, s36
    s_addc_u32 s5, s5, 0
    s_add_u32 s8, s8, s36
    s_addc_u32 s9, s9, 0
    s_and_b32 s5, s5, 0xffff
    s_mov_b32 s6, 0x80000
    s_mov_b32 s7, 0x00020000
    s_and_b32 s9, s9, 0xffff
    s_mov_b32 s10, 0x80000
    s_mov_b32 s11, 0x00020000
    s_lshl_b32 s36, s32, 3
    s_lshl_b32 s37, s24, 1
    s_add_u32 s36, s36, s37
    s_mov_b32 s39, s36
    s_lshl_b32 s36, s36, 15
    s_add_u32 s36, s36, 0x100000
    s_add_u32 s16, s34, s36
    s_addc_u32 s17, s35, 0
    s_and_b32 s17, s17, 0xffff
    s_mov_b32 s18, 0x10000
    s_mov_b32 s19, 0x00020000
    v_lshlrev_b32 v201, 4, v2
    v_add_u32 v202, 0x8000, v201
    v_lshrrev_b32 v4, 4, v2
    v_and_b32 v5, 15, v2
    v_lshlrev_b32 v6, 2, v4
    v_xor_b32 v6, v5, v6
    v_lshlrev_b32 v6, 4, v6
    s_lshl_b32 s36, s24, 3
    v_add_u32 v7, s36, v4
    v_lshl_add_u32 v206, v7, 8, v6
    v_xor_b32 v6, 32, v6
    v_lshl_add_u32 v207, v7, 8, v6
    v_add_u32 v24, 0, v7
    v_and_b32 v24, 15, v24
    v_xor_b32 v24, v5, v24
    v_lshlrev_b32 v24, 4, v24
    v_lshl_add_u32 v204, v7, 8, v24
    v_add_u32 v24, 4, v7
    v_and_b32 v24, 15, v24
    v_xor_b32 v24, v5, v24
    v_lshlrev_b32 v24, 4, v24
    v_lshl_add_u32 v205, v7, 8, v24
    v_accvgpr_write_b32 a0, 0
    v_accvgpr_write_b32 a1, 0
    v_accvgpr_write_b32 a2, 0
    v_accvgpr_write_b32 a3, 0
    v_accvgpr_write_b32 a4, 0
    v_accvgpr_write_b32 a5, 0
    v_accvgpr_write_b32 a6, 0
    v_accvgpr_write_b32 a7, 0
    v_accvgpr_write_b32 a8, 0
    v_accvgpr_write_b32 a9, 0
    v_accvgpr_write_b32 a10, 0
    v_accvgpr_write_b32 a11, 0
    v_accvgpr_write_b32 a12, 0
    v_accvgpr_write_b32 a13, 0
    v_accvgpr_write_b32 a14, 0
    v_accvgpr_write_b32 a15, 0
    v_accvgpr_write_b32 a16, 0
    v_accvgpr_write_b32 a17, 0
    v_accvgpr_write_b32 a18, 0
    v_accvgpr_write_b32 a19, 0
    v_accvgpr_write_b32 a20, 0
    v_accvgpr_write_b32 a21, 0
    v_accvgpr_write_b32 a22, 0
    v_accvgpr_write_b32 a23, 0
    v_accvgpr_write_b32 a24, 0
    v_accvgpr_write_b32 a25, 0
    v_accvgpr_write_b32 a26, 0
    v_accvgpr_write_b32 a27, 0
    v_accvgpr_write_b32 a28, 0
    v_accvgpr_write_b32 a29, 0
    v_accvgpr_write_b32 a30, 0
    v_accvgpr_write_b32 a31, 0
    v_accvgpr_write_b32 a32, 0
    v_accvgpr_write_b32 a33, 0
    v_accvgpr_write_b32 a34, 0
    v_accvgpr_write_b32 a35, 0
    v_accvgpr_write_b32 a36, 0
    v_accvgpr_write_b32 a37, 0
    v_accvgpr_write_b32 a38, 0
    v_accvgpr_write_b32 a39, 0
    v_accvgpr_write_b32 a40, 0
    v_accvgpr_write_b32 a41, 0
    v_accvgpr_write_b32 a42, 0
    v_accvgpr_write_b32 a43, 0
    v_accvgpr_write_b32 a44, 0
    v_accvgpr_write_b32 a45, 0
    v_accvgpr_write_b32 a46, 0
    v_accvgpr_write_b32 a47, 0
    v_accvgpr_write_b32 a48, 0
    v_accvgpr_write_b32 a49, 0
    v_accvgpr_write_b32 a50, 0
    v_accvgpr_write_b32 a51, 0
    v_accvgpr_write_b32 a52, 0
    v_accvgpr_write_b32 a53, 0
    v_accvgpr_write_b32 a54, 0
    v_accvgpr_write_b32 a55, 0
    v_accvgpr_write_b32 a56, 0
    v_accvgpr_write_b32 a57, 0
    v_accvgpr_write_b32 a58, 0
    v_accvgpr_write_b32 a59, 0
    v_accvgpr_write_b32 a60, 0
    v_accvgpr_write_b32 a61, 0
    v_accvgpr_write_b32 a62, 0
    v_accvgpr_write_b32 a63, 0
    v_accvgpr_write_b32 a64, 0
    v_accvgpr_write_b32 a65, 0
    v_accvgpr_write_b32 a66, 0
    v_accvgpr_write_b32 a67, 0
    v_accvgpr_write_b32 a68, 0
    v_accvgpr_write_b32 a69, 0
    v_accvgpr_write_b32 a70, 0
    v_accvgpr_write_b32 a71, 0
    v_accvgpr_write_b32 a72, 0
    v_accvgpr_write_b32 a73, 0
    v_accvgpr_write_b32 a74, 0
    v_accvgpr_write_b32 a75, 0
    v_accvgpr_write_b32 a76, 0
    v_accvgpr_write_b32 a77, 0
    v_accvgpr_write_b32 a78, 0
    v_accvgpr_write_b32 a79, 0
    v_accvgpr_write_b32 a80, 0
    v_accvgpr_write_b32 a81, 0
    v_accvgpr_write_b32 a82, 0
    v_accvgpr_write_b32 a83, 0
    v_accvgpr_write_b32 a84, 0
    v_accvgpr_write_b32 a85, 0
    v_accvgpr_write_b32 a86, 0
    v_accvgpr_write_b32 a87, 0
    v_accvgpr_write_b32 a88, 0
    v_accvgpr_write_b32 a89, 0
    v_accvgpr_write_b32 a90, 0
    v_accvgpr_write_b32 a91, 0
    v_accvgpr_write_b32 a92, 0
    v_accvgpr_write_b32 a93, 0
    v_accvgpr_write_b32 a94, 0
    v_accvgpr_write_b32 a95, 0
    v_accvgpr_write_b32 a96, 0
    v_accvgpr_write_b32 a97, 0
    v_accvgpr_write_b32 a98, 0
    v_accvgpr_write_b32 a99, 0
    v_accvgpr_write_b32 a100, 0
    v_accvgpr_write_b32 a101, 0
    v_accvgpr_write_b32 a102, 0
    v_accvgpr_write_b32 a103, 0
    v_accvgpr_write_b32 a104, 0
    v_accvgpr_write_b32 a105, 0
    v_accvgpr_write_b32 a106, 0
    v_accvgpr_write_b32 a107, 0
    v_accvgpr_write_b32 a108, 0
    v_accvgpr_write_b32 a109, 0
    v_accvgpr_write_b32 a110, 0
    v_accvgpr_write_b32 a111, 0
    v_accvgpr_write_b32 a112, 0
    v_accvgpr_write_b32 a113, 0
    v_accvgpr_write_b32 a114, 0
    v_accvgpr_write_b32 a115, 0
    v_accvgpr_write_b32 a116, 0
    v_accvgpr_write_b32 a117, 0
    v_accvgpr_write_b32 a118, 0
    v_accvgpr_write_b32 a119, 0
    v_accvgpr_write_b32 a120, 0
    v_accvgpr_write_b32 a121, 0
    v_accvgpr_write_b32 a122, 0
    v_accvgpr_write_b32 a123, 0
    v_accvgpr_write_b32 a124, 0
    v_accvgpr_write_b32 a125, 0
    v_accvgpr_write_b32 a126, 0
    v_accvgpr_write_b32 a127, 0
    v_lshrrev_b32 v24, 2, v5
    v_and_b32 v25, 3, v5
    v_lshrrev_b32 v26, 1, v4
    v_and_b32 v27, 1, v4
    v_lshl_add_u32 v28, v26, 3, v24
    v_lshlrev_b32 v28, 8, v28
    v_and_b32 v29, 1, v25
    v_lshl_add_u32 v29, v27, 1, v29
    v_lshrrev_b32 v30, 1, v25
    v_lshlrev_b32 v30, 3, v30
    v_lshl_add_u32 v28, v29, 4, v28
    v_add_u32 v28, v28, v30
    v_xor_b32 v31, 0, v24
    v_lshl_add_u32 v192, v31, 6, v28
    v_add_u32 v196, 0x10000, v192
    v_xor_b32 v31, 1, v24
    v_lshl_add_u32 v193, v31, 6, v28
    v_add_u32 v197, 0x10000, v193
    v_xor_b32 v31, 2, v24
    v_lshl_add_u32 v194, v31, 6, v28
    v_add_u32 v198, 0x10000, v194
    v_xor_b32 v31, 3, v24
    v_lshl_add_u32 v195, v31, 6, v28
    v_add_u32 v199, 0x10000, v195
    s_cmp_lg_u32 s33, 0
    s_cbranch_scc1 wn_ok_mod_3
    s_mov_b32 s47, 400000
    v_mov_b32 v9, 0
wn_loop_mod_3:
    global_load_dword v8, v9, s[48:49] sc1
    s_waitcnt vmcnt(0)
    v_readfirstlane_b32 s33, v8
    s_cmp_lg_u32 s33, 0
    s_cbranch_scc1 wn_ok_mod_3
    s_sub_u32 s47, s47, 1
    s_cmp_lg_u32 s47, 0
    s_cbranch_scc1 wn_loop_mod_3
wn_ok_mod_3:
    s_lshl_b32 s20, s65, 2
    s_add_u32 s20, s20, s24
    s_lshl_b32 s21, s20, 10
    s_add_u32 s21, s21, 0x3600000
    s_add_u32 s44, s34, s21
    s_addc_u32 s45, s35, 0
    s_and_b32 s45, s45, 0xffff
    s_cmp_lt_u32 s20, 736
    s_cselect_b32 s46, 1024, 0
    s_mov_b32 s47, 0x00020000
    v_mbcnt_lo_u32_b32 v2, -1, 0
    v_mbcnt_hi_u32_b32 v2, -1, v2
    v_lshlrev_b32 v3, 4, v2
    s_waitcnt vmcnt(0)
    buffer_store_dwordx4 a[208:211], v3, s[44:47], 0 offen sc1
    s_mov_b32 s46, 0
    s_branch p0_join
p0_ln:
    s_sub_u32 s20, s65, 192
    v_mbcnt_lo_u32_b32 v2, -1, 0
    v_mbcnt_hi_u32_b32 v2, -1, v2
    v_and_b32 v3, 31, v2
    v_lshrrev_b32 v4, 5, v2
    s_lshl_b32 s21, s20, 15
    s_lshl_b32 s22, s24, 8
    s_add_u32 s21, s21, s22
    v_lshlrev_b32 v5, 10, v3
    v_lshl_add_u32 v5, v4, 4, v5
    s_and_b32 s13, s13, 0xffff
    s_mov_b32 s14, 2097152
    s_mov_b32 s15, 0x00020000
    buffer_load_dwordx4 v[8:11], v5, s[12:15], s21 offen offset:0
    buffer_load_dwordx4 v[12:15], v5, s[12:15], s21 offen offset:32
    buffer_load_dwordx4 v[16:19], v5, s[12:15], s21 offen offset:64
    buffer_load_dwordx4 v[20:23], v5, s[12:15], s21 offen offset:96
    buffer_load_dwordx4 v[24:27], v5, s[12:15], s21 offen offset:128
    buffer_load_dwordx4 v[28:31], v5, s[12:15], s21 offen offset:160
    buffer_load_dwordx4 v[32:35], v5, s[12:15], s21 offen offset:192
    buffer_load_dwordx4 v[36:39], v5, s[12:15], s21 offen offset:224
    s_getpc_b64 s[40:41]
code_here_l:
    s_sub_u32 s40, s40, code_here_l-adaLN_cond__mha_block_cached__swiglu_ffn__prompt_kernel
    s_subb_u32 s41, s41, 0
    s_lshr_b32 s42, s2, 3
    s_lshl_b32 s42, s42, 2
    s_add_u32 s42, s42, s24
    s_lshl_b32 s42, s42, 3
    v_and_b32 v126, 7, v0
    v_add_u32 v126, s42, v126
    s_mov_b32 s42, ((code_end-adaLN_cond__mha_block_cached__swiglu_ffn__prompt_kernel)>>7)
    v_cmp_gt_u32 vcc, s42, v126
    v_lshlrev_b32 v126, 7, v126
    s_and_saveexec_b64 s[42:43], vcc
    s_cbranch_execz ctouch_done_l
    global_load_dword v255, v126, s[40:41]
ctouch_done_l:
    s_mov_b64 exec, s[42:43]
    s_waitcnt vmcnt(7)
    v_lshlrev_b32 v48, 16, v8
    v_and_b32 v49, 0xffff0000, v8
    v_lshlrev_b32 v50, 16, v9
    v_and_b32 v51, 0xffff0000, v9
    v_lshlrev_b32 v52, 16, v10
    v_and_b32 v53, 0xffff0000, v10
    v_lshlrev_b32 v54, 16, v11
    v_and_b32 v55, 0xffff0000, v11
    s_waitcnt vmcnt(6)
    v_lshlrev_b32 v56, 16, v12
    v_and_b32 v57, 0xffff0000, v12
    v_lshlrev_b32 v58, 16, v13
    v_and_b32 v59, 0xffff0000, v13
    v_lshlrev_b32 v60, 16, v14
    v_and_b32 v61, 0xffff0000, v14
    v_lshlrev_b32 v62, 16, v15
    v_and_b32 v63, 0xffff0000, v15
    s_waitcnt vmcnt(5)
    v_lshlrev_b32 v64, 16, v16
    v_and_b32 v65, 0xffff0000, v16
    v_lshlrev_b32 v66, 16, v17
    v_and_b32 v67, 0xffff0000, v17
    v_lshlrev_b32 v68, 16, v18
    v_and_b32 v69, 0xffff0000, v18
    v_lshlrev_b32 v70, 16, v19
    v_and_b32 v71, 0xffff0000, v19
    s_waitcnt vmcnt(4)
    v_lshlrev_b32 v72, 16, v20
    v_and_b32 v73, 0xffff0000, v20
    v_lshlrev_b32 v74, 16, v21
    v_and_b32 v75, 0xffff0000, v21
    v_lshlrev_b32 v76, 16, v22
    v_and_b32 v77, 0xffff0000, v22
    v_lshlrev_b32 v78, 16, v23
    v_and_b32 v79, 0xffff0000, v23
    s_waitcnt vmcnt(3)
    v_lshlrev_b32 v80, 16, v24
    v_and_b32 v81, 0xffff0000, v24
    v_lshlrev_b32 v82, 16, v25
    v_and_b32 v83, 0xffff0000, v25
    v_lshlrev_b32 v84, 16, v26
    v_and_b32 v85, 0xffff0000, v26
    v_lshlrev_b32 v86, 16, v27
    v_and_b32 v87, 0xffff0000, v27
    s_waitcnt vmcnt(2)
    v_lshlrev_b32 v88, 16, v28
    v_and_b32 v89, 0xffff0000, v28
    v_lshlrev_b32 v90, 16, v29
    v_and_b32 v91, 0xffff0000, v29
    v_lshlrev_b32 v92, 16, v30
    v_and_b32 v93, 0xffff0000, v30
    v_lshlrev_b32 v94, 16, v31
    v_and_b32 v95, 0xffff0000, v31
    s_waitcnt vmcnt(1)
    v_lshlrev_b32 v96, 16, v32
    v_and_b32 v97, 0xffff0000, v32
    v_lshlrev_b32 v98, 16, v33
    v_and_b32 v99, 0xffff0000, v33
    v_lshlrev_b32 v100, 16, v34
    v_and_b32 v101, 0xffff0000, v34
    v_lshlrev_b32 v102, 16, v35
    v_and_b32 v103, 0xffff0000, v35
    s_waitcnt vmcnt(0)
    v_lshlrev_b32 v104, 16, v36
    v_and_b32 v105, 0xffff0000, v36
    v_lshlrev_b32 v106, 16, v37
    v_and_b32 v107, 0xffff0000, v37
    v_lshlrev_b32 v108, 16, v38
    v_and_b32 v109, 0xffff0000, v38
    v_lshlrev_b32 v110, 16, v39
    v_and_b32 v111, 0xffff0000, v39
    v_mov_b32 v125, 0
    global_load_dword v124, v125, s[48:49] sc1
    s_and_b32 s56, s2, 7
    s_lshr_b32 s57, s2, 3
    s_lshr_b32 s59, s57, 2
    s_and_b32 s57, s57, 3
    s_lshl_b32 s56, s56, 2
    s_add_u32 s56, s56, s57
    s_lshl_b32 s56, s56, 8
    v_mbcnt_lo_u32_b32 v250, -1, 0
    v_mbcnt_hi_u32_b32 v250, -1, v250
    v_lshrrev_b32 v251, 1, v250
    v_and_b32 v251, 15, v251
    s_lshl_b32 s59, s59, 6
    s_lshl_b32 s57, s24, 4
    s_add_u32 s59, s59, s57
    v_add_u32 v251, s59, v251
    v_lshlrev_b32 v251, 13, v251
    v_and_b32 v252, 1, v250
    v_lshl_add_u32 v251, v252, 7, v251
    s_add_u32 s52, s52, s56
    s_addc_u32 s53, s53, 0
    s_and_b32 s53, s53, 0xffff
    s_sub_u32 s54, 0x400000, s56
    s_mov_b32 s55, 0x00020000
    buffer_load_dword v255, v251, s[52:55], 0 offen
    v_add_f32 v44, v48, v52
    v_add_f32 v45, v49, v53
    v_add_f32 v46, v50, v54
    v_add_f32 v47, v51, v55
    v_add_f32 v44, v44, v56
    v_add_f32 v45, v45, v57
    v_add_f32 v46, v46, v58
    v_add_f32 v47, v47, v59
    v_add_f32 v44, v44, v60
    v_add_f32 v45, v45, v61
    v_add_f32 v46, v46, v62
    v_add_f32 v47, v47, v63
    v_add_f32 v44, v44, v64
    v_add_f32 v45, v45, v65
    v_add_f32 v46, v46, v66
    v_add_f32 v47, v47, v67
    v_add_f32 v44, v44, v68
    v_add_f32 v45, v45, v69
    v_add_f32 v46, v46, v70
    v_add_f32 v47, v47, v71
    v_add_f32 v44, v44, v72
    v_add_f32 v45, v45, v73
    v_add_f32 v46, v46, v74
    v_add_f32 v47, v47, v75
    v_add_f32 v44, v44, v76
    v_add_f32 v45, v45, v77
    v_add_f32 v46, v46, v78
    v_add_f32 v47, v47, v79
    v_add_f32 v44, v44, v80
    v_add_f32 v45, v45, v81
    v_add_f32 v46, v46, v82
    v_add_f32 v47, v47, v83
    v_add_f32 v44, v44, v84
    v_add_f32 v45, v45, v85
    v_add_f32 v46, v46, v86
    v_add_f32 v47, v47, v87
    v_add_f32 v44, v44, v88
    v_add_f32 v45, v45, v89
    v_add_f32 v46, v46, v90
    v_add_f32 v47, v47, v91
    v_add_f32 v44, v44, v92
    v_add_f32 v45, v45, v93
    v_add_f32 v46, v46, v94
    v_add_f32 v47, v47, v95
    v_add_f32 v44, v44, v96
    v_add_f32 v45, v45, v97
    v_add_f32 v46, v46, v98
    v_add_f32 v47, v47, v99
    v_add_f32 v44, v44, v100
    v_add_f32 v45, v45, v101
    v_add_f32 v46, v46, v102
    v_add_f32 v47, v47, v103
    v_add_f32 v44, v44, v104
    v_add_f32 v45, v45, v105
    v_add_f32 v46, v46, v106
    v_add_f32 v47, v47, v107
    v_add_f32 v44, v44, v108
    v_add_f32 v45, v45, v109
    v_add_f32 v46, v46, v110
    v_add_f32 v47, v47, v111
    v_add_f32 v44, v44, v45
    v_add_f32 v46, v46, v47
    v_add_f32 v44, v44, v46
    v_mov_b32 v6, v44
    s_nop 1
    v_permlane32_swap_b32 v6, v44
    s_nop 1
    v_add_f32 v44, v44, v6
    v_mul_f32 v44, 0x3c000000, v44
    v_sub_f32 v116, v48, v44
    v_mul_f32 v112, v116, v116
    v_sub_f32 v117, v49, v44
    v_mul_f32 v113, v117, v117
    v_sub_f32 v118, v50, v44
    v_mul_f32 v114, v118, v118
    v_sub_f32 v119, v51, v44
    v_mul_f32 v115, v119, v119
    v_sub_f32 v116, v52, v44
    v_fmac_f32 v112, v116, v116
    v_sub_f32 v117, v53, v44
    v_fmac_f32 v113, v117, v117
    v_sub_f32 v118, v54, v44
    v_fmac_f32 v114, v118, v118
    v_sub_f32 v119, v55, v44
    v_fmac_f32 v115, v119, v119
    v_sub_f32 v116, v56, v44
    v_fmac_f32 v112, v116, v116
    v_sub_f32 v117, v57, v44
    v_fmac_f32 v113, v117, v117
    v_sub_f32 v118, v58, v44
    v_fmac_f32 v114, v118, v118
    v_sub_f32 v119, v59, v44
    v_fmac_f32 v115, v119, v119
    v_sub_f32 v116, v60, v44
    v_fmac_f32 v112, v116, v116
    v_sub_f32 v117, v61, v44
    v_fmac_f32 v113, v117, v117
    v_sub_f32 v118, v62, v44
    v_fmac_f32 v114, v118, v118
    v_sub_f32 v119, v63, v44
    v_fmac_f32 v115, v119, v119
    v_sub_f32 v116, v64, v44
    v_fmac_f32 v112, v116, v116
    v_sub_f32 v117, v65, v44
    v_fmac_f32 v113, v117, v117
    v_sub_f32 v118, v66, v44
    v_fmac_f32 v114, v118, v118
    v_sub_f32 v119, v67, v44
    v_fmac_f32 v115, v119, v119
    v_sub_f32 v116, v68, v44
    v_fmac_f32 v112, v116, v116
    v_sub_f32 v117, v69, v44
    v_fmac_f32 v113, v117, v117
    v_sub_f32 v118, v70, v44
    v_fmac_f32 v114, v118, v118
    v_sub_f32 v119, v71, v44
    v_fmac_f32 v115, v119, v119
    v_sub_f32 v116, v72, v44
    v_fmac_f32 v112, v116, v116
    v_sub_f32 v117, v73, v44
    v_fmac_f32 v113, v117, v117
    v_sub_f32 v118, v74, v44
    v_fmac_f32 v114, v118, v118
    v_sub_f32 v119, v75, v44
    v_fmac_f32 v115, v119, v119
    v_sub_f32 v116, v76, v44
    v_fmac_f32 v112, v116, v116
    v_sub_f32 v117, v77, v44
    v_fmac_f32 v113, v117, v117
    v_sub_f32 v118, v78, v44
    v_fmac_f32 v114, v118, v118
    v_sub_f32 v119, v79, v44
    v_fmac_f32 v115, v119, v119
    v_sub_f32 v116, v80, v44
    v_fmac_f32 v112, v116, v116
    v_sub_f32 v117, v81, v44
    v_fmac_f32 v113, v117, v117
    v_sub_f32 v118, v82, v44
    v_fmac_f32 v114, v118, v118
    v_sub_f32 v119, v83, v44
    v_fmac_f32 v115, v119, v119
    v_sub_f32 v116, v84, v44
    v_fmac_f32 v112, v116, v116
    v_sub_f32 v117, v85, v44
    v_fmac_f32 v113, v117, v117
    v_sub_f32 v118, v86, v44
    v_fmac_f32 v114, v118, v118
    v_sub_f32 v119, v87, v44
    v_fmac_f32 v115, v119, v119
    v_sub_f32 v116, v88, v44
    v_fmac_f32 v112, v116, v116
    v_sub_f32 v117, v89, v44
    v_fmac_f32 v113, v117, v117
    v_sub_f32 v118, v90, v44
    v_fmac_f32 v114, v118, v118
    v_sub_f32 v119, v91, v44
    v_fmac_f32 v115, v119, v119
    v_sub_f32 v116, v92, v44
    v_fmac_f32 v112, v116, v116
    v_sub_f32 v117, v93, v44
    v_fmac_f32 v113, v117, v117
    v_sub_f32 v118, v94, v44
    v_fmac_f32 v114, v118, v118
    v_sub_f32 v119, v95, v44
    v_fmac_f32 v115, v119, v119
    v_sub_f32 v116, v96, v44
    v_fmac_f32 v112, v116, v116
    v_sub_f32 v117, v97, v44
    v_fmac_f32 v113, v117, v117
    v_sub_f32 v118, v98, v44
    v_fmac_f32 v114, v118, v118
    v_sub_f32 v119, v99, v44
    v_fmac_f32 v115, v119, v119
    v_sub_f32 v116, v100, v44
    v_fmac_f32 v112, v116, v116
    v_sub_f32 v117, v101, v44
    v_fmac_f32 v113, v117, v117
    v_sub_f32 v118, v102, v44
    v_fmac_f32 v114, v118, v118
    v_sub_f32 v119, v103, v44
    v_fmac_f32 v115, v119, v119
    v_sub_f32 v116, v104, v44
    v_fmac_f32 v112, v116, v116
    v_sub_f32 v117, v105, v44
    v_fmac_f32 v113, v117, v117
    v_sub_f32 v118, v106, v44
    v_fmac_f32 v114, v118, v118
    v_sub_f32 v119, v107, v44
    v_fmac_f32 v115, v119, v119
    v_sub_f32 v116, v108, v44
    v_fmac_f32 v112, v116, v116
    v_sub_f32 v117, v109, v44
    v_fmac_f32 v113, v117, v117
    v_sub_f32 v118, v110, v44
    v_fmac_f32 v114, v118, v118
    v_sub_f32 v119, v111, v44
    v_fmac_f32 v115, v119, v119
    v_add_f32 v112, v112, v113
    v_add_f32 v114, v114, v115
    v_add_f32 v45, v112, v114
    v_mov_b32 v6, v45
    s_nop 1
    v_permlane32_swap_b32 v6, v45
    s_nop 1
    v_add_f32 v45, v45, v6
    v_lshlrev_b32 v7, 3, v3
    v_add_u32 v7, 131072, v7
    s_lshl_b32 s22, s24, 8
    v_add_u32 v6, s22, v7
    ds_write_b64 v6, v[44:45]
    s_waitcnt lgkmcnt(0)
    s_barrier
    ds_read_b64 v[112:113], v7 offset:0
    ds_read_b64 v[114:115], v7 offset:256
    ds_read_b64 v[116:117], v7 offset:512
    ds_read_b64 v[118:119], v7 offset:768
    s_waitcnt lgkmcnt(2)
    v_add_f32 v44, v112, v114
    s_waitcnt lgkmcnt(0)
    v_add_f32 v45, v116, v118
    v_add_f32 v44, v44, v45
    v_mul_f32 v44, 0x3e800000, v44
    v_add_f32 v45, v113, v115
    v_add_f32 v46, v117, v119
    v_add_f32 v45, v45, v46
    v_mov_b32 v47, 0
    v_sub_f32 v46, v112, v44
    v_fmac_f32 v47, v46, v46
    v_sub_f32 v46, v114, v44
    v_fmac_f32 v47, v46, v46
    v_sub_f32 v46, v116, v44
    v_fmac_f32 v47, v46, v46
    v_sub_f32 v46, v118, v44
    v_fmac_f32 v47, v46, v46
    v_fmac_f32 v45, 0x43000000, v47
    v_mov_b32 v46, 0x3727c5ac
    v_fmac_f32 v46, 0x3b000000, v45
    v_rsq_f32 v46, v46
    s_nop 0
    v_sub_f32 v48, v48, v44
    v_sub_f32 v49, v49, v44
    v_sub_f32 v50, v50, v44
    v_sub_f32 v51, v51, v44
    v_sub_f32 v52, v52, v44
    v_sub_f32 v53, v53, v44
    v_sub_f32 v54, v54, v44
    v_sub_f32 v55, v55, v44
    v_sub_f32 v56, v56, v44
    v_sub_f32 v57, v57, v44
    v_sub_f32 v58, v58, v44
    v_sub_f32 v59, v59, v44
    v_sub_f32 v60, v60, v44
    v_sub_f32 v61, v61, v44
    v_sub_f32 v62, v62, v44
    v_sub_f32 v63, v63, v44
    v_sub_f32 v64, v64, v44
    v_sub_f32 v65, v65, v44
    v_sub_f32 v66, v66, v44
    v_sub_f32 v67, v67, v44
    v_sub_f32 v68, v68, v44
    v_sub_f32 v69, v69, v44
    v_sub_f32 v70, v70, v44
    v_sub_f32 v71, v71, v44
    v_sub_f32 v72, v72, v44
    v_sub_f32 v73, v73, v44
    v_sub_f32 v74, v74, v44
    v_sub_f32 v75, v75, v44
    v_sub_f32 v76, v76, v44
    v_sub_f32 v77, v77, v44
    v_sub_f32 v78, v78, v44
    v_sub_f32 v79, v79, v44
    v_sub_f32 v80, v80, v44
    v_sub_f32 v81, v81, v44
    v_sub_f32 v82, v82, v44
    v_sub_f32 v83, v83, v44
    v_sub_f32 v84, v84, v44
    v_sub_f32 v85, v85, v44
    v_sub_f32 v86, v86, v44
    v_sub_f32 v87, v87, v44
    v_sub_f32 v88, v88, v44
    v_sub_f32 v89, v89, v44
    v_sub_f32 v90, v90, v44
    v_sub_f32 v91, v91, v44
    v_sub_f32 v92, v92, v44
    v_sub_f32 v93, v93, v44
    v_sub_f32 v94, v94, v44
    v_sub_f32 v95, v95, v44
    v_sub_f32 v96, v96, v44
    v_sub_f32 v97, v97, v44
    v_sub_f32 v98, v98, v44
    v_sub_f32 v99, v99, v44
    v_sub_f32 v100, v100, v44
    v_sub_f32 v101, v101, v44
    v_sub_f32 v102, v102, v44
    v_sub_f32 v103, v103, v44
    v_sub_f32 v104, v104, v44
    v_sub_f32 v105, v105, v44
    v_sub_f32 v106, v106, v44
    v_sub_f32 v107, v107, v44
    v_sub_f32 v108, v108, v44
    v_sub_f32 v109, v109, v44
    v_sub_f32 v110, v110, v44
    v_sub_f32 v111, v111, v44
    v_mul_f32 v48, v48, v46
    v_mul_f32 v49, v49, v46
    v_mul_f32 v50, v50, v46
    v_mul_f32 v51, v51, v46
    v_mul_f32 v52, v52, v46
    v_mul_f32 v53, v53, v46
    v_mul_f32 v54, v54, v46
    v_mul_f32 v55, v55, v46
    v_mul_f32 v56, v56, v46
    v_mul_f32 v57, v57, v46
    v_mul_f32 v58, v58, v46
    v_mul_f32 v59, v59, v46
    v_mul_f32 v60, v60, v46
    v_mul_f32 v61, v61, v46
    v_mul_f32 v62, v62, v46
    v_mul_f32 v63, v63, v46
    v_mul_f32 v64, v64, v46
    v_mul_f32 v65, v65, v46
    v_mul_f32 v66, v66, v46
    v_mul_f32 v67, v67, v46
    v_mul_f32 v68, v68, v46
    v_mul_f32 v69, v69, v46
    v_mul_f32 v70, v70, v46
    v_mul_f32 v71, v71, v46
    v_mul_f32 v72, v72, v46
    v_mul_f32 v73, v73, v46
    v_mul_f32 v74, v74, v46
    v_mul_f32 v75, v75, v46
    v_mul_f32 v76, v76, v46
    v_mul_f32 v77, v77, v46
    v_mul_f32 v78, v78, v46
    v_mul_f32 v79, v79, v46
    v_mul_f32 v80, v80, v46
    v_mul_f32 v81, v81, v46
    v_mul_f32 v82, v82, v46
    v_mul_f32 v83, v83, v46
    v_mul_f32 v84, v84, v46
    v_mul_f32 v85, v85, v46
    v_mul_f32 v86, v86, v46
    v_mul_f32 v87, v87, v46
    v_mul_f32 v88, v88, v46
    v_mul_f32 v89, v89, v46
    v_mul_f32 v90, v90, v46
    v_mul_f32 v91, v91, v46
    v_mul_f32 v92, v92, v46
    v_mul_f32 v93, v93, v46
    v_mul_f32 v94, v94, v46
    v_mul_f32 v95, v95, v46
    v_mul_f32 v96, v96, v46
    v_mul_f32 v97, v97, v46
    v_mul_f32 v98, v98, v46
    v_mul_f32 v99, v99, v46
    v_mul_f32 v100, v100, v46
    v_mul_f32 v101, v101, v46
    v_mul_f32 v102, v102, v46
    v_mul_f32 v103, v103, v46
    v_mul_f32 v104, v104, v46
    v_mul_f32 v105, v105, v46
    v_mul_f32 v106, v106, v46
    v_mul_f32 v107, v107, v46
    v_mul_f32 v108, v108, v46
    v_mul_f32 v109, v109, v46
    v_mul_f32 v110, v110, v46
    v_mul_f32 v111, v111, v46
    s_waitcnt vmcnt(1)
    v_readfirstlane_b32 s33, v124
    s_lshl_b32 s22, s24, 10
    v_lshlrev_b32 v120, 4, v2
    v_add_u32 v120, s22, v120
    v_add_u32 v120, 655360, v120
    v_add_u32 v121, 0x1000, v120
    v_add_u32 v122, 0, v120
    global_load_dwordx4 v[8:11], v122, s[34:35] sc1
    v_add_u32 v122, 0, v121
    global_load_dwordx4 v[32:35], v122, s[34:35] sc1
    v_add_u32 v122, 8192, v120
    global_load_dwordx4 v[12:15], v122, s[34:35] sc1
    v_add_u32 v122, 8192, v121
    global_load_dwordx4 v[36:39], v122, s[34:35] sc1
    v_add_u32 v122, 16384, v120
    global_load_dwordx4 v[16:19], v122, s[34:35] sc1
    v_add_u32 v122, 16384, v121
    global_load_dwordx4 v[40:43], v122, s[34:35] sc1
    v_add_u32 v122, 24576, v120
    global_load_dwordx4 v[20:23], v122, s[34:35] sc1
    v_add_u32 v122, 24576, v121
    global_load_dwordx4 v[44:47], v122, s[34:35] sc1
    s_load_dwordx2 s[4:5], s[0:1], 8
    s_load_dwordx2 s[8:9], s[0:1], 16
    s_and_b32 s36, s2, 7
    s_lshr_b32 s37, s2, 3
    s_and_b32 s38, s37, 3
    s_lshl_b32 s29, s36, 2
    s_add_u32 s29, s29, s38
    s_lshr_b32 s32, s37, 2
    s_lshl_b32 s25, s24, 11
    v_mbcnt_lo_u32_b32 v2, -1, 0
    v_mbcnt_hi_u32_b32 v2, -1, v2
    s_waitcnt lgkmcnt(0)
    s_lshl_b32 s36, s29, 19
    s_add_u32 s4, s4, s36
    s_addc_u32 s5, s5, 0
    s_add_u32 s8, s8, s36
    s_addc_u32 s9, s9, 0
    s_and_b32 s5, s5, 0xffff
    s_mov_b32 s6, 0x80000
    s_mov_b32 s7, 0x00020000
    s_and_b32 s9, s9, 0xffff
    s_mov_b32 s10, 0x80000
    s_mov_b32 s11, 0x00020000
    s_lshl_b32 s36, s32, 3
    s_lshl_b32 s37, s24, 1
    s_add_u32 s36, s36, s37
    s_mov_b32 s39, s36
    s_lshl_b32 s36, s36, 15
    s_add_u32 s36, s36, 0x100000
    s_add_u32 s16, s34, s36
    s_addc_u32 s17, s35, 0
    s_and_b32 s17, s17, 0xffff
    s_mov_b32 s18, 0x10000
    s_mov_b32 s19, 0x00020000
    v_lshlrev_b32 v201, 4, v2
    v_add_u32 v202, 0x8000, v201
    v_lshrrev_b32 v4, 4, v2
    v_and_b32 v5, 15, v2
    v_lshlrev_b32 v6, 2, v4
    v_xor_b32 v6, v5, v6
    v_lshlrev_b32 v6, 4, v6
    s_lshl_b32 s36, s24, 3
    v_add_u32 v7, s36, v4
    v_lshl_add_u32 v206, v7, 8, v6
    v_xor_b32 v6, 32, v6
    v_lshl_add_u32 v207, v7, 8, v6
    v_add_u32 v24, 0, v7
    v_and_b32 v24, 15, v24
    v_xor_b32 v24, v5, v24
    v_lshlrev_b32 v24, 4, v24
    v_lshl_add_u32 v204, v7, 8, v24
    v_add_u32 v24, 4, v7
    v_and_b32 v24, 15, v24
    v_xor_b32 v24, v5, v24
    v_lshlrev_b32 v24, 4, v24
    v_lshl_add_u32 v205, v7, 8, v24
    v_accvgpr_write_b32 a0, 0
    v_accvgpr_write_b32 a1, 0
    v_accvgpr_write_b32 a2, 0
    v_accvgpr_write_b32 a3, 0
    v_accvgpr_write_b32 a4, 0
    v_accvgpr_write_b32 a5, 0
    v_accvgpr_write_b32 a6, 0
    v_accvgpr_write_b32 a7, 0
    v_accvgpr_write_b32 a8, 0
    v_accvgpr_write_b32 a9, 0
    v_accvgpr_write_b32 a10, 0
    v_accvgpr_write_b32 a11, 0
    v_accvgpr_write_b32 a12, 0
    v_accvgpr_write_b32 a13, 0
    v_accvgpr_write_b32 a14, 0
    v_accvgpr_write_b32 a15, 0
    v_accvgpr_write_b32 a16, 0
    v_accvgpr_write_b32 a17, 0
    v_accvgpr_write_b32 a18, 0
    v_accvgpr_write_b32 a19, 0
    v_accvgpr_write_b32 a20, 0
    v_accvgpr_write_b32 a21, 0
    v_accvgpr_write_b32 a22, 0
    v_accvgpr_write_b32 a23, 0
    v_accvgpr_write_b32 a24, 0
    v_accvgpr_write_b32 a25, 0
    v_accvgpr_write_b32 a26, 0
    v_accvgpr_write_b32 a27, 0
    v_accvgpr_write_b32 a28, 0
    v_accvgpr_write_b32 a29, 0
    v_accvgpr_write_b32 a30, 0
    v_accvgpr_write_b32 a31, 0
    v_accvgpr_write_b32 a32, 0
    v_accvgpr_write_b32 a33, 0
    v_accvgpr_write_b32 a34, 0
    v_accvgpr_write_b32 a35, 0
    v_accvgpr_write_b32 a36, 0
    v_accvgpr_write_b32 a37, 0
    v_accvgpr_write_b32 a38, 0
    v_accvgpr_write_b32 a39, 0
    v_accvgpr_write_b32 a40, 0
    v_accvgpr_write_b32 a41, 0
    v_accvgpr_write_b32 a42, 0
    v_accvgpr_write_b32 a43, 0
    v_accvgpr_write_b32 a44, 0
    v_accvgpr_write_b32 a45, 0
    v_accvgpr_write_b32 a46, 0
    v_accvgpr_write_b32 a47, 0
    v_accvgpr_write_b32 a48, 0
    v_accvgpr_write_b32 a49, 0
    v_accvgpr_write_b32 a50, 0
    v_accvgpr_write_b32 a51, 0
    v_accvgpr_write_b32 a52, 0
    v_accvgpr_write_b32 a53, 0
    v_accvgpr_write_b32 a54, 0
    v_accvgpr_write_b32 a55, 0
    v_accvgpr_write_b32 a56, 0
    v_accvgpr_write_b32 a57, 0
    v_accvgpr_write_b32 a58, 0
    v_accvgpr_write_b32 a59, 0
    v_accvgpr_write_b32 a60, 0
    v_accvgpr_write_b32 a61, 0
    v_accvgpr_write_b32 a62, 0
    v_accvgpr_write_b32 a63, 0
    v_accvgpr_write_b32 a64, 0
    v_accvgpr_write_b32 a65, 0
    v_accvgpr_write_b32 a66, 0
    v_accvgpr_write_b32 a67, 0
    v_accvgpr_write_b32 a68, 0
    v_accvgpr_write_b32 a69, 0
    v_accvgpr_write_b32 a70, 0
    v_accvgpr_write_b32 a71, 0
    v_accvgpr_write_b32 a72, 0
    v_accvgpr_write_b32 a73, 0
    v_accvgpr_write_b32 a74, 0
    v_accvgpr_write_b32 a75, 0
    v_accvgpr_write_b32 a76, 0
    v_accvgpr_write_b32 a77, 0
    v_accvgpr_write_b32 a78, 0
    v_accvgpr_write_b32 a79, 0
    v_accvgpr_write_b32 a80, 0
    v_accvgpr_write_b32 a81, 0
    v_accvgpr_write_b32 a82, 0
    v_accvgpr_write_b32 a83, 0
    v_accvgpr_write_b32 a84, 0
    v_accvgpr_write_b32 a85, 0
    v_accvgpr_write_b32 a86, 0
    v_accvgpr_write_b32 a87, 0
    v_accvgpr_write_b32 a88, 0
    v_accvgpr_write_b32 a89, 0
    v_accvgpr_write_b32 a90, 0
    v_accvgpr_write_b32 a91, 0
    v_accvgpr_write_b32 a92, 0
    v_accvgpr_write_b32 a93, 0
    v_accvgpr_write_b32 a94, 0
    v_accvgpr_write_b32 a95, 0
    v_accvgpr_write_b32 a96, 0
    v_accvgpr_write_b32 a97, 0
    v_accvgpr_write_b32 a98, 0
    v_accvgpr_write_b32 a99, 0
    v_accvgpr_write_b32 a100, 0
    v_accvgpr_write_b32 a101, 0
    v_accvgpr_write_b32 a102, 0
    v_accvgpr_write_b32 a103, 0
    v_accvgpr_write_b32 a104, 0
    v_accvgpr_write_b32 a105, 0
    v_accvgpr_write_b32 a106, 0
    v_accvgpr_write_b32 a107, 0
    v_accvgpr_write_b32 a108, 0
    v_accvgpr_write_b32 a109, 0
    v_accvgpr_write_b32 a110, 0
    v_accvgpr_write_b32 a111, 0
    v_accvgpr_write_b32 a112, 0
    v_accvgpr_write_b32 a113, 0
    v_accvgpr_write_b32 a114, 0
    v_accvgpr_write_b32 a115, 0
    v_accvgpr_write_b32 a116, 0
    v_accvgpr_write_b32 a117, 0
    v_accvgpr_write_b32 a118, 0
    v_accvgpr_write_b32 a119, 0
    v_accvgpr_write_b32 a120, 0
    v_accvgpr_write_b32 a121, 0
    v_accvgpr_write_b32 a122, 0
    v_accvgpr_write_b32 a123, 0
    v_accvgpr_write_b32 a124, 0
    v_accvgpr_write_b32 a125, 0
    v_accvgpr_write_b32 a126, 0
    v_accvgpr_write_b32 a127, 0
    v_lshrrev_b32 v24, 2, v5
    v_and_b32 v25, 3, v5
    v_lshrrev_b32 v26, 1, v4
    v_and_b32 v27, 1, v4
    v_lshl_add_u32 v28, v26, 3, v24
    v_lshlrev_b32 v28, 8, v28
    v_and_b32 v29, 1, v25
    v_lshl_add_u32 v29, v27, 1, v29
    v_lshrrev_b32 v30, 1, v25
    v_lshlrev_b32 v30, 3, v30
    v_lshl_add_u32 v28, v29, 4, v28
    v_add_u32 v28, v28, v30
    v_xor_b32 v31, 0, v24
    v_lshl_add_u32 v192, v31, 6, v28
    v_add_u32 v196, 0x10000, v192
    v_xor_b32 v31, 1, v24
    v_lshl_add_u32 v193, v31, 6, v28
    v_add_u32 v197, 0x10000, v193
    v_xor_b32 v31, 2, v24
    v_lshl_add_u32 v194, v31, 6, v28
    v_add_u32 v198, 0x10000, v194
    v_xor_b32 v31, 3, v24
    v_lshl_add_u32 v195, v31, 6, v28
    v_add_u32 v199, 0x10000, v195
    v_lshrrev_b32 v4, 5, v2
    s_cmp_lg_u32 s33, 0
    s_cbranch_scc1 ln_have_nonce
    s_mov_b32 s47, 400000
    v_mov_b32 v125, 0
ln_nloop:
    global_load_dword v124, v125, s[48:49] sc1
    s_waitcnt vmcnt(0)
    v_readfirstlane_b32 s33, v124
    s_cmp_lg_u32 s33, 0
    s_cbranch_scc1 ln_have_nonce
    s_sub_u32 s47, s47, 1
    s_cmp_lg_u32 s47, 0
    s_cbranch_scc1 ln_nloop
ln_have_nonce:
    s_mov_b32 s47, 400000
    s_branch modt_chk
modt_loop:
    v_add_u32 v122, 0, v120
    global_load_dwordx4 v[8:11], v122, s[34:35] sc1
    v_add_u32 v122, 0, v121
    global_load_dwordx4 v[32:35], v122, s[34:35] sc1
    v_add_u32 v122, 8192, v120
    global_load_dwordx4 v[12:15], v122, s[34:35] sc1
    v_add_u32 v122, 8192, v121
    global_load_dwordx4 v[36:39], v122, s[34:35] sc1
    v_add_u32 v122, 16384, v120
    global_load_dwordx4 v[16:19], v122, s[34:35] sc1
    v_add_u32 v122, 16384, v121
    global_load_dwordx4 v[40:43], v122, s[34:35] sc1
    v_add_u32 v122, 24576, v120
    global_load_dwordx4 v[20:23], v122, s[34:35] sc1
    v_add_u32 v122, 24576, v121
    global_load_dwordx4 v[44:47], v122, s[34:35] sc1
modt_chk:
    s_waitcnt vmcnt(0)
    v_cmp_ne_u32 vcc, s33, v9
    v_cmp_ne_u32 s[42:43], s33, v11
    s_or_b64 vcc, vcc, s[42:43]
    v_cmp_ne_u32 s[42:43], s33, v13
    s_or_b64 vcc, vcc, s[42:43]
    v_cmp_ne_u32 s[42:43], s33, v15
    s_or_b64 vcc, vcc, s[42:43]
    v_cmp_ne_u32 s[42:43], s33, v17
    s_or_b64 vcc, vcc, s[42:43]
    v_cmp_ne_u32 s[42:43], s33, v19
    s_or_b64 vcc, vcc, s[42:43]
    v_cmp_ne_u32 s[42:43], s33, v21
    s_or_b64 vcc, vcc, s[42:43]
    v_cmp_ne_u32 s[42:43], s33, v23
    s_or_b64 vcc, vcc, s[42:43]
    v_cmp_ne_u32 s[42:43], s33, v33
    s_or_b64 vcc, vcc, s[42:43]
    v_cmp_ne_u32 s[42:43], s33, v35
    s_or_b64 vcc, vcc, s[42:43]
    v_cmp_ne_u32 s[42:43], s33, v37
    s_or_b64 vcc, vcc, s[42:43]
    v_cmp_ne_u32 s[42:43], s33, v39
    s_or_b64 vcc, vcc, s[42:43]
    v_cmp_ne_u32 s[42:43], s33, v41
    s_or_b64 vcc, vcc, s[42:43]
    v_cmp_ne_u32 s[42:43], s33, v43
    s_or_b64 vcc, vcc, s[42:43]
    v_cmp_ne_u32 s[42:43], s33, v45
    s_or_b64 vcc, vcc, s[42:43]
    v_cmp_ne_u32 s[42:43], s33, v47
    s_or_b64 vcc, vcc, s[42:43]
    s_cmp_eq_u64 vcc, 0
    s_cbranch_scc1 modt_done
    s_sub_u32 s47, s47, 1
    s_cmp_lg_u32 s47, 0
    s_cbranch_scc1 modt_loop
modt_done:
    v_add_f32 v24, v8, v12
    v_add_f32 v25, v16, v20
    v_add_f32 v26, v24, v25
    v_add_f32 v24, v10, v14
    v_add_f32 v25, v18, v22
    v_add_f32 v27, v24, v25
    v_add_f32 v24, v32, v36
    v_add_f32 v25, v40, v44
    v_add_f32 v28, v24, v25
    v_add_f32 v24, v34, v38
    v_add_f32 v25, v42, v46
    v_add_f32 v29, v24, v25
    v_mov_b32 v8, v26
    v_mov_b32 v9, v27
    v_mov_b32 v16, v28
    v_mov_b32 v17, v29
    s_lshl_b32 s22, s24, 9
    v_lshlrev_b32 v3, 3, v2
    v_add_u32 v3, s22, v3
    v_cvt_pk_bf16_f32 v10, v8, v9
    v_cvt_pk_bf16_f32 v18, v16, v17
    v_lshlrev_b32 v8, 16, v10
    v_and_b32 v9, 0xffff0000, v10
    v_lshlrev_b32 v16, 16, v18
    v_and_b32 v17, 0xffff0000, v18
    v_add_f32 v16, 1.0, v16
    v_add_f32 v17, 1.0, v17
    v_cvt_pk_bf16_f32 v18, v16, v17
    v_lshlrev_b32 v16, 16, v18
    v_and_b32 v17, 0xffff0000, v18
    s_mov_b32 s22, 0x3e0293ee
    v_mul_f32 v8, s22, v8
    v_mul_f32 v9, s22, v9
    v_mul_f32 v16, s22, v16
    v_mul_f32 v17, s22, v17
    v_add_u32 v3, 135168, v3
    ds_write_b64 v3, v[16:17]
    ds_write_b64 v3, v[8:9] offset:2048
    s_waitcnt lgkmcnt(0)
    s_barrier
    s_lshl_b32 s22, s24, 9
    v_lshlrev_b32 v6, 5, v4
    v_add_u32 v6, s22, v6
    v_add_u32 v6, 135168, v6
    s_lshl_b32 s21, s20, 15
    s_lshl_b32 s22, s24, 13
    s_add_u32 s21, s21, s22
    s_add_u32 s21, s21, 1048576
    v_lshlrev_b32 v5, 4, v2
    v_add_u32 v5, s21, v5
    ds_read_b128 v[8:11], v6 offset:0
    ds_read_b128 v[16:19], v6 offset:2048
    ds_read_b128 v[12:15], v6 offset:16
    ds_read_b128 v[20:23], v6 offset:2064
    s_waitcnt lgkmcnt(2)
    v_fma_f32 v48, v48, v8, v16
    v_fma_f32 v49, v49, v9, v17
    v_fma_f32 v50, v50, v10, v18
    v_fma_f32 v51, v51, v11, v19
    s_waitcnt lgkmcnt(0)
    v_fma_f32 v52, v52, v12, v20
    v_fma_f32 v53, v53, v13, v21
    v_fma_f32 v54, v54, v14, v22
    v_fma_f32 v55, v55, v15, v23
    v_cvt_pk_bf16_f32 v112, v48, v49
    v_cvt_pk_bf16_f32 v113, v50, v51
    v_cvt_pk_bf16_f32 v114, v52, v53
    v_cvt_pk_bf16_f32 v115, v54, v55
    global_store_dwordx4 v5, v[112:115], s[34:35] offset:0 sc1
    ds_read_b128 v[24:27], v6 offset:64
    ds_read_b128 v[32:35], v6 offset:2112
    ds_read_b128 v[28:31], v6 offset:80
    ds_read_b128 v[36:39], v6 offset:2128
    s_waitcnt lgkmcnt(2)
    v_fma_f32 v56, v56, v24, v32
    v_fma_f32 v57, v57, v25, v33
    v_fma_f32 v58, v58, v26, v34
    v_fma_f32 v59, v59, v27, v35
    s_waitcnt lgkmcnt(0)
    v_fma_f32 v60, v60, v28, v36
    v_fma_f32 v61, v61, v29, v37
    v_fma_f32 v62, v62, v30, v38
    v_fma_f32 v63, v63, v31, v39
    v_cvt_pk_bf16_f32 v116, v56, v57
    v_cvt_pk_bf16_f32 v117, v58, v59
    v_cvt_pk_bf16_f32 v118, v60, v61
    v_cvt_pk_bf16_f32 v119, v62, v63
    global_store_dwordx4 v5, v[116:119], s[34:35] offset:1024 sc1
    ds_read_b128 v[8:11], v6 offset:128
    ds_read_b128 v[16:19], v6 offset:2176
    ds_read_b128 v[12:15], v6 offset:144
    ds_read_b128 v[20:23], v6 offset:2192
    s_waitcnt lgkmcnt(2)
    v_fma_f32 v64, v64, v8, v16
    v_fma_f32 v65, v65, v9, v17
    v_fma_f32 v66, v66, v10, v18
    v_fma_f32 v67, v67, v11, v19
    s_waitcnt lgkmcnt(0)
    v_fma_f32 v68, v68, v12, v20
    v_fma_f32 v69, v69, v13, v21
    v_fma_f32 v70, v70, v14, v22
    v_fma_f32 v71, v71, v15, v23
    v_cvt_pk_bf16_f32 v112, v64, v65
    v_cvt_pk_bf16_f32 v113, v66, v67
    v_cvt_pk_bf16_f32 v114, v68, v69
    v_cvt_pk_bf16_f32 v115, v70, v71
    global_store_dwordx4 v5, v[112:115], s[34:35] offset:2048 sc1
    ds_read_b128 v[24:27], v6 offset:192
    ds_read_b128 v[32:35], v6 offset:2240
    ds_read_b128 v[28:31], v6 offset:208
    ds_read_b128 v[36:39], v6 offset:2256
    s_waitcnt lgkmcnt(2)
    v_fma_f32 v72, v72, v24, v32
    v_fma_f32 v73, v73, v25, v33
    v_fma_f32 v74, v74, v26, v34
    v_fma_f32 v75, v75, v27, v35
    s_waitcnt lgkmcnt(0)
    v_fma_f32 v76, v76, v28, v36
    v_fma_f32 v77, v77, v29, v37
    v_fma_f32 v78, v78, v30, v38
    v_fma_f32 v79, v79, v31, v39
    v_cvt_pk_bf16_f32 v116, v72, v73
    v_cvt_pk_bf16_f32 v117, v74, v75
    v_cvt_pk_bf16_f32 v118, v76, v77
    v_cvt_pk_bf16_f32 v119, v78, v79
    global_store_dwordx4 v5, v[116:119], s[34:35] offset:3072 sc1
    ds_read_b128 v[8:11], v6 offset:256
    ds_read_b128 v[16:19], v6 offset:2304
    ds_read_b128 v[12:15], v6 offset:272
    ds_read_b128 v[20:23], v6 offset:2320
    s_waitcnt lgkmcnt(2)
    v_fma_f32 v80, v80, v8, v16
    v_fma_f32 v81, v81, v9, v17
    v_fma_f32 v82, v82, v10, v18
    v_fma_f32 v83, v83, v11, v19
    s_waitcnt lgkmcnt(0)
    v_fma_f32 v84, v84, v12, v20
    v_fma_f32 v85, v85, v13, v21
    v_fma_f32 v86, v86, v14, v22
    v_fma_f32 v87, v87, v15, v23
    v_cvt_pk_bf16_f32 v112, v80, v81
    v_cvt_pk_bf16_f32 v113, v82, v83
    v_cvt_pk_bf16_f32 v114, v84, v85
    v_cvt_pk_bf16_f32 v115, v86, v87
    v_add_u32 v5, 0x1000, v5
    global_store_dwordx4 v5, v[112:115], s[34:35] offset:0 sc1
    ds_read_b128 v[24:27], v6 offset:320
    ds_read_b128 v[32:35], v6 offset:2368
    ds_read_b128 v[28:31], v6 offset:336
    ds_read_b128 v[36:39], v6 offset:2384
    s_waitcnt lgkmcnt(2)
    v_fma_f32 v88, v88, v24, v32
    v_fma_f32 v89, v89, v25, v33
    v_fma_f32 v90, v90, v26, v34
    v_fma_f32 v91, v91, v27, v35
    s_waitcnt lgkmcnt(0)
    v_fma_f32 v92, v92, v28, v36
    v_fma_f32 v93, v93, v29, v37
    v_fma_f32 v94, v94, v30, v38
    v_fma_f32 v95, v95, v31, v39
    v_cvt_pk_bf16_f32 v116, v88, v89
    v_cvt_pk_bf16_f32 v117, v90, v91
    v_cvt_pk_bf16_f32 v118, v92, v93
    v_cvt_pk_bf16_f32 v119, v94, v95
    global_store_dwordx4 v5, v[116:119], s[34:35] offset:1024 sc1
    ds_read_b128 v[8:11], v6 offset:384
    ds_read_b128 v[16:19], v6 offset:2432
    ds_read_b128 v[12:15], v6 offset:400
    ds_read_b128 v[20:23], v6 offset:2448
    s_waitcnt lgkmcnt(2)
    v_fma_f32 v96, v96, v8, v16
    v_fma_f32 v97, v97, v9, v17
    v_fma_f32 v98, v98, v10, v18
    v_fma_f32 v99, v99, v11, v19
    s_waitcnt lgkmcnt(0)
    v_fma_f32 v100, v100, v12, v20
    v_fma_f32 v101, v101, v13, v21
    v_fma_f32 v102, v102, v14, v22
    v_fma_f32 v103, v103, v15, v23
    v_cvt_pk_bf16_f32 v112, v96, v97
    v_cvt_pk_bf16_f32 v113, v98, v99
    v_cvt_pk_bf16_f32 v114, v100, v101
    v_cvt_pk_bf16_f32 v115, v102, v103
    global_store_dwordx4 v5, v[112:115], s[34:35] offset:2048 sc1
    ds_read_b128 v[24:27], v6 offset:448
    ds_read_b128 v[32:35], v6 offset:2496
    ds_read_b128 v[28:31], v6 offset:464
    ds_read_b128 v[36:39], v6 offset:2512
    s_waitcnt lgkmcnt(2)
    v_fma_f32 v104, v104, v24, v32
    v_fma_f32 v105, v105, v25, v33
    v_fma_f32 v106, v106, v26, v34
    v_fma_f32 v107, v107, v27, v35
    s_waitcnt lgkmcnt(0)
    v_fma_f32 v108, v108, v28, v36
    v_fma_f32 v109, v109, v29, v37
    v_fma_f32 v110, v110, v30, v38
    v_fma_f32 v111, v111, v31, v39
    v_cvt_pk_bf16_f32 v116, v104, v105
    v_cvt_pk_bf16_f32 v117, v106, v107
    v_cvt_pk_bf16_f32 v118, v108, v109
    v_cvt_pk_bf16_f32 v119, v110, v111
    global_store_dwordx4 v5, v[116:119], s[34:35] offset:3072 sc1
    s_lshr_b32 s22, s20, 3
    s_lshl_b32 s22, s22, 7
    s_and_b32 s23, s20, 7
    s_lshl_b32 s23, s23, 2
    s_add_u32 s22, s22, s23
    s_add_u32 s22, s22, 0x3003000
    s_waitcnt vmcnt(0)
    s_barrier
    s_cmp_lg_u32 s24, 0
    s_cbranch_scc1 fskip_xn_4
    v_mov_b32 v44, s33
    v_mov_b32 v45, s22
    s_mov_b64 exec, 1
    global_store_dword v45, v44, s[34:35] sc1
    s_mov_b64 exec, -1
fskip_xn_4:
    v_mbcnt_lo_u32_b32 v40, -1, 0
    v_mbcnt_hi_u32_b32 v40, -1, v40
    v_and_b32 v40, 1, v40
    v_lshlrev_b32 v40, 2, v40
    s_lshl_b32 s36, s32, 7
    s_lshl_b32 s37, s24, 3
    s_add_u32 s36, s36, s37
    s_add_u32 s36, s36, 0x3003000
    v_add_u32 v40, s36, v40
    s_mov_b32 s47, 400000
wp_loop_lnx_5:
    global_load_dword v8, v40, s[34:35] sc1
    s_waitcnt vmcnt(0)
    v_cmp_ne_u32 vcc, s33, v8
    s_cmp_eq_u64 vcc, 0
    s_cbranch_scc1 wp_ok_lnx_5
    s_sub_u32 s47, s47, 1
    s_cmp_lg_u32 s47, 0
    s_cbranch_scc1 wp_loop_lnx_5
wp_ok_lnx_5:
    s_mov_b32 s46, 1
    v_mbcnt_lo_u32_b32 v250, -1, 0
    v_mbcnt_hi_u32_b32 v250, -1, v250
    v_lshrrev_b32 v251, 4, v250
    v_and_b32 v252, 15, v250
    v_lshlrev_b32 v253, 2, v251
    v_xor_b32 v253, v252, v253
    v_lshlrev_b32 v253, 4, v253
    s_lshl_b32 s57, s24, 3
    v_add_u32 v254, s57, v251
    v_lshl_add_u32 v203, v254, 13, v253
    v_add_u32 v200, 31744, v203
    s_lshl_b32 s58, s24, 11
    s_add_u32 m0, s58, 0x0
    s_mov_b32 s59, 0x0
    buffer_load_dwordx4 v203, s[52:55], s59 offen lds
    buffer_load_dwordx4 v200, s[52:55], s59 offen offset:1024 lds
    s_add_u32 m0, s58, 0x2000
    s_mov_b32 s59, 0x40000
    buffer_load_dwordx4 v203, s[52:55], s59 offen lds
    buffer_load_dwordx4 v200, s[52:55], s59 offen offset:1024 lds
    s_add_u32 m0, s58, 0x4000
    s_mov_b32 s59, 0x80000
    buffer_load_dwordx4 v203, s[52:55], s59 offen lds
    buffer_load_dwordx4 v200, s[52:55], s59 offen offset:1024 lds
    s_add_u32 m0, s58, 0x6000
    s_mov_b32 s59, 0xc0000
    buffer_load_dwordx4 v203, s[52:55], s59 offen lds
    buffer_load_dwordx4 v200, s[52:55], s59 offen offset:1024 lds
    s_add_u32 m0, s58, 0x10000
    s_mov_b32 s59, 0x100000
    buffer_load_dwordx4 v203, s[52:55], s59 offen lds
    buffer_load_dwordx4 v200, s[52:55], s59 offen offset:1024 lds
    s_add_u32 m0, s58, 0x12000
    s_mov_b32 s59, 0x140000
    buffer_load_dwordx4 v203, s[52:55], s59 offen lds
    buffer_load_dwordx4 v200, s[52:55], s59 offen offset:1024 lds
    s_add_u32 m0, s58, 0x8000
    s_mov_b32 s59, 0x180000
    buffer_load_dwordx4 v203, s[52:55], s59 offen lds
    buffer_load_dwordx4 v200, s[52:55], s59 offen offset:1024 lds
    s_add_u32 m0, s58, 0xa000
    s_mov_b32 s59, 0x1c0000
    buffer_load_dwordx4 v203, s[52:55], s59 offen lds
    buffer_load_dwordx4 v200, s[52:55], s59 offen offset:1024 lds
    s_add_u32 m0, s58, 0xc000
    s_mov_b32 s59, 0x200000
    buffer_load_dwordx4 v203, s[52:55], s59 offen lds
    buffer_load_dwordx4 v200, s[52:55], s59 offen offset:1024 lds
    s_add_u32 m0, s58, 0x14000
    s_mov_b32 s59, 0x240000
    buffer_load_dwordx4 v203, s[52:55], s59 offen lds
    buffer_load_dwordx4 v200, s[52:55], s59 offen offset:1024 lds
    s_add_u32 m0, s58, 0x16000
    s_mov_b32 s59, 0x280000
    buffer_load_dwordx4 v203, s[52:55], s59 offen lds
    buffer_load_dwordx4 v200, s[52:55], s59 offen offset:1024 lds
    s_add_u32 m0, s58, 0x18000
    s_mov_b32 s59, 0x2c0000
    buffer_load_dwordx4 v203, s[52:55], s59 offen lds
    buffer_load_dwordx4 v200, s[52:55], s59 offen offset:1024 lds
    s_add_u32 m0, s58, 0xe000
    s_mov_b32 s59, 0x300000
    buffer_load_dwordx4 v203, s[52:55], s59 offen lds
    buffer_load_dwordx4 v200, s[52:55], s59 offen offset:1024 lds
    s_add_u32 m0, s58, 0x1a000
    s_mov_b32 s59, 0x340000
    buffer_load_dwordx4 v203, s[52:55], s59 offen lds
    buffer_load_dwordx4 v200, s[52:55], s59 offen offset:1024 lds
    s_add_u32 m0, s58, 0x1c000
    s_mov_b32 s59, 0x380000
    buffer_load_dwordx4 v203, s[52:55], s59 offen lds
    buffer_load_dwordx4 v200, s[52:55], s59 offen offset:1024 lds
    s_add_u32 m0, s58, 0x1e000
    s_mov_b32 s59, 0x3c0000
    buffer_load_dwordx4 v203, s[52:55], s59 offen lds
    buffer_load_dwordx4 v200, s[52:55], s59 offen offset:1024 lds
p0_join:
    s_load_dwordx2 s[52:53], s[0:1], 32
    s_load_dwordx4 s[56:59], s[0:1], 48
    s_load_dwordx2 s[60:61], s[0:1], 64
    v_mbcnt_lo_u32_b32 v2, -1, 0
    v_mbcnt_hi_u32_b32 v2, -1, v2
    s_and_b32 s38, s29, 3
    s_lshl_b32 s38, s38, 14
    v_lshlrev_b32 v24, 7, v2
    v_mbcnt_lo_u32_b32 v40, -1, 0
    v_mbcnt_hi_u32_b32 v40, -1, v40
    v_and_b32 v40, 1, v40
    v_lshlrev_b32 v40, 2, v40
    s_lshl_b32 s36, s32, 7
    s_lshl_b32 s37, s24, 3
    s_add_u32 s36, s36, s37
    s_add_u32 s36, s36, 0x3003000
    v_add_u32 v40, s36, v40
    v_lshlrev_b32 v214, 2, v2
    v_add_u32 v214, 0x3000000, v214
    s_waitcnt lgkmcnt(0)
    s_cmp_lg_u32 s46, 0
    s_cbranch_scc1 wp_ok_p0x_6
    s_mov_b32 s47, 400000
wp_loop_p0x_6:
    global_load_dword v8, v40, s[34:35] sc1
    s_waitcnt vmcnt(0)
    v_cmp_ne_u32 vcc, s33, v8
    s_cmp_eq_u64 vcc, 0
    s_cbranch_scc1 wp_ok_p0x_6
    s_sub_u32 s47, s47, 1
    s_cmp_lg_u32 s47, 0
    s_cbranch_scc1 wp_loop_p0x_6
wp_ok_p0x_6:
    s_mov_b32 s37, 0x0
    buffer_load_dwordx4 v[128:131], v201, s[16:19], s37 offen offset:0 sc1
    buffer_load_dwordx4 v[132:135], v202, s[16:19], s37 offen offset:0 sc1
    s_mov_b32 s37, 0x0
    buffer_load_dwordx4 v[136:139], v201, s[16:19], s37 offen offset:1024 sc1
    buffer_load_dwordx4 v[140:143], v202, s[16:19], s37 offen offset:1024 sc1
    s_mov_b32 s37, 0x0
    buffer_load_dwordx4 v[144:147], v201, s[16:19], s37 offen offset:2048 sc1
    buffer_load_dwordx4 v[148:151], v202, s[16:19], s37 offen offset:2048 sc1
    s_mov_b32 s37, 0x0
    buffer_load_dwordx4 v[152:155], v201, s[16:19], s37 offen offset:3072 sc1
    buffer_load_dwordx4 v[156:159], v202, s[16:19], s37 offen offset:3072 sc1
    s_mov_b32 s37, 0x1000
    buffer_load_dwordx4 v[160:163], v201, s[16:19], s37 offen offset:0 sc1
    buffer_load_dwordx4 v[164:167], v202, s[16:19], s37 offen offset:0 sc1
    s_mov_b32 s37, 0x1000
    buffer_load_dwordx4 v[168:171], v201, s[16:19], s37 offen offset:1024 sc1
    buffer_load_dwordx4 v[172:175], v202, s[16:19], s37 offen offset:1024 sc1
    s_mov_b32 s37, 0x1000
    buffer_load_dwordx4 v[176:179], v201, s[16:19], s37 offen offset:2048 sc1
    buffer_load_dwordx4 v[180:183], v202, s[16:19], s37 offen offset:2048 sc1
    s_mov_b32 s37, 0x1000
    buffer_load_dwordx4 v[184:187], v201, s[16:19], s37 offen offset:3072 sc1
    buffer_load_dwordx4 v[188:191], v202, s[16:19], s37 offen offset:3072 sc1
    s_mov_b32 s37, 0x2000
    buffer_load_dwordx4 v[216:219], v201, s[16:19], s37 offen offset:0 sc1
    buffer_load_dwordx4 v[220:223], v202, s[16:19], s37 offen offset:0 sc1
    s_mov_b32 s37, 0x2000
    buffer_load_dwordx4 v[224:227], v201, s[16:19], s37 offen offset:1024 sc1
    buffer_load_dwordx4 v[228:231], v202, s[16:19], s37 offen offset:1024 sc1
    s_mov_b32 s37, 0x2000
    buffer_load_dwordx4 v[232:235], v201, s[16:19], s37 offen offset:2048 sc1
    buffer_load_dwordx4 v[236:239], v202, s[16:19], s37 offen offset:2048 sc1
    s_waitcnt vmcnt(20)
    s_barrier
    ds_read_b64_tr_b16 a[128:129], v192 offset:0
    ds_read_b64_tr_b16 a[130:131], v192 offset:1024
    ds_read_b64_tr_b16 a[132:133], v193 offset:0
    ds_read_b64_tr_b16 a[134:135], v193 offset:1024
    ds_read_b64_tr_b16 a[136:137], v194 offset:0
    ds_read_b64_tr_b16 a[138:139], v194 offset:1024
    ds_read_b64_tr_b16 a[140:141], v195 offset:0
    ds_read_b64_tr_b16 a[142:143], v195 offset:1024
    s_mov_b32 s26, 0
    s_mov_b32 s27, 0
    s_waitcnt lgkmcnt(6)
    v_mfma_f32_32x32x16_bf16 v[0:15], a[128:131], v[128:131], 0
    ds_read_b64_tr_b16 a[144:145], v192 offset:4096
    ds_read_b64_tr_b16 a[146:147], v192 offset:5120
    v_mfma_f32_32x32x16_bf16 v[16:31], a[128:131], v[132:135], 0
    s_waitcnt lgkmcnt(6)
    v_mfma_f32_32x32x16_bf16 v[32:47], a[132:135], v[128:131], 0
    ds_read_b64_tr_b16 a[148:149], v193 offset:4096
    ds_read_b64_tr_b16 a[150:151], v193 offset:5120
    v_mfma_f32_32x32x16_bf16 v[48:63], a[132:135], v[132:135], 0
    s_waitcnt lgkmcnt(6)
    v_mfma_f32_32x32x16_bf16 v[64:79], a[136:139], v[128:131], 0
    ds_read_b64_tr_b16 a[152:153], v194 offset:4096
    ds_read_b64_tr_b16 a[154:155], v194 offset:5120
    v_mfma_f32_32x32x16_bf16 v[80:95], a[136:139], v[132:135], 0
    s_mov_b32 s37, 0x2000
    s_waitcnt lgkmcnt(6)
    v_mfma_f32_32x32x16_bf16 v[96:111], a[140:143], v[128:131], 0
    ds_read_b64_tr_b16 a[156:157], v195 offset:4096
    ds_read_b64_tr_b16 a[158:159], v195 offset:5120
    buffer_load_dwordx4 v[240:243], v201, s[16:19], s37 offen offset:3072 sc1
    buffer_load_dwordx4 v[244:247], v202, s[16:19], s37 offen offset:3072 sc1
    v_mfma_f32_32x32x16_bf16 v[112:127], a[140:143], v[132:135], 0
    s_waitcnt vmcnt(21) lgkmcnt(6)
    v_mfma_f32_32x32x16_bf16 v[0:15], a[144:147], v[136:139], v[0:15]
    ds_read_b64_tr_b16 a[128:129], v192 offset:8192
    ds_read_b64_tr_b16 a[130:131], v192 offset:9216
    s_waitcnt vmcnt(20)
    v_mfma_f32_32x32x16_bf16 v[16:31], a[144:147], v[140:143], v[16:31]
    s_waitcnt lgkmcnt(6)
    v_mfma_f32_32x32x16_bf16 v[32:47], a[148:151], v[136:139], v[32:47]
    ds_read_b64_tr_b16 a[132:133], v193 offset:8192
    ds_read_b64_tr_b16 a[134:135], v193 offset:9216
    v_mfma_f32_32x32x16_bf16 v[48:63], a[148:151], v[140:143], v[48:63]
    s_waitcnt lgkmcnt(6)
    v_mfma_f32_32x32x16_bf16 v[64:79], a[152:155], v[136:139], v[64:79]
    ds_read_b64_tr_b16 a[136:137], v194 offset:8192
    ds_read_b64_tr_b16 a[138:139], v194 offset:9216
    v_mfma_f32_32x32x16_bf16 v[80:95], a[152:155], v[140:143], v[80:95]
    s_mov_b32 s37, 0x3000
    s_waitcnt lgkmcnt(6)
    v_mfma_f32_32x32x16_bf16 v[96:111], a[156:159], v[136:139], v[96:111]
    ds_read_b64_tr_b16 a[140:141], v195 offset:8192
    ds_read_b64_tr_b16 a[142:143], v195 offset:9216
    buffer_load_dwordx4 v[128:131], v201, s[16:19], s37 offen offset:0 sc1
    buffer_load_dwordx4 v[132:135], v202, s[16:19], s37 offen offset:0 sc1
    v_mfma_f32_32x32x16_bf16 v[112:127], a[156:159], v[140:143], v[112:127]
    s_waitcnt vmcnt(21) lgkmcnt(6)
    v_mfma_f32_32x32x16_bf16 v[0:15], a[128:131], v[144:147], v[0:15]
    ds_read_b64_tr_b16 a[144:145], v192 offset:12288
    ds_read_b64_tr_b16 a[146:147], v192 offset:13312
    s_waitcnt vmcnt(20)
    v_mfma_f32_32x32x16_bf16 v[16:31], a[128:131], v[148:151], v[16:31]
    s_waitcnt lgkmcnt(6)
    v_mfma_f32_32x32x16_bf16 v[32:47], a[132:135], v[144:147], v[32:47]
    ds_read_b64_tr_b16 a[148:149], v193 offset:12288
    ds_read_b64_tr_b16 a[150:151], v193 offset:13312
    v_mfma_f32_32x32x16_bf16 v[48:63], a[132:135], v[148:151], v[48:63]
    s_waitcnt lgkmcnt(6)
    v_mfma_f32_32x32x16_bf16 v[64:79], a[136:139], v[144:147], v[64:79]
    ds_read_b64_tr_b16 a[152:153], v194 offset:12288
    ds_read_b64_tr_b16 a[154:155], v194 offset:13312
    v_mfma_f32_32x32x16_bf16 v[80:95], a[136:139], v[148:151], v[80:95]
    s_mov_b32 s37, 0x3000
    s_waitcnt lgkmcnt(6)
    v_mfma_f32_32x32x16_bf16 v[96:111], a[140:143], v[144:147], v[96:111]
    ds_read_b64_tr_b16 a[156:157], v195 offset:12288
    ds_read_b64_tr_b16 a[158:159], v195 offset:13312
    buffer_load_dwordx4 v[136:139], v201, s[16:19], s37 offen offset:1024 sc1
    buffer_load_dwordx4 v[140:143], v202, s[16:19], s37 offen offset:1024 sc1
    v_mfma_f32_32x32x16_bf16 v[112:127], a[140:143], v[148:151], v[112:127]
    s_waitcnt vmcnt(21) lgkmcnt(6)
    v_mfma_f32_32x32x16_bf16 v[0:15], a[144:147], v[152:155], v[0:15]
    ds_read_b64_tr_b16 a[128:129], v192 offset:16384
    ds_read_b64_tr_b16 a[130:131], v192 offset:17408
    s_waitcnt vmcnt(20)
    v_mfma_f32_32x32x16_bf16 v[16:31], a[144:147], v[156:159], v[16:31]
    s_waitcnt lgkmcnt(6)
    v_mfma_f32_32x32x16_bf16 v[32:47], a[148:151], v[152:155], v[32:47]
    ds_read_b64_tr_b16 a[132:133], v193 offset:16384
    ds_read_b64_tr_b16 a[134:135], v193 offset:17408
    v_mfma_f32_32x32x16_bf16 v[48:63], a[148:151], v[156:159], v[48:63]
    s_waitcnt lgkmcnt(6)
    v_mfma_f32_32x32x16_bf16 v[64:79], a[152:155], v[152:155], v[64:79]
    ds_read_b64_tr_b16 a[136:137], v194 offset:16384
    ds_read_b64_tr_b16 a[138:139], v194 offset:17408
    v_mfma_f32_32x32x16_bf16 v[80:95], a[152:155], v[156:159], v[80:95]
    s_mov_b32 s37, 0x3000
    s_waitcnt lgkmcnt(6)
    v_mfma_f32_32x32x16_bf16 v[96:111], a[156:159], v[152:155], v[96:111]
    ds_read_b64_tr_b16 a[140:141], v195 offset:16384
    ds_read_b64_tr_b16 a[142:143], v195 offset:17408
    buffer_load_dwordx4 v[144:147], v201, s[16:19], s37 offen offset:2048 sc1
    buffer_load_dwordx4 v[148:151], v202, s[16:19], s37 offen offset:2048 sc1
    v_mfma_f32_32x32x16_bf16 v[112:127], a[156:159], v[156:159], v[112:127]
    s_barrier
    s_waitcnt vmcnt(21) lgkmcnt(6)
    v_mfma_f32_32x32x16_bf16 v[0:15], a[128:131], v[160:163], v[0:15]
    ds_read_b64_tr_b16 a[144:145], v192 offset:20480
    ds_read_b64_tr_b16 a[146:147], v192 offset:21504
    s_add_u32 m0, s25, 0x0
    s_waitcnt vmcnt(20)
    v_mfma_f32_32x32x16_bf16 v[16:31], a[128:131], v[164:167], v[16:31]
    buffer_load_dwordx4 v204, s[4:7], s26 offen lds
    buffer_load_dwordx4 v205, s[4:7], s26 offen offset:1024 lds
    s_add_u32 s26, s26, 0x2000
    s_waitcnt lgkmcnt(6)
    v_mfma_f32_32x32x16_bf16 v[32:47], a[132:135], v[160:163], v[32:47]
    ds_read_b64_tr_b16 a[148:149], v193 offset:20480
    ds_read_b64_tr_b16 a[150:151], v193 offset:21504
    s_add_u32 m0, s25, 0x2000
    v_mfma_f32_32x32x16_bf16 v[48:63], a[132:135], v[164:167], v[48:63]
    buffer_load_dwordx4 v204, s[4:7], s26 offen lds
    buffer_load_dwordx4 v205, s[4:7], s26 offen offset:1024 lds
    s_add_u32 s26, s26, 0x2000
    s_waitcnt lgkmcnt(6)
    v_mfma_f32_32x32x16_bf16 v[64:79], a[136:139], v[160:163], v[64:79]
    ds_read_b64_tr_b16 a[152:153], v194 offset:20480
    ds_read_b64_tr_b16 a[154:155], v194 offset:21504
    v_mfma_f32_32x32x16_bf16 v[80:95], a[136:139], v[164:167], v[80:95]
    s_mov_b32 s37, 0x3000
    s_waitcnt lgkmcnt(6)
    v_mfma_f32_32x32x16_bf16 v[96:111], a[140:143], v[160:163], v[96:111]
    ds_read_b64_tr_b16 a[156:157], v195 offset:20480
    ds_read_b64_tr_b16 a[158:159], v195 offset:21504
    buffer_load_dwordx4 v[152:155], v201, s[16:19], s37 offen offset:3072 sc1
    buffer_load_dwordx4 v[156:159], v202, s[16:19], s37 offen offset:3072 sc1
    v_mfma_f32_32x32x16_bf16 v[112:127], a[140:143], v[164:167], v[112:127]
    s_waitcnt vmcnt(25) lgkmcnt(6)
    v_mfma_f32_32x32x16_bf16 v[0:15], a[144:147], v[168:171], v[0:15]
    ds_read_b64_tr_b16 a[128:129], v192 offset:24576
    ds_read_b64_tr_b16 a[130:131], v192 offset:25600
    s_waitcnt vmcnt(24)
    v_mfma_f32_32x32x16_bf16 v[16:31], a[144:147], v[172:175], v[16:31]
    s_waitcnt lgkmcnt(6)
    v_mfma_f32_32x32x16_bf16 v[32:47], a[148:151], v[168:171], v[32:47]
    ds_read_b64_tr_b16 a[132:133], v193 offset:24576
    ds_read_b64_tr_b16 a[134:135], v193 offset:25600
    v_mfma_f32_32x32x16_bf16 v[48:63], a[148:151], v[172:175], v[48:63]
    s_waitcnt lgkmcnt(6)
    v_mfma_f32_32x32x16_bf16 v[64:79], a[152:155], v[168:171], v[64:79]
    ds_read_b64_tr_b16 a[136:137], v194 offset:24576
    ds_read_b64_tr_b16 a[138:139], v194 offset:25600
    v_mfma_f32_32x32x16_bf16 v[80:95], a[152:155], v[172:175], v[80:95]
    s_mov_b32 s37, 0x4000
    s_waitcnt lgkmcnt(6)
    v_mfma_f32_32x32x16_bf16 v[96:111], a[156:159], v[168:171], v[96:111]
    ds_read_b64_tr_b16 a[140:141], v195 offset:24576
    ds_read_b64_tr_b16 a[142:143], v195 offset:25600
    buffer_load_dwordx4 v[160:163], v201, s[16:19], s37 offen offset:0 sc1
    buffer_load_dwordx4 v[164:167], v202, s[16:19], s37 offen offset:0 sc1
    v_mfma_f32_32x32x16_bf16 v[112:127], a[156:159], v[172:175], v[112:127]
    s_waitcnt vmcnt(25) lgkmcnt(6)
    v_mfma_f32_32x32x16_bf16 v[0:15], a[128:131], v[176:179], v[0:15]
    ds_read_b64_tr_b16 a[144:145], v192 offset:28672
    ds_read_b64_tr_b16 a[146:147], v192 offset:29696
    s_waitcnt vmcnt(24)
    v_mfma_f32_32x32x16_bf16 v[16:31], a[128:131], v[180:183], v[16:31]
    s_waitcnt lgkmcnt(6)
    v_mfma_f32_32x32x16_bf16 v[32:47], a[132:135], v[176:179], v[32:47]
    ds_read_b64_tr_b16 a[148:149], v193 offset:28672
    ds_read_b64_tr_b16 a[150:151], v193 offset:29696
    v_mfma_f32_32x32x16_bf16 v[48:63], a[132:135], v[180:183], v[48:63]
    s_waitcnt lgkmcnt(6)
    v_mfma_f32_32x32x16_bf16 v[64:79], a[136:139], v[176:179], v[64:79]
    ds_read_b64_tr_b16 a[152:153], v194 offset:28672
    ds_read_b64_tr_b16 a[154:155], v194 offset:29696
    v_mfma_f32_32x32x16_bf16 v[80:95], a[136:139], v[180:183], v[80:95]
    s_mov_b32 s37, 0x4000
    s_waitcnt lgkmcnt(6)
    v_mfma_f32_32x32x16_bf16 v[96:111], a[140:143], v[176:179], v[96:111]
    ds_read_b64_tr_b16 a[156:157], v195 offset:28672
    ds_read_b64_tr_b16 a[158:159], v195 offset:29696
    buffer_load_dwordx4 v[168:171], v201, s[16:19], s37 offen offset:1024 sc1
    buffer_load_dwordx4 v[172:175], v202, s[16:19], s37 offen offset:1024 sc1
    v_mfma_f32_32x32x16_bf16 v[112:127], a[140:143], v[180:183], v[112:127]
    s_waitcnt vmcnt(25) lgkmcnt(6)
    v_mfma_f32_32x32x16_bf16 v[0:15], a[144:147], v[184:187], v[0:15]
    ds_read_b64_tr_b16 a[128:129], v196 offset:0
    ds_read_b64_tr_b16 a[130:131], v196 offset:1024
    s_waitcnt vmcnt(24)
    v_mfma_f32_32x32x16_bf16 v[16:31], a[144:147], v[188:191], v[16:31]
    s_waitcnt lgkmcnt(6)
    v_mfma_f32_32x32x16_bf16 v[32:47], a[148:151], v[184:187], v[32:47]
    ds_read_b64_tr_b16 a[132:133], v197 offset:0
    ds_read_b64_tr_b16 a[134:135], v197 offset:1024
    v_mfma_f32_32x32x16_bf16 v[48:63], a[148:151], v[188:191], v[48:63]
    s_waitcnt lgkmcnt(6)
    v_mfma_f32_32x32x16_bf16 v[64:79], a[152:155], v[184:187], v[64:79]
    ds_read_b64_tr_b16 a[136:137], v198 offset:0
    ds_read_b64_tr_b16 a[138:139], v198 offset:1024
    v_mfma_f32_32x32x16_bf16 v[80:95], a[152:155], v[188:191], v[80:95]
    s_mov_b32 s37, 0x4000
    s_waitcnt lgkmcnt(6)
    v_mfma_f32_32x32x16_bf16 v[96:111], a[156:159], v[184:187], v[96:111]
    ds_read_b64_tr_b16 a[140:141], v199 offset:0
    ds_read_b64_tr_b16 a[142:143], v199 offset:1024
    buffer_load_dwordx4 v[176:179], v201, s[16:19], s37 offen offset:2048 sc1
    buffer_load_dwordx4 v[180:183], v202, s[16:19], s37 offen offset:2048 sc1
    v_mfma_f32_32x32x16_bf16 v[112:127], a[156:159], v[188:191], v[112:127]
    s_barrier
    s_waitcnt vmcnt(25) lgkmcnt(6)
    v_mfma_f32_32x32x16_bf16 v[0:15], a[128:131], v[216:219], v[0:15]
    ds_read_b64_tr_b16 a[144:145], v196 offset:4096
    ds_read_b64_tr_b16 a[146:147], v196 offset:5120
    s_add_u32 m0, s25, 0x4000
    s_waitcnt vmcnt(24)
    v_mfma_f32_32x32x16_bf16 v[16:31], a[128:131], v[220:223], v[16:31]
    buffer_load_dwordx4 v204, s[4:7], s26 offen lds
    buffer_load_dwordx4 v205, s[4:7], s26 offen offset:1024 lds
    s_add_u32 s26, s26, 0x2000
    s_waitcnt lgkmcnt(6)
    v_mfma_f32_32x32x16_bf16 v[32:47], a[132:135], v[216:219], v[32:47]
    ds_read_b64_tr_b16 a[148:149], v197 offset:4096
    ds_read_b64_tr_b16 a[150:151], v197 offset:5120
    s_add_u32 m0, s25, 0x6000
    v_mfma_f32_32x32x16_bf16 v[48:63], a[132:135], v[220:223], v[48:63]
    buffer_load_dwordx4 v204, s[4:7], s26 offen lds
    buffer_load_dwordx4 v205, s[4:7], s26 offen offset:1024 lds
    s_add_u32 s26, s26, 0x2000
    s_waitcnt lgkmcnt(6)
    v_mfma_f32_32x32x16_bf16 v[64:79], a[136:139], v[216:219], v[64:79]
    ds_read_b64_tr_b16 a[152:153], v198 offset:4096
    ds_read_b64_tr_b16 a[154:155], v198 offset:5120
    v_mfma_f32_32x32x16_bf16 v[80:95], a[136:139], v[220:223], v[80:95]
    s_mov_b32 s37, 0x4000
    s_waitcnt lgkmcnt(6)
    v_mfma_f32_32x32x16_bf16 v[96:111], a[140:143], v[216:219], v[96:111]
    ds_read_b64_tr_b16 a[156:157], v199 offset:4096
    ds_read_b64_tr_b16 a[158:159], v199 offset:5120
    buffer_load_dwordx4 v[184:187], v201, s[16:19], s37 offen offset:3072 sc1
    buffer_load_dwordx4 v[188:191], v202, s[16:19], s37 offen offset:3072 sc1
    v_mfma_f32_32x32x16_bf16 v[112:127], a[140:143], v[220:223], v[112:127]
    s_waitcnt vmcnt(29) lgkmcnt(6)
    v_mfma_f32_32x32x16_bf16 v[0:15], a[144:147], v[224:227], v[0:15]
    ds_read_b64_tr_b16 a[128:129], v196 offset:8192
    ds_read_b64_tr_b16 a[130:131], v196 offset:9216
    s_waitcnt vmcnt(28)
    v_mfma_f32_32x32x16_bf16 v[16:31], a[144:147], v[228:231], v[16:31]
    s_waitcnt lgkmcnt(6)
    v_mfma_f32_32x32x16_bf16 v[32:47], a[148:151], v[224:227], v[32:47]
    ds_read_b64_tr_b16 a[132:133], v197 offset:8192
    ds_read_b64_tr_b16 a[134:135], v197 offset:9216
    v_mfma_f32_32x32x16_bf16 v[48:63], a[148:151], v[228:231], v[48:63]
    s_waitcnt lgkmcnt(6)
    v_mfma_f32_32x32x16_bf16 v[64:79], a[152:155], v[224:227], v[64:79]
    ds_read_b64_tr_b16 a[136:137], v198 offset:8192
    ds_read_b64_tr_b16 a[138:139], v198 offset:9216
    v_mfma_f32_32x32x16_bf16 v[80:95], a[152:155], v[228:231], v[80:95]
    s_mov_b32 s37, 0x5000
    s_waitcnt lgkmcnt(6)
    v_mfma_f32_32x32x16_bf16 v[96:111], a[156:159], v[224:227], v[96:111]
    ds_read_b64_tr_b16 a[140:141], v199 offset:8192
    ds_read_b64_tr_b16 a[142:143], v199 offset:9216
    buffer_load_dwordx4 v[216:219], v201, s[16:19], s37 offen offset:0 sc1
    buffer_load_dwordx4 v[220:223], v202, s[16:19], s37 offen offset:0 sc1
    v_mfma_f32_32x32x16_bf16 v[112:127], a[156:159], v[228:231], v[112:127]
    s_waitcnt vmcnt(29) lgkmcnt(6)
    v_mfma_f32_32x32x16_bf16 v[0:15], a[128:131], v[232:235], v[0:15]
    ds_read_b64_tr_b16 a[144:145], v196 offset:12288
    ds_read_b64_tr_b16 a[146:147], v196 offset:13312
    s_waitcnt vmcnt(28)
    v_mfma_f32_32x32x16_bf16 v[16:31], a[128:131], v[236:239], v[16:31]
    s_waitcnt lgkmcnt(6)
    v_mfma_f32_32x32x16_bf16 v[32:47], a[132:135], v[232:235], v[32:47]
    ds_read_b64_tr_b16 a[148:149], v197 offset:12288
    ds_read_b64_tr_b16 a[150:151], v197 offset:13312
    v_mfma_f32_32x32x16_bf16 v[48:63], a[132:135], v[236:239], v[48:63]
    s_waitcnt lgkmcnt(6)
    v_mfma_f32_32x32x16_bf16 v[64:79], a[136:139], v[232:235], v[64:79]
    ds_read_b64_tr_b16 a[152:153], v198 offset:12288
    ds_read_b64_tr_b16 a[154:155], v198 offset:13312
    v_mfma_f32_32x32x16_bf16 v[80:95], a[136:139], v[236:239], v[80:95]
    s_mov_b32 s37, 0x5000
    s_waitcnt lgkmcnt(6)
    v_mfma_f32_32x32x16_bf16 v[96:111], a[140:143], v[232:235], v[96:111]
    ds_read_b64_tr_b16 a[156:157], v199 offset:12288
    ds_read_b64_tr_b16 a[158:159], v199 offset:13312
    buffer_load_dwordx4 v[224:227], v201, s[16:19], s37 offen offset:1024 sc1
    buffer_load_dwordx4 v[228:231], v202, s[16:19], s37 offen offset:1024 sc1
    v_mfma_f32_32x32x16_bf16 v[112:127], a[140:143], v[236:239], v[112:127]
    s_waitcnt vmcnt(29) lgkmcnt(6)
    v_mfma_f32_32x32x16_bf16 v[0:15], a[144:147], v[240:243], v[0:15]
    ds_read_b64_tr_b16 a[128:129], v192 offset:32768
    ds_read_b64_tr_b16 a[130:131], v192 offset:33792
    s_waitcnt vmcnt(28)
    v_mfma_f32_32x32x16_bf16 v[16:31], a[144:147], v[244:247], v[16:31]
    s_waitcnt lgkmcnt(6)
    v_mfma_f32_32x32x16_bf16 v[32:47], a[148:151], v[240:243], v[32:47]
    ds_read_b64_tr_b16 a[132:133], v193 offset:32768
    ds_read_b64_tr_b16 a[134:135], v193 offset:33792
    v_mfma_f32_32x32x16_bf16 v[48:63], a[148:151], v[244:247], v[48:63]
    s_waitcnt lgkmcnt(6)
    v_mfma_f32_32x32x16_bf16 v[64:79], a[152:155], v[240:243], v[64:79]
    ds_read_b64_tr_b16 a[136:137], v194 offset:32768
    ds_read_b64_tr_b16 a[138:139], v194 offset:33792
    v_mfma_f32_32x32x16_bf16 v[80:95], a[152:155], v[244:247], v[80:95]
    s_mov_b32 s37, 0x5000
    s_waitcnt lgkmcnt(6)
    v_mfma_f32_32x32x16_bf16 v[96:111], a[156:159], v[240:243], v[96:111]
    ds_read_b64_tr_b16 a[140:141], v195 offset:32768
    ds_read_b64_tr_b16 a[142:143], v195 offset:33792
    buffer_load_dwordx4 v[232:235], v201, s[16:19], s37 offen offset:2048 sc1
    buffer_load_dwordx4 v[236:239], v202, s[16:19], s37 offen offset:2048 sc1
    v_mfma_f32_32x32x16_bf16 v[112:127], a[156:159], v[244:247], v[112:127]
    s_barrier
    s_waitcnt vmcnt(29) lgkmcnt(6)
    v_mfma_f32_32x32x16_bf16 v[0:15], a[128:131], v[128:131], v[0:15]
    ds_read_b64_tr_b16 a[144:145], v192 offset:36864
    ds_read_b64_tr_b16 a[146:147], v192 offset:37888
    s_add_u32 m0, s25, 0x10000
    s_waitcnt vmcnt(28)
    v_mfma_f32_32x32x16_bf16 v[16:31], a[128:131], v[132:135], v[16:31]
    buffer_load_dwordx4 v206, s[8:11], s27 offen lds
    buffer_load_dwordx4 v207, s[8:11], s27 offen offset:1024 lds
    s_add_u32 s27, s27, 0x2000
    s_waitcnt lgkmcnt(6)
    v_mfma_f32_32x32x16_bf16 v[32:47], a[132:135], v[128:131], v[32:47]
    ds_read_b64_tr_b16 a[148:149], v193 offset:36864
    ds_read_b64_tr_b16 a[150:151], v193 offset:37888
    s_add_u32 m0, s25, 0x12000
    v_mfma_f32_32x32x16_bf16 v[48:63], a[132:135], v[132:135], v[48:63]
    buffer_load_dwordx4 v206, s[8:11], s27 offen lds
    buffer_load_dwordx4 v207, s[8:11], s27 offen offset:1024 lds
    s_add_u32 s27, s27, 0x2000
    s_waitcnt lgkmcnt(6)
    v_mfma_f32_32x32x16_bf16 v[64:79], a[136:139], v[128:131], v[64:79]
    ds_read_b64_tr_b16 a[152:153], v194 offset:36864
    ds_read_b64_tr_b16 a[154:155], v194 offset:37888
    v_mfma_f32_32x32x16_bf16 v[80:95], a[136:139], v[132:135], v[80:95]
    s_mov_b32 s37, 0x5000
    s_waitcnt lgkmcnt(6)
    v_mfma_f32_32x32x16_bf16 v[96:111], a[140:143], v[128:131], v[96:111]
    ds_read_b64_tr_b16 a[156:157], v195 offset:36864
    ds_read_b64_tr_b16 a[158:159], v195 offset:37888
    buffer_load_dwordx4 v[240:243], v201, s[16:19], s37 offen offset:3072 sc1
    buffer_load_dwordx4 v[244:247], v202, s[16:19], s37 offen offset:3072 sc1
    v_mfma_f32_32x32x16_bf16 v[112:127], a[140:143], v[132:135], v[112:127]
    s_waitcnt vmcnt(33) lgkmcnt(6)
    v_mfma_f32_32x32x16_bf16 v[0:15], a[144:147], v[136:139], v[0:15]
    ds_read_b64_tr_b16 a[128:129], v192 offset:40960
    ds_read_b64_tr_b16 a[130:131], v192 offset:41984
    s_waitcnt vmcnt(32)
    v_mfma_f32_32x32x16_bf16 v[16:31], a[144:147], v[140:143], v[16:31]
    s_waitcnt lgkmcnt(6)
    v_mfma_f32_32x32x16_bf16 v[32:47], a[148:151], v[136:139], v[32:47]
    ds_read_b64_tr_b16 a[132:133], v193 offset:40960
    ds_read_b64_tr_b16 a[134:135], v193 offset:41984
    v_mfma_f32_32x32x16_bf16 v[48:63], a[148:151], v[140:143], v[48:63]
    s_waitcnt lgkmcnt(6)
    v_mfma_f32_32x32x16_bf16 v[64:79], a[152:155], v[136:139], v[64:79]
    ds_read_b64_tr_b16 a[136:137], v194 offset:40960
    ds_read_b64_tr_b16 a[138:139], v194 offset:41984
    v_mfma_f32_32x32x16_bf16 v[80:95], a[152:155], v[140:143], v[80:95]
    s_mov_b32 s37, 0x6000
    s_waitcnt lgkmcnt(6)
    v_mfma_f32_32x32x16_bf16 v[96:111], a[156:159], v[136:139], v[96:111]
    ds_read_b64_tr_b16 a[140:141], v195 offset:40960
    ds_read_b64_tr_b16 a[142:143], v195 offset:41984
    buffer_load_dwordx4 v[128:131], v201, s[16:19], s37 offen offset:0 sc1
    buffer_load_dwordx4 v[132:135], v202, s[16:19], s37 offen offset:0 sc1
    v_mfma_f32_32x32x16_bf16 v[112:127], a[156:159], v[140:143], v[112:127]
    s_waitcnt vmcnt(33) lgkmcnt(6)
    v_mfma_f32_32x32x16_bf16 v[0:15], a[128:131], v[144:147], v[0:15]
    ds_read_b64_tr_b16 a[144:145], v192 offset:45056
    ds_read_b64_tr_b16 a[146:147], v192 offset:46080
    s_waitcnt vmcnt(32)
    v_mfma_f32_32x32x16_bf16 v[16:31], a[128:131], v[148:151], v[16:31]
    s_waitcnt lgkmcnt(6)
    v_mfma_f32_32x32x16_bf16 v[32:47], a[132:135], v[144:147], v[32:47]
    ds_read_b64_tr_b16 a[148:149], v193 offset:45056
    ds_read_b64_tr_b16 a[150:151], v193 offset:46080
    v_mfma_f32_32x32x16_bf16 v[48:63], a[132:135], v[148:151], v[48:63]
    s_waitcnt lgkmcnt(6)
    v_mfma_f32_32x32x16_bf16 v[64:79], a[136:139], v[144:147], v[64:79]
    ds_read_b64_tr_b16 a[152:153], v194 offset:45056
    ds_read_b64_tr_b16 a[154:155], v194 offset:46080
    v_mfma_f32_32x32x16_bf16 v[80:95], a[136:139], v[148:151], v[80:95]
    s_mov_b32 s37, 0x6000
    s_waitcnt lgkmcnt(6)
    v_mfma_f32_32x32x16_bf16 v[96:111], a[140:143], v[144:147], v[96:111]
    ds_read_b64_tr_b16 a[156:157], v195 offset:45056
    ds_read_b64_tr_b16 a[158:159], v195 offset:46080
    buffer_load_dwordx4 v[136:139], v201, s[16:19], s37 offen offset:1024 sc1
    buffer_load_dwordx4 v[140:143], v202, s[16:19], s37 offen offset:1024 sc1
    v_mfma_f32_32x32x16_bf16 v[112:127], a[140:143], v[148:151], v[112:127]
    s_waitcnt vmcnt(29) lgkmcnt(6)
    v_mfma_f32_32x32x16_bf16 v[0:15], a[144:147], v[152:155], v[0:15]
    ds_read_b64_tr_b16 a[128:129], v192 offset:49152
    ds_read_b64_tr_b16 a[130:131], v192 offset:50176
    s_waitcnt vmcnt(28)
    v_mfma_f32_32x32x16_bf16 v[16:31], a[144:147], v[156:159], v[16:31]
    s_waitcnt lgkmcnt(6)
    v_mfma_f32_32x32x16_bf16 v[32:47], a[148:151], v[152:155], v[32:47]
    ds_read_b64_tr_b16 a[132:133], v193 offset:49152
    ds_read_b64_tr_b16 a[134:135], v193 offset:50176
    v_mfma_f32_32x32x16_bf16 v[48:63], a[148:151], v[156:159], v[48:63]
    s_waitcnt lgkmcnt(6)
    v_mfma_f32_32x32x16_bf16 v[64:79], a[152:155], v[152:155], v[64:79]
    ds_read_b64_tr_b16 a[136:137], v194 offset:49152
    ds_read_b64_tr_b16 a[138:139], v194 offset:50176
    v_mfma_f32_32x32x16_bf16 v[80:95], a[152:155], v[156:159], v[80:95]
    s_mov_b32 s37, 0x6000
    s_waitcnt lgkmcnt(6)
    v_mfma_f32_32x32x16_bf16 v[96:111], a[156:159], v[152:155], v[96:111]
    ds_read_b64_tr_b16 a[140:141], v195 offset:49152
    ds_read_b64_tr_b16 a[142:143], v195 offset:50176
    buffer_load_dwordx4 v[144:147], v201, s[16:19], s37 offen offset:2048 sc1
    buffer_load_dwordx4 v[148:151], v202, s[16:19], s37 offen offset:2048 sc1
    v_mfma_f32_32x32x16_bf16 v[112:127], a[156:159], v[156:159], v[112:127]
    s_barrier
    s_waitcnt vmcnt(29) lgkmcnt(6)
    v_mfma_f32_32x32x16_bf16 v[0:15], a[128:131], v[160:163], v[0:15]
    ds_read_b64_tr_b16 a[144:145], v192 offset:53248
    ds_read_b64_tr_b16 a[146:147], v192 offset:54272
    s_add_u32 m0, s25, 0x8000
    s_waitcnt vmcnt(28)
    v_mfma_f32_32x32x16_bf16 v[16:31], a[128:131], v[164:167], v[16:31]
    buffer_load_dwordx4 v204, s[4:7], s26 offen lds
    buffer_load_dwordx4 v205, s[4:7], s26 offen offset:1024 lds
    s_add_u32 s26, s26, 0x2000
    s_waitcnt lgkmcnt(6)
    v_mfma_f32_32x32x16_bf16 v[32:47], a[132:135], v[160:163], v[32:47]
    ds_read_b64_tr_b16 a[148:149], v193 offset:53248
    ds_read_b64_tr_b16 a[150:151], v193 offset:54272
    s_add_u32 m0, s25, 0xa000
    v_mfma_f32_32x32x16_bf16 v[48:63], a[132:135], v[164:167], v[48:63]
    buffer_load_dwordx4 v204, s[4:7], s26 offen lds
    buffer_load_dwordx4 v205, s[4:7], s26 offen offset:1024 lds
    s_add_u32 s26, s26, 0x2000
    s_waitcnt lgkmcnt(6)
    v_mfma_f32_32x32x16_bf16 v[64:79], a[136:139], v[160:163], v[64:79]
    ds_read_b64_tr_b16 a[152:153], v194 offset:53248
    ds_read_b64_tr_b16 a[154:155], v194 offset:54272
    v_mfma_f32_32x32x16_bf16 v[80:95], a[136:139], v[164:167], v[80:95]
    s_mov_b32 s37, 0x6000
    s_waitcnt lgkmcnt(6)
    v_mfma_f32_32x32x16_bf16 v[96:111], a[140:143], v[160:163], v[96:111]
    ds_read_b64_tr_b16 a[156:157], v195 offset:53248
    ds_read_b64_tr_b16 a[158:159], v195 offset:54272
    buffer_load_dwordx4 v[152:155], v201, s[16:19], s37 offen offset:3072 sc1
    buffer_load_dwordx4 v[156:159], v202, s[16:19], s37 offen offset:3072 sc1
    v_mfma_f32_32x32x16_bf16 v[112:127], a[140:143], v[164:167], v[112:127]
    s_waitcnt vmcnt(33) lgkmcnt(6)
    v_mfma_f32_32x32x16_bf16 v[0:15], a[144:147], v[168:171], v[0:15]
    ds_read_b64_tr_b16 a[128:129], v196 offset:16384
    ds_read_b64_tr_b16 a[130:131], v196 offset:17408
    s_waitcnt vmcnt(32)
    v_mfma_f32_32x32x16_bf16 v[16:31], a[144:147], v[172:175], v[16:31]
    s_waitcnt lgkmcnt(6)
    v_mfma_f32_32x32x16_bf16 v[32:47], a[148:151], v[168:171], v[32:47]
    ds_read_b64_tr_b16 a[132:133], v197 offset:16384
    ds_read_b64_tr_b16 a[134:135], v197 offset:17408
    v_mfma_f32_32x32x16_bf16 v[48:63], a[148:151], v[172:175], v[48:63]
    s_waitcnt lgkmcnt(6)
    v_mfma_f32_32x32x16_bf16 v[64:79], a[152:155], v[168:171], v[64:79]
    ds_read_b64_tr_b16 a[136:137], v198 offset:16384
    ds_read_b64_tr_b16 a[138:139], v198 offset:17408
    v_mfma_f32_32x32x16_bf16 v[80:95], a[152:155], v[172:175], v[80:95]
    s_mov_b32 s37, 0x7000
    s_waitcnt lgkmcnt(6)
    v_mfma_f32_32x32x16_bf16 v[96:111], a[156:159], v[168:171], v[96:111]
    ds_read_b64_tr_b16 a[140:141], v199 offset:16384
    ds_read_b64_tr_b16 a[142:143], v199 offset:17408
    buffer_load_dwordx4 v[160:163], v201, s[16:19], s37 offen offset:0 sc1
    buffer_load_dwordx4 v[164:167], v202, s[16:19], s37 offen offset:0 sc1
    v_mfma_f32_32x32x16_bf16 v[112:127], a[156:159], v[172:175], v[112:127]
    s_waitcnt vmcnt(33) lgkmcnt(6)
    v_mfma_f32_32x32x16_bf16 v[0:15], a[128:131], v[176:179], v[0:15]
    ds_read_b64_tr_b16 a[144:145], v196 offset:20480
    ds_read_b64_tr_b16 a[146:147], v196 offset:21504
    s_waitcnt vmcnt(32)
    v_mfma_f32_32x32x16_bf16 v[16:31], a[128:131], v[180:183], v[16:31]
    s_waitcnt lgkmcnt(6)
    v_mfma_f32_32x32x16_bf16 v[32:47], a[132:135], v[176:179], v[32:47]
    ds_read_b64_tr_b16 a[148:149], v197 offset:20480
    ds_read_b64_tr_b16 a[150:151], v197 offset:21504
    v_mfma_f32_32x32x16_bf16 v[48:63], a[132:135], v[180:183], v[48:63]
    s_waitcnt lgkmcnt(6)
    v_mfma_f32_32x32x16_bf16 v[64:79], a[136:139], v[176:179], v[64:79]
    ds_read_b64_tr_b16 a[152:153], v198 offset:20480
    ds_read_b64_tr_b16 a[154:155], v198 offset:21504
    v_mfma_f32_32x32x16_bf16 v[80:95], a[136:139], v[180:183], v[80:95]
    s_mov_b32 s37, 0x7000
    s_waitcnt lgkmcnt(6)
    v_mfma_f32_32x32x16_bf16 v[96:111], a[140:143], v[176:179], v[96:111]
    ds_read_b64_tr_b16 a[156:157], v199 offset:20480
    ds_read_b64_tr_b16 a[158:159], v199 offset:21504
    buffer_load_dwordx4 v[168:171], v201, s[16:19], s37 offen offset:1024 sc1
    buffer_load_dwordx4 v[172:175], v202, s[16:19], s37 offen offset:1024 sc1
    v_mfma_f32_32x32x16_bf16 v[112:127], a[140:143], v[180:183], v[112:127]
    s_waitcnt vmcnt(29) lgkmcnt(6)
    v_mfma_f32_32x32x16_bf16 v[0:15], a[144:147], v[184:187], v[0:15]
    ds_read_b64_tr_b16 a[128:129], v196 offset:24576
    ds_read_b64_tr_b16 a[130:131], v196 offset:25600
    s_waitcnt vmcnt(28)
    v_mfma_f32_32x32x16_bf16 v[16:31], a[144:147], v[188:191], v[16:31]
    s_waitcnt lgkmcnt(6)
    v_mfma_f32_32x32x16_bf16 v[32:47], a[148:151], v[184:187], v[32:47]
    ds_read_b64_tr_b16 a[132:133], v197 offset:24576
    ds_read_b64_tr_b16 a[134:135], v197 offset:25600
    v_mfma_f32_32x32x16_bf16 v[48:63], a[148:151], v[188:191], v[48:63]
    s_waitcnt lgkmcnt(6)
    v_mfma_f32_32x32x16_bf16 v[64:79], a[152:155], v[184:187], v[64:79]
    ds_read_b64_tr_b16 a[136:137], v198 offset:24576
    ds_read_b64_tr_b16 a[138:139], v198 offset:25600
    v_mfma_f32_32x32x16_bf16 v[80:95], a[152:155], v[188:191], v[80:95]
    s_mov_b32 s37, 0x7000
    s_waitcnt lgkmcnt(6)
    v_mfma_f32_32x32x16_bf16 v[96:111], a[156:159], v[184:187], v[96:111]
    ds_read_b64_tr_b16 a[140:141], v199 offset:24576
    ds_read_b64_tr_b16 a[142:143], v199 offset:25600
    buffer_load_dwordx4 v[176:179], v201, s[16:19], s37 offen offset:2048 sc1
    buffer_load_dwordx4 v[180:183], v202, s[16:19], s37 offen offset:2048 sc1
    v_mfma_f32_32x32x16_bf16 v[112:127], a[156:159], v[188:191], v[112:127]
    s_barrier
    s_waitcnt vmcnt(29) lgkmcnt(6)
    v_mfma_f32_32x32x16_bf16 v[0:15], a[128:131], v[216:219], v[0:15]
    ds_read_b64_tr_b16 a[144:145], v196 offset:28672
    ds_read_b64_tr_b16 a[146:147], v196 offset:29696
    s_add_u32 m0, s25, 0xc000
    s_waitcnt vmcnt(28)
    v_mfma_f32_32x32x16_bf16 v[16:31], a[128:131], v[220:223], v[16:31]
    buffer_load_dwordx4 v204, s[4:7], s26 offen lds
    buffer_load_dwordx4 v205, s[4:7], s26 offen offset:1024 lds
    s_add_u32 s26, s26, 0x2000
    s_waitcnt lgkmcnt(6)
    v_mfma_f32_32x32x16_bf16 v[32:47], a[132:135], v[216:219], v[32:47]
    ds_read_b64_tr_b16 a[148:149], v197 offset:28672
    ds_read_b64_tr_b16 a[150:151], v197 offset:29696
    s_add_u32 m0, s25, 0x14000
    v_mfma_f32_32x32x16_bf16 v[48:63], a[132:135], v[220:223], v[48:63]
    buffer_load_dwordx4 v206, s[8:11], s27 offen lds
    buffer_load_dwordx4 v207, s[8:11], s27 offen offset:1024 lds
    s_add_u32 s27, s27, 0x2000
    s_waitcnt lgkmcnt(6)
    v_mfma_f32_32x32x16_bf16 v[64:79], a[136:139], v[216:219], v[64:79]
    ds_read_b64_tr_b16 a[152:153], v198 offset:28672
    ds_read_b64_tr_b16 a[154:155], v198 offset:29696
    v_mfma_f32_32x32x16_bf16 v[80:95], a[136:139], v[220:223], v[80:95]
    s_mov_b32 s37, 0x7000
    s_waitcnt lgkmcnt(6)
    v_mfma_f32_32x32x16_bf16 v[96:111], a[140:143], v[216:219], v[96:111]
    ds_read_b64_tr_b16 a[156:157], v199 offset:28672
    ds_read_b64_tr_b16 a[158:159], v199 offset:29696
    buffer_load_dwordx4 v[184:187], v201, s[16:19], s37 offen offset:3072 sc1
    buffer_load_dwordx4 v[188:191], v202, s[16:19], s37 offen offset:3072 sc1
    v_mfma_f32_32x32x16_bf16 v[112:127], a[140:143], v[220:223], v[112:127]
    s_waitcnt vmcnt(33) lgkmcnt(6)
    v_mfma_f32_32x32x16_bf16 v[0:15], a[144:147], v[224:227], v[0:15]
    ds_read_b64_tr_b16 a[128:129], v196 offset:32768
    ds_read_b64_tr_b16 a[130:131], v196 offset:33792
    s_waitcnt vmcnt(32)
    v_mfma_f32_32x32x16_bf16 v[16:31], a[144:147], v[228:231], v[16:31]
    s_waitcnt lgkmcnt(6)
    v_mfma_f32_32x32x16_bf16 v[32:47], a[148:151], v[224:227], v[32:47]
    ds_read_b64_tr_b16 a[132:133], v197 offset:32768
    ds_read_b64_tr_b16 a[134:135], v197 offset:33792
    v_mfma_f32_32x32x16_bf16 v[48:63], a[148:151], v[228:231], v[48:63]
    s_waitcnt lgkmcnt(6)
    v_mfma_f32_32x32x16_bf16 v[64:79], a[152:155], v[224:227], v[64:79]
    ds_read_b64_tr_b16 a[136:137], v198 offset:32768
    ds_read_b64_tr_b16 a[138:139], v198 offset:33792
    v_mfma_f32_32x32x16_bf16 v[80:95], a[152:155], v[228:231], v[80:95]
    s_waitcnt lgkmcnt(6)
    v_mfma_f32_32x32x16_bf16 v[96:111], a[156:159], v[224:227], v[96:111]
    ds_read_b64_tr_b16 a[140:141], v199 offset:32768
    ds_read_b64_tr_b16 a[142:143], v199 offset:33792
    v_mfma_f32_32x32x16_bf16 v[112:127], a[156:159], v[228:231], v[112:127]
    s_waitcnt vmcnt(31) lgkmcnt(6)
    v_mfma_f32_32x32x16_bf16 v[0:15], a[128:131], v[232:235], v[0:15]
    ds_read_b64_tr_b16 a[144:145], v196 offset:36864
    ds_read_b64_tr_b16 a[146:147], v196 offset:37888
    s_waitcnt vmcnt(30)
    v_mfma_f32_32x32x16_bf16 v[16:31], a[128:131], v[236:239], v[16:31]
    global_load_dword v211, v214, s[34:35] offset:0 sc1
    s_waitcnt lgkmcnt(6)
    v_mfma_f32_32x32x16_bf16 v[32:47], a[132:135], v[232:235], v[32:47]
    ds_read_b64_tr_b16 a[148:149], v197 offset:36864
    ds_read_b64_tr_b16 a[150:151], v197 offset:37888
    v_mfma_f32_32x32x16_bf16 v[48:63], a[132:135], v[236:239], v[48:63]
    global_load_dword v212, v214, s[34:35] offset:256 sc1
    s_waitcnt lgkmcnt(6)
    v_mfma_f32_32x32x16_bf16 v[64:79], a[136:139], v[232:235], v[64:79]
    ds_read_b64_tr_b16 a[152:153], v198 offset:36864
    ds_read_b64_tr_b16 a[154:155], v198 offset:37888
    v_mfma_f32_32x32x16_bf16 v[80:95], a[136:139], v[236:239], v[80:95]
    global_load_dword v213, v214, s[34:35] offset:512 sc1
    v_mov_b32 v209, 0
    s_waitcnt lgkmcnt(6)
    v_mfma_f32_32x32x16_bf16 v[96:111], a[140:143], v[232:235], v[96:111]
    ds_read_b64_tr_b16 a[156:157], v199 offset:36864
    ds_read_b64_tr_b16 a[158:159], v199 offset:37888
    v_mfma_f32_32x32x16_bf16 v[112:127], a[140:143], v[236:239], v[112:127]
    global_load_dword v210, v209, s[48:49] sc1
    s_waitcnt vmcnt(29) lgkmcnt(6)
    v_mfma_f32_32x32x16_bf16 v[0:15], a[144:147], v[240:243], v[0:15]
    ds_read_b64_tr_b16 a[128:129], v192 offset:57344
    ds_read_b64_tr_b16 a[130:131], v192 offset:58368
    s_waitcnt vmcnt(28)
    v_mfma_f32_32x32x16_bf16 v[16:31], a[144:147], v[244:247], v[16:31]
    s_waitcnt lgkmcnt(6)
    v_mfma_f32_32x32x16_bf16 v[32:47], a[148:151], v[240:243], v[32:47]
    ds_read_b64_tr_b16 a[132:133], v193 offset:57344
    ds_read_b64_tr_b16 a[134:135], v193 offset:58368
    v_mfma_f32_32x32x16_bf16 v[48:63], a[148:151], v[244:247], v[48:63]
    s_waitcnt lgkmcnt(6)
    v_mfma_f32_32x32x16_bf16 v[64:79], a[152:155], v[240:243], v[64:79]
    ds_read_b64_tr_b16 a[136:137], v194 offset:57344
    ds_read_b64_tr_b16 a[138:139], v194 offset:58368
    v_mfma_f32_32x32x16_bf16 v[80:95], a[152:155], v[244:247], v[80:95]
    s_waitcnt lgkmcnt(6)
    v_mfma_f32_32x32x16_bf16 v[96:111], a[156:159], v[240:243], v[96:111]
    ds_read_b64_tr_b16 a[140:141], v195 offset:57344
    ds_read_b64_tr_b16 a[142:143], v195 offset:58368
    v_mfma_f32_32x32x16_bf16 v[112:127], a[156:159], v[244:247], v[112:127]
    s_barrier
    s_waitcnt vmcnt(27) lgkmcnt(6)
    v_mfma_f32_32x32x16_bf16 v[0:15], a[128:131], v[128:131], v[0:15]
    ds_read_b64_tr_b16 a[144:145], v192 offset:61440
    ds_read_b64_tr_b16 a[146:147], v192 offset:62464
    s_add_u32 m0, s25, 0x16000
    s_waitcnt vmcnt(26)
    v_mfma_f32_32x32x16_bf16 v[16:31], a[128:131], v[132:135], v[16:31]
    buffer_load_dwordx4 v206, s[8:11], s27 offen lds
    buffer_load_dwordx4 v207, s[8:11], s27 offen offset:1024 lds
    s_add_u32 s27, s27, 0x2000
    s_waitcnt lgkmcnt(6)
    v_mfma_f32_32x32x16_bf16 v[32:47], a[132:135], v[128:131], v[32:47]
    ds_read_b64_tr_b16 a[148:149], v193 offset:61440
    ds_read_b64_tr_b16 a[150:151], v193 offset:62464
    s_add_u32 m0, s25, 0x18000
    v_mfma_f32_32x32x16_bf16 v[48:63], a[132:135], v[132:135], v[48:63]
    buffer_load_dwordx4 v206, s[8:11], s27 offen lds
    buffer_load_dwordx4 v207, s[8:11], s27 offen offset:1024 lds
    s_add_u32 s27, s27, 0x2000
    s_waitcnt lgkmcnt(6)
    v_mfma_f32_32x32x16_bf16 v[64:79], a[136:139], v[128:131], v[64:79]
    ds_read_b64_tr_b16 a[152:153], v194 offset:61440
    ds_read_b64_tr_b16 a[154:155], v194 offset:62464
    v_mfma_f32_32x32x16_bf16 v[80:95], a[136:139], v[132:135], v[80:95]
    s_waitcnt lgkmcnt(6)
    v_mfma_f32_32x32x16_bf16 v[96:111], a[140:143], v[128:131], v[96:111]
    ds_read_b64_tr_b16 a[156:157], v195 offset:61440
    ds_read_b64_tr_b16 a[158:159], v195 offset:62464
    v_mfma_f32_32x32x16_bf16 v[112:127], a[140:143], v[132:135], v[112:127]
    s_waitcnt vmcnt(29) lgkmcnt(6)
    v_mfma_f32_32x32x16_bf16 v[0:15], a[144:147], v[136:139], v[0:15]
    ds_read_b64_tr_b16 a[128:129], v196 offset:40960
    ds_read_b64_tr_b16 a[130:131], v196 offset:41984
    s_waitcnt vmcnt(28)
    v_mfma_f32_32x32x16_bf16 v[16:31], a[144:147], v[140:143], v[16:31]
    s_waitcnt lgkmcnt(6)
    v_mfma_f32_32x32x16_bf16 v[32:47], a[148:151], v[136:139], v[32:47]
    ds_read_b64_tr_b16 a[132:133], v197 offset:40960
    ds_read_b64_tr_b16 a[134:135], v197 offset:41984
    v_mfma_f32_32x32x16_bf16 v[48:63], a[148:151], v[140:143], v[48:63]
    s_waitcnt lgkmcnt(6)
    v_mfma_f32_32x32x16_bf16 v[64:79], a[152:155], v[136:139], v[64:79]
    ds_read_b64_tr_b16 a[136:137], v198 offset:40960
    ds_read_b64_tr_b16 a[138:139], v198 offset:41984
    v_mfma_f32_32x32x16_bf16 v[80:95], a[152:155], v[140:143], v[80:95]
    s_waitcnt lgkmcnt(6)
    v_mfma_f32_32x32x16_bf16 v[96:111], a[156:159], v[136:139], v[96:111]
    ds_read_b64_tr_b16 a[140:141], v199 offset:40960
    ds_read_b64_tr_b16 a[142:143], v199 offset:41984
    v_mfma_f32_32x32x16_bf16 v[112:127], a[156:159], v[140:143], v[112:127]
    s_waitcnt vmcnt(27) lgkmcnt(6)
    v_mfma_f32_32x32x16_bf16 v[0:15], a[128:131], v[144:147], v[0:15]
    ds_read_b64_tr_b16 a[144:145], v196 offset:45056
    ds_read_b64_tr_b16 a[146:147], v196 offset:46080
    s_waitcnt vmcnt(26)
    v_mfma_f32_32x32x16_bf16 v[16:31], a[128:131], v[148:151], v[16:31]
    s_waitcnt lgkmcnt(6)
    v_mfma_f32_32x32x16_bf16 v[32:47], a[132:135], v[144:147], v[32:47]
    ds_read_b64_tr_b16 a[148:149], v197 offset:45056
    ds_read_b64_tr_b16 a[150:151], v197 offset:46080
    v_mfma_f32_32x32x16_bf16 v[48:63], a[132:135], v[148:151], v[48:63]
    s_waitcnt lgkmcnt(6)
    v_mfma_f32_32x32x16_bf16 v[64:79], a[136:139], v[144:147], v[64:79]
    ds_read_b64_tr_b16 a[152:153], v198 offset:45056
    ds_read_b64_tr_b16 a[154:155], v198 offset:46080
    v_mfma_f32_32x32x16_bf16 v[80:95], a[136:139], v[148:151], v[80:95]
    s_waitcnt lgkmcnt(6)
    v_mfma_f32_32x32x16_bf16 v[96:111], a[140:143], v[144:147], v[96:111]
    ds_read_b64_tr_b16 a[156:157], v199 offset:45056
    ds_read_b64_tr_b16 a[158:159], v199 offset:46080
    v_mfma_f32_32x32x16_bf16 v[112:127], a[140:143], v[148:151], v[112:127]
    s_waitcnt vmcnt(21) lgkmcnt(6)
    v_mfma_f32_32x32x16_bf16 v[0:15], a[144:147], v[152:155], v[0:15]
    ds_read_b64_tr_b16 a[128:129], v196 offset:49152
    ds_read_b64_tr_b16 a[130:131], v196 offset:50176
    s_waitcnt vmcnt(20)
    v_mfma_f32_32x32x16_bf16 v[16:31], a[144:147], v[156:159], v[16:31]
    s_waitcnt lgkmcnt(6)
    v_mfma_f32_32x32x16_bf16 v[32:47], a[148:151], v[152:155], v[32:47]
    ds_read_b64_tr_b16 a[132:133], v197 offset:49152
    ds_read_b64_tr_b16 a[134:135], v197 offset:50176
    v_mfma_f32_32x32x16_bf16 v[48:63], a[148:151], v[156:159], v[48:63]
    s_waitcnt lgkmcnt(6)
    v_mfma_f32_32x32x16_bf16 v[64:79], a[152:155], v[152:155], v[64:79]
    ds_read_b64_tr_b16 a[136:137], v198 offset:49152
    ds_read_b64_tr_b16 a[138:139], v198 offset:50176
    v_mfma_f32_32x32x16_bf16 v[80:95], a[152:155], v[156:159], v[80:95]
    s_waitcnt lgkmcnt(6)
    v_mfma_f32_32x32x16_bf16 v[96:111], a[156:159], v[152:155], v[96:111]
    ds_read_b64_tr_b16 a[140:141], v199 offset:49152
    ds_read_b64_tr_b16 a[142:143], v199 offset:50176
    v_mfma_f32_32x32x16_bf16 v[112:127], a[156:159], v[156:159], v[112:127]
    s_waitcnt vmcnt(19) lgkmcnt(6)
    v_mfma_f32_32x32x16_bf16 v[0:15], a[128:131], v[160:163], v[0:15]
    ds_read_b64_tr_b16 a[144:145], v196 offset:53248
    ds_read_b64_tr_b16 a[146:147], v196 offset:54272
    s_waitcnt vmcnt(18)
    v_mfma_f32_32x32x16_bf16 v[16:31], a[128:131], v[164:167], v[16:31]
    s_waitcnt lgkmcnt(6)
    v_mfma_f32_32x32x16_bf16 v[32:47], a[132:135], v[160:163], v[32:47]
    ds_read_b64_tr_b16 a[148:149], v197 offset:53248
    ds_read_b64_tr_b16 a[150:151], v197 offset:54272
    v_mfma_f32_32x32x16_bf16 v[48:63], a[132:135], v[164:167], v[48:63]
    s_waitcnt lgkmcnt(6)
    v_mfma_f32_32x32x16_bf16 v[64:79], a[136:139], v[160:163], v[64:79]
    ds_read_b64_tr_b16 a[152:153], v198 offset:53248
    ds_read_b64_tr_b16 a[154:155], v198 offset:54272
    v_mfma_f32_32x32x16_bf16 v[80:95], a[136:139], v[164:167], v[80:95]
    s_waitcnt lgkmcnt(6)
    v_mfma_f32_32x32x16_bf16 v[96:111], a[140:143], v[160:163], v[96:111]
    ds_read_b64_tr_b16 a[156:157], v199 offset:53248
    ds_read_b64_tr_b16 a[158:159], v199 offset:54272
    v_mfma_f32_32x32x16_bf16 v[112:127], a[140:143], v[164:167], v[112:127]
    s_waitcnt vmcnt(17) lgkmcnt(6)
    v_mfma_f32_32x32x16_bf16 v[0:15], a[144:147], v[168:171], v[0:15]
    ds_read_b64_tr_b16 a[128:129], v196 offset:57344
    ds_read_b64_tr_b16 a[130:131], v196 offset:58368
    s_waitcnt vmcnt(16)
    v_mfma_f32_32x32x16_bf16 v[16:31], a[144:147], v[172:175], v[16:31]
    s_waitcnt lgkmcnt(6)
    v_mfma_f32_32x32x16_bf16 v[32:47], a[148:151], v[168:171], v[32:47]
    ds_read_b64_tr_b16 a[132:133], v197 offset:57344
    ds_read_b64_tr_b16 a[134:135], v197 offset:58368
    v_mfma_f32_32x32x16_bf16 v[48:63], a[148:151], v[172:175], v[48:63]
    s_waitcnt lgkmcnt(6)
    v_mfma_f32_32x32x16_bf16 v[64:79], a[152:155], v[168:171], v[64:79]
    ds_read_b64_tr_b16 a[136:137], v198 offset:57344
    ds_read_b64_tr_b16 a[138:139], v198 offset:58368
    v_mfma_f32_32x32x16_bf16 v[80:95], a[152:155], v[172:175], v[80:95]
    s_waitcnt lgkmcnt(6)
    v_mfma_f32_32x32x16_bf16 v[96:111], a[156:159], v[168:171], v[96:111]
    ds_read_b64_tr_b16 a[140:141], v199 offset:57344
    ds_read_b64_tr_b16 a[142:143], v199 offset:58368
    v_mfma_f32_32x32x16_bf16 v[112:127], a[156:159], v[172:175], v[112:127]
    s_waitcnt vmcnt(15) lgkmcnt(6)
    v_mfma_f32_32x32x16_bf16 v[0:15], a[128:131], v[176:179], v[0:15]
    ds_read_b64_tr_b16 a[144:145], v196 offset:61440
    ds_read_b64_tr_b16 a[146:147], v196 offset:62464
    s_waitcnt vmcnt(14)
    v_mfma_f32_32x32x16_bf16 v[16:31], a[128:131], v[180:183], v[16:31]
    s_waitcnt lgkmcnt(6)
    v_mfma_f32_32x32x16_bf16 v[32:47], a[132:135], v[176:179], v[32:47]
    ds_read_b64_tr_b16 a[148:149], v197 offset:61440
    ds_read_b64_tr_b16 a[150:151], v197 offset:62464
    v_mfma_f32_32x32x16_bf16 v[48:63], a[132:135], v[180:183], v[48:63]
    s_waitcnt lgkmcnt(6)
    v_mfma_f32_32x32x16_bf16 v[64:79], a[136:139], v[176:179], v[64:79]
    ds_read_b64_tr_b16 a[152:153], v198 offset:61440
    ds_read_b64_tr_b16 a[154:155], v198 offset:62464
    v_mfma_f32_32x32x16_bf16 v[80:95], a[136:139], v[180:183], v[80:95]
    s_waitcnt lgkmcnt(6)
    v_mfma_f32_32x32x16_bf16 v[96:111], a[140:143], v[176:179], v[96:111]
    ds_read_b64_tr_b16 a[156:157], v199 offset:61440
    ds_read_b64_tr_b16 a[158:159], v199 offset:62464
    v_mfma_f32_32x32x16_bf16 v[112:127], a[140:143], v[180:183], v[112:127]
    s_waitcnt vmcnt(9) lgkmcnt(6)
    v_mfma_f32_32x32x16_bf16 v[0:15], a[144:147], v[184:187], v[0:15]
    s_waitcnt vmcnt(8)
    v_mfma_f32_32x32x16_bf16 v[16:31], a[144:147], v[188:191], v[16:31]
    s_waitcnt lgkmcnt(4)
    v_mfma_f32_32x32x16_bf16 v[32:47], a[148:151], v[184:187], v[32:47]
    v_mfma_f32_32x32x16_bf16 v[48:63], a[148:151], v[188:191], v[48:63]
    s_waitcnt lgkmcnt(2)
    v_mfma_f32_32x32x16_bf16 v[64:79], a[152:155], v[184:187], v[64:79]
    v_mfma_f32_32x32x16_bf16 v[80:95], a[152:155], v[188:191], v[80:95]
    s_waitcnt lgkmcnt(0)
    v_mfma_f32_32x32x16_bf16 v[96:111], a[156:159], v[184:187], v[96:111]
    v_mfma_f32_32x32x16_bf16 v[112:127], a[156:159], v[188:191], v[112:127]
    v_mbcnt_lo_u32_b32 v248, -1, 0
    v_mbcnt_hi_u32_b32 v248, -1, v248
    v_and_b32 v249, 15, v248
    v_lshrrev_b32 v250, 4, v248
    v_lshlrev_b32 v251, 8, v249
    v_add_u32 v252, 0, v250
    v_xor_b32 v252, v252, v249
    v_lshl_add_u32 v192, v252, 4, v251
    v_add_u32 v252, 4, v250
    v_xor_b32 v252, v252, v249
    v_lshl_add_u32 v193, v252, 4, v251
    v_add_u32 v252, 8, v250
    v_xor_b32 v252, v252, v249
    v_lshl_add_u32 v194, v252, 4, v251
    v_add_u32 v252, 12, v250
    v_xor_b32 v252, v252, v249
    v_lshl_add_u32 v195, v252, 4, v251
    v_lshrrev_b32 v251, 2, v249
    v_and_b32 v249, 3, v249
    v_lshl_add_u32 v252, v250, 2, v251
    v_lshlrev_b32 v252, 8, v252
    v_and_b32 v253, 1, v249
    v_lshl_add_u32 v252, v253, 3, v252
    v_add_u32 v252, 0x10000, v252
    v_lshlrev_b32 v251, 2, v251
    v_and_b32 v250, 1, v250
    v_lshlrev_b32 v250, 1, v250
    v_xor_b32 v251, v251, v250
    v_lshrrev_b32 v249, 1, v249
    v_add_u32 v253, 0, v249
    v_xor_b32 v253, v253, v251
    v_lshl_add_u32 v196, v253, 4, v252
    v_add_u32 v253, 2, v249
    v_xor_b32 v253, v253, v251
    v_lshl_add_u32 v197, v253, 4, v252
    v_add_u32 v253, 4, v249
    v_xor_b32 v253, v253, v251
    v_lshl_add_u32 v198, v253, 4, v252
    v_add_u32 v253, 6, v249
    v_xor_b32 v253, v253, v251
    v_lshl_add_u32 v199, v253, 4, v252
    v_add_u32 v253, 8, v249
    v_xor_b32 v253, v253, v251
    v_lshl_add_u32 v200, v253, 4, v252
    v_add_u32 v253, 10, v249
    v_xor_b32 v253, v253, v251
    v_lshl_add_u32 v201, v253, 4, v252
    v_add_u32 v253, 12, v249
    v_xor_b32 v253, v253, v251
    v_lshl_add_u32 v202, v253, 4, v252
    v_add_u32 v253, 14, v249
    v_xor_b32 v253, v253, v251
    v_lshl_add_u32 v203, v253, 4, v252
    s_nop 7
    v_cvt_pk_bf16_f32 v128, v0, v1
    v_cvt_pk_bf16_f32 v144, v8, v9
    v_cvt_pk_bf16_f32 v129, v2, v3
    v_cvt_pk_bf16_f32 v145, v10, v11
    v_cvt_pk_bf16_f32 v130, v4, v5
    v_cvt_pk_bf16_f32 v146, v12, v13
    v_cvt_pk_bf16_f32 v131, v6, v7
    v_cvt_pk_bf16_f32 v147, v14, v15
    v_permlane32_swap_b32 v128, v144
    v_permlane32_swap_b32 v129, v145
    v_permlane32_swap_b32 v130, v146
    v_permlane32_swap_b32 v131, v147
    v_permlane16_swap_b32 v128, v144
    v_permlane16_swap_b32 v129, v145
    v_permlane16_swap_b32 v130, v146
    v_permlane16_swap_b32 v131, v147
    v_cvt_pk_bf16_f32 v132, v32, v33
    v_cvt_pk_bf16_f32 v148, v40, v41
    v_cvt_pk_bf16_f32 v133, v34, v35
    v_cvt_pk_bf16_f32 v149, v42, v43
    v_cvt_pk_bf16_f32 v134, v36, v37
    v_cvt_pk_bf16_f32 v150, v44, v45
    v_cvt_pk_bf16_f32 v135, v38, v39
    v_cvt_pk_bf16_f32 v151, v46, v47
    v_permlane32_swap_b32 v132, v148
    v_permlane32_swap_b32 v133, v149
    v_permlane32_swap_b32 v134, v150
    v_permlane32_swap_b32 v135, v151
    v_permlane16_swap_b32 v132, v148
    v_permlane16_swap_b32 v133, v149
    v_permlane16_swap_b32 v134, v150
    v_permlane16_swap_b32 v135, v151
    v_cvt_pk_bf16_f32 v136, v64, v65
    v_cvt_pk_bf16_f32 v152, v72, v73
    v_cvt_pk_bf16_f32 v137, v66, v67
    v_cvt_pk_bf16_f32 v153, v74, v75
    v_cvt_pk_bf16_f32 v138, v68, v69
    v_cvt_pk_bf16_f32 v154, v76, v77
    v_cvt_pk_bf16_f32 v139, v70, v71
    v_cvt_pk_bf16_f32 v155, v78, v79
    v_permlane32_swap_b32 v136, v152
    v_permlane32_swap_b32 v137, v153
    v_permlane32_swap_b32 v138, v154
    v_permlane32_swap_b32 v139, v155
    v_permlane16_swap_b32 v136, v152
    v_permlane16_swap_b32 v137, v153
    v_permlane16_swap_b32 v138, v154
    v_permlane16_swap_b32 v139, v155
    v_cvt_pk_bf16_f32 v140, v96, v97
    v_cvt_pk_bf16_f32 v156, v104, v105
    v_cvt_pk_bf16_f32 v141, v98, v99
    v_cvt_pk_bf16_f32 v157, v106, v107
    v_cvt_pk_bf16_f32 v142, v100, v101
    v_cvt_pk_bf16_f32 v158, v108, v109
    v_cvt_pk_bf16_f32 v143, v102, v103
    v_cvt_pk_bf16_f32 v159, v110, v111
    v_permlane32_swap_b32 v140, v156
    v_permlane32_swap_b32 v141, v157
    v_permlane32_swap_b32 v142, v158
    v_permlane32_swap_b32 v143, v159
    v_permlane16_swap_b32 v140, v156
    v_permlane16_swap_b32 v141, v157
    v_permlane16_swap_b32 v142, v158
    v_permlane16_swap_b32 v143, v159
    v_cvt_pk_bf16_f32 v160, v16, v17
    v_cvt_pk_bf16_f32 v176, v24, v25
    v_cvt_pk_bf16_f32 v161, v18, v19
    v_cvt_pk_bf16_f32 v177, v26, v27
    v_cvt_pk_bf16_f32 v162, v20, v21
    v_cvt_pk_bf16_f32 v178, v28, v29
    v_cvt_pk_bf16_f32 v163, v22, v23
    v_cvt_pk_bf16_f32 v179, v30, v31
    v_permlane32_swap_b32 v160, v176
    v_permlane32_swap_b32 v161, v177
    v_permlane32_swap_b32 v162, v178
    v_permlane32_swap_b32 v163, v179
    v_permlane16_swap_b32 v160, v176
    v_permlane16_swap_b32 v161, v177
    v_permlane16_swap_b32 v162, v178
    v_permlane16_swap_b32 v163, v179
    v_cvt_pk_bf16_f32 v164, v48, v49
    v_cvt_pk_bf16_f32 v180, v56, v57
    v_cvt_pk_bf16_f32 v165, v50, v51
    v_cvt_pk_bf16_f32 v181, v58, v59
    v_cvt_pk_bf16_f32 v166, v52, v53
    v_cvt_pk_bf16_f32 v182, v60, v61
    v_cvt_pk_bf16_f32 v167, v54, v55
    v_cvt_pk_bf16_f32 v183, v62, v63
    v_permlane32_swap_b32 v164, v180
    v_permlane32_swap_b32 v165, v181
    v_permlane32_swap_b32 v166, v182
    v_permlane32_swap_b32 v167, v183
    v_permlane16_swap_b32 v164, v180
    v_permlane16_swap_b32 v165, v181
    v_permlane16_swap_b32 v166, v182
    v_permlane16_swap_b32 v167, v183
    v_cvt_pk_bf16_f32 v168, v80, v81
    v_cvt_pk_bf16_f32 v184, v88, v89
    v_cvt_pk_bf16_f32 v169, v82, v83
    v_cvt_pk_bf16_f32 v185, v90, v91
    v_cvt_pk_bf16_f32 v170, v84, v85
    v_cvt_pk_bf16_f32 v186, v92, v93
    v_cvt_pk_bf16_f32 v171, v86, v87
    v_cvt_pk_bf16_f32 v187, v94, v95
    v_permlane32_swap_b32 v168, v184
    v_permlane32_swap_b32 v169, v185
    v_permlane32_swap_b32 v170, v186
    v_permlane32_swap_b32 v171, v187
    v_permlane16_swap_b32 v168, v184
    v_permlane16_swap_b32 v169, v185
    v_permlane16_swap_b32 v170, v186
    v_permlane16_swap_b32 v171, v187
    v_cvt_pk_bf16_f32 v172, v112, v113
    v_cvt_pk_bf16_f32 v188, v120, v121
    v_cvt_pk_bf16_f32 v173, v114, v115
    v_cvt_pk_bf16_f32 v189, v122, v123
    v_cvt_pk_bf16_f32 v174, v116, v117
    v_cvt_pk_bf16_f32 v190, v124, v125
    v_cvt_pk_bf16_f32 v175, v118, v119
    v_cvt_pk_bf16_f32 v191, v126, v127
    v_permlane32_swap_b32 v172, v188
    v_permlane32_swap_b32 v173, v189
    v_permlane32_swap_b32 v174, v190
    v_permlane32_swap_b32 v175, v191
    v_permlane16_swap_b32 v172, v188
    v_permlane16_swap_b32 v173, v189
    v_permlane16_swap_b32 v174, v190
    v_permlane16_swap_b32 v175, v191
    v_mov_b32 v248, 0x3f803f80
    v_accvgpr_write_b32 a216, v248
    v_accvgpr_write_b32 a217, v248
    v_accvgpr_write_b32 a218, v248
    v_accvgpr_write_b32 a219, v248
    s_waitcnt vmcnt(0)
    s_cmp_lg_u32 s24, 0
    s_cbranch_scc1 modok
    v_cmp_ne_u32 vcc, s33, v211
    v_cmp_ne_u32 s[42:43], s33, v212
    s_or_b64 vcc, vcc, s[42:43]
    v_cmp_ne_u32 s[42:43], s33, v213
    s_or_b64 vcc, vcc, s[42:43]
    s_cmp_eq_u64 vcc, 0
    s_cbranch_scc1 modok
    s_cmp_lg_u32 s24, 0
    s_cbranch_scc1 pskip_p0m_7
    s_mov_b32 s47, 400000
ploop_p0m_7:
    global_load_dword v211, v214, s[34:35] offset:0 sc1
    global_load_dword v212, v214, s[34:35] offset:256 sc1
    global_load_dword v213, v214, s[34:35] offset:512 sc1
    s_waitcnt vmcnt(0)
    v_cmp_ne_u32 vcc, s33, v211
    v_cmp_ne_u32 s[42:43], s33, v212
    s_or_b64 vcc, vcc, s[42:43]
    v_cmp_ne_u32 s[42:43], s33, v213
    s_or_b64 vcc, vcc, s[42:43]
    s_cmp_eq_u64 vcc, 0
    s_cbranch_scc1 pskip_p0m_7
    s_sub_u32 s47, s47, 1
    s_cmp_lg_u32 s47, 0
    s_cbranch_scc1 ploop_p0m_7
pskip_p0m_7:
modok:
    v_readfirstlane_b32 s33, v210
    s_barrier
    s_mul_hi_u32 s36, s2, 0x4924925
    s_mul_i32 s37, s36, 56
    s_sub_u32 s37, s2, s37
    s_cmp_ge_u32 s37, 28
    s_cselect_b32 s38, 1, 0
    s_mul_i32 s40, s38, 28
    s_sub_u32 s40, s37, s40
    v_mbcnt_lo_u32_b32 v248, -1, 0
    v_mbcnt_hi_u32_b32 v248, -1, v248
    s_lshl_b32 s41, s36, 7
    s_lshl_b32 s42, s24, 5
    s_add_u32 s41, s41, s42
    v_lshrrev_b32 v249, 3, v248
    v_add_u32 v249, s41, v249
    v_and_b32 v248, 7, v248
    s_mov_b32 s41, 3584
    v_mul_lo_u32 v250, v249, s41
    s_lshl_b32 s41, s40, 7
    v_lshl_add_u32 v250, v248, 4, v250
    v_add_u32 v250, s41, v250
    v_lshlrev_b32 v251, 2, v249
    s_cmp_eq_u32 s38, 0
    s_cselect_b32 s20, s56, s58
    s_cselect_b32 s21, s57, s59
    s_and_b32 s21, s21, 0xffff
    s_cmp_lt_u32 s2, 224
    s_cselect_b32 s22, 1835008, 0
    s_mov_b32 s23, 0x00020000
    s_add_u32 s12, s34, 0
    s_addc_u32 s13, s35, 0
    s_and_b32 s13, s13, 0xffff
    s_mov_b32 s14, 49152
    s_mov_b32 s15, 0x00020000
    s_cmp_ge_u32 s65, 184
    s_cbranch_scc1 fn_hot_8
    s_cmp_lg_u32 s24, 0
    s_cbranch_scc1 fn_hot_8
    s_lshl_b32 s40, s65, 2
    s_add_u32 s40, s40, 0x3005000
    v_mov_b32 v248, s33
    v_mov_b32 v249, s40
    s_mov_b64 exec, 1
    global_store_dword v249, v248, s[34:35] sc1
    s_mov_b64 exec, -1
fn_hot_8:
    s_cmp_eq_u32 s24, 1
    s_cselect_b32 s40, s60, s52
    s_cselect_b32 s41, s61, s53
    s_cmp_eq_u32 s24, 2
    s_cselect_b32 s40, s56, s40
    s_cselect_b32 s41, s57, s41
    s_cmp_eq_u32 s24, 3
    s_cselect_b32 s40, s58, s40
    s_cselect_b32 s41, s59, s41
    s_and_b32 s41, s41, 0xffff
    s_mov_b32 s43, 0x00020000
    s_cmp_eq_u32 s24, 0
    s_mov_b32 s63, 0x1c0000
    s_cselect_b32 s42, 0x400000, s63
    s_mov_b32 s63, 7168
    s_cselect_b32 s63, 16384, s63
    s_mul_i32 s63, s63, s2
    v_mbcnt_lo_u32_b32 v236, -1, 0
    v_mbcnt_hi_u32_b32 v236, -1, v236
    v_lshrrev_b32 v236, 4, v236
    v_lshlrev_b32 v236, 7, v236
    ds_read_b128 a[128:131], v192 offset:0
    ds_read_b128 a[132:135], v193 offset:0
    ds_read_b128 a[136:139], v194 offset:0
    ds_read_b128 a[140:143], v195 offset:0
    s_waitcnt lgkmcnt(3)
    v_mfma_f32_16x16x32_bf16 v[0:3], a[128:131], v[128:131], 0
    v_mfma_f32_16x16x32_bf16 v[8:11], a[128:131], v[144:147], 0
    v_mfma_f32_16x16x32_bf16 v[16:19], a[128:131], v[160:163], 0
    ds_read_b128 a[144:147], v192 offset:4096
    v_mfma_f32_16x16x32_bf16 v[24:27], a[128:131], v[176:179], 0
    s_waitcnt lgkmcnt(3)
    v_mfma_f32_16x16x32_bf16 v[0:3], a[132:135], v[132:135], v[0:3]
    v_mfma_f32_16x16x32_bf16 v[8:11], a[132:135], v[148:151], v[8:11]
    v_mfma_f32_16x16x32_bf16 v[16:19], a[132:135], v[164:167], v[16:19]
    ds_read_b128 a[148:151], v193 offset:4096
    v_mfma_f32_16x16x32_bf16 v[24:27], a[132:135], v[180:183], v[24:27]
    s_waitcnt lgkmcnt(3)
    v_mfma_f32_16x16x32_bf16 v[0:3], a[136:139], v[136:139], v[0:3]
    v_mfma_f32_16x16x32_bf16 v[8:11], a[136:139], v[152:155], v[8:11]
    v_mfma_f32_16x16x32_bf16 v[16:19], a[136:139], v[168:171], v[16:19]
    ds_read_b128 a[152:155], v194 offset:4096
    v_mfma_f32_16x16x32_bf16 v[24:27], a[136:139], v[184:187], v[24:27]
    s_waitcnt lgkmcnt(3)
    v_mfma_f32_16x16x32_bf16 v[0:3], a[140:143], v[140:143], v[0:3]
    v_mfma_f32_16x16x32_bf16 v[8:11], a[140:143], v[156:159], v[8:11]
    v_mfma_f32_16x16x32_bf16 v[16:19], a[140:143], v[172:175], v[16:19]
    ds_read_b128 a[156:159], v195 offset:4096
    v_mfma_f32_16x16x32_bf16 v[24:27], a[140:143], v[188:191], v[24:27]
    s_waitcnt lgkmcnt(3)
    v_mfma_f32_16x16x32_bf16 v[4:7], a[144:147], v[128:131], 0
    v_mfma_f32_16x16x32_bf16 v[12:15], a[144:147], v[144:147], 0
    v_mfma_f32_16x16x32_bf16 v[20:23], a[144:147], v[160:163], 0
    v_mfma_f32_16x16x32_bf16 v[28:31], a[144:147], v[176:179], 0
    s_waitcnt lgkmcnt(2)
    v_mfma_f32_16x16x32_bf16 v[4:7], a[148:151], v[132:135], v[4:7]
    v_mfma_f32_16x16x32_bf16 v[12:15], a[148:151], v[148:151], v[12:15]
    v_mfma_f32_16x16x32_bf16 v[20:23], a[148:151], v[164:167], v[20:23]
    v_mfma_f32_16x16x32_bf16 v[28:31], a[148:151], v[180:183], v[28:31]
    s_waitcnt lgkmcnt(1)
    v_mfma_f32_16x16x32_bf16 v[4:7], a[152:155], v[136:139], v[4:7]
    v_mfma_f32_16x16x32_bf16 v[12:15], a[152:155], v[152:155], v[12:15]
    v_mfma_f32_16x16x32_bf16 v[20:23], a[152:155], v[168:171], v[20:23]
    v_mfma_f32_16x16x32_bf16 v[28:31], a[152:155], v[184:187], v[28:31]
    s_waitcnt lgkmcnt(0)
    v_mfma_f32_16x16x32_bf16 v[4:7], a[156:159], v[140:143], v[4:7]
    v_mfma_f32_16x16x32_bf16 v[12:15], a[156:159], v[156:159], v[12:15]
    v_mfma_f32_16x16x32_bf16 v[20:23], a[156:159], v[172:175], v[20:23]
    v_mfma_f32_16x16x32_bf16 v[28:31], a[156:159], v[188:191], v[28:31]
    ds_read_b128 a[128:131], v192 offset:8192
    ds_read_b128 a[132:135], v193 offset:8192
    ds_read_b128 a[136:139], v194 offset:8192
    ds_read_b128 a[140:143], v195 offset:8192
    s_nop 7
    v_max3_f32 v224, v0, v1, v2
    v_max3_f32 v225, v8, v9, v10
    v_max3_f32 v226, v16, v17, v18
    v_max3_f32 v227, v24, v25, v26
    v_max3_f32 v224, v224, v3, v4
    v_max3_f32 v225, v225, v11, v12
    v_max3_f32 v226, v226, v19, v20
    v_max3_f32 v227, v227, v27, v28
    v_max3_f32 v224, v224, v5, v6
    v_max3_f32 v225, v225, v13, v14
    v_max3_f32 v226, v226, v21, v22
    v_max3_f32 v227, v227, v29, v30
    v_max_f32 v224, v224, v7
    v_max_f32 v225, v225, v15
    v_max_f32 v226, v226, v23
    v_max_f32 v227, v227, v31
    v_mov_b32 v228, v224
    v_mov_b32 v229, v225
    v_mov_b32 v230, v226
    v_mov_b32 v231, v227
    v_permlane32_swap_b32 v228, v224
    v_permlane32_swap_b32 v229, v225
    v_permlane32_swap_b32 v230, v226
    v_permlane32_swap_b32 v231, v227
    v_max_f32 v224, v224, v228
    v_max_f32 v225, v225, v229
    v_max_f32 v226, v226, v230
    v_max_f32 v227, v227, v231
    v_mov_b32 v228, v224
    v_mov_b32 v229, v225
    v_mov_b32 v230, v226
    v_mov_b32 v231, v227
    v_permlane16_swap_b32 v228, v224
    v_permlane16_swap_b32 v229, v225
    v_permlane16_swap_b32 v230, v226
    v_permlane16_swap_b32 v231, v227
    v_max_f32 v224, v224, v228
    v_max_f32 v225, v225, v229
    v_max_f32 v226, v226, v230
    v_max_f32 v227, v227, v231
    v_add_f32 v224, 0x42c80000, v224
    v_add_f32 v225, 0x42c80000, v225
    v_add_f32 v226, 0x42c80000, v226
    v_add_f32 v227, 0x42c80000, v227
    v_sub_f32 v0, v0, v224
    v_sub_f32 v1, v1, v224
    v_sub_f32 v2, v2, v224
    v_sub_f32 v3, v3, v224
    v_sub_f32 v4, v4, v224
    v_sub_f32 v5, v5, v224
    v_sub_f32 v6, v6, v224
    v_sub_f32 v7, v7, v224
    v_sub_f32 v8, v8, v225
    v_sub_f32 v9, v9, v225
    v_sub_f32 v10, v10, v225
    v_sub_f32 v11, v11, v225
    v_sub_f32 v12, v12, v225
    v_sub_f32 v13, v13, v225
    v_sub_f32 v14, v14, v225
    v_sub_f32 v15, v15, v225
    v_sub_f32 v16, v16, v226
    v_sub_f32 v17, v17, v226
    v_sub_f32 v18, v18, v226
    v_sub_f32 v19, v19, v226
    v_sub_f32 v20, v20, v226
    v_sub_f32 v21, v21, v226
    v_sub_f32 v22, v22, v226
    v_sub_f32 v23, v23, v226
    v_sub_f32 v24, v24, v227
    v_sub_f32 v25, v25, v227
    v_sub_f32 v26, v26, v227
    v_sub_f32 v27, v27, v227
    v_sub_f32 v28, v28, v227
    v_sub_f32 v29, v29, v227
    v_sub_f32 v30, v30, v227
    v_sub_f32 v31, v31, v227
    v_sub_f32 v96, 0, v224
    v_mov_b32 v208, 0
    v_sub_f32 v97, 0, v224
    v_mov_b32 v209, 0
    v_sub_f32 v98, 0, v224
    v_mov_b32 v210, 0
    v_sub_f32 v99, 0, v224
    v_mov_b32 v211, 0
    v_sub_f32 v100, 0, v225
    v_mov_b32 v212, 0
    v_sub_f32 v101, 0, v225
    v_mov_b32 v213, 0
    v_sub_f32 v102, 0, v225
    v_mov_b32 v214, 0
    v_sub_f32 v103, 0, v225
    v_mov_b32 v215, 0
    v_sub_f32 v104, 0, v226
    v_mov_b32 v216, 0
    v_sub_f32 v105, 0, v226
    v_mov_b32 v217, 0
    v_sub_f32 v106, 0, v226
    v_mov_b32 v218, 0
    v_sub_f32 v107, 0, v226
    v_mov_b32 v219, 0
    v_sub_f32 v108, 0, v227
    v_mov_b32 v220, 0
    v_sub_f32 v109, 0, v227
    v_mov_b32 v221, 0
    v_sub_f32 v110, 0, v227
    v_mov_b32 v222, 0
    v_sub_f32 v111, 0, v227
    v_mov_b32 v223, 0
    s_waitcnt lgkmcnt(3)
    v_mfma_f32_16x16x32_bf16 v[32:35], a[128:131], v[128:131], v[96:99]
    v_exp_f32 v224, v0
    v_mfma_f32_16x16x32_bf16 v[40:43], a[128:131], v[144:147], v[100:103]
    v_exp_f32 v225, v1
    v_mfma_f32_16x16x32_bf16 v[48:51], a[128:131], v[160:163], v[104:107]
    ds_read_b128 a[144:147], v192 offset:12288
    v_cvt_pk_bf16_f32 v64, v224, v225
    v_mfma_f32_16x16x32_bf16 v[56:59], a[128:131], v[176:179], v[108:111]
    v_exp_f32 v226, v2
    s_waitcnt lgkmcnt(3)
    v_mfma_f32_16x16x32_bf16 v[32:35], a[132:135], v[132:135], v[32:35]
    v_exp_f32 v227, v3
    v_mfma_f32_16x16x32_bf16 v[40:43], a[132:135], v[148:151], v[40:43]
    v_exp_f32 v228, v4
    v_mfma_f32_16x16x32_bf16 v[48:51], a[132:135], v[164:167], v[48:51]
    ds_read_b128 a[148:151], v193 offset:12288
    v_cvt_pk_bf16_f32 v65, v226, v227
    v_mfma_f32_16x16x32_bf16 v[56:59], a[132:135], v[180:183], v[56:59]
    s_waitcnt lgkmcnt(2)
    v_mfma_f32_16x16x32_bf16 v[32:35], a[136:139], v[136:139], v[32:35]
    v_exp_f32 v229, v5
    v_mfma_f32_16x16x32_bf16 v[40:43], a[136:139], v[152:155], v[40:43]
    v_exp_f32 v230, v6
    v_mfma_f32_16x16x32_bf16 v[48:51], a[136:139], v[168:171], v[48:51]
    ds_read_b128 a[152:155], v194 offset:12288
    v_cvt_pk_bf16_f32 v66, v228, v229
    v_mfma_f32_16x16x32_bf16 v[56:59], a[136:139], v[184:187], v[56:59]
    v_exp_f32 v231, v7
    v_mfma_f32_16x16x32_bf16 v[32:35], a[140:143], v[140:143], v[32:35]
    v_exp_f32 v224, v8
    v_mfma_f32_16x16x32_bf16 v[40:43], a[140:143], v[156:159], v[40:43]
    v_exp_f32 v225, v9
    v_mfma_f32_16x16x32_bf16 v[48:51], a[140:143], v[172:175], v[48:51]
    ds_read_b128 a[156:159], v195 offset:12288
    v_cvt_pk_bf16_f32 v67, v230, v231
    v_mfma_f32_16x16x32_bf16 v[56:59], a[140:143], v[188:191], v[56:59]
    v_cvt_pk_bf16_f32 v68, v224, v225
    s_waitcnt lgkmcnt(2)
    v_mfma_f32_16x16x32_bf16 v[112:115], a[216:219], v[64:67], v[208:211]
    v_exp_f32 v226, v10
    v_mfma_f32_16x16x32_bf16 v[36:39], a[144:147], v[128:131], v[96:99]
    v_exp_f32 v227, v11
    v_mfma_f32_16x16x32_bf16 v[44:47], a[144:147], v[144:147], v[100:103]
    v_exp_f32 v228, v12
    v_mfma_f32_16x16x32_bf16 v[52:55], a[144:147], v[160:163], v[104:107]
    v_exp_f32 v229, v13
    v_mfma_f32_16x16x32_bf16 v[60:63], a[144:147], v[176:179], v[108:111]
    v_exp_f32 v230, v14
    v_mfma_f32_16x16x32_bf16 v[36:39], a[148:151], v[132:135], v[36:39]
    v_exp_f32 v231, v15
    v_mfma_f32_16x16x32_bf16 v[44:47], a[148:151], v[148:151], v[44:47]
    v_exp_f32 v224, v16
    v_mfma_f32_16x16x32_bf16 v[52:55], a[148:151], v[164:167], v[52:55]
    v_exp_f32 v225, v17
    v_mfma_f32_16x16x32_bf16 v[60:63], a[148:151], v[180:183], v[60:63]
    v_cvt_pk_bf16_f32 v69, v226, v227
    s_waitcnt lgkmcnt(0)
    v_mfma_f32_16x16x32_bf16 v[36:39], a[152:155], v[136:139], v[36:39]
    v_exp_f32 v226, v18
    v_mfma_f32_16x16x32_bf16 v[44:47], a[152:155], v[152:155], v[44:47]
    v_exp_f32 v227, v19
    v_mfma_f32_16x16x32_bf16 v[52:55], a[152:155], v[168:171], v[52:55]
    v_cvt_pk_bf16_f32 v70, v228, v229
    v_cvt_pk_bf16_f32 v71, v230, v231
    v_mfma_f32_16x16x32_bf16 v[60:63], a[152:155], v[184:187], v[60:63]
    v_exp_f32 v228, v20
    v_mfma_f32_16x16x32_bf16 v[116:119], a[216:219], v[68:71], v[212:215]
    v_exp_f32 v229, v21
    v_mfma_f32_16x16x32_bf16 v[36:39], a[156:159], v[140:143], v[36:39]
    v_exp_f32 v230, v22
    v_mfma_f32_16x16x32_bf16 v[44:47], a[156:159], v[156:159], v[44:47]
    v_exp_f32 v231, v23
    v_mfma_f32_16x16x32_bf16 v[52:55], a[156:159], v[172:175], v[52:55]
    v_cvt_pk_bf16_f32 v72, v224, v225
    v_cvt_pk_bf16_f32 v73, v226, v227
    v_mfma_f32_16x16x32_bf16 v[60:63], a[156:159], v[188:191], v[60:63]
    v_exp_f32 v224, v24
    v_exp_f32 v225, v25
    v_exp_f32 v226, v26
    v_exp_f32 v227, v27
    v_cvt_pk_bf16_f32 v74, v228, v229
    v_cvt_pk_bf16_f32 v75, v230, v231
    v_exp_f32 v228, v28
    v_exp_f32 v229, v29
    v_mfma_f32_16x16x32_bf16 v[120:123], a[216:219], v[72:75], v[216:219]
    v_exp_f32 v230, v30
    v_exp_f32 v231, v31
    v_cvt_pk_bf16_f32 v76, v224, v225
    v_cvt_pk_bf16_f32 v77, v226, v227
    v_cvt_pk_bf16_f32 v78, v228, v229
    v_cvt_pk_bf16_f32 v79, v230, v231
    ds_read_b128 a[128:131], v192 offset:16384
    ds_read_b128 a[132:135], v193 offset:16384
    v_mfma_f32_16x16x32_bf16 v[124:127], a[216:219], v[76:79], v[220:223]
    s_add_u32 m0, s25, 0xe000
    s_nop 0
    buffer_load_dwordx4 v204, s[4:7], s26 offen lds
    buffer_load_dwordx4 v205, s[4:7], s26 offen offset:1024 lds
    s_add_u32 s26, s26, 0x2000
    ds_read_b128 a[136:139], v194 offset:16384
    s_add_u32 m0, s25, 0x1a000
    s_nop 0
    buffer_load_dwordx4 v206, s[8:11], s27 offen lds
    buffer_load_dwordx4 v207, s[8:11], s27 offen offset:1024 lds
    s_add_u32 s27, s27, 0x2000
    ds_read_b128 a[140:143], v195 offset:16384
    s_waitcnt lgkmcnt(2)
    v_max3_f32 v252, v112, v116, v120
    v_max_f32 v252, v252, v124
    v_cmp_lt_f32 vcc, 0x67800000, v252
    s_nop 1
    s_cbranch_vccnz TRAMP_T0
BACK_T0:
    s_mov_b32 s28, 7
attn_loop:
    v_mfma_f32_16x16x32_bf16 v[0:3], a[128:131], v[128:131], v[96:99]
    v_exp_f32 v224, v32
    v_mfma_f32_16x16x32_bf16 v[8:11], a[128:131], v[144:147], v[100:103]
    v_exp_f32 v225, v33
    v_mfma_f32_16x16x32_bf16 v[16:19], a[128:131], v[160:163], v[104:107]
    ds_read_b128 a[144:147], v192 offset:20480
    v_cvt_pk_bf16_f32 v80, v224, v225
    v_mfma_f32_16x16x32_bf16 v[24:27], a[128:131], v[176:179], v[108:111]
    v_exp_f32 v226, v34
    v_mfma_f32_16x16x32_bf16 v[0:3], a[132:135], v[132:135], v[0:3]
    v_exp_f32 v227, v35
    v_mfma_f32_16x16x32_bf16 v[8:11], a[132:135], v[148:151], v[8:11]
    v_exp_f32 v228, v36
    v_mfma_f32_16x16x32_bf16 v[16:19], a[132:135], v[164:167], v[16:19]
    ds_read_b128 a[148:151], v193 offset:20480
    v_cvt_pk_bf16_f32 v81, v226, v227
    v_mfma_f32_16x16x32_bf16 v[24:27], a[132:135], v[180:183], v[24:27]
    s_waitcnt lgkmcnt(2)
    v_mfma_f32_16x16x32_bf16 v[0:3], a[136:139], v[136:139], v[0:3]
    v_exp_f32 v229, v37
    v_mfma_f32_16x16x32_bf16 v[8:11], a[136:139], v[152:155], v[8:11]
    v_exp_f32 v230, v38
    v_mfma_f32_16x16x32_bf16 v[16:19], a[136:139], v[168:171], v[16:19]
    ds_read_b128 a[152:155], v194 offset:20480
    v_cvt_pk_bf16_f32 v82, v228, v229
    v_mfma_f32_16x16x32_bf16 v[24:27], a[136:139], v[184:187], v[24:27]
    v_exp_f32 v231, v39
    v_mfma_f32_16x16x32_bf16 v[0:3], a[140:143], v[140:143], v[0:3]
    v_exp_f32 v224, v40
    v_mfma_f32_16x16x32_bf16 v[8:11], a[140:143], v[156:159], v[8:11]
    v_exp_f32 v225, v41
    v_mfma_f32_16x16x32_bf16 v[16:19], a[140:143], v[172:175], v[16:19]
    ds_read_b128 a[156:159], v195 offset:20480
    v_cvt_pk_bf16_f32 v83, v230, v231
    v_mfma_f32_16x16x32_bf16 v[24:27], a[140:143], v[188:191], v[24:27]
    v_cvt_pk_bf16_f32 v84, v224, v225
    s_waitcnt lgkmcnt(2)
    v_mfma_f32_16x16x32_bf16 v[208:211], a[216:219], v[80:83], v[112:115]
    v_exp_f32 v226, v42
    v_mfma_f32_16x16x32_bf16 v[4:7], a[144:147], v[128:131], v[96:99]
    v_exp_f32 v227, v43
    v_mfma_f32_16x16x32_bf16 v[12:15], a[144:147], v[144:147], v[100:103]
    v_exp_f32 v228, v44
    v_mfma_f32_16x16x32_bf16 v[20:23], a[144:147], v[160:163], v[104:107]
    ds_read_b64_tr_b16 a[128:129], v196 offset:0
    ds_read_b64_tr_b16 a[130:131], v196 offset:4096
    v_mfma_f32_16x16x32_bf16 v[28:31], a[144:147], v[176:179], v[108:111]
    v_exp_f32 v229, v45
    v_mfma_f32_16x16x32_bf16 v[4:7], a[148:151], v[132:135], v[4:7]
    v_exp_f32 v230, v46
    v_mfma_f32_16x16x32_bf16 v[12:15], a[148:151], v[148:151], v[12:15]
    v_exp_f32 v231, v47
    v_mfma_f32_16x16x32_bf16 v[20:23], a[148:151], v[164:167], v[20:23]
    ds_read_b64_tr_b16 a[132:133], v197 offset:0
    ds_read_b64_tr_b16 a[134:135], v197 offset:4096
    v_mfma_f32_16x16x32_bf16 v[28:31], a[148:151], v[180:183], v[28:31]
    v_cvt_pk_bf16_f32 v85, v226, v227
    s_waitcnt lgkmcnt(4)
    v_mfma_f32_16x16x32_bf16 v[4:7], a[152:155], v[136:139], v[4:7]
    v_exp_f32 v224, v48
    v_mfma_f32_16x16x32_bf16 v[12:15], a[152:155], v[152:155], v[12:15]
    v_exp_f32 v225, v49
    v_mfma_f32_16x16x32_bf16 v[20:23], a[152:155], v[168:171], v[20:23]
    ds_read_b64_tr_b16 a[136:137], v198 offset:0
    ds_read_b64_tr_b16 a[138:139], v198 offset:4096
    v_mfma_f32_16x16x32_bf16 v[28:31], a[152:155], v[184:187], v[28:31]
    v_exp_f32 v226, v50
    v_mfma_f32_16x16x32_bf16 v[4:7], a[156:159], v[140:143], v[4:7]
    v_exp_f32 v227, v51
    v_mfma_f32_16x16x32_bf16 v[12:15], a[156:159], v[156:159], v[12:15]
    v_cvt_pk_bf16_f32 v86, v228, v229
    v_cvt_pk_bf16_f32 v87, v230, v231
    v_mfma_f32_16x16x32_bf16 v[20:23], a[156:159], v[172:175], v[20:23]
    ds_read_b64_tr_b16 a[140:141], v199 offset:0
    ds_read_b64_tr_b16 a[142:143], v199 offset:4096
    v_mfma_f32_16x16x32_bf16 v[212:215], a[216:219], v[84:87], v[116:119]
    v_exp_f32 v228, v52
    v_mfma_f32_16x16x32_bf16 v[28:31], a[156:159], v[188:191], v[28:31]
    v_cvt_pk_bf16_f32 v88, v224, v225
    s_waitcnt lgkmcnt(4)
    v_mfma_f32_16x16x32_bf16 a[0:3], a[128:131], v[64:67], a[0:3]
    v_exp_f32 v229, v53
    v_mfma_f32_16x16x32_bf16 a[4:7], a[128:131], v[68:71], a[4:7]
    v_exp_f32 v230, v54
    v_mfma_f32_16x16x32_bf16 a[8:11], a[128:131], v[72:75], a[8:11]
    ds_read_b64_tr_b16 a[144:145], v200 offset:0
    ds_read_b64_tr_b16 a[146:147], v200 offset:4096
    v_mfma_f32_16x16x32_bf16 a[12:15], a[128:131], v[76:79], a[12:15]
    v_exp_f32 v231, v55
    v_mfma_f32_16x16x32_bf16 a[16:19], a[132:135], v[64:67], a[16:19]
    v_exp_f32 v224, v56
    v_mfma_f32_16x16x32_bf16 a[20:23], a[132:135], v[68:71], a[20:23]
    v_exp_f32 v225, v57
    v_mfma_f32_16x16x32_bf16 a[24:27], a[132:135], v[72:75], a[24:27]
    ds_read_b64_tr_b16 a[148:149], v201 offset:0
    ds_read_b64_tr_b16 a[150:151], v201 offset:4096
    v_mfma_f32_16x16x32_bf16 a[28:31], a[132:135], v[76:79], a[28:31]
    v_cvt_pk_bf16_f32 v89, v226, v227
    s_waitcnt lgkmcnt(4)
    v_mfma_f32_16x16x32_bf16 a[32:35], a[136:139], v[64:67], a[32:35]
    v_exp_f32 v226, v58
    v_mfma_f32_16x16x32_bf16 a[36:39], a[136:139], v[68:71], a[36:39]
    v_exp_f32 v227, v59
    v_mfma_f32_16x16x32_bf16 a[40:43], a[136:139], v[72:75], a[40:43]
    ds_read_b64_tr_b16 a[152:153], v202 offset:0
    ds_read_b64_tr_b16 a[154:155], v202 offset:4096
    v_mfma_f32_16x16x32_bf16 a[44:47], a[136:139], v[76:79], a[44:47]
    v_cvt_pk_bf16_f32 v90, v228, v229
    v_cvt_pk_bf16_f32 v91, v230, v231
    v_mfma_f32_16x16x32_bf16 a[48:51], a[140:143], v[64:67], a[48:51]
    v_exp_f32 v228, v60
    v_mfma_f32_16x16x32_bf16 v[216:219], a[216:219], v[88:91], v[120:123]
    v_exp_f32 v229, v61
    v_mfma_f32_16x16x32_bf16 a[52:55], a[140:143], v[68:71], a[52:55]
    v_exp_f32 v230, v62
    v_mfma_f32_16x16x32_bf16 a[56:59], a[140:143], v[72:75], a[56:59]
    ds_read_b64_tr_b16 a[156:157], v203 offset:0
    ds_read_b64_tr_b16 a[158:159], v203 offset:4096
    v_mfma_f32_16x16x32_bf16 a[60:63], a[140:143], v[76:79], a[60:63]
    v_cvt_pk_bf16_f32 v92, v224, v225
    s_waitcnt lgkmcnt(4)
    v_mfma_f32_16x16x32_bf16 a[64:67], a[144:147], v[64:67], a[64:67]
    v_exp_f32 v231, v63
    v_mfma_f32_16x16x32_bf16 a[68:71], a[144:147], v[68:71], a[68:71]
    v_cvt_pk_bf16_f32 v93, v226, v227
    v_cvt_pk_bf16_f32 v94, v228, v229
    v_mfma_f32_16x16x32_bf16 a[72:75], a[144:147], v[72:75], a[72:75]
    ds_read_b128 a[128:131], v192 offset:24576
    v_cvt_pk_bf16_f32 v95, v230, v231
    v_mfma_f32_16x16x32_bf16 a[76:79], a[144:147], v[76:79], a[76:79]
    v_mfma_f32_16x16x32_bf16 a[80:83], a[148:151], v[64:67], a[80:83]
    buffer_load_dword v239, v236, s[40:43], s63 offen
    s_add_u32 s63, s63, 512
    v_mfma_f32_16x16x32_bf16 v[220:223], a[216:219], v[92:95], v[124:127]
    v_mfma_f32_16x16x32_bf16 a[84:87], a[148:151], v[68:71], a[84:87]
    v_mfma_f32_16x16x32_bf16 a[88:91], a[148:151], v[72:75], a[88:91]
    ds_read_b128 a[132:135], v193 offset:24576
    v_mfma_f32_16x16x32_bf16 a[92:95], a[148:151], v[76:79], a[92:95]
    s_add_u32 m0, s25, 0x0
    s_waitcnt lgkmcnt(2)
    v_mfma_f32_16x16x32_bf16 a[96:99], a[152:155], v[64:67], a[96:99]
    buffer_load_dwordx4 v204, s[4:7], s26 offen lds
    v_mfma_f32_16x16x32_bf16 a[100:103], a[152:155], v[68:71], a[100:103]
    buffer_load_dwordx4 v205, s[4:7], s26 offen offset:1024 lds
    s_add_u32 s26, s26, 0x2000
    v_mfma_f32_16x16x32_bf16 a[104:107], a[152:155], v[72:75], a[104:107]
    ds_read_b128 a[136:139], v194 offset:24576
    v_max3_f32 v252, v208, v212, v216
    v_mfma_f32_16x16x32_bf16 a[108:111], a[152:155], v[76:79], a[108:111]
    v_max_f32 v252, v252, v220
    s_add_u32 m0, s25, 0x1c000
    v_mfma_f32_16x16x32_bf16 a[112:115], a[156:159], v[64:67], a[112:115]
    buffer_load_dwordx4 v206, s[8:11], s27 offen lds
    v_cmp_lt_f32 vcc, 0x67800000, v252
    v_mfma_f32_16x16x32_bf16 a[116:119], a[156:159], v[68:71], a[116:119]
    buffer_load_dwordx4 v207, s[8:11], s27 offen offset:1024 lds
    s_add_u32 s27, s27, 0x2000
    v_mfma_f32_16x16x32_bf16 a[120:123], a[156:159], v[72:75], a[120:123]
    ds_read_b128 a[140:143], v195 offset:24576
    s_waitcnt lgkmcnt(2)
    v_mfma_f32_16x16x32_bf16 a[124:127], a[156:159], v[76:79], a[124:127]
    s_cbranch_vccnz TRAMP_L1
BACK_L1:
    s_waitcnt vmcnt(15)
    s_barrier
    v_mfma_f32_16x16x32_bf16 v[32:35], a[128:131], v[128:131], v[96:99]
    v_exp_f32 v224, v0
    v_mfma_f32_16x16x32_bf16 v[40:43], a[128:131], v[144:147], v[100:103]
    v_exp_f32 v225, v1
    v_mfma_f32_16x16x32_bf16 v[48:51], a[128:131], v[160:163], v[104:107]
    ds_read_b128 a[144:147], v192 offset:28672
    v_cvt_pk_bf16_f32 v64, v224, v225
    v_mfma_f32_16x16x32_bf16 v[56:59], a[128:131], v[176:179], v[108:111]
    v_exp_f32 v226, v2
    v_mfma_f32_16x16x32_bf16 v[32:35], a[132:135], v[132:135], v[32:35]
    v_exp_f32 v227, v3
    v_mfma_f32_16x16x32_bf16 v[40:43], a[132:135], v[148:151], v[40:43]
    v_exp_f32 v228, v4
    v_mfma_f32_16x16x32_bf16 v[48:51], a[132:135], v[164:167], v[48:51]
    ds_read_b128 a[148:151], v193 offset:28672
    v_cvt_pk_bf16_f32 v65, v226, v227
    v_mfma_f32_16x16x32_bf16 v[56:59], a[132:135], v[180:183], v[56:59]
    s_waitcnt lgkmcnt(2)
    v_mfma_f32_16x16x32_bf16 v[32:35], a[136:139], v[136:139], v[32:35]
    v_exp_f32 v229, v5
    v_mfma_f32_16x16x32_bf16 v[40:43], a[136:139], v[152:155], v[40:43]
    v_exp_f32 v230, v6
    v_mfma_f32_16x16x32_bf16 v[48:51], a[136:139], v[168:171], v[48:51]
    ds_read_b128 a[152:155], v194 offset:28672
    v_cvt_pk_bf16_f32 v66, v228, v229
    v_mfma_f32_16x16x32_bf16 v[56:59], a[136:139], v[184:187], v[56:59]
    v_exp_f32 v231, v7
    v_mfma_f32_16x16x32_bf16 v[32:35], a[140:143], v[140:143], v[32:35]
    v_exp_f32 v224, v8
    v_mfma_f32_16x16x32_bf16 v[40:43], a[140:143], v[156:159], v[40:43]
    v_exp_f32 v225, v9
    v_mfma_f32_16x16x32_bf16 v[48:51], a[140:143], v[172:175], v[48:51]
    ds_read_b128 a[156:159], v195 offset:28672
    v_cvt_pk_bf16_f32 v67, v230, v231
    v_mfma_f32_16x16x32_bf16 v[56:59], a[140:143], v[188:191], v[56:59]
    v_cvt_pk_bf16_f32 v68, v224, v225
    s_waitcnt lgkmcnt(2)
    v_mfma_f32_16x16x32_bf16 v[112:115], a[216:219], v[64:67], v[208:211]
    v_exp_f32 v226, v10
    v_mfma_f32_16x16x32_bf16 v[36:39], a[144:147], v[128:131], v[96:99]
    v_exp_f32 v227, v11
    v_mfma_f32_16x16x32_bf16 v[44:47], a[144:147], v[144:147], v[100:103]
    v_exp_f32 v228, v12
    v_mfma_f32_16x16x32_bf16 v[52:55], a[144:147], v[160:163], v[104:107]
    ds_read_b64_tr_b16 a[128:129], v196 offset:8192
    ds_read_b64_tr_b16 a[130:131], v196 offset:12288
    v_mfma_f32_16x16x32_bf16 v[60:63], a[144:147], v[176:179], v[108:111]
    v_exp_f32 v229, v13
    v_mfma_f32_16x16x32_bf16 v[36:39], a[148:151], v[132:135], v[36:39]
    v_exp_f32 v230, v14
    v_mfma_f32_16x16x32_bf16 v[44:47], a[148:151], v[148:151], v[44:47]
    v_exp_f32 v231, v15
    v_mfma_f32_16x16x32_bf16 v[52:55], a[148:151], v[164:167], v[52:55]
    ds_read_b64_tr_b16 a[132:133], v197 offset:8192
    ds_read_b64_tr_b16 a[134:135], v197 offset:12288
    v_mfma_f32_16x16x32_bf16 v[60:63], a[148:151], v[180:183], v[60:63]
    v_cvt_pk_bf16_f32 v69, v226, v227
    s_waitcnt lgkmcnt(4)
    v_mfma_f32_16x16x32_bf16 v[36:39], a[152:155], v[136:139], v[36:39]
    v_exp_f32 v224, v16
    v_mfma_f32_16x16x32_bf16 v[44:47], a[152:155], v[152:155], v[44:47]
    v_exp_f32 v225, v17
    v_mfma_f32_16x16x32_bf16 v[52:55], a[152:155], v[168:171], v[52:55]
    ds_read_b64_tr_b16 a[136:137], v198 offset:8192
    ds_read_b64_tr_b16 a[138:139], v198 offset:12288
    v_mfma_f32_16x16x32_bf16 v[60:63], a[152:155], v[184:187], v[60:63]
    v_exp_f32 v226, v18
    v_mfma_f32_16x16x32_bf16 v[36:39], a[156:159], v[140:143], v[36:39]
    v_exp_f32 v227, v19
    v_mfma_f32_16x16x32_bf16 v[44:47], a[156:159], v[156:159], v[44:47]
    v_cvt_pk_bf16_f32 v70, v228, v229
    v_cvt_pk_bf16_f32 v71, v230, v231
    v_mfma_f32_16x16x32_bf16 v[52:55], a[156:159], v[172:175], v[52:55]
    ds_read_b64_tr_b16 a[140:141], v199 offset:8192
    ds_read_b64_tr_b16 a[142:143], v199 offset:12288
    v_mfma_f32_16x16x32_bf16 v[116:119], a[216:219], v[68:71], v[212:215]
    v_exp_f32 v228, v20
    v_mfma_f32_16x16x32_bf16 v[60:63], a[156:159], v[188:191], v[60:63]
    v_cvt_pk_bf16_f32 v72, v224, v225
    s_waitcnt lgkmcnt(4)
    v_mfma_f32_16x16x32_bf16 a[0:3], a[128:131], v[80:83], a[0:3]
    v_exp_f32 v229, v21
    v_mfma_f32_16x16x32_bf16 a[4:7], a[128:131], v[84:87], a[4:7]
    v_exp_f32 v230, v22
    v_mfma_f32_16x16x32_bf16 a[8:11], a[128:131], v[88:91], a[8:11]
    ds_read_b64_tr_b16 a[144:145], v200 offset:8192
    ds_read_b64_tr_b16 a[146:147], v200 offset:12288
    v_mfma_f32_16x16x32_bf16 a[12:15], a[128:131], v[92:95], a[12:15]
    v_exp_f32 v231, v23
    v_mfma_f32_16x16x32_bf16 a[16:19], a[132:135], v[80:83], a[16:19]
    v_exp_f32 v224, v24
    v_mfma_f32_16x16x32_bf16 a[20:23], a[132:135], v[84:87], a[20:23]
    v_exp_f32 v225, v25
    v_mfma_f32_16x16x32_bf16 a[24:27], a[132:135], v[88:91], a[24:27]
    ds_read_b64_tr_b16 a[148:149], v201 offset:8192
    ds_read_b64_tr_b16 a[150:151], v201 offset:12288
    v_mfma_f32_16x16x32_bf16 a[28:31], a[132:135], v[92:95], a[28:31]
    v_cvt_pk_bf16_f32 v73, v226, v227
    s_waitcnt lgkmcnt(4)
    v_mfma_f32_16x16x32_bf16 a[32:35], a[136:139], v[80:83], a[32:35]
    v_exp_f32 v226, v26
    v_mfma_f32_16x16x32_bf16 a[36:39], a[136:139], v[84:87], a[36:39]
    v_exp_f32 v227, v27
    v_mfma_f32_16x16x32_bf16 a[40:43], a[136:139], v[88:91], a[40:43]
    ds_read_b64_tr_b16 a[152:153], v202 offset:8192
    ds_read_b64_tr_b16 a[154:155], v202 offset:12288
    v_mfma_f32_16x16x32_bf16 a[44:47], a[136:139], v[92:95], a[44:47]
    v_cvt_pk_bf16_f32 v74, v228, v229
    v_cvt_pk_bf16_f32 v75, v230, v231
    v_mfma_f32_16x16x32_bf16 a[48:51], a[140:143], v[80:83], a[48:51]
    v_exp_f32 v228, v28
    v_mfma_f32_16x16x32_bf16 v[120:123], a[216:219], v[72:75], v[216:219]
    v_exp_f32 v229, v29
    v_mfma_f32_16x16x32_bf16 a[52:55], a[140:143], v[84:87], a[52:55]
    v_exp_f32 v230, v30
    v_mfma_f32_16x16x32_bf16 a[56:59], a[140:143], v[88:91], a[56:59]
    ds_read_b64_tr_b16 a[156:157], v203 offset:8192
    ds_read_b64_tr_b16 a[158:159], v203 offset:12288
    v_mfma_f32_16x16x32_bf16 a[60:63], a[140:143], v[92:95], a[60:63]
    v_cvt_pk_bf16_f32 v76, v224, v225
    s_waitcnt lgkmcnt(4)
    v_mfma_f32_16x16x32_bf16 a[64:67], a[144:147], v[80:83], a[64:67]
    v_exp_f32 v231, v31
    v_mfma_f32_16x16x32_bf16 a[68:71], a[144:147], v[84:87], a[68:71]
    v_cvt_pk_bf16_f32 v77, v226, v227
    v_cvt_pk_bf16_f32 v78, v228, v229
    v_mfma_f32_16x16x32_bf16 a[72:75], a[144:147], v[88:91], a[72:75]
    ds_read_b128 a[128:131], v192 offset:32768
    v_cvt_pk_bf16_f32 v79, v230, v231
    v_mfma_f32_16x16x32_bf16 a[76:79], a[144:147], v[92:95], a[76:79]
    v_mfma_f32_16x16x32_bf16 a[80:83], a[148:151], v[80:83], a[80:83]
    buffer_load_dword v240, v236, s[40:43], s63 offen
    s_add_u32 s63, s63, 512
    v_mfma_f32_16x16x32_bf16 v[124:127], a[216:219], v[76:79], v[220:223]
    v_mfma_f32_16x16x32_bf16 a[84:87], a[148:151], v[84:87], a[84:87]
    v_mfma_f32_16x16x32_bf16 a[88:91], a[148:151], v[88:91], a[88:91]
    ds_read_b128 a[132:135], v193 offset:32768
    v_mfma_f32_16x16x32_bf16 a[92:95], a[148:151], v[92:95], a[92:95]
    s_add_u32 m0, s25, 0x2000
    s_waitcnt lgkmcnt(2)
    v_mfma_f32_16x16x32_bf16 a[96:99], a[152:155], v[80:83], a[96:99]
    buffer_load_dwordx4 v204, s[4:7], s26 offen lds
    v_mfma_f32_16x16x32_bf16 a[100:103], a[152:155], v[84:87], a[100:103]
    buffer_load_dwordx4 v205, s[4:7], s26 offen offset:1024 lds
    s_add_u32 s26, s26, 0x2000
    v_mfma_f32_16x16x32_bf16 a[104:107], a[152:155], v[88:91], a[104:107]
    ds_read_b128 a[136:139], v194 offset:32768
    v_max3_f32 v252, v112, v116, v120
    v_mfma_f32_16x16x32_bf16 a[108:111], a[152:155], v[92:95], a[108:111]
    v_max_f32 v252, v252, v124
    s_add_u32 m0, s25, 0x1e000
    v_mfma_f32_16x16x32_bf16 a[112:115], a[156:159], v[80:83], a[112:115]
    buffer_load_dwordx4 v206, s[8:11], s27 offen lds
    v_cmp_lt_f32 vcc, 0x67800000, v252
    v_mfma_f32_16x16x32_bf16 a[116:119], a[156:159], v[84:87], a[116:119]
    buffer_load_dwordx4 v207, s[8:11], s27 offen offset:1024 lds
    s_add_u32 s27, s27, 0x2000
    v_mfma_f32_16x16x32_bf16 a[120:123], a[156:159], v[88:91], a[120:123]
    ds_read_b128 a[140:143], v195 offset:32768
    s_waitcnt lgkmcnt(2)
    v_mfma_f32_16x16x32_bf16 a[124:127], a[156:159], v[92:95], a[124:127]
    s_cbranch_vccnz TRAMP_L2
BACK_L2:
    v_mfma_f32_16x16x32_bf16 v[0:3], a[128:131], v[128:131], v[96:99]
    v_exp_f32 v224, v32
    v_mfma_f32_16x16x32_bf16 v[8:11], a[128:131], v[144:147], v[100:103]
    v_exp_f32 v225, v33
    v_mfma_f32_16x16x32_bf16 v[16:19], a[128:131], v[160:163], v[104:107]
    ds_read_b128 a[144:147], v192 offset:36864
    v_cvt_pk_bf16_f32 v80, v224, v225
    v_mfma_f32_16x16x32_bf16 v[24:27], a[128:131], v[176:179], v[108:111]
    v_exp_f32 v226, v34
    v_mfma_f32_16x16x32_bf16 v[0:3], a[132:135], v[132:135], v[0:3]
    v_exp_f32 v227, v35
    v_mfma_f32_16x16x32_bf16 v[8:11], a[132:135], v[148:151], v[8:11]
    v_exp_f32 v228, v36
    v_mfma_f32_16x16x32_bf16 v[16:19], a[132:135], v[164:167], v[16:19]
    ds_read_b128 a[148:151], v193 offset:36864
    v_cvt_pk_bf16_f32 v81, v226, v227
    v_mfma_f32_16x16x32_bf16 v[24:27], a[132:135], v[180:183], v[24:27]
    s_waitcnt lgkmcnt(2)
    v_mfma_f32_16x16x32_bf16 v[0:3], a[136:139], v[136:139], v[0:3]
    v_exp_f32 v229, v37
    v_mfma_f32_16x16x32_bf16 v[8:11], a[136:139], v[152:155], v[8:11]
    v_exp_f32 v230, v38
    v_mfma_f32_16x16x32_bf16 v[16:19], a[136:139], v[168:171], v[16:19]
    ds_read_b128 a[152:155], v194 offset:36864
    v_cvt_pk_bf16_f32 v82, v228, v229
    v_mfma_f32_16x16x32_bf16 v[24:27], a[136:139], v[184:187], v[24:27]
    v_exp_f32 v231, v39
    v_mfma_f32_16x16x32_bf16 v[0:3], a[140:143], v[140:143], v[0:3]
    v_exp_f32 v224, v40
    v_mfma_f32_16x16x32_bf16 v[8:11], a[140:143], v[156:159], v[8:11]
    v_exp_f32 v225, v41
    v_mfma_f32_16x16x32_bf16 v[16:19], a[140:143], v[172:175], v[16:19]
    ds_read_b128 a[156:159], v195 offset:36864
    v_cvt_pk_bf16_f32 v83, v230, v231
    v_mfma_f32_16x16x32_bf16 v[24:27], a[140:143], v[188:191], v[24:27]
    v_cvt_pk_bf16_f32 v84, v224, v225
    s_waitcnt lgkmcnt(2)
    v_mfma_f32_16x16x32_bf16 v[208:211], a[216:219], v[80:83], v[112:115]
    v_exp_f32 v226, v42
    v_mfma_f32_16x16x32_bf16 v[4:7], a[144:147], v[128:131], v[96:99]
    v_exp_f32 v227, v43
    v_mfma_f32_16x16x32_bf16 v[12:15], a[144:147], v[144:147], v[100:103]
    v_exp_f32 v228, v44
    v_mfma_f32_16x16x32_bf16 v[20:23], a[144:147], v[160:163], v[104:107]
    ds_read_b64_tr_b16 a[128:129], v196 offset:16384
    ds_read_b64_tr_b16 a[130:131], v196 offset:20480
    v_mfma_f32_16x16x32_bf16 v[28:31], a[144:147], v[176:179], v[108:111]
    v_exp_f32 v229, v45
    v_mfma_f32_16x16x32_bf16 v[4:7], a[148:151], v[132:135], v[4:7]
    v_exp_f32 v230, v46
    v_mfma_f32_16x16x32_bf16 v[12:15], a[148:151], v[148:151], v[12:15]
    v_exp_f32 v231, v47
    v_mfma_f32_16x16x32_bf16 v[20:23], a[148:151], v[164:167], v[20:23]
    ds_read_b64_tr_b16 a[132:133], v197 offset:16384
    ds_read_b64_tr_b16 a[134:135], v197 offset:20480
    v_mfma_f32_16x16x32_bf16 v[28:31], a[148:151], v[180:183], v[28:31]
    v_cvt_pk_bf16_f32 v85, v226, v227
    s_waitcnt lgkmcnt(4)
    v_mfma_f32_16x16x32_bf16 v[4:7], a[152:155], v[136:139], v[4:7]
    v_exp_f32 v224, v48
    v_mfma_f32_16x16x32_bf16 v[12:15], a[152:155], v[152:155], v[12:15]
    v_exp_f32 v225, v49
    v_mfma_f32_16x16x32_bf16 v[20:23], a[152:155], v[168:171], v[20:23]
    ds_read_b64_tr_b16 a[136:137], v198 offset:16384
    ds_read_b64_tr_b16 a[138:139], v198 offset:20480
    v_mfma_f32_16x16x32_bf16 v[28:31], a[152:155], v[184:187], v[28:31]
    v_exp_f32 v226, v50
    v_mfma_f32_16x16x32_bf16 v[4:7], a[156:159], v[140:143], v[4:7]
    v_exp_f32 v227, v51
    v_mfma_f32_16x16x32_bf16 v[12:15], a[156:159], v[156:159], v[12:15]
    v_cvt_pk_bf16_f32 v86, v228, v229
    v_cvt_pk_bf16_f32 v87, v230, v231
    v_mfma_f32_16x16x32_bf16 v[20:23], a[156:159], v[172:175], v[20:23]
    ds_read_b64_tr_b16 a[140:141], v199 offset:16384
    ds_read_b64_tr_b16 a[142:143], v199 offset:20480
    v_mfma_f32_16x16x32_bf16 v[212:215], a[216:219], v[84:87], v[116:119]
    v_exp_f32 v228, v52
    v_mfma_f32_16x16x32_bf16 v[28:31], a[156:159], v[188:191], v[28:31]
    v_cvt_pk_bf16_f32 v88, v224, v225
    s_waitcnt lgkmcnt(4)
    v_mfma_f32_16x16x32_bf16 a[0:3], a[128:131], v[64:67], a[0:3]
    v_exp_f32 v229, v53
    v_mfma_f32_16x16x32_bf16 a[4:7], a[128:131], v[68:71], a[4:7]
    v_exp_f32 v230, v54
    v_mfma_f32_16x16x32_bf16 a[8:11], a[128:131], v[72:75], a[8:11]
    ds_read_b64_tr_b16 a[144:145], v200 offset:16384
    ds_read_b64_tr_b16 a[146:147], v200 offset:20480
    v_mfma_f32_16x16x32_bf16 a[12:15], a[128:131], v[76:79], a[12:15]
    v_exp_f32 v231, v55
    v_mfma_f32_16x16x32_bf16 a[16:19], a[132:135], v[64:67], a[16:19]
    v_exp_f32 v224, v56
    v_mfma_f32_16x16x32_bf16 a[20:23], a[132:135], v[68:71], a[20:23]
    v_exp_f32 v225, v57
    v_mfma_f32_16x16x32_bf16 a[24:27], a[132:135], v[72:75], a[24:27]
    ds_read_b64_tr_b16 a[148:149], v201 offset:16384
    ds_read_b64_tr_b16 a[150:151], v201 offset:20480
    v_mfma_f32_16x16x32_bf16 a[28:31], a[132:135], v[76:79], a[28:31]
    v_cvt_pk_bf16_f32 v89, v226, v227
    s_waitcnt lgkmcnt(4)
    v_mfma_f32_16x16x32_bf16 a[32:35], a[136:139], v[64:67], a[32:35]
    v_exp_f32 v226, v58
    v_mfma_f32_16x16x32_bf16 a[36:39], a[136:139], v[68:71], a[36:39]
    v_exp_f32 v227, v59
    v_mfma_f32_16x16x32_bf16 a[40:43], a[136:139], v[72:75], a[40:43]
    ds_read_b64_tr_b16 a[152:153], v202 offset:16384
    ds_read_b64_tr_b16 a[154:155], v202 offset:20480
    v_mfma_f32_16x16x32_bf16 a[44:47], a[136:139], v[76:79], a[44:47]
    v_cvt_pk_bf16_f32 v90, v228, v229
    v_cvt_pk_bf16_f32 v91, v230, v231
    v_mfma_f32_16x16x32_bf16 a[48:51], a[140:143], v[64:67], a[48:51]
    v_exp_f32 v228, v60
    v_mfma_f32_16x16x32_bf16 v[216:219], a[216:219], v[88:91], v[120:123]
    v_exp_f32 v229, v61
    v_mfma_f32_16x16x32_bf16 a[52:55], a[140:143], v[68:71], a[52:55]
    v_exp_f32 v230, v62
    v_mfma_f32_16x16x32_bf16 a[56:59], a[140:143], v[72:75], a[56:59]
    ds_read_b64_tr_b16 a[156:157], v203 offset:16384
    ds_read_b64_tr_b16 a[158:159], v203 offset:20480
    v_mfma_f32_16x16x32_bf16 a[60:63], a[140:143], v[76:79], a[60:63]
    v_cvt_pk_bf16_f32 v92, v224, v225
    s_waitcnt lgkmcnt(4)
    v_mfma_f32_16x16x32_bf16 a[64:67], a[144:147], v[64:67], a[64:67]
    v_exp_f32 v231, v63
    v_mfma_f32_16x16x32_bf16 a[68:71], a[144:147], v[68:71], a[68:71]
    v_cvt_pk_bf16_f32 v93, v226, v227
    v_cvt_pk_bf16_f32 v94, v228, v229
    v_mfma_f32_16x16x32_bf16 a[72:75], a[144:147], v[72:75], a[72:75]
    ds_read_b128 a[128:131], v192 offset:40960
    v_cvt_pk_bf16_f32 v95, v230, v231
    v_mfma_f32_16x16x32_bf16 a[76:79], a[144:147], v[76:79], a[76:79]
    v_mfma_f32_16x16x32_bf16 a[80:83], a[148:151], v[64:67], a[80:83]
    buffer_load_dword v241, v236, s[40:43], s63 offen
    s_add_u32 s63, s63, 512
    v_mfma_f32_16x16x32_bf16 v[220:223], a[216:219], v[92:95], v[124:127]
    v_mfma_f32_16x16x32_bf16 a[84:87], a[148:151], v[68:71], a[84:87]
    v_mfma_f32_16x16x32_bf16 a[88:91], a[148:151], v[72:75], a[88:91]
    ds_read_b128 a[132:135], v193 offset:40960
    v_mfma_f32_16x16x32_bf16 a[92:95], a[148:151], v[76:79], a[92:95]
    s_add_u32 m0, s25, 0x4000
    s_waitcnt lgkmcnt(2)
    v_mfma_f32_16x16x32_bf16 a[96:99], a[152:155], v[64:67], a[96:99]
    buffer_load_dwordx4 v204, s[4:7], s26 offen lds
    v_mfma_f32_16x16x32_bf16 a[100:103], a[152:155], v[68:71], a[100:103]
    buffer_load_dwordx4 v205, s[4:7], s26 offen offset:1024 lds
    s_add_u32 s26, s26, 0x2000
    v_mfma_f32_16x16x32_bf16 a[104:107], a[152:155], v[72:75], a[104:107]
    ds_read_b128 a[136:139], v194 offset:40960
    v_max3_f32 v252, v208, v212, v216
    v_mfma_f32_16x16x32_bf16 a[108:111], a[152:155], v[76:79], a[108:111]
    v_max_f32 v252, v252, v220
    s_add_u32 m0, s25, 0x10000
    v_mfma_f32_16x16x32_bf16 a[112:115], a[156:159], v[64:67], a[112:115]
    buffer_load_dwordx4 v206, s[8:11], s27 offen lds
    v_cmp_lt_f32 vcc, 0x67800000, v252
    v_mfma_f32_16x16x32_bf16 a[116:119], a[156:159], v[68:71], a[116:119]
    buffer_load_dwordx4 v207, s[8:11], s27 offen offset:1024 lds
    s_add_u32 s27, s27, 0x2000
    v_mfma_f32_16x16x32_bf16 a[120:123], a[156:159], v[72:75], a[120:123]
    ds_read_b128 a[140:143], v195 offset:40960
    s_waitcnt lgkmcnt(2)
    v_mfma_f32_16x16x32_bf16 a[124:127], a[156:159], v[76:79], a[124:127]
    s_cbranch_vccnz TRAMP_L3
BACK_L3:
    s_waitcnt vmcnt(15)
    s_barrier
    v_mfma_f32_16x16x32_bf16 v[32:35], a[128:131], v[128:131], v[96:99]
    v_exp_f32 v224, v0
    v_mfma_f32_16x16x32_bf16 v[40:43], a[128:131], v[144:147], v[100:103]
    v_exp_f32 v225, v1
    v_mfma_f32_16x16x32_bf16 v[48:51], a[128:131], v[160:163], v[104:107]
    ds_read_b128 a[144:147], v192 offset:45056
    v_cvt_pk_bf16_f32 v64, v224, v225
    v_mfma_f32_16x16x32_bf16 v[56:59], a[128:131], v[176:179], v[108:111]
    v_exp_f32 v226, v2
    v_mfma_f32_16x16x32_bf16 v[32:35], a[132:135], v[132:135], v[32:35]
    v_exp_f32 v227, v3
    v_mfma_f32_16x16x32_bf16 v[40:43], a[132:135], v[148:151], v[40:43]
    v_exp_f32 v228, v4
    v_mfma_f32_16x16x32_bf16 v[48:51], a[132:135], v[164:167], v[48:51]
    ds_read_b128 a[148:151], v193 offset:45056
    v_cvt_pk_bf16_f32 v65, v226, v227
    v_mfma_f32_16x16x32_bf16 v[56:59], a[132:135], v[180:183], v[56:59]
    s_waitcnt lgkmcnt(2)
    v_mfma_f32_16x16x32_bf16 v[32:35], a[136:139], v[136:139], v[32:35]
    v_exp_f32 v229, v5
    v_mfma_f32_16x16x32_bf16 v[40:43], a[136:139], v[152:155], v[40:43]
    v_exp_f32 v230, v6
    v_mfma_f32_16x16x32_bf16 v[48:51], a[136:139], v[168:171], v[48:51]
    ds_read_b128 a[152:155], v194 offset:45056
    v_cvt_pk_bf16_f32 v66, v228, v229
    v_mfma_f32_16x16x32_bf16 v[56:59], a[136:139], v[184:187], v[56:59]
    v_exp_f32 v231, v7
    v_mfma_f32_16x16x32_bf16 v[32:35], a[140:143], v[140:143], v[32:35]
    v_exp_f32 v224, v8
    v_mfma_f32_16x16x32_bf16 v[40:43], a[140:143], v[156:159], v[40:43]
    v_exp_f32 v225, v9
    v_mfma_f32_16x16x32_bf16 v[48:51], a[140:143], v[172:175], v[48:51]
    ds_read_b128 a[156:159], v195 offset:45056
    v_cvt_pk_bf16_f32 v67, v230, v231
    v_mfma_f32_16x16x32_bf16 v[56:59], a[140:143], v[188:191], v[56:59]
    v_cvt_pk_bf16_f32 v68, v224, v225
    s_waitcnt lgkmcnt(2)
    v_mfma_f32_16x16x32_bf16 v[112:115], a[216:219], v[64:67], v[208:211]
    v_exp_f32 v226, v10
    v_mfma_f32_16x16x32_bf16 v[36:39], a[144:147], v[128:131], v[96:99]
    v_exp_f32 v227, v11
    v_mfma_f32_16x16x32_bf16 v[44:47], a[144:147], v[144:147], v[100:103]
    v_exp_f32 v228, v12
    v_mfma_f32_16x16x32_bf16 v[52:55], a[144:147], v[160:163], v[104:107]
    ds_read_b64_tr_b16 a[128:129], v196 offset:24576
    ds_read_b64_tr_b16 a[130:131], v196 offset:28672
    v_mfma_f32_16x16x32_bf16 v[60:63], a[144:147], v[176:179], v[108:111]
    v_exp_f32 v229, v13
    v_mfma_f32_16x16x32_bf16 v[36:39], a[148:151], v[132:135], v[36:39]
    v_exp_f32 v230, v14
    v_mfma_f32_16x16x32_bf16 v[44:47], a[148:151], v[148:151], v[44:47]
    v_exp_f32 v231, v15
    v_mfma_f32_16x16x32_bf16 v[52:55], a[148:151], v[164:167], v[52:55]
    ds_read_b64_tr_b16 a[132:133], v197 offset:24576
    ds_read_b64_tr_b16 a[134:135], v197 offset:28672
    v_mfma_f32_16x16x32_bf16 v[60:63], a[148:151], v[180:183], v[60:63]
    v_cvt_pk_bf16_f32 v69, v226, v227
    s_waitcnt lgkmcnt(4)
    v_mfma_f32_16x16x32_bf16 v[36:39], a[152:155], v[136:139], v[36:39]
    v_exp_f32 v224, v16
    v_mfma_f32_16x16x32_bf16 v[44:47], a[152:155], v[152:155], v[44:47]
    v_exp_f32 v225, v17
    v_mfma_f32_16x16x32_bf16 v[52:55], a[152:155], v[168:171], v[52:55]
    ds_read_b64_tr_b16 a[136:137], v198 offset:24576
    ds_read_b64_tr_b16 a[138:139], v198 offset:28672
    v_mfma_f32_16x16x32_bf16 v[60:63], a[152:155], v[184:187], v[60:63]
    v_exp_f32 v226, v18
    v_mfma_f32_16x16x32_bf16 v[36:39], a[156:159], v[140:143], v[36:39]
    v_exp_f32 v227, v19
    v_mfma_f32_16x16x32_bf16 v[44:47], a[156:159], v[156:159], v[44:47]
    v_cvt_pk_bf16_f32 v70, v228, v229
    v_cvt_pk_bf16_f32 v71, v230, v231
    v_mfma_f32_16x16x32_bf16 v[52:55], a[156:159], v[172:175], v[52:55]
    ds_read_b64_tr_b16 a[140:141], v199 offset:24576
    ds_read_b64_tr_b16 a[142:143], v199 offset:28672
    v_mfma_f32_16x16x32_bf16 v[116:119], a[216:219], v[68:71], v[212:215]
    v_exp_f32 v228, v20
    v_mfma_f32_16x16x32_bf16 v[60:63], a[156:159], v[188:191], v[60:63]
    v_cvt_pk_bf16_f32 v72, v224, v225
    s_waitcnt lgkmcnt(4)
    v_mfma_f32_16x16x32_bf16 a[0:3], a[128:131], v[80:83], a[0:3]
    v_exp_f32 v229, v21
    v_mfma_f32_16x16x32_bf16 a[4:7], a[128:131], v[84:87], a[4:7]
    v_exp_f32 v230, v22
    v_mfma_f32_16x16x32_bf16 a[8:11], a[128:131], v[88:91], a[8:11]
    ds_read_b64_tr_b16 a[144:145], v200 offset:24576
    ds_read_b64_tr_b16 a[146:147], v200 offset:28672
    v_mfma_f32_16x16x32_bf16 a[12:15], a[128:131], v[92:95], a[12:15]
    v_exp_f32 v231, v23
    v_mfma_f32_16x16x32_bf16 a[16:19], a[132:135], v[80:83], a[16:19]
    v_exp_f32 v224, v24
    v_mfma_f32_16x16x32_bf16 a[20:23], a[132:135], v[84:87], a[20:23]
    v_exp_f32 v225, v25
    v_mfma_f32_16x16x32_bf16 a[24:27], a[132:135], v[88:91], a[24:27]
    ds_read_b64_tr_b16 a[148:149], v201 offset:24576
    ds_read_b64_tr_b16 a[150:151], v201 offset:28672
    v_mfma_f32_16x16x32_bf16 a[28:31], a[132:135], v[92:95], a[28:31]
    v_cvt_pk_bf16_f32 v73, v226, v227
    s_waitcnt lgkmcnt(4)
    v_mfma_f32_16x16x32_bf16 a[32:35], a[136:139], v[80:83], a[32:35]
    v_exp_f32 v226, v26
    v_mfma_f32_16x16x32_bf16 a[36:39], a[136:139], v[84:87], a[36:39]
    v_exp_f32 v227, v27
    v_mfma_f32_16x16x32_bf16 a[40:43], a[136:139], v[88:91], a[40:43]
    ds_read_b64_tr_b16 a[152:153], v202 offset:24576
    ds_read_b64_tr_b16 a[154:155], v202 offset:28672
    v_mfma_f32_16x16x32_bf16 a[44:47], a[136:139], v[92:95], a[44:47]
    v_cvt_pk_bf16_f32 v74, v228, v229
    v_cvt_pk_bf16_f32 v75, v230, v231
    v_mfma_f32_16x16x32_bf16 a[48:51], a[140:143], v[80:83], a[48:51]
    v_exp_f32 v228, v28
    v_mfma_f32_16x16x32_bf16 v[120:123], a[216:219], v[72:75], v[216:219]
    v_exp_f32 v229, v29
    v_mfma_f32_16x16x32_bf16 a[52:55], a[140:143], v[84:87], a[52:55]
    v_exp_f32 v230, v30
    v_mfma_f32_16x16x32_bf16 a[56:59], a[140:143], v[88:91], a[56:59]
    ds_read_b64_tr_b16 a[156:157], v203 offset:24576
    ds_read_b64_tr_b16 a[158:159], v203 offset:28672
    v_mfma_f32_16x16x32_bf16 a[60:63], a[140:143], v[92:95], a[60:63]
    v_cvt_pk_bf16_f32 v76, v224, v225
    s_waitcnt lgkmcnt(4)
    v_mfma_f32_16x16x32_bf16 a[64:67], a[144:147], v[80:83], a[64:67]
    v_exp_f32 v231, v31
    v_mfma_f32_16x16x32_bf16 a[68:71], a[144:147], v[84:87], a[68:71]
    v_cvt_pk_bf16_f32 v77, v226, v227
    v_cvt_pk_bf16_f32 v78, v228, v229
    v_mfma_f32_16x16x32_bf16 a[72:75], a[144:147], v[88:91], a[72:75]
    ds_read_b128 a[128:131], v192 offset:49152
    v_cvt_pk_bf16_f32 v79, v230, v231
    v_mfma_f32_16x16x32_bf16 a[76:79], a[144:147], v[92:95], a[76:79]
    v_mfma_f32_16x16x32_bf16 a[80:83], a[148:151], v[80:83], a[80:83]
    buffer_load_dword v242, v236, s[40:43], s63 offen
    s_add_u32 s63, s63, 512
    v_mfma_f32_16x16x32_bf16 v[124:127], a[216:219], v[76:79], v[220:223]
    v_mfma_f32_16x16x32_bf16 a[84:87], a[148:151], v[84:87], a[84:87]
    v_mfma_f32_16x16x32_bf16 a[88:91], a[148:151], v[88:91], a[88:91]
    ds_read_b128 a[132:135], v193 offset:49152
    v_mfma_f32_16x16x32_bf16 a[92:95], a[148:151], v[92:95], a[92:95]
    s_add_u32 m0, s25, 0x6000
    s_waitcnt lgkmcnt(2)
    v_mfma_f32_16x16x32_bf16 a[96:99], a[152:155], v[80:83], a[96:99]
    buffer_load_dwordx4 v204, s[4:7], s26 offen lds
    v_mfma_f32_16x16x32_bf16 a[100:103], a[152:155], v[84:87], a[100:103]
    buffer_load_dwordx4 v205, s[4:7], s26 offen offset:1024 lds
    s_add_u32 s26, s26, 0x2000
    v_mfma_f32_16x16x32_bf16 a[104:107], a[152:155], v[88:91], a[104:107]
    ds_read_b128 a[136:139], v194 offset:49152
    v_max3_f32 v252, v112, v116, v120
    v_mfma_f32_16x16x32_bf16 a[108:111], a[152:155], v[92:95], a[108:111]
    v_max_f32 v252, v252, v124
    s_add_u32 m0, s25, 0x12000
    v_mfma_f32_16x16x32_bf16 a[112:115], a[156:159], v[80:83], a[112:115]
    buffer_load_dwordx4 v206, s[8:11], s27 offen lds
    v_cmp_lt_f32 vcc, 0x67800000, v252
    v_mfma_f32_16x16x32_bf16 a[116:119], a[156:159], v[84:87], a[116:119]
    buffer_load_dwordx4 v207, s[8:11], s27 offen offset:1024 lds
    s_add_u32 s27, s27, 0x2000
    v_mfma_f32_16x16x32_bf16 a[120:123], a[156:159], v[88:91], a[120:123]
    ds_read_b128 a[140:143], v195 offset:49152
    s_waitcnt lgkmcnt(2)
    v_mfma_f32_16x16x32_bf16 a[124:127], a[156:159], v[92:95], a[124:127]
    s_cbranch_vccnz TRAMP_L4
BACK_L4:
    v_mfma_f32_16x16x32_bf16 v[0:3], a[128:131], v[128:131], v[96:99]
    v_exp_f32 v224, v32
    v_mfma_f32_16x16x32_bf16 v[8:11], a[128:131], v[144:147], v[100:103]
    v_exp_f32 v225, v33
    v_mfma_f32_16x16x32_bf16 v[16:19], a[128:131], v[160:163], v[104:107]
    ds_read_b128 a[144:147], v192 offset:53248
    v_cvt_pk_bf16_f32 v80, v224, v225
    v_mfma_f32_16x16x32_bf16 v[24:27], a[128:131], v[176:179], v[108:111]
    v_exp_f32 v226, v34
    v_mfma_f32_16x16x32_bf16 v[0:3], a[132:135], v[132:135], v[0:3]
    v_exp_f32 v227, v35
    v_mfma_f32_16x16x32_bf16 v[8:11], a[132:135], v[148:151], v[8:11]
    v_exp_f32 v228, v36
    v_mfma_f32_16x16x32_bf16 v[16:19], a[132:135], v[164:167], v[16:19]
    ds_read_b128 a[148:151], v193 offset:53248
    v_cvt_pk_bf16_f32 v81, v226, v227
    v_mfma_f32_16x16x32_bf16 v[24:27], a[132:135], v[180:183], v[24:27]
    s_waitcnt lgkmcnt(2)
    v_mfma_f32_16x16x32_bf16 v[0:3], a[136:139], v[136:139], v[0:3]
    v_exp_f32 v229, v37
    v_mfma_f32_16x16x32_bf16 v[8:11], a[136:139], v[152:155], v[8:11]
    v_exp_f32 v230, v38
    v_mfma_f32_16x16x32_bf16 v[16:19], a[136:139], v[168:171], v[16:19]
    ds_read_b128 a[152:155], v194 offset:53248
    v_cvt_pk_bf16_f32 v82, v228, v229
    v_mfma_f32_16x16x32_bf16 v[24:27], a[136:139], v[184:187], v[24:27]
    v_exp_f32 v231, v39
    v_mfma_f32_16x16x32_bf16 v[0:3], a[140:143], v[140:143], v[0:3]
    v_exp_f32 v224, v40
    v_mfma_f32_16x16x32_bf16 v[8:11], a[140:143], v[156:159], v[8:11]
    v_exp_f32 v225, v41
    v_mfma_f32_16x16x32_bf16 v[16:19], a[140:143], v[172:175], v[16:19]
    ds_read_b128 a[156:159], v195 offset:53248
    v_cvt_pk_bf16_f32 v83, v230, v231
    v_mfma_f32_16x16x32_bf16 v[24:27], a[140:143], v[188:191], v[24:27]
    v_cvt_pk_bf16_f32 v84, v224, v225
    s_waitcnt lgkmcnt(2)
    v_mfma_f32_16x16x32_bf16 v[208:211], a[216:219], v[80:83], v[112:115]
    v_exp_f32 v226, v42
    v_mfma_f32_16x16x32_bf16 v[4:7], a[144:147], v[128:131], v[96:99]
    v_exp_f32 v227, v43
    v_mfma_f32_16x16x32_bf16 v[12:15], a[144:147], v[144:147], v[100:103]
    v_exp_f32 v228, v44
    v_mfma_f32_16x16x32_bf16 v[20:23], a[144:147], v[160:163], v[104:107]
    ds_read_b64_tr_b16 a[128:129], v196 offset:32768
    ds_read_b64_tr_b16 a[130:131], v196 offset:36864
    v_mfma_f32_16x16x32_bf16 v[28:31], a[144:147], v[176:179], v[108:111]
    v_exp_f32 v229, v45
    v_mfma_f32_16x16x32_bf16 v[4:7], a[148:151], v[132:135], v[4:7]
    v_exp_f32 v230, v46
    v_mfma_f32_16x16x32_bf16 v[12:15], a[148:151], v[148:151], v[12:15]
    v_exp_f32 v231, v47
    v_mfma_f32_16x16x32_bf16 v[20:23], a[148:151], v[164:167], v[20:23]
    ds_read_b64_tr_b16 a[132:133], v197 offset:32768
    ds_read_b64_tr_b16 a[134:135], v197 offset:36864
    v_mfma_f32_16x16x32_bf16 v[28:31], a[148:151], v[180:183], v[28:31]
    v_cvt_pk_bf16_f32 v85, v226, v227
    s_waitcnt lgkmcnt(4)
    v_mfma_f32_16x16x32_bf16 v[4:7], a[152:155], v[136:139], v[4:7]
    v_exp_f32 v224, v48
    v_mfma_f32_16x16x32_bf16 v[12:15], a[152:155], v[152:155], v[12:15]
    v_exp_f32 v225, v49
    v_mfma_f32_16x16x32_bf16 v[20:23], a[152:155], v[168:171], v[20:23]
    ds_read_b64_tr_b16 a[136:137], v198 offset:32768
    ds_read_b64_tr_b16 a[138:139], v198 offset:36864
    v_mfma_f32_16x16x32_bf16 v[28:31], a[152:155], v[184:187], v[28:31]
    v_exp_f32 v226, v50
    v_mfma_f32_16x16x32_bf16 v[4:7], a[156:159], v[140:143], v[4:7]
    v_exp_f32 v227, v51
    v_mfma_f32_16x16x32_bf16 v[12:15], a[156:159], v[156:159], v[12:15]
    v_cvt_pk_bf16_f32 v86, v228, v229
    v_cvt_pk_bf16_f32 v87, v230, v231
    v_mfma_f32_16x16x32_bf16 v[20:23], a[156:159], v[172:175], v[20:23]
    ds_read_b64_tr_b16 a[140:141], v199 offset:32768
    ds_read_b64_tr_b16 a[142:143], v199 offset:36864
    v_mfma_f32_16x16x32_bf16 v[212:215], a[216:219], v[84:87], v[116:119]
    v_exp_f32 v228, v52
    v_mfma_f32_16x16x32_bf16 v[28:31], a[156:159], v[188:191], v[28:31]
    v_cvt_pk_bf16_f32 v88, v224, v225
    s_waitcnt lgkmcnt(4)
    v_mfma_f32_16x16x32_bf16 a[0:3], a[128:131], v[64:67], a[0:3]
    v_exp_f32 v229, v53
    v_mfma_f32_16x16x32_bf16 a[4:7], a[128:131], v[68:71], a[4:7]
    v_exp_f32 v230, v54
    v_mfma_f32_16x16x32_bf16 a[8:11], a[128:131], v[72:75], a[8:11]
    ds_read_b64_tr_b16 a[144:145], v200 offset:32768
    ds_read_b64_tr_b16 a[146:147], v200 offset:36864
    v_mfma_f32_16x16x32_bf16 a[12:15], a[128:131], v[76:79], a[12:15]
    v_exp_f32 v231, v55
    v_mfma_f32_16x16x32_bf16 a[16:19], a[132:135], v[64:67], a[16:19]
    v_exp_f32 v224, v56
    v_mfma_f32_16x16x32_bf16 a[20:23], a[132:135], v[68:71], a[20:23]
    v_exp_f32 v225, v57
    v_mfma_f32_16x16x32_bf16 a[24:27], a[132:135], v[72:75], a[24:27]
    ds_read_b64_tr_b16 a[148:149], v201 offset:32768
    ds_read_b64_tr_b16 a[150:151], v201 offset:36864
    v_mfma_f32_16x16x32_bf16 a[28:31], a[132:135], v[76:79], a[28:31]
    v_cvt_pk_bf16_f32 v89, v226, v227
    s_waitcnt lgkmcnt(4)
    v_mfma_f32_16x16x32_bf16 a[32:35], a[136:139], v[64:67], a[32:35]
    v_exp_f32 v226, v58
    v_mfma_f32_16x16x32_bf16 a[36:39], a[136:139], v[68:71], a[36:39]
    v_exp_f32 v227, v59
    v_mfma_f32_16x16x32_bf16 a[40:43], a[136:139], v[72:75], a[40:43]
    ds_read_b64_tr_b16 a[152:153], v202 offset:32768
    ds_read_b64_tr_b16 a[154:155], v202 offset:36864
    v_mfma_f32_16x16x32_bf16 a[44:47], a[136:139], v[76:79], a[44:47]
    v_cvt_pk_bf16_f32 v90, v228, v229
    v_cvt_pk_bf16_f32 v91, v230, v231
    v_mfma_f32_16x16x32_bf16 a[48:51], a[140:143], v[64:67], a[48:51]
    v_exp_f32 v228, v60
    v_mfma_f32_16x16x32_bf16 v[216:219], a[216:219], v[88:91], v[120:123]
    v_exp_f32 v229, v61
    v_mfma_f32_16x16x32_bf16 a[52:55], a[140:143], v[68:71], a[52:55]
    v_exp_f32 v230, v62
    v_mfma_f32_16x16x32_bf16 a[56:59], a[140:143], v[72:75], a[56:59]
    ds_read_b64_tr_b16 a[156:157], v203 offset:32768
    ds_read_b64_tr_b16 a[158:159], v203 offset:36864
    v_mfma_f32_16x16x32_bf16 a[60:63], a[140:143], v[76:79], a[60:63]
    v_cvt_pk_bf16_f32 v92, v224, v225
    s_waitcnt lgkmcnt(4)
    v_mfma_f32_16x16x32_bf16 a[64:67], a[144:147], v[64:67], a[64:67]
    v_exp_f32 v231, v63
    v_mfma_f32_16x16x32_bf16 a[68:71], a[144:147], v[68:71], a[68:71]
    v_cvt_pk_bf16_f32 v93, v226, v227
    v_cvt_pk_bf16_f32 v94, v228, v229
    v_mfma_f32_16x16x32_bf16 a[72:75], a[144:147], v[72:75], a[72:75]
    ds_read_b128 a[128:131], v192 offset:57344
    v_cvt_pk_bf16_f32 v95, v230, v231
    v_mfma_f32_16x16x32_bf16 a[76:79], a[144:147], v[76:79], a[76:79]
    v_mfma_f32_16x16x32_bf16 a[80:83], a[148:151], v[64:67], a[80:83]
    buffer_load_dword v243, v236, s[40:43], s63 offen
    s_add_u32 s63, s63, 512
    v_mfma_f32_16x16x32_bf16 v[220:223], a[216:219], v[92:95], v[124:127]
    v_mfma_f32_16x16x32_bf16 a[84:87], a[148:151], v[68:71], a[84:87]
    v_mfma_f32_16x16x32_bf16 a[88:91], a[148:151], v[72:75], a[88:91]
    ds_read_b128 a[132:135], v193 offset:57344
    v_mfma_f32_16x16x32_bf16 a[92:95], a[148:151], v[76:79], a[92:95]
    s_add_u32 m0, s25, 0x8000
    s_waitcnt lgkmcnt(2)
    v_mfma_f32_16x16x32_bf16 a[96:99], a[152:155], v[64:67], a[96:99]
    buffer_load_dwordx4 v204, s[4:7], s26 offen lds
    v_mfma_f32_16x16x32_bf16 a[100:103], a[152:155], v[68:71], a[100:103]
    buffer_load_dwordx4 v205, s[4:7], s26 offen offset:1024 lds
    s_add_u32 s26, s26, 0x2000
    v_mfma_f32_16x16x32_bf16 a[104:107], a[152:155], v[72:75], a[104:107]
    ds_read_b128 a[136:139], v194 offset:57344
    v_max3_f32 v252, v208, v212, v216
    v_mfma_f32_16x16x32_bf16 a[108:111], a[152:155], v[76:79], a[108:111]
    v_max_f32 v252, v252, v220
    s_add_u32 m0, s25, 0x14000
    v_mfma_f32_16x16x32_bf16 a[112:115], a[156:159], v[64:67], a[112:115]
    buffer_load_dwordx4 v206, s[8:11], s27 offen lds
    v_cmp_lt_f32 vcc, 0x67800000, v252
    v_mfma_f32_16x16x32_bf16 a[116:119], a[156:159], v[68:71], a[116:119]
    buffer_load_dwordx4 v207, s[8:11], s27 offen offset:1024 lds
    s_add_u32 s27, s27, 0x2000
    v_mfma_f32_16x16x32_bf16 a[120:123], a[156:159], v[72:75], a[120:123]
    ds_read_b128 a[140:143], v195 offset:57344
    s_waitcnt lgkmcnt(2)
    v_mfma_f32_16x16x32_bf16 a[124:127], a[156:159], v[76:79], a[124:127]
    s_cbranch_vccnz TRAMP_L5
BACK_L5:
    s_waitcnt vmcnt(15)
    s_barrier
    v_mfma_f32_16x16x32_bf16 v[32:35], a[128:131], v[128:131], v[96:99]
    v_exp_f32 v224, v0
    v_mfma_f32_16x16x32_bf16 v[40:43], a[128:131], v[144:147], v[100:103]
    v_exp_f32 v225, v1
    v_mfma_f32_16x16x32_bf16 v[48:51], a[128:131], v[160:163], v[104:107]
    ds_read_b128 a[144:147], v192 offset:61440
    v_cvt_pk_bf16_f32 v64, v224, v225
    v_mfma_f32_16x16x32_bf16 v[56:59], a[128:131], v[176:179], v[108:111]
    v_exp_f32 v226, v2
    v_mfma_f32_16x16x32_bf16 v[32:35], a[132:135], v[132:135], v[32:35]
    v_exp_f32 v227, v3
    v_mfma_f32_16x16x32_bf16 v[40:43], a[132:135], v[148:151], v[40:43]
    v_exp_f32 v228, v4
    v_mfma_f32_16x16x32_bf16 v[48:51], a[132:135], v[164:167], v[48:51]
    ds_read_b128 a[148:151], v193 offset:61440
    v_cvt_pk_bf16_f32 v65, v226, v227
    v_mfma_f32_16x16x32_bf16 v[56:59], a[132:135], v[180:183], v[56:59]
    s_waitcnt lgkmcnt(2)
    v_mfma_f32_16x16x32_bf16 v[32:35], a[136:139], v[136:139], v[32:35]
    v_exp_f32 v229, v5
    v_mfma_f32_16x16x32_bf16 v[40:43], a[136:139], v[152:155], v[40:43]
    v_exp_f32 v230, v6
    v_mfma_f32_16x16x32_bf16 v[48:51], a[136:139], v[168:171], v[48:51]
    ds_read_b128 a[152:155], v194 offset:61440
    v_cvt_pk_bf16_f32 v66, v228, v229
    v_mfma_f32_16x16x32_bf16 v[56:59], a[136:139], v[184:187], v[56:59]
    v_exp_f32 v231, v7
    v_mfma_f32_16x16x32_bf16 v[32:35], a[140:143], v[140:143], v[32:35]
    v_exp_f32 v224, v8
    v_mfma_f32_16x16x32_bf16 v[40:43], a[140:143], v[156:159], v[40:43]
    v_exp_f32 v225, v9
    v_mfma_f32_16x16x32_bf16 v[48:51], a[140:143], v[172:175], v[48:51]
    ds_read_b128 a[156:159], v195 offset:61440
    v_cvt_pk_bf16_f32 v67, v230, v231
    v_mfma_f32_16x16x32_bf16 v[56:59], a[140:143], v[188:191], v[56:59]
    v_cvt_pk_bf16_f32 v68, v224, v225
    s_waitcnt lgkmcnt(2)
    v_mfma_f32_16x16x32_bf16 v[112:115], a[216:219], v[64:67], v[208:211]
    v_exp_f32 v226, v10
    v_mfma_f32_16x16x32_bf16 v[36:39], a[144:147], v[128:131], v[96:99]
    v_exp_f32 v227, v11
    v_mfma_f32_16x16x32_bf16 v[44:47], a[144:147], v[144:147], v[100:103]
    v_exp_f32 v228, v12
    v_mfma_f32_16x16x32_bf16 v[52:55], a[144:147], v[160:163], v[104:107]
    ds_read_b64_tr_b16 a[128:129], v196 offset:40960
    ds_read_b64_tr_b16 a[130:131], v196 offset:45056
    v_mfma_f32_16x16x32_bf16 v[60:63], a[144:147], v[176:179], v[108:111]
    v_exp_f32 v229, v13
    v_mfma_f32_16x16x32_bf16 v[36:39], a[148:151], v[132:135], v[36:39]
    v_exp_f32 v230, v14
    v_mfma_f32_16x16x32_bf16 v[44:47], a[148:151], v[148:151], v[44:47]
    v_exp_f32 v231, v15
    v_mfma_f32_16x16x32_bf16 v[52:55], a[148:151], v[164:167], v[52:55]
    ds_read_b64_tr_b16 a[132:133], v197 offset:40960
    ds_read_b64_tr_b16 a[134:135], v197 offset:45056
    v_mfma_f32_16x16x32_bf16 v[60:63], a[148:151], v[180:183], v[60:63]
    v_cvt_pk_bf16_f32 v69, v226, v227
    s_waitcnt lgkmcnt(4)
    v_mfma_f32_16x16x32_bf16 v[36:39], a[152:155], v[136:139], v[36:39]
    v_exp_f32 v224, v16
    v_mfma_f32_16x16x32_bf16 v[44:47], a[152:155], v[152:155], v[44:47]
    v_exp_f32 v225, v17
    v_mfma_f32_16x16x32_bf16 v[52:55], a[152:155], v[168:171], v[52:55]
    ds_read_b64_tr_b16 a[136:137], v198 offset:40960
    ds_read_b64_tr_b16 a[138:139], v198 offset:45056
    v_mfma_f32_16x16x32_bf16 v[60:63], a[152:155], v[184:187], v[60:63]
    v_exp_f32 v226, v18
    v_mfma_f32_16x16x32_bf16 v[36:39], a[156:159], v[140:143], v[36:39]
    v_exp_f32 v227, v19
    v_mfma_f32_16x16x32_bf16 v[44:47], a[156:159], v[156:159], v[44:47]
    v_cvt_pk_bf16_f32 v70, v228, v229
    v_cvt_pk_bf16_f32 v71, v230, v231
    v_mfma_f32_16x16x32_bf16 v[52:55], a[156:159], v[172:175], v[52:55]
    ds_read_b64_tr_b16 a[140:141], v199 offset:40960
    ds_read_b64_tr_b16 a[142:143], v199 offset:45056
    v_mfma_f32_16x16x32_bf16 v[116:119], a[216:219], v[68:71], v[212:215]
    v_exp_f32 v228, v20
    v_mfma_f32_16x16x32_bf16 v[60:63], a[156:159], v[188:191], v[60:63]
    v_cvt_pk_bf16_f32 v72, v224, v225
    s_waitcnt lgkmcnt(4)
    v_mfma_f32_16x16x32_bf16 a[0:3], a[128:131], v[80:83], a[0:3]
    v_exp_f32 v229, v21
    v_mfma_f32_16x16x32_bf16 a[4:7], a[128:131], v[84:87], a[4:7]
    v_exp_f32 v230, v22
    v_mfma_f32_16x16x32_bf16 a[8:11], a[128:131], v[88:91], a[8:11]
    ds_read_b64_tr_b16 a[144:145], v200 offset:40960
    ds_read_b64_tr_b16 a[146:147], v200 offset:45056
    v_mfma_f32_16x16x32_bf16 a[12:15], a[128:131], v[92:95], a[12:15]
    v_exp_f32 v231, v23
    v_mfma_f32_16x16x32_bf16 a[16:19], a[132:135], v[80:83], a[16:19]
    v_exp_f32 v224, v24
    v_mfma_f32_16x16x32_bf16 a[20:23], a[132:135], v[84:87], a[20:23]
    v_exp_f32 v225, v25
    v_mfma_f32_16x16x32_bf16 a[24:27], a[132:135], v[88:91], a[24:27]
    ds_read_b64_tr_b16 a[148:149], v201 offset:40960
    ds_read_b64_tr_b16 a[150:151], v201 offset:45056
    v_mfma_f32_16x16x32_bf16 a[28:31], a[132:135], v[92:95], a[28:31]
    v_cvt_pk_bf16_f32 v73, v226, v227
    s_waitcnt lgkmcnt(4)
    v_mfma_f32_16x16x32_bf16 a[32:35], a[136:139], v[80:83], a[32:35]
    v_exp_f32 v226, v26
    v_mfma_f32_16x16x32_bf16 a[36:39], a[136:139], v[84:87], a[36:39]
    v_exp_f32 v227, v27
    v_mfma_f32_16x16x32_bf16 a[40:43], a[136:139], v[88:91], a[40:43]
    ds_read_b64_tr_b16 a[152:153], v202 offset:40960
    ds_read_b64_tr_b16 a[154:155], v202 offset:45056
    v_mfma_f32_16x16x32_bf16 a[44:47], a[136:139], v[92:95], a[44:47]
    v_cvt_pk_bf16_f32 v74, v228, v229
    v_cvt_pk_bf16_f32 v75, v230, v231
    v_mfma_f32_16x16x32_bf16 a[48:51], a[140:143], v[80:83], a[48:51]
    v_exp_f32 v228, v28
    v_mfma_f32_16x16x32_bf16 v[120:123], a[216:219], v[72:75], v[216:219]
    v_exp_f32 v229, v29
    v_mfma_f32_16x16x32_bf16 a[52:55], a[140:143], v[84:87], a[52:55]
    v_exp_f32 v230, v30
    v_mfma_f32_16x16x32_bf16 a[56:59], a[140:143], v[88:91], a[56:59]
    ds_read_b64_tr_b16 a[156:157], v203 offset:40960
    ds_read_b64_tr_b16 a[158:159], v203 offset:45056
    v_mfma_f32_16x16x32_bf16 a[60:63], a[140:143], v[92:95], a[60:63]
    v_cvt_pk_bf16_f32 v76, v224, v225
    s_waitcnt lgkmcnt(4)
    v_mfma_f32_16x16x32_bf16 a[64:67], a[144:147], v[80:83], a[64:67]
    v_exp_f32 v231, v31
    v_mfma_f32_16x16x32_bf16 a[68:71], a[144:147], v[84:87], a[68:71]
    v_cvt_pk_bf16_f32 v77, v226, v227
    v_cvt_pk_bf16_f32 v78, v228, v229
    v_mfma_f32_16x16x32_bf16 a[72:75], a[144:147], v[88:91], a[72:75]
    ds_read_b128 a[128:131], v192 offset:0
    v_cvt_pk_bf16_f32 v79, v230, v231
    v_mfma_f32_16x16x32_bf16 a[76:79], a[144:147], v[92:95], a[76:79]
    v_mfma_f32_16x16x32_bf16 a[80:83], a[148:151], v[80:83], a[80:83]
    buffer_load_dword v244, v236, s[40:43], s63 offen
    s_add_u32 s63, s63, 512
    v_mfma_f32_16x16x32_bf16 v[124:127], a[216:219], v[76:79], v[220:223]
    v_mfma_f32_16x16x32_bf16 a[84:87], a[148:151], v[84:87], a[84:87]
    v_mfma_f32_16x16x32_bf16 a[88:91], a[148:151], v[88:91], a[88:91]
    ds_read_b128 a[132:135], v193 offset:0
    v_mfma_f32_16x16x32_bf16 a[92:95], a[148:151], v[92:95], a[92:95]
    s_add_u32 m0, s25, 0xa000
    s_waitcnt lgkmcnt(2)
    v_mfma_f32_16x16x32_bf16 a[96:99], a[152:155], v[80:83], a[96:99]
    buffer_load_dwordx4 v204, s[4:7], s26 offen lds
    v_mfma_f32_16x16x32_bf16 a[100:103], a[152:155], v[84:87], a[100:103]
    buffer_load_dwordx4 v205, s[4:7], s26 offen offset:1024 lds
    s_add_u32 s26, s26, 0x2000
    v_mfma_f32_16x16x32_bf16 a[104:107], a[152:155], v[88:91], a[104:107]
    ds_read_b128 a[136:139], v194 offset:0
    v_max3_f32 v252, v112, v116, v120
    v_mfma_f32_16x16x32_bf16 a[108:111], a[152:155], v[92:95], a[108:111]
    v_max_f32 v252, v252, v124
    s_add_u32 m0, s25, 0x16000
    v_mfma_f32_16x16x32_bf16 a[112:115], a[156:159], v[80:83], a[112:115]
    buffer_load_dwordx4 v206, s[8:11], s27 offen lds
    v_cmp_lt_f32 vcc, 0x67800000, v252
    v_mfma_f32_16x16x32_bf16 a[116:119], a[156:159], v[84:87], a[116:119]
    buffer_load_dwordx4 v207, s[8:11], s27 offen offset:1024 lds
    s_add_u32 s27, s27, 0x2000
    v_mfma_f32_16x16x32_bf16 a[120:123], a[156:159], v[88:91], a[120:123]
    ds_read_b128 a[140:143], v195 offset:0
    s_waitcnt lgkmcnt(2)
    v_mfma_f32_16x16x32_bf16 a[124:127], a[156:159], v[92:95], a[124:127]
    s_cbranch_vccnz TRAMP_L6
BACK_L6:
    v_mfma_f32_16x16x32_bf16 v[0:3], a[128:131], v[128:131], v[96:99]
    v_exp_f32 v224, v32
    v_mfma_f32_16x16x32_bf16 v[8:11], a[128:131], v[144:147], v[100:103]
    v_exp_f32 v225, v33
    v_mfma_f32_16x16x32_bf16 v[16:19], a[128:131], v[160:163], v[104:107]
    ds_read_b128 a[144:147], v192 offset:4096
    v_cvt_pk_bf16_f32 v80, v224, v225
    v_mfma_f32_16x16x32_bf16 v[24:27], a[128:131], v[176:179], v[108:111]
    v_exp_f32 v226, v34
    v_mfma_f32_16x16x32_bf16 v[0:3], a[132:135], v[132:135], v[0:3]
    v_exp_f32 v227, v35
    v_mfma_f32_16x16x32_bf16 v[8:11], a[132:135], v[148:151], v[8:11]
    v_exp_f32 v228, v36
    v_mfma_f32_16x16x32_bf16 v[16:19], a[132:135], v[164:167], v[16:19]
    ds_read_b128 a[148:151], v193 offset:4096
    v_cvt_pk_bf16_f32 v81, v226, v227
    v_mfma_f32_16x16x32_bf16 v[24:27], a[132:135], v[180:183], v[24:27]
    s_waitcnt lgkmcnt(2)
    v_mfma_f32_16x16x32_bf16 v[0:3], a[136:139], v[136:139], v[0:3]
    v_exp_f32 v229, v37
    v_mfma_f32_16x16x32_bf16 v[8:11], a[136:139], v[152:155], v[8:11]
    v_exp_f32 v230, v38
    v_mfma_f32_16x16x32_bf16 v[16:19], a[136:139], v[168:171], v[16:19]
    ds_read_b128 a[152:155], v194 offset:4096
    v_cvt_pk_bf16_f32 v82, v228, v229
    v_mfma_f32_16x16x32_bf16 v[24:27], a[136:139], v[184:187], v[24:27]
    v_exp_f32 v231, v39
    v_mfma_f32_16x16x32_bf16 v[0:3], a[140:143], v[140:143], v[0:3]
    v_exp_f32 v224, v40
    v_mfma_f32_16x16x32_bf16 v[8:11], a[140:143], v[156:159], v[8:11]
    v_exp_f32 v225, v41
    v_mfma_f32_16x16x32_bf16 v[16:19], a[140:143], v[172:175], v[16:19]
    ds_read_b128 a[156:159], v195 offset:4096
    v_cvt_pk_bf16_f32 v83, v230, v231
    v_mfma_f32_16x16x32_bf16 v[24:27], a[140:143], v[188:191], v[24:27]
    v_cvt_pk_bf16_f32 v84, v224, v225
    s_waitcnt lgkmcnt(2)
    v_mfma_f32_16x16x32_bf16 v[208:211], a[216:219], v[80:83], v[112:115]
    v_exp_f32 v226, v42
    v_mfma_f32_16x16x32_bf16 v[4:7], a[144:147], v[128:131], v[96:99]
    v_exp_f32 v227, v43
    v_mfma_f32_16x16x32_bf16 v[12:15], a[144:147], v[144:147], v[100:103]
    v_exp_f32 v228, v44
    v_mfma_f32_16x16x32_bf16 v[20:23], a[144:147], v[160:163], v[104:107]
    ds_read_b64_tr_b16 a[128:129], v196 offset:49152
    ds_read_b64_tr_b16 a[130:131], v196 offset:53248
    v_mfma_f32_16x16x32_bf16 v[28:31], a[144:147], v[176:179], v[108:111]
    v_exp_f32 v229, v45
    v_mfma_f32_16x16x32_bf16 v[4:7], a[148:151], v[132:135], v[4:7]
    v_exp_f32 v230, v46
    v_mfma_f32_16x16x32_bf16 v[12:15], a[148:151], v[148:151], v[12:15]
    v_exp_f32 v231, v47
    v_mfma_f32_16x16x32_bf16 v[20:23], a[148:151], v[164:167], v[20:23]
    ds_read_b64_tr_b16 a[132:133], v197 offset:49152
    ds_read_b64_tr_b16 a[134:135], v197 offset:53248
    v_mfma_f32_16x16x32_bf16 v[28:31], a[148:151], v[180:183], v[28:31]
    v_cvt_pk_bf16_f32 v85, v226, v227
    s_waitcnt lgkmcnt(4)
    v_mfma_f32_16x16x32_bf16 v[4:7], a[152:155], v[136:139], v[4:7]
    v_exp_f32 v224, v48
    v_mfma_f32_16x16x32_bf16 v[12:15], a[152:155], v[152:155], v[12:15]
    v_exp_f32 v225, v49
    v_mfma_f32_16x16x32_bf16 v[20:23], a[152:155], v[168:171], v[20:23]
    ds_read_b64_tr_b16 a[136:137], v198 offset:49152
    ds_read_b64_tr_b16 a[138:139], v198 offset:53248
    v_mfma_f32_16x16x32_bf16 v[28:31], a[152:155], v[184:187], v[28:31]
    v_exp_f32 v226, v50
    v_mfma_f32_16x16x32_bf16 v[4:7], a[156:159], v[140:143], v[4:7]
    v_exp_f32 v227, v51
    v_mfma_f32_16x16x32_bf16 v[12:15], a[156:159], v[156:159], v[12:15]
    v_cvt_pk_bf16_f32 v86, v228, v229
    v_cvt_pk_bf16_f32 v87, v230, v231
    v_mfma_f32_16x16x32_bf16 v[20:23], a[156:159], v[172:175], v[20:23]
    ds_read_b64_tr_b16 a[140:141], v199 offset:49152
    ds_read_b64_tr_b16 a[142:143], v199 offset:53248
    v_mfma_f32_16x16x32_bf16 v[212:215], a[216:219], v[84:87], v[116:119]
    v_exp_f32 v228, v52
    v_mfma_f32_16x16x32_bf16 v[28:31], a[156:159], v[188:191], v[28:31]
    v_cvt_pk_bf16_f32 v88, v224, v225
    s_waitcnt lgkmcnt(4)
    v_mfma_f32_16x16x32_bf16 a[0:3], a[128:131], v[64:67], a[0:3]
    v_exp_f32 v229, v53
    v_mfma_f32_16x16x32_bf16 a[4:7], a[128:131], v[68:71], a[4:7]
    v_exp_f32 v230, v54
    v_mfma_f32_16x16x32_bf16 a[8:11], a[128:131], v[72:75], a[8:11]
    ds_read_b64_tr_b16 a[144:145], v200 offset:49152
    ds_read_b64_tr_b16 a[146:147], v200 offset:53248
    v_mfma_f32_16x16x32_bf16 a[12:15], a[128:131], v[76:79], a[12:15]
    v_exp_f32 v231, v55
    v_mfma_f32_16x16x32_bf16 a[16:19], a[132:135], v[64:67], a[16:19]
    v_exp_f32 v224, v56
    v_mfma_f32_16x16x32_bf16 a[20:23], a[132:135], v[68:71], a[20:23]
    v_exp_f32 v225, v57
    v_mfma_f32_16x16x32_bf16 a[24:27], a[132:135], v[72:75], a[24:27]
    ds_read_b64_tr_b16 a[148:149], v201 offset:49152
    ds_read_b64_tr_b16 a[150:151], v201 offset:53248
    v_mfma_f32_16x16x32_bf16 a[28:31], a[132:135], v[76:79], a[28:31]
    v_cvt_pk_bf16_f32 v89, v226, v227
    s_waitcnt lgkmcnt(4)
    v_mfma_f32_16x16x32_bf16 a[32:35], a[136:139], v[64:67], a[32:35]
    v_exp_f32 v226, v58
    v_mfma_f32_16x16x32_bf16 a[36:39], a[136:139], v[68:71], a[36:39]
    v_exp_f32 v227, v59
    v_mfma_f32_16x16x32_bf16 a[40:43], a[136:139], v[72:75], a[40:43]
    ds_read_b64_tr_b16 a[152:153], v202 offset:49152
    ds_read_b64_tr_b16 a[154:155], v202 offset:53248
    v_mfma_f32_16x16x32_bf16 a[44:47], a[136:139], v[76:79], a[44:47]
    v_cvt_pk_bf16_f32 v90, v228, v229
    v_cvt_pk_bf16_f32 v91, v230, v231
    v_mfma_f32_16x16x32_bf16 a[48:51], a[140:143], v[64:67], a[48:51]
    v_exp_f32 v228, v60
    v_mfma_f32_16x16x32_bf16 v[216:219], a[216:219], v[88:91], v[120:123]
    v_exp_f32 v229, v61
    v_mfma_f32_16x16x32_bf16 a[52:55], a[140:143], v[68:71], a[52:55]
    v_exp_f32 v230, v62
    v_mfma_f32_16x16x32_bf16 a[56:59], a[140:143], v[72:75], a[56:59]
    ds_read_b64_tr_b16 a[156:157], v203 offset:49152
    ds_read_b64_tr_b16 a[158:159], v203 offset:53248
    v_mfma_f32_16x16x32_bf16 a[60:63], a[140:143], v[76:79], a[60:63]
    v_cvt_pk_bf16_f32 v92, v224, v225
    s_waitcnt lgkmcnt(4)
    v_mfma_f32_16x16x32_bf16 a[64:67], a[144:147], v[64:67], a[64:67]
    v_exp_f32 v231, v63
    v_mfma_f32_16x16x32_bf16 a[68:71], a[144:147], v[68:71], a[68:71]
    v_cvt_pk_bf16_f32 v93, v226, v227
    v_cvt_pk_bf16_f32 v94, v228, v229
    v_mfma_f32_16x16x32_bf16 a[72:75], a[144:147], v[72:75], a[72:75]
    ds_read_b128 a[128:131], v192 offset:8192
    v_cvt_pk_bf16_f32 v95, v230, v231
    v_mfma_f32_16x16x32_bf16 a[76:79], a[144:147], v[76:79], a[76:79]
    v_mfma_f32_16x16x32_bf16 a[80:83], a[148:151], v[64:67], a[80:83]
    buffer_load_dword v245, v236, s[40:43], s63 offen
    s_add_u32 s63, s63, 512
    v_mfma_f32_16x16x32_bf16 v[220:223], a[216:219], v[92:95], v[124:127]
    v_mfma_f32_16x16x32_bf16 a[84:87], a[148:151], v[68:71], a[84:87]
    v_mfma_f32_16x16x32_bf16 a[88:91], a[148:151], v[72:75], a[88:91]
    ds_read_b128 a[132:135], v193 offset:8192
    v_mfma_f32_16x16x32_bf16 a[92:95], a[148:151], v[76:79], a[92:95]
    s_add_u32 m0, s25, 0xc000
    s_waitcnt lgkmcnt(2)
    v_mfma_f32_16x16x32_bf16 a[96:99], a[152:155], v[64:67], a[96:99]
    buffer_load_dwordx4 v204, s[4:7], s26 offen lds
    v_mfma_f32_16x16x32_bf16 a[100:103], a[152:155], v[68:71], a[100:103]
    buffer_load_dwordx4 v205, s[4:7], s26 offen offset:1024 lds
    s_add_u32 s26, s26, 0x2000
    v_mfma_f32_16x16x32_bf16 a[104:107], a[152:155], v[72:75], a[104:107]
    ds_read_b128 a[136:139], v194 offset:8192
    v_max3_f32 v252, v208, v212, v216
    v_mfma_f32_16x16x32_bf16 a[108:111], a[152:155], v[76:79], a[108:111]
    v_max_f32 v252, v252, v220
    s_add_u32 m0, s25, 0x18000
    v_mfma_f32_16x16x32_bf16 a[112:115], a[156:159], v[64:67], a[112:115]
    buffer_load_dwordx4 v206, s[8:11], s27 offen lds
    v_cmp_lt_f32 vcc, 0x67800000, v252
    v_mfma_f32_16x16x32_bf16 a[116:119], a[156:159], v[68:71], a[116:119]
    buffer_load_dwordx4 v207, s[8:11], s27 offen offset:1024 lds
    s_add_u32 s27, s27, 0x2000
    v_mfma_f32_16x16x32_bf16 a[120:123], a[156:159], v[72:75], a[120:123]
    ds_read_b128 a[140:143], v195 offset:8192
    s_waitcnt lgkmcnt(2)
    v_mfma_f32_16x16x32_bf16 a[124:127], a[156:159], v[76:79], a[124:127]
    s_cbranch_vccnz TRAMP_L7
BACK_L7:
    s_waitcnt vmcnt(15)
    s_barrier
    v_mfma_f32_16x16x32_bf16 v[32:35], a[128:131], v[128:131], v[96:99]
    v_exp_f32 v224, v0
    v_mfma_f32_16x16x32_bf16 v[40:43], a[128:131], v[144:147], v[100:103]
    v_exp_f32 v225, v1
    v_mfma_f32_16x16x32_bf16 v[48:51], a[128:131], v[160:163], v[104:107]
    ds_read_b128 a[144:147], v192 offset:12288
    v_cvt_pk_bf16_f32 v64, v224, v225
    v_mfma_f32_16x16x32_bf16 v[56:59], a[128:131], v[176:179], v[108:111]
    v_exp_f32 v226, v2
    v_mfma_f32_16x16x32_bf16 v[32:35], a[132:135], v[132:135], v[32:35]
    v_exp_f32 v227, v3
    v_mfma_f32_16x16x32_bf16 v[40:43], a[132:135], v[148:151], v[40:43]
    v_exp_f32 v228, v4
    v_mfma_f32_16x16x32_bf16 v[48:51], a[132:135], v[164:167], v[48:51]
    ds_read_b128 a[148:151], v193 offset:12288
    v_cvt_pk_bf16_f32 v65, v226, v227
    v_mfma_f32_16x16x32_bf16 v[56:59], a[132:135], v[180:183], v[56:59]
    s_waitcnt lgkmcnt(2)
    v_mfma_f32_16x16x32_bf16 v[32:35], a[136:139], v[136:139], v[32:35]
    v_exp_f32 v229, v5
    v_mfma_f32_16x16x32_bf16 v[40:43], a[136:139], v[152:155], v[40:43]
    v_exp_f32 v230, v6
    v_mfma_f32_16x16x32_bf16 v[48:51], a[136:139], v[168:171], v[48:51]
    ds_read_b128 a[152:155], v194 offset:12288
    v_cvt_pk_bf16_f32 v66, v228, v229
    v_mfma_f32_16x16x32_bf16 v[56:59], a[136:139], v[184:187], v[56:59]
    v_exp_f32 v231, v7
    v_mfma_f32_16x16x32_bf16 v[32:35], a[140:143], v[140:143], v[32:35]
    v_exp_f32 v224, v8
    v_mfma_f32_16x16x32_bf16 v[40:43], a[140:143], v[156:159], v[40:43]
    v_exp_f32 v225, v9
    v_mfma_f32_16x16x32_bf16 v[48:51], a[140:143], v[172:175], v[48:51]
    ds_read_b128 a[156:159], v195 offset:12288
    v_cvt_pk_bf16_f32 v67, v230, v231
    v_mfma_f32_16x16x32_bf16 v[56:59], a[140:143], v[188:191], v[56:59]
    v_cvt_pk_bf16_f32 v68, v224, v225
    s_waitcnt lgkmcnt(2)
    v_mfma_f32_16x16x32_bf16 v[112:115], a[216:219], v[64:67], v[208:211]
    v_exp_f32 v226, v10
    v_mfma_f32_16x16x32_bf16 v[36:39], a[144:147], v[128:131], v[96:99]
    v_exp_f32 v227, v11
    v_mfma_f32_16x16x32_bf16 v[44:47], a[144:147], v[144:147], v[100:103]
    v_exp_f32 v228, v12
    v_mfma_f32_16x16x32_bf16 v[52:55], a[144:147], v[160:163], v[104:107]
    ds_read_b64_tr_b16 a[128:129], v196 offset:57344
    ds_read_b64_tr_b16 a[130:131], v196 offset:61440
    v_mfma_f32_16x16x32_bf16 v[60:63], a[144:147], v[176:179], v[108:111]
    v_exp_f32 v229, v13
    v_mfma_f32_16x16x32_bf16 v[36:39], a[148:151], v[132:135], v[36:39]
    v_exp_f32 v230, v14
    v_mfma_f32_16x16x32_bf16 v[44:47], a[148:151], v[148:151], v[44:47]
    v_exp_f32 v231, v15
    v_mfma_f32_16x16x32_bf16 v[52:55], a[148:151], v[164:167], v[52:55]
    ds_read_b64_tr_b16 a[132:133], v197 offset:57344
    ds_read_b64_tr_b16 a[134:135], v197 offset:61440
    v_mfma_f32_16x16x32_bf16 v[60:63], a[148:151], v[180:183], v[60:63]
    v_cvt_pk_bf16_f32 v69, v226, v227
    s_waitcnt lgkmcnt(4)
    v_mfma_f32_16x16x32_bf16 v[36:39], a[152:155], v[136:139], v[36:39]
    v_exp_f32 v224, v16
    v_mfma_f32_16x16x32_bf16 v[44:47], a[152:155], v[152:155], v[44:47]
    v_exp_f32 v225, v17
    v_mfma_f32_16x16x32_bf16 v[52:55], a[152:155], v[168:171], v[52:55]
    ds_read_b64_tr_b16 a[136:137], v198 offset:57344
    ds_read_b64_tr_b16 a[138:139], v198 offset:61440
    v_mfma_f32_16x16x32_bf16 v[60:63], a[152:155], v[184:187], v[60:63]
    v_exp_f32 v226, v18
    v_mfma_f32_16x16x32_bf16 v[36:39], a[156:159], v[140:143], v[36:39]
    v_exp_f32 v227, v19
    v_mfma_f32_16x16x32_bf16 v[44:47], a[156:159], v[156:159], v[44:47]
    v_cvt_pk_bf16_f32 v70, v228, v229
    v_cvt_pk_bf16_f32 v71, v230, v231
    v_mfma_f32_16x16x32_bf16 v[52:55], a[156:159], v[172:175], v[52:55]
    ds_read_b64_tr_b16 a[140:141], v199 offset:57344
    ds_read_b64_tr_b16 a[142:143], v199 offset:61440
    v_mfma_f32_16x16x32_bf16 v[116:119], a[216:219], v[68:71], v[212:215]
    v_exp_f32 v228, v20
    v_mfma_f32_16x16x32_bf16 v[60:63], a[156:159], v[188:191], v[60:63]
    v_cvt_pk_bf16_f32 v72, v224, v225
    s_waitcnt lgkmcnt(4)
    v_mfma_f32_16x16x32_bf16 a[0:3], a[128:131], v[80:83], a[0:3]
    v_exp_f32 v229, v21
    v_mfma_f32_16x16x32_bf16 a[4:7], a[128:131], v[84:87], a[4:7]
    v_exp_f32 v230, v22
    v_mfma_f32_16x16x32_bf16 a[8:11], a[128:131], v[88:91], a[8:11]
    ds_read_b64_tr_b16 a[144:145], v200 offset:57344
    ds_read_b64_tr_b16 a[146:147], v200 offset:61440
    v_mfma_f32_16x16x32_bf16 a[12:15], a[128:131], v[92:95], a[12:15]
    v_exp_f32 v231, v23
    v_mfma_f32_16x16x32_bf16 a[16:19], a[132:135], v[80:83], a[16:19]
    v_exp_f32 v224, v24
    v_mfma_f32_16x16x32_bf16 a[20:23], a[132:135], v[84:87], a[20:23]
    v_exp_f32 v225, v25
    v_mfma_f32_16x16x32_bf16 a[24:27], a[132:135], v[88:91], a[24:27]
    ds_read_b64_tr_b16 a[148:149], v201 offset:57344
    ds_read_b64_tr_b16 a[150:151], v201 offset:61440
    v_mfma_f32_16x16x32_bf16 a[28:31], a[132:135], v[92:95], a[28:31]
    v_cvt_pk_bf16_f32 v73, v226, v227
    s_waitcnt lgkmcnt(4)
    v_mfma_f32_16x16x32_bf16 a[32:35], a[136:139], v[80:83], a[32:35]
    v_exp_f32 v226, v26
    v_mfma_f32_16x16x32_bf16 a[36:39], a[136:139], v[84:87], a[36:39]
    v_exp_f32 v227, v27
    v_mfma_f32_16x16x32_bf16 a[40:43], a[136:139], v[88:91], a[40:43]
    ds_read_b64_tr_b16 a[152:153], v202 offset:57344
    ds_read_b64_tr_b16 a[154:155], v202 offset:61440
    v_mfma_f32_16x16x32_bf16 a[44:47], a[136:139], v[92:95], a[44:47]
    v_cvt_pk_bf16_f32 v74, v228, v229
    v_cvt_pk_bf16_f32 v75, v230, v231
    v_mfma_f32_16x16x32_bf16 a[48:51], a[140:143], v[80:83], a[48:51]
    v_exp_f32 v228, v28
    v_mfma_f32_16x16x32_bf16 v[120:123], a[216:219], v[72:75], v[216:219]
    v_exp_f32 v229, v29
    v_mfma_f32_16x16x32_bf16 a[52:55], a[140:143], v[84:87], a[52:55]
    v_exp_f32 v230, v30
    v_mfma_f32_16x16x32_bf16 a[56:59], a[140:143], v[88:91], a[56:59]
    ds_read_b64_tr_b16 a[156:157], v203 offset:57344
    ds_read_b64_tr_b16 a[158:159], v203 offset:61440
    v_mfma_f32_16x16x32_bf16 a[60:63], a[140:143], v[92:95], a[60:63]
    v_cvt_pk_bf16_f32 v76, v224, v225
    s_waitcnt lgkmcnt(4)
    v_mfma_f32_16x16x32_bf16 a[64:67], a[144:147], v[80:83], a[64:67]
    v_exp_f32 v231, v31
    v_mfma_f32_16x16x32_bf16 a[68:71], a[144:147], v[84:87], a[68:71]
    v_cvt_pk_bf16_f32 v77, v226, v227
    v_cvt_pk_bf16_f32 v78, v228, v229
    v_mfma_f32_16x16x32_bf16 a[72:75], a[144:147], v[88:91], a[72:75]
    ds_read_b128 a[128:131], v192 offset:16384
    v_cvt_pk_bf16_f32 v79, v230, v231
    v_mfma_f32_16x16x32_bf16 a[76:79], a[144:147], v[92:95], a[76:79]
    v_mfma_f32_16x16x32_bf16 a[80:83], a[148:151], v[80:83], a[80:83]
    buffer_load_dword v238, v236, s[40:43], s63 offen
    s_add_u32 s63, s63, 512
    v_mfma_f32_16x16x32_bf16 v[124:127], a[216:219], v[76:79], v[220:223]
    v_mfma_f32_16x16x32_bf16 a[84:87], a[148:151], v[84:87], a[84:87]
    v_mfma_f32_16x16x32_bf16 a[88:91], a[148:151], v[88:91], a[88:91]
    ds_read_b128 a[132:135], v193 offset:16384
    v_mfma_f32_16x16x32_bf16 a[92:95], a[148:151], v[92:95], a[92:95]
    s_add_u32 m0, s25, 0xe000
    s_waitcnt lgkmcnt(2)
    v_mfma_f32_16x16x32_bf16 a[96:99], a[152:155], v[80:83], a[96:99]
    buffer_load_dwordx4 v204, s[4:7], s26 offen lds
    v_mfma_f32_16x16x32_bf16 a[100:103], a[152:155], v[84:87], a[100:103]
    buffer_load_dwordx4 v205, s[4:7], s26 offen offset:1024 lds
    s_add_u32 s26, s26, 0x2000
    v_mfma_f32_16x16x32_bf16 a[104:107], a[152:155], v[88:91], a[104:107]
    ds_read_b128 a[136:139], v194 offset:16384
    v_max3_f32 v252, v112, v116, v120
    v_mfma_f32_16x16x32_bf16 a[108:111], a[152:155], v[92:95], a[108:111]
    v_max_f32 v252, v252, v124
    s_add_u32 m0, s25, 0x1a000
    v_mfma_f32_16x16x32_bf16 a[112:115], a[156:159], v[80:83], a[112:115]
    buffer_load_dwordx4 v206, s[8:11], s27 offen lds
    v_cmp_lt_f32 vcc, 0x67800000, v252
    v_mfma_f32_16x16x32_bf16 a[116:119], a[156:159], v[84:87], a[116:119]
    buffer_load_dwordx4 v207, s[8:11], s27 offen offset:1024 lds
    s_add_u32 s27, s27, 0x2000
    v_mfma_f32_16x16x32_bf16 a[120:123], a[156:159], v[88:91], a[120:123]
    ds_read_b128 a[140:143], v195 offset:16384
    s_waitcnt lgkmcnt(2)
    v_mfma_f32_16x16x32_bf16 a[124:127], a[156:159], v[92:95], a[124:127]
    s_cbranch_vccnz TRAMP_L0
BACK_L0:
    s_sub_u32 s28, s28, 1
    s_cmp_lg_u32 s28, 0
    s_cbranch_scc1 attn_loop
    v_mfma_f32_16x16x32_bf16 v[0:3], a[128:131], v[128:131], v[96:99]
    v_exp_f32 v224, v32
    v_mfma_f32_16x16x32_bf16 v[8:11], a[128:131], v[144:147], v[100:103]
    v_exp_f32 v225, v33
    v_mfma_f32_16x16x32_bf16 v[16:19], a[128:131], v[160:163], v[104:107]
    ds_read_b128 a[144:147], v192 offset:20480
    v_cvt_pk_bf16_f32 v80, v224, v225
    v_mfma_f32_16x16x32_bf16 v[24:27], a[128:131], v[176:179], v[108:111]
    v_exp_f32 v226, v34
    v_mfma_f32_16x16x32_bf16 v[0:3], a[132:135], v[132:135], v[0:3]
    v_exp_f32 v227, v35
    v_mfma_f32_16x16x32_bf16 v[8:11], a[132:135], v[148:151], v[8:11]
    v_exp_f32 v228, v36
    v_mfma_f32_16x16x32_bf16 v[16:19], a[132:135], v[164:167], v[16:19]
    ds_read_b128 a[148:151], v193 offset:20480
    v_cvt_pk_bf16_f32 v81, v226, v227
    v_mfma_f32_16x16x32_bf16 v[24:27], a[132:135], v[180:183], v[24:27]
    s_waitcnt lgkmcnt(2)
    v_mfma_f32_16x16x32_bf16 v[0:3], a[136:139], v[136:139], v[0:3]
    v_exp_f32 v229, v37
    v_mfma_f32_16x16x32_bf16 v[8:11], a[136:139], v[152:155], v[8:11]
    v_exp_f32 v230, v38
    v_mfma_f32_16x16x32_bf16 v[16:19], a[136:139], v[168:171], v[16:19]
    ds_read_b128 a[152:155], v194 offset:20480
    v_cvt_pk_bf16_f32 v82, v228, v229
    v_mfma_f32_16x16x32_bf16 v[24:27], a[136:139], v[184:187], v[24:27]
    v_exp_f32 v231, v39
    v_mfma_f32_16x16x32_bf16 v[0:3], a[140:143], v[140:143], v[0:3]
    v_exp_f32 v224, v40
    v_mfma_f32_16x16x32_bf16 v[8:11], a[140:143], v[156:159], v[8:11]
    v_exp_f32 v225, v41
    v_mfma_f32_16x16x32_bf16 v[16:19], a[140:143], v[172:175], v[16:19]
    ds_read_b128 a[156:159], v195 offset:20480
    v_cvt_pk_bf16_f32 v83, v230, v231
    v_mfma_f32_16x16x32_bf16 v[24:27], a[140:143], v[188:191], v[24:27]
    v_cvt_pk_bf16_f32 v84, v224, v225
    s_waitcnt lgkmcnt(2)
    v_mfma_f32_16x16x32_bf16 v[208:211], a[216:219], v[80:83], v[112:115]
    v_exp_f32 v226, v42
    v_mfma_f32_16x16x32_bf16 v[4:7], a[144:147], v[128:131], v[96:99]
    v_exp_f32 v227, v43
    v_mfma_f32_16x16x32_bf16 v[12:15], a[144:147], v[144:147], v[100:103]
    v_exp_f32 v228, v44
    v_mfma_f32_16x16x32_bf16 v[20:23], a[144:147], v[160:163], v[104:107]
    ds_read_b64_tr_b16 a[128:129], v196 offset:0
    ds_read_b64_tr_b16 a[130:131], v196 offset:4096
    v_mfma_f32_16x16x32_bf16 v[28:31], a[144:147], v[176:179], v[108:111]
    v_exp_f32 v229, v45
    v_mfma_f32_16x16x32_bf16 v[4:7], a[148:151], v[132:135], v[4:7]
    v_exp_f32 v230, v46
    v_mfma_f32_16x16x32_bf16 v[12:15], a[148:151], v[148:151], v[12:15]
    v_exp_f32 v231, v47
    v_mfma_f32_16x16x32_bf16 v[20:23], a[148:151], v[164:167], v[20:23]
    ds_read_b64_tr_b16 a[132:133], v197 offset:0
    ds_read_b64_tr_b16 a[134:135], v197 offset:4096
    v_mfma_f32_16x16x32_bf16 v[28:31], a[148:151], v[180:183], v[28:31]
    v_cvt_pk_bf16_f32 v85, v226, v227
    s_waitcnt lgkmcnt(4)
    v_mfma_f32_16x16x32_bf16 v[4:7], a[152:155], v[136:139], v[4:7]
    v_exp_f32 v224, v48
    v_mfma_f32_16x16x32_bf16 v[12:15], a[152:155], v[152:155], v[12:15]
    v_exp_f32 v225, v49
    v_mfma_f32_16x16x32_bf16 v[20:23], a[152:155], v[168:171], v[20:23]
    ds_read_b64_tr_b16 a[136:137], v198 offset:0
    ds_read_b64_tr_b16 a[138:139], v198 offset:4096
    v_mfma_f32_16x16x32_bf16 v[28:31], a[152:155], v[184:187], v[28:31]
    v_exp_f32 v226, v50
    v_mfma_f32_16x16x32_bf16 v[4:7], a[156:159], v[140:143], v[4:7]
    v_exp_f32 v227, v51
    v_mfma_f32_16x16x32_bf16 v[12:15], a[156:159], v[156:159], v[12:15]
    v_cvt_pk_bf16_f32 v86, v228, v229
    v_cvt_pk_bf16_f32 v87, v230, v231
    v_mfma_f32_16x16x32_bf16 v[20:23], a[156:159], v[172:175], v[20:23]
    ds_read_b64_tr_b16 a[140:141], v199 offset:0
    ds_read_b64_tr_b16 a[142:143], v199 offset:4096
    v_mfma_f32_16x16x32_bf16 v[212:215], a[216:219], v[84:87], v[116:119]
    v_exp_f32 v228, v52
    v_mfma_f32_16x16x32_bf16 v[28:31], a[156:159], v[188:191], v[28:31]
    v_cvt_pk_bf16_f32 v88, v224, v225
    s_waitcnt lgkmcnt(4)
    v_mfma_f32_16x16x32_bf16 a[0:3], a[128:131], v[64:67], a[0:3]
    v_exp_f32 v229, v53
    v_mfma_f32_16x16x32_bf16 a[4:7], a[128:131], v[68:71], a[4:7]
    v_exp_f32 v230, v54
    v_mfma_f32_16x16x32_bf16 a[8:11], a[128:131], v[72:75], a[8:11]
    ds_read_b64_tr_b16 a[144:145], v200 offset:0
    ds_read_b64_tr_b16 a[146:147], v200 offset:4096
    v_mfma_f32_16x16x32_bf16 a[12:15], a[128:131], v[76:79], a[12:15]
    v_exp_f32 v231, v55
    v_mfma_f32_16x16x32_bf16 a[16:19], a[132:135], v[64:67], a[16:19]
    v_exp_f32 v224, v56
    v_mfma_f32_16x16x32_bf16 a[20:23], a[132:135], v[68:71], a[20:23]
    v_exp_f32 v225, v57
    v_mfma_f32_16x16x32_bf16 a[24:27], a[132:135], v[72:75], a[24:27]
    ds_read_b64_tr_b16 a[148:149], v201 offset:0
    ds_read_b64_tr_b16 a[150:151], v201 offset:4096
    v_mfma_f32_16x16x32_bf16 a[28:31], a[132:135], v[76:79], a[28:31]
    v_cvt_pk_bf16_f32 v89, v226, v227
    s_waitcnt lgkmcnt(4)
    v_mfma_f32_16x16x32_bf16 a[32:35], a[136:139], v[64:67], a[32:35]
    v_exp_f32 v226, v58
    v_mfma_f32_16x16x32_bf16 a[36:39], a[136:139], v[68:71], a[36:39]
    v_exp_f32 v227, v59
    v_mfma_f32_16x16x32_bf16 a[40:43], a[136:139], v[72:75], a[40:43]
    ds_read_b64_tr_b16 a[152:153], v202 offset:0
    ds_read_b64_tr_b16 a[154:155], v202 offset:4096
    v_mfma_f32_16x16x32_bf16 a[44:47], a[136:139], v[76:79], a[44:47]
    v_cvt_pk_bf16_f32 v90, v228, v229
    v_cvt_pk_bf16_f32 v91, v230, v231
    v_mfma_f32_16x16x32_bf16 a[48:51], a[140:143], v[64:67], a[48:51]
    v_exp_f32 v228, v60
    v_mfma_f32_16x16x32_bf16 v[216:219], a[216:219], v[88:91], v[120:123]
    v_exp_f32 v229, v61
    v_mfma_f32_16x16x32_bf16 a[52:55], a[140:143], v[68:71], a[52:55]
    v_exp_f32 v230, v62
    v_mfma_f32_16x16x32_bf16 a[56:59], a[140:143], v[72:75], a[56:59]
    ds_read_b64_tr_b16 a[156:157], v203 offset:0
    ds_read_b64_tr_b16 a[158:159], v203 offset:4096
    v_mfma_f32_16x16x32_bf16 a[60:63], a[140:143], v[76:79], a[60:63]
    v_cvt_pk_bf16_f32 v92, v224, v225
    s_waitcnt lgkmcnt(4)
    v_mfma_f32_16x16x32_bf16 a[64:67], a[144:147], v[64:67], a[64:67]
    v_exp_f32 v231, v63
    v_mfma_f32_16x16x32_bf16 a[68:71], a[144:147], v[68:71], a[68:71]
    v_cvt_pk_bf16_f32 v93, v226, v227
    v_cvt_pk_bf16_f32 v94, v228, v229
    v_mfma_f32_16x16x32_bf16 a[72:75], a[144:147], v[72:75], a[72:75]
    ds_read_b128 a[128:131], v192 offset:24576
    v_cvt_pk_bf16_f32 v95, v230, v231
    v_mfma_f32_16x16x32_bf16 a[76:79], a[144:147], v[76:79], a[76:79]
    v_mfma_f32_16x16x32_bf16 a[80:83], a[148:151], v[64:67], a[80:83]
    v_mfma_f32_16x16x32_bf16 v[220:223], a[216:219], v[92:95], v[124:127]
    v_mfma_f32_16x16x32_bf16 a[84:87], a[148:151], v[68:71], a[84:87]
    v_mfma_f32_16x16x32_bf16 a[88:91], a[148:151], v[72:75], a[88:91]
    ds_read_b128 a[132:135], v193 offset:24576
    v_mfma_f32_16x16x32_bf16 a[92:95], a[148:151], v[76:79], a[92:95]
    s_waitcnt lgkmcnt(2)
    v_mfma_f32_16x16x32_bf16 a[96:99], a[152:155], v[64:67], a[96:99]
    v_mfma_f32_16x16x32_bf16 a[100:103], a[152:155], v[68:71], a[100:103]
    v_mfma_f32_16x16x32_bf16 a[104:107], a[152:155], v[72:75], a[104:107]
    ds_read_b128 a[136:139], v194 offset:24576
    v_mfma_f32_16x16x32_bf16 a[108:111], a[152:155], v[76:79], a[108:111]
    v_max3_f32 v252, v208, v212, v216
    s_add_u32 m0, s25, 0x1c000
    v_mfma_f32_16x16x32_bf16 a[112:115], a[156:159], v[64:67], a[112:115]
    buffer_load_dwordx4 v206, s[8:11], s27 offen lds
    v_max_f32 v252, v252, v220
    v_mfma_f32_16x16x32_bf16 a[116:119], a[156:159], v[68:71], a[116:119]
    buffer_load_dwordx4 v207, s[8:11], s27 offen offset:1024 lds
    s_add_u32 s27, s27, 0x2000
    v_mfma_f32_16x16x32_bf16 a[120:123], a[156:159], v[72:75], a[120:123]
    ds_read_b128 a[140:143], v195 offset:24576
    s_waitcnt lgkmcnt(2)
    v_mfma_f32_16x16x32_bf16 a[124:127], a[156:159], v[76:79], a[124:127]
    v_cmp_lt_f32 vcc, 0x67800000, v252
    s_nop 1
    s_cbranch_vccnz TRAMP_T57
BACK_T57:
    s_waitcnt vmcnt(12)
    s_barrier
    v_mfma_f32_16x16x32_bf16 v[32:35], a[128:131], v[128:131], v[96:99]
    v_exp_f32 v224, v0
    v_mfma_f32_16x16x32_bf16 v[40:43], a[128:131], v[144:147], v[100:103]
    v_exp_f32 v225, v1
    v_mfma_f32_16x16x32_bf16 v[48:51], a[128:131], v[160:163], v[104:107]
    ds_read_b128 a[144:147], v192 offset:28672
    v_cvt_pk_bf16_f32 v64, v224, v225
    v_mfma_f32_16x16x32_bf16 v[56:59], a[128:131], v[176:179], v[108:111]
    v_exp_f32 v226, v2
    v_mfma_f32_16x16x32_bf16 v[32:35], a[132:135], v[132:135], v[32:35]
    v_exp_f32 v227, v3
    v_mfma_f32_16x16x32_bf16 v[40:43], a[132:135], v[148:151], v[40:43]
    v_exp_f32 v228, v4
    v_mfma_f32_16x16x32_bf16 v[48:51], a[132:135], v[164:167], v[48:51]
    ds_read_b128 a[148:151], v193 offset:28672
    v_cvt_pk_bf16_f32 v65, v226, v227
    v_mfma_f32_16x16x32_bf16 v[56:59], a[132:135], v[180:183], v[56:59]
    s_waitcnt lgkmcnt(2)
    v_mfma_f32_16x16x32_bf16 v[32:35], a[136:139], v[136:139], v[32:35]
    v_exp_f32 v229, v5
    v_mfma_f32_16x16x32_bf16 v[40:43], a[136:139], v[152:155], v[40:43]
    v_exp_f32 v230, v6
    v_mfma_f32_16x16x32_bf16 v[48:51], a[136:139], v[168:171], v[48:51]
    ds_read_b128 a[152:155], v194 offset:28672
    v_cvt_pk_bf16_f32 v66, v228, v229
    v_mfma_f32_16x16x32_bf16 v[56:59], a[136:139], v[184:187], v[56:59]
    v_exp_f32 v231, v7
    v_mfma_f32_16x16x32_bf16 v[32:35], a[140:143], v[140:143], v[32:35]
    v_exp_f32 v224, v8
    v_mfma_f32_16x16x32_bf16 v[40:43], a[140:143], v[156:159], v[40:43]
    v_exp_f32 v225, v9
    v_mfma_f32_16x16x32_bf16 v[48:51], a[140:143], v[172:175], v[48:51]
    ds_read_b128 a[156:159], v195 offset:28672
    v_cvt_pk_bf16_f32 v67, v230, v231
    v_mfma_f32_16x16x32_bf16 v[56:59], a[140:143], v[188:191], v[56:59]
    v_cvt_pk_bf16_f32 v68, v224, v225
    s_waitcnt lgkmcnt(2)
    v_mfma_f32_16x16x32_bf16 v[112:115], a[216:219], v[64:67], v[208:211]
    v_exp_f32 v226, v10
    v_mfma_f32_16x16x32_bf16 v[36:39], a[144:147], v[128:131], v[96:99]
    v_exp_f32 v227, v11
    v_mfma_f32_16x16x32_bf16 v[44:47], a[144:147], v[144:147], v[100:103]
    v_exp_f32 v228, v12
    v_mfma_f32_16x16x32_bf16 v[52:55], a[144:147], v[160:163], v[104:107]
    ds_read_b64_tr_b16 a[128:129], v196 offset:8192
    ds_read_b64_tr_b16 a[130:131], v196 offset:12288
    v_mfma_f32_16x16x32_bf16 v[60:63], a[144:147], v[176:179], v[108:111]
    v_exp_f32 v229, v13
    v_mfma_f32_16x16x32_bf16 v[36:39], a[148:151], v[132:135], v[36:39]
    v_exp_f32 v230, v14
    v_mfma_f32_16x16x32_bf16 v[44:47], a[148:151], v[148:151], v[44:47]
    v_exp_f32 v231, v15
    v_mfma_f32_16x16x32_bf16 v[52:55], a[148:151], v[164:167], v[52:55]
    ds_read_b64_tr_b16 a[132:133], v197 offset:8192
    ds_read_b64_tr_b16 a[134:135], v197 offset:12288
    v_mfma_f32_16x16x32_bf16 v[60:63], a[148:151], v[180:183], v[60:63]
    v_cvt_pk_bf16_f32 v69, v226, v227
    s_waitcnt lgkmcnt(4)
    v_mfma_f32_16x16x32_bf16 v[36:39], a[152:155], v[136:139], v[36:39]
    v_exp_f32 v224, v16
    v_mfma_f32_16x16x32_bf16 v[44:47], a[152:155], v[152:155], v[44:47]
    v_exp_f32 v225, v17
    v_mfma_f32_16x16x32_bf16 v[52:55], a[152:155], v[168:171], v[52:55]
    ds_read_b64_tr_b16 a[136:137], v198 offset:8192
    ds_read_b64_tr_b16 a[138:139], v198 offset:12288
    v_mfma_f32_16x16x32_bf16 v[60:63], a[152:155], v[184:187], v[60:63]
    v_exp_f32 v226, v18
    v_mfma_f32_16x16x32_bf16 v[36:39], a[156:159], v[140:143], v[36:39]
    v_exp_f32 v227, v19
    v_mfma_f32_16x16x32_bf16 v[44:47], a[156:159], v[156:159], v[44:47]
    v_cvt_pk_bf16_f32 v70, v228, v229
    v_cvt_pk_bf16_f32 v71, v230, v231
    v_mfma_f32_16x16x32_bf16 v[52:55], a[156:159], v[172:175], v[52:55]
    ds_read_b64_tr_b16 a[140:141], v199 offset:8192
    ds_read_b64_tr_b16 a[142:143], v199 offset:12288
    v_mfma_f32_16x16x32_bf16 v[116:119], a[216:219], v[68:71], v[212:215]
    v_exp_f32 v228, v20
    v_mfma_f32_16x16x32_bf16 v[60:63], a[156:159], v[188:191], v[60:63]
    v_cvt_pk_bf16_f32 v72, v224, v225
    s_waitcnt lgkmcnt(4)
    v_mfma_f32_16x16x32_bf16 a[0:3], a[128:131], v[80:83], a[0:3]
    v_exp_f32 v229, v21
    v_mfma_f32_16x16x32_bf16 a[4:7], a[128:131], v[84:87], a[4:7]
    v_exp_f32 v230, v22
    v_mfma_f32_16x16x32_bf16 a[8:11], a[128:131], v[88:91], a[8:11]
    ds_read_b64_tr_b16 a[144:145], v200 offset:8192
    ds_read_b64_tr_b16 a[146:147], v200 offset:12288
    v_mfma_f32_16x16x32_bf16 a[12:15], a[128:131], v[92:95], a[12:15]
    v_exp_f32 v231, v23
    v_mfma_f32_16x16x32_bf16 a[16:19], a[132:135], v[80:83], a[16:19]
    v_exp_f32 v224, v24
    v_mfma_f32_16x16x32_bf16 a[20:23], a[132:135], v[84:87], a[20:23]
    v_exp_f32 v225, v25
    v_mfma_f32_16x16x32_bf16 a[24:27], a[132:135], v[88:91], a[24:27]
    ds_read_b64_tr_b16 a[148:149], v201 offset:8192
    ds_read_b64_tr_b16 a[150:151], v201 offset:12288
    v_mfma_f32_16x16x32_bf16 a[28:31], a[132:135], v[92:95], a[28:31]
    v_cvt_pk_bf16_f32 v73, v226, v227
    s_waitcnt lgkmcnt(4)
    v_mfma_f32_16x16x32_bf16 a[32:35], a[136:139], v[80:83], a[32:35]
    v_exp_f32 v226, v26
    v_mfma_f32_16x16x32_bf16 a[36:39], a[136:139], v[84:87], a[36:39]
    v_exp_f32 v227, v27
    v_mfma_f32_16x16x32_bf16 a[40:43], a[136:139], v[88:91], a[40:43]
    ds_read_b64_tr_b16 a[152:153], v202 offset:8192
    ds_read_b64_tr_b16 a[154:155], v202 offset:12288
    v_mfma_f32_16x16x32_bf16 a[44:47], a[136:139], v[92:95], a[44:47]
    v_cvt_pk_bf16_f32 v74, v228, v229
    v_cvt_pk_bf16_f32 v75, v230, v231
    v_mfma_f32_16x16x32_bf16 a[48:51], a[140:143], v[80:83], a[48:51]
    v_exp_f32 v228, v28
    v_mfma_f32_16x16x32_bf16 v[120:123], a[216:219], v[72:75], v[216:219]
    v_exp_f32 v229, v29
    v_mfma_f32_16x16x32_bf16 a[52:55], a[140:143], v[84:87], a[52:55]
    v_exp_f32 v230, v30
    v_mfma_f32_16x16x32_bf16 a[56:59], a[140:143], v[88:91], a[56:59]
    ds_read_b64_tr_b16 a[156:157], v203 offset:8192
    ds_read_b64_tr_b16 a[158:159], v203 offset:12288
    v_mfma_f32_16x16x32_bf16 a[60:63], a[140:143], v[92:95], a[60:63]
    v_cvt_pk_bf16_f32 v76, v224, v225
    s_waitcnt lgkmcnt(4)
    v_mfma_f32_16x16x32_bf16 a[64:67], a[144:147], v[80:83], a[64:67]
    v_exp_f32 v231, v31
    v_mfma_f32_16x16x32_bf16 a[68:71], a[144:147], v[84:87], a[68:71]
    v_cvt_pk_bf16_f32 v77, v226, v227
    v_cvt_pk_bf16_f32 v78, v228, v229
    v_mfma_f32_16x16x32_bf16 a[72:75], a[144:147], v[88:91], a[72:75]
    ds_read_b128 a[128:131], v192 offset:32768
    v_cvt_pk_bf16_f32 v79, v230, v231
    v_mfma_f32_16x16x32_bf16 a[76:79], a[144:147], v[92:95], a[76:79]
    v_mfma_f32_16x16x32_bf16 a[80:83], a[148:151], v[80:83], a[80:83]
    v_mfma_f32_16x16x32_bf16 v[124:127], a[216:219], v[76:79], v[220:223]
    v_mfma_f32_16x16x32_bf16 a[84:87], a[148:151], v[84:87], a[84:87]
    v_mfma_f32_16x16x32_bf16 a[88:91], a[148:151], v[88:91], a[88:91]
    ds_read_b128 a[132:135], v193 offset:32768
    v_mfma_f32_16x16x32_bf16 a[92:95], a[148:151], v[92:95], a[92:95]
    s_waitcnt lgkmcnt(2)
    v_mfma_f32_16x16x32_bf16 a[96:99], a[152:155], v[80:83], a[96:99]
    v_mfma_f32_16x16x32_bf16 a[100:103], a[152:155], v[84:87], a[100:103]
    v_mfma_f32_16x16x32_bf16 a[104:107], a[152:155], v[88:91], a[104:107]
    ds_read_b128 a[136:139], v194 offset:32768
    v_mfma_f32_16x16x32_bf16 a[108:111], a[152:155], v[92:95], a[108:111]
    v_max3_f32 v252, v112, v116, v120
    s_add_u32 m0, s25, 0x1e000
    v_mfma_f32_16x16x32_bf16 a[112:115], a[156:159], v[80:83], a[112:115]
    buffer_load_dwordx4 v206, s[8:11], s27 offen lds
    v_max_f32 v252, v252, v124
    v_mfma_f32_16x16x32_bf16 a[116:119], a[156:159], v[84:87], a[116:119]
    buffer_load_dwordx4 v207, s[8:11], s27 offen offset:1024 lds
    s_add_u32 s27, s27, 0x2000
    v_mfma_f32_16x16x32_bf16 a[120:123], a[156:159], v[88:91], a[120:123]
    ds_read_b128 a[140:143], v195 offset:32768
    s_waitcnt lgkmcnt(2)
    v_mfma_f32_16x16x32_bf16 a[124:127], a[156:159], v[92:95], a[124:127]
    v_cmp_lt_f32 vcc, 0x67800000, v252
    s_nop 1
    s_cbranch_vccnz TRAMP_T58
BACK_T58:
    v_mfma_f32_16x16x32_bf16 v[0:3], a[128:131], v[128:131], v[96:99]
    v_exp_f32 v224, v32
    v_mfma_f32_16x16x32_bf16 v[8:11], a[128:131], v[144:147], v[100:103]
    v_exp_f32 v225, v33
    v_mfma_f32_16x16x32_bf16 v[16:19], a[128:131], v[160:163], v[104:107]
    ds_read_b128 a[144:147], v192 offset:36864
    v_cvt_pk_bf16_f32 v80, v224, v225
    v_mfma_f32_16x16x32_bf16 v[24:27], a[128:131], v[176:179], v[108:111]
    v_exp_f32 v226, v34
    v_mfma_f32_16x16x32_bf16 v[0:3], a[132:135], v[132:135], v[0:3]
    v_exp_f32 v227, v35
    v_mfma_f32_16x16x32_bf16 v[8:11], a[132:135], v[148:151], v[8:11]
    v_exp_f32 v228, v36
    v_mfma_f32_16x16x32_bf16 v[16:19], a[132:135], v[164:167], v[16:19]
    ds_read_b128 a[148:151], v193 offset:36864
    v_cvt_pk_bf16_f32 v81, v226, v227
    v_mfma_f32_16x16x32_bf16 v[24:27], a[132:135], v[180:183], v[24:27]
    s_waitcnt lgkmcnt(2)
    v_mfma_f32_16x16x32_bf16 v[0:3], a[136:139], v[136:139], v[0:3]
    v_exp_f32 v229, v37
    v_mfma_f32_16x16x32_bf16 v[8:11], a[136:139], v[152:155], v[8:11]
    v_exp_f32 v230, v38
    v_mfma_f32_16x16x32_bf16 v[16:19], a[136:139], v[168:171], v[16:19]
    ds_read_b128 a[152:155], v194 offset:36864
    v_cvt_pk_bf16_f32 v82, v228, v229
    v_mfma_f32_16x16x32_bf16 v[24:27], a[136:139], v[184:187], v[24:27]
    v_exp_f32 v231, v39
    v_mfma_f32_16x16x32_bf16 v[0:3], a[140:143], v[140:143], v[0:3]
    v_cvt_pk_bf16_f32 v83, v230, v231
    s_mov_b32 s46, 0
    v_mfma_f32_16x16x32_bf16 v[8:11], a[140:143], v[156:159], v[8:11]
    v_exp_f32 v224, v40
    v_mfma_f32_16x16x32_bf16 v[208:211], a[216:219], v[80:83], v[112:115]
    v_exp_f32 v225, v41
    v_mfma_f32_16x16x32_bf16 v[16:19], a[140:143], v[172:175], v[16:19]
    ds_read_b128 a[156:159], v195 offset:36864
    buffer_load_dwordx4 a[160:163], v250, s[20:23], s46 offen
    v_mfma_f32_16x16x32_bf16 v[24:27], a[140:143], v[188:191], v[24:27]
    v_cvt_pk_bf16_f32 v84, v224, v225
    s_waitcnt lgkmcnt(2)
    v_mfma_f32_16x16x32_bf16 v[4:7], a[144:147], v[128:131], v[96:99]
    s_mov_b32 s46, 28672
    v_mfma_f32_16x16x32_bf16 v[12:15], a[144:147], v[144:147], v[100:103]
    v_exp_f32 v226, v42
    v_mfma_f32_16x16x32_bf16 v[20:23], a[144:147], v[160:163], v[104:107]
    ds_read_b64_tr_b16 a[128:129], v196 offset:16384
    ds_read_b64_tr_b16 a[130:131], v196 offset:20480
    buffer_load_dwordx4 a[164:167], v250, s[20:23], s46 offen
    v_mfma_f32_16x16x32_bf16 v[28:31], a[144:147], v[176:179], v[108:111]
    v_exp_f32 v227, v43
    v_mfma_f32_16x16x32_bf16 v[4:7], a[148:151], v[132:135], v[4:7]
    v_cvt_pk_bf16_f32 v85, v226, v227
    s_mov_b32 s46, 57344
    v_mfma_f32_16x16x32_bf16 v[12:15], a[148:151], v[148:151], v[12:15]
    v_exp_f32 v228, v44
    v_mfma_f32_16x16x32_bf16 v[20:23], a[148:151], v[164:167], v[20:23]
    ds_read_b64_tr_b16 a[132:133], v197 offset:16384
    ds_read_b64_tr_b16 a[134:135], v197 offset:20480
    buffer_load_dwordx4 a[168:171], v250, s[20:23], s46 offen
    v_mfma_f32_16x16x32_bf16 v[28:31], a[148:151], v[180:183], v[28:31]
    s_waitcnt lgkmcnt(4)
    v_mfma_f32_16x16x32_bf16 v[4:7], a[152:155], v[136:139], v[4:7]
    s_mov_b32 s46, 86016
    v_mfma_f32_16x16x32_bf16 v[12:15], a[152:155], v[152:155], v[12:15]
    v_exp_f32 v229, v45
    v_mfma_f32_16x16x32_bf16 v[20:23], a[152:155], v[168:171], v[20:23]
    ds_read_b64_tr_b16 a[136:137], v198 offset:16384
    ds_read_b64_tr_b16 a[138:139], v198 offset:20480
    buffer_load_dwordx4 a[172:175], v250, s[20:23], s46 offen
    v_mfma_f32_16x16x32_bf16 v[28:31], a[152:155], v[184:187], v[28:31]
    v_exp_f32 v230, v46
    v_mfma_f32_16x16x32_bf16 v[4:7], a[156:159], v[140:143], v[4:7]
    v_cvt_pk_bf16_f32 v86, v228, v229
    s_mov_b32 s46, 6144
    v_mfma_f32_16x16x32_bf16 v[12:15], a[156:159], v[156:159], v[12:15]
    v_exp_f32 v231, v47
    v_mfma_f32_16x16x32_bf16 v[20:23], a[156:159], v[172:175], v[20:23]
    ds_read_b64_tr_b16 a[140:141], v199 offset:16384
    ds_read_b64_tr_b16 a[142:143], v199 offset:20480
    buffer_load_dword a176, v251, s[12:15], s46 offen offset:0 sc1
    v_mfma_f32_16x16x32_bf16 v[28:31], a[156:159], v[188:191], v[28:31]
    v_cvt_pk_bf16_f32 v87, v230, v231
    s_waitcnt lgkmcnt(4)
    v_mfma_f32_16x16x32_bf16 a[0:3], a[128:131], v[64:67], a[0:3]
    v_exp_f32 v224, v48
    v_mfma_f32_16x16x32_bf16 v[212:215], a[216:219], v[84:87], v[116:119]
    v_exp_f32 v225, v49
    v_mfma_f32_16x16x32_bf16 a[4:7], a[128:131], v[68:71], a[4:7]
    v_exp_f32 v226, v50
    v_mfma_f32_16x16x32_bf16 a[8:11], a[128:131], v[72:75], a[8:11]
    ds_read_b64_tr_b16 a[144:145], v200 offset:16384
    ds_read_b64_tr_b16 a[146:147], v200 offset:20480
    buffer_load_dword a192, v251, s[12:15], s46 offen offset:2048 sc1
    v_mfma_f32_16x16x32_bf16 a[12:15], a[128:131], v[76:79], a[12:15]
    v_exp_f32 v227, v51
    v_mfma_f32_16x16x32_bf16 a[16:19], a[132:135], v[64:67], a[16:19]
    v_exp_f32 v228, v52
    v_mfma_f32_16x16x32_bf16 a[20:23], a[132:135], v[68:71], a[20:23]
    v_exp_f32 v229, v53
    v_mfma_f32_16x16x32_bf16 a[24:27], a[132:135], v[72:75], a[24:27]
    ds_read_b64_tr_b16 a[148:149], v201 offset:16384
    ds_read_b64_tr_b16 a[150:151], v201 offset:20480
    buffer_load_dword a180, v251, s[12:15], s46 offen offset:32 sc1
    v_mfma_f32_16x16x32_bf16 a[28:31], a[132:135], v[76:79], a[28:31]
    v_cvt_pk_bf16_f32 v88, v224, v225
    s_waitcnt lgkmcnt(4)
    v_mfma_f32_16x16x32_bf16 a[32:35], a[136:139], v[64:67], a[32:35]
    v_exp_f32 v230, v54
    v_mfma_f32_16x16x32_bf16 a[36:39], a[136:139], v[68:71], a[36:39]
    v_exp_f32 v231, v55
    v_mfma_f32_16x16x32_bf16 a[40:43], a[136:139], v[72:75], a[40:43]
    ds_read_b64_tr_b16 a[152:153], v202 offset:16384
    ds_read_b64_tr_b16 a[154:155], v202 offset:20480
    buffer_load_dword a196, v251, s[12:15], s46 offen offset:2080 sc1
    v_mfma_f32_16x16x32_bf16 a[44:47], a[136:139], v[76:79], a[44:47]
    v_exp_f32 v224, v56
    v_mfma_f32_16x16x32_bf16 a[48:51], a[140:143], v[64:67], a[48:51]
    v_exp_f32 v225, v57
    v_mfma_f32_16x16x32_bf16 a[52:55], a[140:143], v[68:71], a[52:55]
    v_cvt_pk_bf16_f32 v89, v226, v227
    v_cvt_pk_bf16_f32 v90, v228, v229
    v_mfma_f32_16x16x32_bf16 a[56:59], a[140:143], v[72:75], a[56:59]
    ds_read_b64_tr_b16 a[156:157], v203 offset:16384
    ds_read_b64_tr_b16 a[158:159], v203 offset:20480
    buffer_load_dword a184, v251, s[12:15], s46 offen offset:64 sc1
    v_mfma_f32_16x16x32_bf16 a[60:63], a[140:143], v[76:79], a[60:63]
    v_cvt_pk_bf16_f32 v91, v230, v231
    s_waitcnt lgkmcnt(4)
    v_mfma_f32_16x16x32_bf16 a[64:67], a[144:147], v[64:67], a[64:67]
    v_exp_f32 v226, v58
    v_mfma_f32_16x16x32_bf16 v[216:219], a[216:219], v[88:91], v[120:123]
    v_exp_f32 v227, v59
    v_mfma_f32_16x16x32_bf16 a[68:71], a[144:147], v[68:71], a[68:71]
    v_exp_f32 v228, v60
    v_mfma_f32_16x16x32_bf16 a[72:75], a[144:147], v[72:75], a[72:75]
    ds_read_b128 a[128:131], v192 offset:40960
    buffer_load_dword a200, v251, s[12:15], s46 offen offset:2112 sc1
    v_mfma_f32_16x16x32_bf16 a[76:79], a[144:147], v[76:79], a[76:79]
    v_exp_f32 v229, v61
    v_mfma_f32_16x16x32_bf16 a[80:83], a[148:151], v[64:67], a[80:83]
    v_exp_f32 v230, v62
    v_mfma_f32_16x16x32_bf16 a[84:87], a[148:151], v[68:71], a[84:87]
    v_exp_f32 v231, v63
    v_mfma_f32_16x16x32_bf16 a[88:91], a[148:151], v[72:75], a[88:91]
    ds_read_b128 a[132:135], v193 offset:40960
    buffer_load_dword a188, v251, s[12:15], s46 offen offset:96 sc1
    v_mfma_f32_16x16x32_bf16 a[92:95], a[148:151], v[76:79], a[92:95]
    v_cvt_pk_bf16_f32 v92, v224, v225
    s_waitcnt lgkmcnt(2)
    v_mfma_f32_16x16x32_bf16 a[96:99], a[152:155], v[64:67], a[96:99]
    v_cvt_pk_bf16_f32 v93, v226, v227
    v_cvt_pk_bf16_f32 v94, v228, v229
    v_mfma_f32_16x16x32_bf16 a[100:103], a[152:155], v[68:71], a[100:103]
    v_cvt_pk_bf16_f32 v95, v230, v231
    v_mfma_f32_16x16x32_bf16 a[104:107], a[152:155], v[72:75], a[104:107]
    ds_read_b128 a[136:139], v194 offset:40960
    buffer_load_dword a204, v251, s[12:15], s46 offen offset:2144 sc1
    v_mfma_f32_16x16x32_bf16 v[220:223], a[216:219], v[92:95], v[124:127]
    v_mfma_f32_16x16x32_bf16 a[108:111], a[152:155], v[76:79], a[108:111]
    v_mfma_f32_16x16x32_bf16 a[112:115], a[156:159], v[64:67], a[112:115]
    v_mfma_f32_16x16x32_bf16 a[116:119], a[156:159], v[68:71], a[116:119]
    v_mfma_f32_16x16x32_bf16 a[120:123], a[156:159], v[72:75], a[120:123]
    ds_read_b128 a[140:143], v195 offset:40960
    s_waitcnt lgkmcnt(2)
    v_mfma_f32_16x16x32_bf16 a[124:127], a[156:159], v[76:79], a[124:127]
    s_nop 3
    s_nop 3
    v_max3_f32 v252, v208, v212, v216
    v_max_f32 v252, v252, v220
    v_cmp_lt_f32 vcc, 0x67800000, v252
    s_nop 1
    s_cbranch_vccnz TRAMP_T59
BACK_T59:
    s_waitcnt vmcnt(16)
    s_barrier
    v_mfma_f32_16x16x32_bf16 v[32:35], a[128:131], v[128:131], v[96:99]
    v_exp_f32 v224, v0
    v_mfma_f32_16x16x32_bf16 v[40:43], a[128:131], v[144:147], v[100:103]
    v_exp_f32 v225, v1
    v_mfma_f32_16x16x32_bf16 v[48:51], a[128:131], v[160:163], v[104:107]
    ds_read_b128 a[144:147], v192 offset:45056
    v_cvt_pk_bf16_f32 v64, v224, v225
    v_mfma_f32_16x16x32_bf16 v[56:59], a[128:131], v[176:179], v[108:111]
    v_exp_f32 v226, v2
    v_mfma_f32_16x16x32_bf16 v[32:35], a[132:135], v[132:135], v[32:35]
    v_exp_f32 v227, v3
    v_mfma_f32_16x16x32_bf16 v[40:43], a[132:135], v[148:151], v[40:43]
    v_exp_f32 v228, v4
    v_mfma_f32_16x16x32_bf16 v[48:51], a[132:135], v[164:167], v[48:51]
    ds_read_b128 a[148:151], v193 offset:45056
    v_cvt_pk_bf16_f32 v65, v226, v227
    v_mfma_f32_16x16x32_bf16 v[56:59], a[132:135], v[180:183], v[56:59]
    s_waitcnt lgkmcnt(2)
    v_mfma_f32_16x16x32_bf16 v[32:35], a[136:139], v[136:139], v[32:35]
    v_exp_f32 v229, v5
    v_mfma_f32_16x16x32_bf16 v[40:43], a[136:139], v[152:155], v[40:43]
    v_exp_f32 v230, v6
    v_mfma_f32_16x16x32_bf16 v[48:51], a[136:139], v[168:171], v[48:51]
    ds_read_b128 a[152:155], v194 offset:45056
    v_cvt_pk_bf16_f32 v66, v228, v229
    v_mfma_f32_16x16x32_bf16 v[56:59], a[136:139], v[184:187], v[56:59]
    v_exp_f32 v231, v7
    v_mfma_f32_16x16x32_bf16 v[32:35], a[140:143], v[140:143], v[32:35]
    v_cvt_pk_bf16_f32 v67, v230, v231
    s_mov_b32 s46, 18432
    v_mfma_f32_16x16x32_bf16 v[40:43], a[140:143], v[156:159], v[40:43]
    v_exp_f32 v224, v8
    v_mfma_f32_16x16x32_bf16 v[112:115], a[216:219], v[64:67], v[208:211]
    v_exp_f32 v225, v9
    v_mfma_f32_16x16x32_bf16 v[48:51], a[140:143], v[172:175], v[48:51]
    ds_read_b128 a[156:159], v195 offset:45056
    buffer_load_dword a177, v251, s[12:15], s46 offen offset:0 sc1
    v_mfma_f32_16x16x32_bf16 v[56:59], a[140:143], v[188:191], v[56:59]
    v_cvt_pk_bf16_f32 v68, v224, v225
    s_waitcnt lgkmcnt(2)
    v_mfma_f32_16x16x32_bf16 v[36:39], a[144:147], v[128:131], v[96:99]
    v_exp_f32 v226, v10
    v_mfma_f32_16x16x32_bf16 v[44:47], a[144:147], v[144:147], v[100:103]
    v_exp_f32 v227, v11
    v_mfma_f32_16x16x32_bf16 v[52:55], a[144:147], v[160:163], v[104:107]
    ds_read_b64_tr_b16 a[128:129], v196 offset:24576
    ds_read_b64_tr_b16 a[130:131], v196 offset:28672
    buffer_load_dword a193, v251, s[12:15], s46 offen offset:2048 sc1
    v_mfma_f32_16x16x32_bf16 v[60:63], a[144:147], v[176:179], v[108:111]
    v_exp_f32 v228, v12
    v_mfma_f32_16x16x32_bf16 v[36:39], a[148:151], v[132:135], v[36:39]
    v_exp_f32 v229, v13
    v_mfma_f32_16x16x32_bf16 v[44:47], a[148:151], v[148:151], v[44:47]
    v_exp_f32 v230, v14
    v_mfma_f32_16x16x32_bf16 v[52:55], a[148:151], v[164:167], v[52:55]
    ds_read_b64_tr_b16 a[132:133], v197 offset:24576
    ds_read_b64_tr_b16 a[134:135], v197 offset:28672
    buffer_load_dword a181, v251, s[12:15], s46 offen offset:32 sc1
    v_mfma_f32_16x16x32_bf16 v[60:63], a[148:151], v[180:183], v[60:63]
    v_cvt_pk_bf16_f32 v69, v226, v227
    s_waitcnt lgkmcnt(4)
    v_mfma_f32_16x16x32_bf16 v[36:39], a[152:155], v[136:139], v[36:39]
    v_exp_f32 v231, v15
    v_mfma_f32_16x16x32_bf16 v[44:47], a[152:155], v[152:155], v[44:47]
    v_exp_f32 v224, v16
    v_mfma_f32_16x16x32_bf16 v[52:55], a[152:155], v[168:171], v[52:55]
    ds_read_b64_tr_b16 a[136:137], v198 offset:24576
    ds_read_b64_tr_b16 a[138:139], v198 offset:28672
    buffer_load_dword a197, v251, s[12:15], s46 offen offset:2080 sc1
    v_mfma_f32_16x16x32_bf16 v[60:63], a[152:155], v[184:187], v[60:63]
    v_exp_f32 v225, v17
    v_mfma_f32_16x16x32_bf16 v[36:39], a[156:159], v[140:143], v[36:39]
    v_exp_f32 v226, v18
    v_mfma_f32_16x16x32_bf16 v[44:47], a[156:159], v[156:159], v[44:47]
    v_exp_f32 v227, v19
    v_mfma_f32_16x16x32_bf16 v[52:55], a[156:159], v[172:175], v[52:55]
    ds_read_b64_tr_b16 a[140:141], v199 offset:24576
    ds_read_b64_tr_b16 a[142:143], v199 offset:28672
    buffer_load_dword a185, v251, s[12:15], s46 offen offset:64 sc1
    v_mfma_f32_16x16x32_bf16 v[60:63], a[156:159], v[188:191], v[60:63]
    v_cvt_pk_bf16_f32 v70, v228, v229
    s_waitcnt lgkmcnt(4)
    v_mfma_f32_16x16x32_bf16 a[0:3], a[128:131], v[80:83], a[0:3]
    v_exp_f32 v228, v20
    v_mfma_f32_16x16x32_bf16 a[4:7], a[128:131], v[84:87], a[4:7]
    v_exp_f32 v229, v21
    v_mfma_f32_16x16x32_bf16 a[8:11], a[128:131], v[88:91], a[8:11]
    ds_read_b64_tr_b16 a[144:145], v200 offset:24576
    ds_read_b64_tr_b16 a[146:147], v200 offset:28672
    buffer_load_dword a201, v251, s[12:15], s46 offen offset:2112 sc1
    v_mfma_f32_16x16x32_bf16 a[12:15], a[128:131], v[92:95], a[12:15]
    v_cvt_pk_bf16_f32 v71, v230, v231
    v_cvt_pk_bf16_f32 v72, v224, v225
    v_mfma_f32_16x16x32_bf16 a[16:19], a[132:135], v[80:83], a[16:19]
    v_exp_f32 v230, v22
    v_mfma_f32_16x16x32_bf16 v[116:119], a[216:219], v[68:71], v[212:215]
    v_exp_f32 v231, v23
    v_mfma_f32_16x16x32_bf16 a[20:23], a[132:135], v[84:87], a[20:23]
    v_exp_f32 v224, v24
    v_mfma_f32_16x16x32_bf16 a[24:27], a[132:135], v[88:91], a[24:27]
    ds_read_b64_tr_b16 a[148:149], v201 offset:24576
    ds_read_b64_tr_b16 a[150:151], v201 offset:28672
    buffer_load_dword a189, v251, s[12:15], s46 offen offset:96 sc1
    v_mfma_f32_16x16x32_bf16 a[28:31], a[132:135], v[92:95], a[28:31]
    v_cvt_pk_bf16_f32 v73, v226, v227
    s_waitcnt lgkmcnt(4)
    v_mfma_f32_16x16x32_bf16 a[32:35], a[136:139], v[80:83], a[32:35]
    v_exp_f32 v225, v25
    v_mfma_f32_16x16x32_bf16 a[36:39], a[136:139], v[84:87], a[36:39]
    v_exp_f32 v226, v26
    v_mfma_f32_16x16x32_bf16 a[40:43], a[136:139], v[88:91], a[40:43]
    ds_read_b64_tr_b16 a[152:153], v202 offset:24576
    ds_read_b64_tr_b16 a[154:155], v202 offset:28672
    buffer_load_dword a205, v251, s[12:15], s46 offen offset:2144 sc1
    v_mfma_f32_16x16x32_bf16 a[44:47], a[136:139], v[92:95], a[44:47]
    v_exp_f32 v227, v27
    v_mfma_f32_16x16x32_bf16 a[48:51], a[140:143], v[80:83], a[48:51]
    v_cvt_pk_bf16_f32 v74, v228, v229
    s_mov_b32 s46, 30720
    v_mfma_f32_16x16x32_bf16 a[52:55], a[140:143], v[84:87], a[52:55]
    v_exp_f32 v228, v28
    v_mfma_f32_16x16x32_bf16 a[56:59], a[140:143], v[88:91], a[56:59]
    ds_read_b64_tr_b16 a[156:157], v203 offset:24576
    ds_read_b64_tr_b16 a[158:159], v203 offset:28672
    buffer_load_dword a178, v251, s[12:15], s46 offen offset:0 sc1
    v_mfma_f32_16x16x32_bf16 a[60:63], a[140:143], v[92:95], a[60:63]
    v_cvt_pk_bf16_f32 v75, v230, v231
    s_waitcnt lgkmcnt(4)
    v_mfma_f32_16x16x32_bf16 a[64:67], a[144:147], v[80:83], a[64:67]
    v_exp_f32 v229, v29
    v_mfma_f32_16x16x32_bf16 v[120:123], a[216:219], v[72:75], v[216:219]
    v_exp_f32 v230, v30
    v_mfma_f32_16x16x32_bf16 a[68:71], a[144:147], v[84:87], a[68:71]
    v_exp_f32 v231, v31
    v_mfma_f32_16x16x32_bf16 a[72:75], a[144:147], v[88:91], a[72:75]
    ds_read_b128 a[128:131], v192 offset:49152
    buffer_load_dword a194, v251, s[12:15], s46 offen offset:2048 sc1
    v_mfma_f32_16x16x32_bf16 a[76:79], a[144:147], v[92:95], a[76:79]
    v_cvt_pk_bf16_f32 v76, v224, v225
    v_cvt_pk_bf16_f32 v77, v226, v227
    v_mfma_f32_16x16x32_bf16 a[80:83], a[148:151], v[80:83], a[80:83]
    v_cvt_pk_bf16_f32 v78, v228, v229
    v_cvt_pk_bf16_f32 v79, v230, v231
    v_mfma_f32_16x16x32_bf16 a[84:87], a[148:151], v[84:87], a[84:87]
    v_mfma_f32_16x16x32_bf16 a[88:91], a[148:151], v[88:91], a[88:91]
    ds_read_b128 a[132:135], v193 offset:49152
    buffer_load_dword a182, v251, s[12:15], s46 offen offset:32 sc1
    v_mfma_f32_16x16x32_bf16 v[124:127], a[216:219], v[76:79], v[220:223]
    v_mfma_f32_16x16x32_bf16 a[92:95], a[148:151], v[92:95], a[92:95]
    s_waitcnt lgkmcnt(2)
    v_mfma_f32_16x16x32_bf16 a[96:99], a[152:155], v[80:83], a[96:99]
    v_mfma_f32_16x16x32_bf16 a[100:103], a[152:155], v[84:87], a[100:103]
    v_mfma_f32_16x16x32_bf16 a[104:107], a[152:155], v[88:91], a[104:107]
    ds_read_b128 a[136:139], v194 offset:49152
    buffer_load_dword a198, v251, s[12:15], s46 offen offset:2080 sc1
    v_mfma_f32_16x16x32_bf16 a[108:111], a[152:155], v[92:95], a[108:111]
    v_mfma_f32_16x16x32_bf16 a[112:115], a[156:159], v[80:83], a[112:115]
    v_mfma_f32_16x16x32_bf16 a[116:119], a[156:159], v[84:87], a[116:119]
    v_max3_f32 v252, v112, v116, v120
    v_max_f32 v252, v252, v124
    v_mfma_f32_16x16x32_bf16 a[120:123], a[156:159], v[88:91], a[120:123]
    ds_read_b128 a[140:143], v195 offset:49152
    s_waitcnt lgkmcnt(2)
    v_mfma_f32_16x16x32_bf16 a[124:127], a[156:159], v[92:95], a[124:127]
    v_cmp_lt_f32 vcc, 0x67800000, v252
    s_nop 1
    s_cbranch_vccnz TRAMP_T60
BACK_T60:
    v_mfma_f32_16x16x32_bf16 v[0:3], a[128:131], v[128:131], v[96:99]
    v_exp_f32 v224, v32
    v_mfma_f32_16x16x32_bf16 v[8:11], a[128:131], v[144:147], v[100:103]
    v_exp_f32 v225, v33
    v_mfma_f32_16x16x32_bf16 v[16:19], a[128:131], v[160:163], v[104:107]
    ds_read_b128 a[144:147], v192 offset:53248
    v_mbcnt_lo_u32_b32 v234, -1, 0
    v_mbcnt_hi_u32_b32 v234, -1, v234
    v_mfma_f32_16x16x32_bf16 v[24:27], a[128:131], v[176:179], v[108:111]
    v_exp_f32 v226, v34
    v_mfma_f32_16x16x32_bf16 v[0:3], a[132:135], v[132:135], v[0:3]
    v_lshlrev_b32 v234, 2, v234
    v_add_u32 v234, 0x3005000, v234
    v_mfma_f32_16x16x32_bf16 v[8:11], a[132:135], v[148:151], v[8:11]
    v_exp_f32 v227, v35
    v_mfma_f32_16x16x32_bf16 v[16:19], a[132:135], v[164:167], v[16:19]
    ds_read_b128 a[148:151], v193 offset:53248
    v_min_u32 v235, 0x30050dc, v234
    v_mfma_f32_16x16x32_bf16 v[24:27], a[132:135], v[180:183], v[24:27]
    v_cvt_pk_bf16_f32 v80, v224, v225
    s_waitcnt lgkmcnt(2)
    v_mfma_f32_16x16x32_bf16 v[0:3], a[136:139], v[136:139], v[0:3]
    v_exp_f32 v228, v36
    v_mfma_f32_16x16x32_bf16 v[8:11], a[136:139], v[152:155], v[8:11]
    v_exp_f32 v229, v37
    v_mfma_f32_16x16x32_bf16 v[16:19], a[136:139], v[168:171], v[16:19]
    ds_read_b128 a[152:155], v194 offset:53248
    global_load_dword a212, v234, s[34:35] sc1
    v_mfma_f32_16x16x32_bf16 v[24:27], a[136:139], v[184:187], v[24:27]
    v_exp_f32 v230, v38
    v_mfma_f32_16x16x32_bf16 v[0:3], a[140:143], v[140:143], v[0:3]
    global_load_dword a213, v234, s[34:35] offset:256 sc1
    v_cvt_pk_bf16_f32 v81, v226, v227
    v_mfma_f32_16x16x32_bf16 v[8:11], a[140:143], v[156:159], v[8:11]
    v_exp_f32 v231, v39
    v_mfma_f32_16x16x32_bf16 v[16:19], a[140:143], v[172:175], v[16:19]
    ds_read_b128 a[156:159], v195 offset:53248
    global_load_dword a214, v235, s[34:35] offset:512 sc1
    buffer_load_dword a186, v251, s[12:15], s46 offen offset:64 sc1
    v_mfma_f32_16x16x32_bf16 v[24:27], a[140:143], v[188:191], v[24:27]
    v_cvt_pk_bf16_f32 v82, v228, v229
    s_waitcnt lgkmcnt(2)
    v_mfma_f32_16x16x32_bf16 v[4:7], a[144:147], v[128:131], v[96:99]
    v_exp_f32 v224, v40
    v_mfma_f32_16x16x32_bf16 v[12:15], a[144:147], v[144:147], v[100:103]
    v_exp_f32 v225, v41
    v_mfma_f32_16x16x32_bf16 v[20:23], a[144:147], v[160:163], v[104:107]
    ds_read_b64_tr_b16 a[128:129], v196 offset:32768
    ds_read_b64_tr_b16 a[130:131], v196 offset:36864
    buffer_load_dword a202, v251, s[12:15], s46 offen offset:2112 sc1
    v_mfma_f32_16x16x32_bf16 v[28:31], a[144:147], v[176:179], v[108:111]
    v_exp_f32 v226, v42
    v_mfma_f32_16x16x32_bf16 v[4:7], a[148:151], v[132:135], v[4:7]
    v_exp_f32 v227, v43
    v_mfma_f32_16x16x32_bf16 v[12:15], a[148:151], v[148:151], v[12:15]
    v_exp_f32 v228, v44
    v_mfma_f32_16x16x32_bf16 v[20:23], a[148:151], v[164:167], v[20:23]
    ds_read_b64_tr_b16 a[132:133], v197 offset:32768
    ds_read_b64_tr_b16 a[134:135], v197 offset:36864
    buffer_load_dword a190, v251, s[12:15], s46 offen offset:96 sc1
    v_mfma_f32_16x16x32_bf16 v[28:31], a[148:151], v[180:183], v[28:31]
    v_cvt_pk_bf16_f32 v83, v230, v231
    s_waitcnt lgkmcnt(4)
    v_mfma_f32_16x16x32_bf16 v[4:7], a[152:155], v[136:139], v[4:7]
    v_exp_f32 v229, v45
    v_mfma_f32_16x16x32_bf16 v[208:211], a[216:219], v[80:83], v[112:115]
    v_exp_f32 v230, v46
    v_mfma_f32_16x16x32_bf16 v[12:15], a[152:155], v[152:155], v[12:15]
    v_exp_f32 v231, v47
    v_mfma_f32_16x16x32_bf16 v[20:23], a[152:155], v[168:171], v[20:23]
    ds_read_b64_tr_b16 a[136:137], v198 offset:32768
    ds_read_b64_tr_b16 a[138:139], v198 offset:36864
    buffer_load_dword a206, v251, s[12:15], s46 offen offset:2144 sc1
    v_mfma_f32_16x16x32_bf16 v[28:31], a[152:155], v[184:187], v[28:31]
    v_cvt_pk_bf16_f32 v84, v224, v225
    v_cvt_pk_bf16_f32 v85, v226, v227
    v_mfma_f32_16x16x32_bf16 v[4:7], a[156:159], v[140:143], v[4:7]
    v_cvt_pk_bf16_f32 v86, v228, v229
    s_mov_b32 s46, 43008
    v_mfma_f32_16x16x32_bf16 v[12:15], a[156:159], v[156:159], v[12:15]
    v_exp_f32 v224, v48
    v_mfma_f32_16x16x32_bf16 v[20:23], a[156:159], v[172:175], v[20:23]
    ds_read_b64_tr_b16 a[140:141], v199 offset:32768
    ds_read_b64_tr_b16 a[142:143], v199 offset:36864
    buffer_load_dword a179, v251, s[12:15], s46 offen offset:0 sc1
    v_mfma_f32_16x16x32_bf16 v[28:31], a[156:159], v[188:191], v[28:31]
    v_cvt_pk_bf16_f32 v87, v230, v231
    s_waitcnt lgkmcnt(4)
    v_mfma_f32_16x16x32_bf16 a[0:3], a[128:131], v[64:67], a[0:3]
    v_exp_f32 v225, v49
    v_mfma_f32_16x16x32_bf16 v[212:215], a[216:219], v[84:87], v[116:119]
    v_exp_f32 v226, v50
    v_mfma_f32_16x16x32_bf16 a[4:7], a[128:131], v[68:71], a[4:7]
    v_exp_f32 v227, v51
    v_mfma_f32_16x16x32_bf16 a[8:11], a[128:131], v[72:75], a[8:11]
    ds_read_b64_tr_b16 a[144:145], v200 offset:32768
    ds_read_b64_tr_b16 a[146:147], v200 offset:36864
    buffer_load_dword a195, v251, s[12:15], s46 offen offset:2048 sc1
    v_mfma_f32_16x16x32_bf16 a[12:15], a[128:131], v[76:79], a[12:15]
    v_exp_f32 v228, v52
    v_mfma_f32_16x16x32_bf16 a[16:19], a[132:135], v[64:67], a[16:19]
    v_exp_f32 v229, v53
    v_mfma_f32_16x16x32_bf16 a[20:23], a[132:135], v[68:71], a[20:23]
    v_exp_f32 v230, v54
    v_mfma_f32_16x16x32_bf16 a[24:27], a[132:135], v[72:75], a[24:27]
    ds_read_b64_tr_b16 a[148:149], v201 offset:32768
    ds_read_b64_tr_b16 a[150:151], v201 offset:36864
    buffer_load_dword a183, v251, s[12:15], s46 offen offset:32 sc1
    v_mfma_f32_16x16x32_bf16 a[28:31], a[132:135], v[76:79], a[28:31]
    v_cvt_pk_bf16_f32 v88, v224, v225
    s_waitcnt lgkmcnt(4)
    v_mfma_f32_16x16x32_bf16 a[32:35], a[136:139], v[64:67], a[32:35]
    v_exp_f32 v231, v55
    v_mfma_f32_16x16x32_bf16 a[36:39], a[136:139], v[68:71], a[36:39]
    v_exp_f32 v224, v56
    v_mfma_f32_16x16x32_bf16 a[40:43], a[136:139], v[72:75], a[40:43]
    ds_read_b64_tr_b16 a[152:153], v202 offset:32768
    ds_read_b64_tr_b16 a[154:155], v202 offset:36864
    buffer_load_dword a199, v251, s[12:15], s46 offen offset:2080 sc1
    v_mfma_f32_16x16x32_bf16 a[44:47], a[136:139], v[76:79], a[44:47]
    v_exp_f32 v225, v57
    v_mfma_f32_16x16x32_bf16 a[48:51], a[140:143], v[64:67], a[48:51]
    v_cvt_pk_bf16_f32 v89, v226, v227
    v_cvt_pk_bf16_f32 v90, v228, v229
    v_mfma_f32_16x16x32_bf16 a[52:55], a[140:143], v[68:71], a[52:55]
    v_exp_f32 v226, v58
    v_mfma_f32_16x16x32_bf16 a[56:59], a[140:143], v[72:75], a[56:59]
    ds_read_b64_tr_b16 a[156:157], v203 offset:32768
    ds_read_b64_tr_b16 a[158:159], v203 offset:36864
    buffer_load_dword a187, v251, s[12:15], s46 offen offset:64 sc1
    v_mfma_f32_16x16x32_bf16 a[60:63], a[140:143], v[76:79], a[60:63]
    v_cvt_pk_bf16_f32 v91, v230, v231
    s_waitcnt lgkmcnt(4)
    v_mfma_f32_16x16x32_bf16 a[64:67], a[144:147], v[64:67], a[64:67]
    v_exp_f32 v227, v59
    v_mfma_f32_16x16x32_bf16 v[216:219], a[216:219], v[88:91], v[120:123]
    v_exp_f32 v228, v60
    v_mfma_f32_16x16x32_bf16 a[68:71], a[144:147], v[68:71], a[68:71]
    v_exp_f32 v229, v61
    v_mfma_f32_16x16x32_bf16 a[72:75], a[144:147], v[72:75], a[72:75]
    ds_read_b128 a[128:131], v192 offset:57344
    buffer_load_dword a203, v251, s[12:15], s46 offen offset:2112 sc1
    v_mfma_f32_16x16x32_bf16 a[76:79], a[144:147], v[76:79], a[76:79]
    v_exp_f32 v230, v62
    v_mfma_f32_16x16x32_bf16 a[80:83], a[148:151], v[64:67], a[80:83]
    v_exp_f32 v231, v63
    v_mfma_f32_16x16x32_bf16 a[84:87], a[148:151], v[68:71], a[84:87]
    v_cvt_pk_bf16_f32 v92, v224, v225
    v_cvt_pk_bf16_f32 v93, v226, v227
    v_mfma_f32_16x16x32_bf16 a[88:91], a[148:151], v[72:75], a[88:91]
    ds_read_b128 a[132:135], v193 offset:57344
    buffer_load_dword a191, v251, s[12:15], s46 offen offset:96 sc1
    v_mfma_f32_16x16x32_bf16 a[92:95], a[148:151], v[76:79], a[92:95]
    v_cvt_pk_bf16_f32 v94, v228, v229
    s_waitcnt lgkmcnt(2)
    v_mfma_f32_16x16x32_bf16 a[96:99], a[152:155], v[64:67], a[96:99]
    v_cvt_pk_bf16_f32 v95, v230, v231
    v_mfma_f32_16x16x32_bf16 a[100:103], a[152:155], v[68:71], a[100:103]
    v_mfma_f32_16x16x32_bf16 a[104:107], a[152:155], v[72:75], a[104:107]
    ds_read_b128 a[136:139], v194 offset:57344
    buffer_load_dword a207, v251, s[12:15], s46 offen offset:2144 sc1
    v_mfma_f32_16x16x32_bf16 v[220:223], a[216:219], v[92:95], v[124:127]
    v_mfma_f32_16x16x32_bf16 a[108:111], a[152:155], v[76:79], a[108:111]
    v_mfma_f32_16x16x32_bf16 a[112:115], a[156:159], v[64:67], a[112:115]
    v_mfma_f32_16x16x32_bf16 a[116:119], a[156:159], v[68:71], a[116:119]
    v_mfma_f32_16x16x32_bf16 a[120:123], a[156:159], v[72:75], a[120:123]
    ds_read_b128 a[140:143], v195 offset:57344
    s_waitcnt lgkmcnt(2)
    v_mfma_f32_16x16x32_bf16 a[124:127], a[156:159], v[76:79], a[124:127]
    s_nop 3
    s_nop 3
    v_max3_f32 v252, v208, v212, v216
    v_max_f32 v252, v252, v220
    v_cmp_lt_f32 vcc, 0x67800000, v252
    s_nop 1
    s_cbranch_vccnz TRAMP_T61
BACK_T61:
    s_waitcnt vmcnt(39)
    s_barrier
    v_mfma_f32_16x16x32_bf16 v[32:35], a[128:131], v[128:131], v[96:99]
    v_exp_f32 v224, v0
    v_mfma_f32_16x16x32_bf16 v[40:43], a[128:131], v[144:147], v[100:103]
    v_exp_f32 v225, v1
    v_mfma_f32_16x16x32_bf16 v[48:51], a[128:131], v[160:163], v[104:107]
    ds_read_b128 a[144:147], v192 offset:61440
    v_cvt_pk_bf16_f32 v64, v224, v225
    v_mfma_f32_16x16x32_bf16 v[56:59], a[128:131], v[176:179], v[108:111]
    v_exp_f32 v226, v2
    v_mfma_f32_16x16x32_bf16 v[32:35], a[132:135], v[132:135], v[32:35]
    v_exp_f32 v227, v3
    v_mfma_f32_16x16x32_bf16 v[40:43], a[132:135], v[148:151], v[40:43]
    v_exp_f32 v228, v4
    v_mfma_f32_16x16x32_bf16 v[48:51], a[132:135], v[164:167], v[48:51]
    ds_read_b128 a[148:151], v193 offset:61440
    v_cvt_pk_bf16_f32 v65, v226, v227
    v_mfma_f32_16x16x32_bf16 v[56:59], a[132:135], v[180:183], v[56:59]
    s_waitcnt lgkmcnt(2)
    v_mfma_f32_16x16x32_bf16 v[32:35], a[136:139], v[136:139], v[32:35]
    v_exp_f32 v229, v5
    v_mfma_f32_16x16x32_bf16 v[40:43], a[136:139], v[152:155], v[40:43]
    v_exp_f32 v230, v6
    v_mfma_f32_16x16x32_bf16 v[48:51], a[136:139], v[168:171], v[48:51]
    ds_read_b128 a[152:155], v194 offset:61440
    v_cvt_pk_bf16_f32 v66, v228, v229
    v_mfma_f32_16x16x32_bf16 v[56:59], a[136:139], v[184:187], v[56:59]
    v_exp_f32 v231, v7
    v_mfma_f32_16x16x32_bf16 v[32:35], a[140:143], v[140:143], v[32:35]
    v_exp_f32 v224, v8
    v_mfma_f32_16x16x32_bf16 v[40:43], a[140:143], v[156:159], v[40:43]
    v_exp_f32 v225, v9
    v_mfma_f32_16x16x32_bf16 v[48:51], a[140:143], v[172:175], v[48:51]
    ds_read_b128 a[156:159], v195 offset:61440
    v_cvt_pk_bf16_f32 v67, v230, v231
    v_mfma_f32_16x16x32_bf16 v[56:59], a[140:143], v[188:191], v[56:59]
    v_cvt_pk_bf16_f32 v68, v224, v225
    s_waitcnt lgkmcnt(2)
    v_mfma_f32_16x16x32_bf16 v[112:115], a[216:219], v[64:67], v[208:211]
    v_exp_f32 v226, v10
    v_mfma_f32_16x16x32_bf16 v[36:39], a[144:147], v[128:131], v[96:99]
    v_exp_f32 v227, v11
    v_mfma_f32_16x16x32_bf16 v[44:47], a[144:147], v[144:147], v[100:103]
    v_exp_f32 v228, v12
    v_mfma_f32_16x16x32_bf16 v[52:55], a[144:147], v[160:163], v[104:107]
    ds_read_b64_tr_b16 a[128:129], v196 offset:40960
    ds_read_b64_tr_b16 a[130:131], v196 offset:45056
    v_mfma_f32_16x16x32_bf16 v[60:63], a[144:147], v[176:179], v[108:111]
    v_exp_f32 v229, v13
    v_mfma_f32_16x16x32_bf16 v[36:39], a[148:151], v[132:135], v[36:39]
    v_exp_f32 v230, v14
    v_mfma_f32_16x16x32_bf16 v[44:47], a[148:151], v[148:151], v[44:47]
    v_exp_f32 v231, v15
    v_mfma_f32_16x16x32_bf16 v[52:55], a[148:151], v[164:167], v[52:55]
    ds_read_b64_tr_b16 a[132:133], v197 offset:40960
    ds_read_b64_tr_b16 a[134:135], v197 offset:45056
    v_mfma_f32_16x16x32_bf16 v[60:63], a[148:151], v[180:183], v[60:63]
    v_cvt_pk_bf16_f32 v69, v226, v227
    s_waitcnt lgkmcnt(4)
    v_mfma_f32_16x16x32_bf16 v[36:39], a[152:155], v[136:139], v[36:39]
    v_exp_f32 v224, v16
    v_mfma_f32_16x16x32_bf16 v[44:47], a[152:155], v[152:155], v[44:47]
    v_exp_f32 v225, v17
    v_mfma_f32_16x16x32_bf16 v[52:55], a[152:155], v[168:171], v[52:55]
    ds_read_b64_tr_b16 a[136:137], v198 offset:40960
    ds_read_b64_tr_b16 a[138:139], v198 offset:45056
    v_mfma_f32_16x16x32_bf16 v[60:63], a[152:155], v[184:187], v[60:63]
    v_exp_f32 v226, v18
    v_mfma_f32_16x16x32_bf16 v[36:39], a[156:159], v[140:143], v[36:39]
    v_exp_f32 v227, v19
    v_mfma_f32_16x16x32_bf16 v[44:47], a[156:159], v[156:159], v[44:47]
    v_cvt_pk_bf16_f32 v70, v228, v229
    v_cvt_pk_bf16_f32 v71, v230, v231
    v_mfma_f32_16x16x32_bf16 v[52:55], a[156:159], v[172:175], v[52:55]
    ds_read_b64_tr_b16 a[140:141], v199 offset:40960
    ds_read_b64_tr_b16 a[142:143], v199 offset:45056
    v_mfma_f32_16x16x32_bf16 v[116:119], a[216:219], v[68:71], v[212:215]
    v_exp_f32 v228, v20
    v_mfma_f32_16x16x32_bf16 v[60:63], a[156:159], v[188:191], v[60:63]
    v_cvt_pk_bf16_f32 v72, v224, v225
    s_waitcnt lgkmcnt(4)
    v_mfma_f32_16x16x32_bf16 a[0:3], a[128:131], v[80:83], a[0:3]
    v_exp_f32 v229, v21
    v_mfma_f32_16x16x32_bf16 a[4:7], a[128:131], v[84:87], a[4:7]
    v_exp_f32 v230, v22
    v_mfma_f32_16x16x32_bf16 a[8:11], a[128:131], v[88:91], a[8:11]
    ds_read_b64_tr_b16 a[144:145], v200 offset:40960
    ds_read_b64_tr_b16 a[146:147], v200 offset:45056
    v_mfma_f32_16x16x32_bf16 a[12:15], a[128:131], v[92:95], a[12:15]
    v_exp_f32 v231, v23
    v_mfma_f32_16x16x32_bf16 a[16:19], a[132:135], v[80:83], a[16:19]
    v_exp_f32 v224, v24
    v_mfma_f32_16x16x32_bf16 a[20:23], a[132:135], v[84:87], a[20:23]
    v_exp_f32 v225, v25
    v_mfma_f32_16x16x32_bf16 a[24:27], a[132:135], v[88:91], a[24:27]
    ds_read_b64_tr_b16 a[148:149], v201 offset:40960
    ds_read_b64_tr_b16 a[150:151], v201 offset:45056
    v_mfma_f32_16x16x32_bf16 a[28:31], a[132:135], v[92:95], a[28:31]
    v_cvt_pk_bf16_f32 v73, v226, v227
    s_waitcnt lgkmcnt(4)
    v_mfma_f32_16x16x32_bf16 a[32:35], a[136:139], v[80:83], a[32:35]
    v_exp_f32 v226, v26
    v_mfma_f32_16x16x32_bf16 a[36:39], a[136:139], v[84:87], a[36:39]
    v_exp_f32 v227, v27
    v_mfma_f32_16x16x32_bf16 a[40:43], a[136:139], v[88:91], a[40:43]
    ds_read_b64_tr_b16 a[152:153], v202 offset:40960
    ds_read_b64_tr_b16 a[154:155], v202 offset:45056
    v_mfma_f32_16x16x32_bf16 a[44:47], a[136:139], v[92:95], a[44:47]
    v_cvt_pk_bf16_f32 v74, v228, v229
    v_cvt_pk_bf16_f32 v75, v230, v231
    v_mfma_f32_16x16x32_bf16 a[48:51], a[140:143], v[80:83], a[48:51]
    v_exp_f32 v228, v28
    v_mfma_f32_16x16x32_bf16 v[120:123], a[216:219], v[72:75], v[216:219]
    v_exp_f32 v229, v29
    v_mfma_f32_16x16x32_bf16 a[52:55], a[140:143], v[84:87], a[52:55]
    v_exp_f32 v230, v30
    v_mfma_f32_16x16x32_bf16 a[56:59], a[140:143], v[88:91], a[56:59]
    ds_read_b64_tr_b16 a[156:157], v203 offset:40960
    ds_read_b64_tr_b16 a[158:159], v203 offset:45056
    v_mfma_f32_16x16x32_bf16 a[60:63], a[140:143], v[92:95], a[60:63]
    v_cvt_pk_bf16_f32 v76, v224, v225
    s_waitcnt lgkmcnt(4)
    v_mfma_f32_16x16x32_bf16 a[64:67], a[144:147], v[80:83], a[64:67]
    v_exp_f32 v231, v31
    v_mfma_f32_16x16x32_bf16 a[68:71], a[144:147], v[84:87], a[68:71]
    v_cvt_pk_bf16_f32 v77, v226, v227
    v_cvt_pk_bf16_f32 v78, v228, v229
    v_mfma_f32_16x16x32_bf16 a[72:75], a[144:147], v[88:91], a[72:75]
    v_cvt_pk_bf16_f32 v79, v230, v231
    v_mfma_f32_16x16x32_bf16 a[76:79], a[144:147], v[92:95], a[76:79]
    v_mfma_f32_16x16x32_bf16 a[80:83], a[148:151], v[80:83], a[80:83]
    v_mfma_f32_16x16x32_bf16 v[124:127], a[216:219], v[76:79], v[220:223]
    v_mfma_f32_16x16x32_bf16 a[84:87], a[148:151], v[84:87], a[84:87]
    v_mfma_f32_16x16x32_bf16 a[88:91], a[148:151], v[88:91], a[88:91]
    v_mfma_f32_16x16x32_bf16 a[92:95], a[148:151], v[92:95], a[92:95]
    s_waitcnt lgkmcnt(0)
    v_mfma_f32_16x16x32_bf16 a[96:99], a[152:155], v[80:83], a[96:99]
    v_mfma_f32_16x16x32_bf16 a[100:103], a[152:155], v[84:87], a[100:103]
    v_mfma_f32_16x16x32_bf16 a[104:107], a[152:155], v[88:91], a[104:107]
    v_mfma_f32_16x16x32_bf16 a[108:111], a[152:155], v[92:95], a[108:111]
    v_mfma_f32_16x16x32_bf16 a[112:115], a[156:159], v[80:83], a[112:115]
    v_mfma_f32_16x16x32_bf16 a[116:119], a[156:159], v[84:87], a[116:119]
    v_max3_f32 v252, v112, v116, v120
    v_max_f32 v252, v252, v124
    v_mfma_f32_16x16x32_bf16 a[120:123], a[156:159], v[88:91], a[120:123]
    v_cmp_lt_f32 vcc, 0x67800000, v252
    v_mfma_f32_16x16x32_bf16 a[124:127], a[156:159], v[92:95], a[124:127]
    s_nop 1
    s_cbranch_vccnz TRAMP_T62
BACK_T62:
    v_exp_f32 v224, v32
    v_exp_f32 v225, v33
    v_exp_f32 v226, v34
    v_exp_f32 v227, v35
    v_exp_f32 v228, v36
    v_exp_f32 v229, v37
    v_exp_f32 v230, v38
    v_exp_f32 v231, v39
    v_cvt_pk_bf16_f32 v80, v224, v225
    v_cvt_pk_bf16_f32 v81, v226, v227
    v_exp_f32 v224, v40
    v_exp_f32 v225, v41
    v_exp_f32 v226, v42
    v_exp_f32 v227, v43
    v_cvt_pk_bf16_f32 v82, v228, v229
    v_cvt_pk_bf16_f32 v83, v230, v231
    v_exp_f32 v228, v44
    v_exp_f32 v229, v45
    v_mfma_f32_16x16x32_bf16 v[208:211], a[216:219], v[80:83], v[112:115]
    v_exp_f32 v230, v46
    v_exp_f32 v231, v47
    v_cvt_pk_bf16_f32 v84, v224, v225
    v_cvt_pk_bf16_f32 v85, v226, v227
    ds_read_b64_tr_b16 a[128:129], v196 offset:49152
    ds_read_b64_tr_b16 a[130:131], v196 offset:53248
    v_exp_f32 v224, v48
    v_exp_f32 v225, v49
    v_exp_f32 v226, v50
    ds_read_b64_tr_b16 a[132:133], v197 offset:49152
    ds_read_b64_tr_b16 a[134:135], v197 offset:53248
    v_exp_f32 v227, v51
    v_cvt_pk_bf16_f32 v86, v228, v229
    v_cvt_pk_bf16_f32 v87, v230, v231
    v_exp_f32 v228, v52
    ds_read_b64_tr_b16 a[136:137], v198 offset:49152
    ds_read_b64_tr_b16 a[138:139], v198 offset:53248
    v_mfma_f32_16x16x32_bf16 v[212:215], a[216:219], v[84:87], v[116:119]
    v_exp_f32 v229, v53
    v_exp_f32 v230, v54
    v_exp_f32 v231, v55
    v_cvt_pk_bf16_f32 v88, v224, v225
    v_cvt_pk_bf16_f32 v89, v226, v227
    ds_read_b64_tr_b16 a[140:141], v199 offset:49152
    ds_read_b64_tr_b16 a[142:143], v199 offset:53248
    v_exp_f32 v224, v56
    s_waitcnt lgkmcnt(4)
    v_mfma_f32_16x16x32_bf16 a[0:3], a[128:131], v[64:67], a[0:3]
    v_exp_f32 v225, v57
    v_mfma_f32_16x16x32_bf16 a[4:7], a[128:131], v[68:71], a[4:7]
    v_exp_f32 v226, v58
    v_mfma_f32_16x16x32_bf16 a[8:11], a[128:131], v[72:75], a[8:11]
    ds_read_b64_tr_b16 a[144:145], v200 offset:49152
    ds_read_b64_tr_b16 a[146:147], v200 offset:53248
    v_mfma_f32_16x16x32_bf16 a[12:15], a[128:131], v[76:79], a[12:15]
    v_exp_f32 v227, v59
    v_mfma_f32_16x16x32_bf16 a[16:19], a[132:135], v[64:67], a[16:19]
    v_cvt_pk_bf16_f32 v90, v228, v229
    v_cvt_pk_bf16_f32 v91, v230, v231
    v_mfma_f32_16x16x32_bf16 a[20:23], a[132:135], v[68:71], a[20:23]
    v_exp_f32 v228, v60
    v_mfma_f32_16x16x32_bf16 v[216:219], a[216:219], v[88:91], v[120:123]
    v_exp_f32 v229, v61
    v_mfma_f32_16x16x32_bf16 a[24:27], a[132:135], v[72:75], a[24:27]
    ds_read_b64_tr_b16 a[148:149], v201 offset:49152
    ds_read_b64_tr_b16 a[150:151], v201 offset:53248
    v_mfma_f32_16x16x32_bf16 a[28:31], a[132:135], v[76:79], a[28:31]
    v_cvt_pk_bf16_f32 v92, v224, v225
    s_waitcnt lgkmcnt(4)
    v_mfma_f32_16x16x32_bf16 a[32:35], a[136:139], v[64:67], a[32:35]
    v_exp_f32 v230, v62
    v_mfma_f32_16x16x32_bf16 a[36:39], a[136:139], v[68:71], a[36:39]
    v_exp_f32 v231, v63
    v_mfma_f32_16x16x32_bf16 a[40:43], a[136:139], v[72:75], a[40:43]
    ds_read_b64_tr_b16 a[152:153], v202 offset:49152
    ds_read_b64_tr_b16 a[154:155], v202 offset:53248
    v_mfma_f32_16x16x32_bf16 a[44:47], a[136:139], v[76:79], a[44:47]
    v_cvt_pk_bf16_f32 v93, v226, v227
    v_cvt_pk_bf16_f32 v94, v228, v229
    v_mfma_f32_16x16x32_bf16 a[48:51], a[140:143], v[64:67], a[48:51]
    v_cvt_pk_bf16_f32 v95, v230, v231
    v_mfma_f32_16x16x32_bf16 a[52:55], a[140:143], v[68:71], a[52:55]
    v_mfma_f32_16x16x32_bf16 a[56:59], a[140:143], v[72:75], a[56:59]
    ds_read_b64_tr_b16 a[156:157], v203 offset:49152
    ds_read_b64_tr_b16 a[158:159], v203 offset:53248
    v_mfma_f32_16x16x32_bf16 v[220:223], a[216:219], v[92:95], v[124:127]
    v_mfma_f32_16x16x32_bf16 a[60:63], a[140:143], v[76:79], a[60:63]
    s_waitcnt lgkmcnt(4)
    v_mfma_f32_16x16x32_bf16 a[64:67], a[144:147], v[64:67], a[64:67]
    v_mfma_f32_16x16x32_bf16 a[68:71], a[144:147], v[68:71], a[68:71]
    v_mfma_f32_16x16x32_bf16 a[72:75], a[144:147], v[72:75], a[72:75]
    v_mfma_f32_16x16x32_bf16 a[76:79], a[144:147], v[76:79], a[76:79]
    v_mfma_f32_16x16x32_bf16 a[80:83], a[148:151], v[64:67], a[80:83]
    v_mfma_f32_16x16x32_bf16 a[84:87], a[148:151], v[68:71], a[84:87]
    v_mfma_f32_16x16x32_bf16 a[88:91], a[148:151], v[72:75], a[88:91]
    v_mfma_f32_16x16x32_bf16 a[92:95], a[148:151], v[76:79], a[92:95]
    v_max3_f32 v252, v208, v212, v216
    s_waitcnt lgkmcnt(0)
    v_mfma_f32_16x16x32_bf16 a[96:99], a[152:155], v[64:67], a[96:99]
    v_max_f32 v252, v252, v220
    v_cmp_lt_f32 vcc, 0x67800000, v252
    v_mfma_f32_16x16x32_bf16 a[100:103], a[152:155], v[68:71], a[100:103]
    v_mfma_f32_16x16x32_bf16 a[104:107], a[152:155], v[72:75], a[104:107]
    v_mfma_f32_16x16x32_bf16 a[108:111], a[152:155], v[76:79], a[108:111]
    v_mfma_f32_16x16x32_bf16 a[112:115], a[156:159], v[64:67], a[112:115]
    v_mfma_f32_16x16x32_bf16 a[116:119], a[156:159], v[68:71], a[116:119]
    v_mfma_f32_16x16x32_bf16 a[120:123], a[156:159], v[72:75], a[120:123]
    v_mfma_f32_16x16x32_bf16 a[124:127], a[156:159], v[76:79], a[124:127]
    s_cbranch_vccnz TRAMP_T63
BACK_T63:
    ds_read_b64_tr_b16 a[128:129], v196 offset:57344
    ds_read_b64_tr_b16 a[130:131], v196 offset:61440
    ds_read_b64_tr_b16 a[132:133], v197 offset:57344
    ds_read_b64_tr_b16 a[134:135], v197 offset:61440
    ds_read_b64_tr_b16 a[136:137], v198 offset:57344
    ds_read_b64_tr_b16 a[138:139], v198 offset:61440
    ds_read_b64_tr_b16 a[140:141], v199 offset:57344
    ds_read_b64_tr_b16 a[142:143], v199 offset:61440
    s_waitcnt lgkmcnt(4)
    v_mfma_f32_16x16x32_bf16 a[0:3], a[128:131], v[80:83], a[0:3]
    v_mfma_f32_16x16x32_bf16 a[4:7], a[128:131], v[84:87], a[4:7]
    v_mfma_f32_16x16x32_bf16 a[8:11], a[128:131], v[88:91], a[8:11]
    ds_read_b64_tr_b16 a[144:145], v200 offset:57344
    ds_read_b64_tr_b16 a[146:147], v200 offset:61440
    v_mfma_f32_16x16x32_bf16 a[12:15], a[128:131], v[92:95], a[12:15]
    v_mfma_f32_16x16x32_bf16 a[16:19], a[132:135], v[80:83], a[16:19]
    v_mfma_f32_16x16x32_bf16 a[20:23], a[132:135], v[84:87], a[20:23]
    v_mfma_f32_16x16x32_bf16 a[24:27], a[132:135], v[88:91], a[24:27]
    ds_read_b64_tr_b16 a[148:149], v201 offset:57344
    ds_read_b64_tr_b16 a[150:151], v201 offset:61440
    v_mfma_f32_16x16x32_bf16 a[28:31], a[132:135], v[92:95], a[28:31]
    s_waitcnt lgkmcnt(4)
    v_mfma_f32_16x16x32_bf16 a[32:35], a[136:139], v[80:83], a[32:35]
    v_mfma_f32_16x16x32_bf16 a[36:39], a[136:139], v[84:87], a[36:39]
    v_mfma_f32_16x16x32_bf16 a[40:43], a[136:139], v[88:91], a[40:43]
    ds_read_b64_tr_b16 a[152:153], v202 offset:57344
    ds_read_b64_tr_b16 a[154:155], v202 offset:61440
    v_mfma_f32_16x16x32_bf16 a[44:47], a[136:139], v[92:95], a[44:47]
    v_mfma_f32_16x16x32_bf16 a[48:51], a[140:143], v[80:83], a[48:51]
    v_mfma_f32_16x16x32_bf16 a[52:55], a[140:143], v[84:87], a[52:55]
    v_mfma_f32_16x16x32_bf16 a[56:59], a[140:143], v[88:91], a[56:59]
    ds_read_b64_tr_b16 a[156:157], v203 offset:57344
    ds_read_b64_tr_b16 a[158:159], v203 offset:61440
    v_mfma_f32_16x16x32_bf16 a[60:63], a[140:143], v[92:95], a[60:63]
    s_waitcnt lgkmcnt(4)
    v_mfma_f32_16x16x32_bf16 a[64:67], a[144:147], v[80:83], a[64:67]
    v_mfma_f32_16x16x32_bf16 a[68:71], a[144:147], v[84:87], a[68:71]
    v_mfma_f32_16x16x32_bf16 a[72:75], a[144:147], v[88:91], a[72:75]
    v_mfma_f32_16x16x32_bf16 a[76:79], a[144:147], v[92:95], a[76:79]
    v_mfma_f32_16x16x32_bf16 a[80:83], a[148:151], v[80:83], a[80:83]
    v_mfma_f32_16x16x32_bf16 a[84:87], a[148:151], v[84:87], a[84:87]
    v_mfma_f32_16x16x32_bf16 a[88:91], a[148:151], v[88:91], a[88:91]
    v_mfma_f32_16x16x32_bf16 a[92:95], a[148:151], v[92:95], a[92:95]
    s_waitcnt lgkmcnt(0)
    v_mfma_f32_16x16x32_bf16 a[96:99], a[152:155], v[80:83], a[96:99]
    v_mfma_f32_16x16x32_bf16 a[100:103], a[152:155], v[84:87], a[100:103]
    v_mfma_f32_16x16x32_bf16 a[104:107], a[152:155], v[88:91], a[104:107]
    v_mfma_f32_16x16x32_bf16 a[108:111], a[152:155], v[92:95], a[108:111]
    v_mfma_f32_16x16x32_bf16 a[112:115], a[156:159], v[80:83], a[112:115]
    v_mfma_f32_16x16x32_bf16 a[116:119], a[156:159], v[84:87], a[116:119]
    v_mfma_f32_16x16x32_bf16 a[120:123], a[156:159], v[88:91], a[120:123]
    v_mfma_f32_16x16x32_bf16 a[124:127], a[156:159], v[92:95], a[124:127]
    s_branch after_slow
TRAMP_T0:
    s_call_b64 s[30:31], SLOW_0
    s_branch BACK_T0
TRAMP_L1:
    s_call_b64 s[30:31], SLOW_1
    s_branch BACK_L1
TRAMP_L2:
    s_call_b64 s[30:31], SLOW_0
    s_branch BACK_L2
TRAMP_L3:
    s_call_b64 s[30:31], SLOW_1
    s_branch BACK_L3
TRAMP_L4:
    s_call_b64 s[30:31], SLOW_0
    s_branch BACK_L4
TRAMP_L5:
    s_call_b64 s[30:31], SLOW_1
    s_branch BACK_L5
TRAMP_L6:
    s_call_b64 s[30:31], SLOW_0
    s_branch BACK_L6
TRAMP_L7:
    s_call_b64 s[30:31], SLOW_1
    s_branch BACK_L7
TRAMP_L0:
    s_call_b64 s[30:31], SLOW_0
    s_branch BACK_L0
TRAMP_T57:
    s_call_b64 s[30:31], SLOW_1
    s_branch BACK_T57
TRAMP_T58:
    s_call_b64 s[30:31], SLOW_0
    s_branch BACK_T58
TRAMP_T59:
    s_call_b64 s[30:31], SLOW_1
    s_branch BACK_T59
TRAMP_T60:
    s_call_b64 s[30:31], SLOW_0
    s_branch BACK_T60
TRAMP_T61:
    s_call_b64 s[30:31], SLOW_1
    s_branch BACK_T61
TRAMP_T62:
    s_call_b64 s[30:31], SLOW_0
    s_branch BACK_T62
TRAMP_T63:
    s_call_b64 s[30:31], SLOW_1
    s_branch BACK_T63
SLOW_0:
    s_nop 15
    s_nop 7
    v_max3_f32 v246, v0, v1, v2
    v_max3_f32 v246, v246, v3, v4
    v_max3_f32 v246, v246, v5, v6
    v_max_f32 v246, v246, v7
    v_mov_b32 v247, v246
    s_nop 1
    v_permlane32_swap_b32 v247, v246
    s_nop 1
    v_max_f32 v246, v246, v247
    v_mov_b32 v247, v246
    s_nop 1
    v_permlane16_swap_b32 v247, v246
    s_nop 1
    v_max_f32 v246, v246, v247
    v_add_f32 v246, 0x42c80000, v246
    v_ceil_f32 v246, v246
    v_max_f32 v248, 0, v246
    v_min_f32 v246, 0x46000000, v248
    v_cvt_i32_f32 v249, v246
    v_sub_u32 v249, 0, v249
    v_ldexp_f32 v208, v208, v249
    v_ldexp_f32 v209, v209, v249
    v_ldexp_f32 v210, v210, v249
    v_ldexp_f32 v211, v211, v249
    v_accvgpr_read_b32 v253, a0
    v_ldexp_f32 v253, v253, v249
    v_accvgpr_write_b32 a0, v253
    v_accvgpr_read_b32 v254, a1
    v_ldexp_f32 v254, v254, v249
    v_accvgpr_write_b32 a1, v254
    v_accvgpr_read_b32 v253, a2
    v_ldexp_f32 v253, v253, v249
    v_accvgpr_write_b32 a2, v253
    v_accvgpr_read_b32 v254, a3
    v_ldexp_f32 v254, v254, v249
    v_accvgpr_write_b32 a3, v254
    v_accvgpr_read_b32 v253, a16
    v_ldexp_f32 v253, v253, v249
    v_accvgpr_write_b32 a16, v253
    v_accvgpr_read_b32 v254, a17
    v_ldexp_f32 v254, v254, v249
    v_accvgpr_write_b32 a17, v254
    v_accvgpr_read_b32 v253, a18
    v_ldexp_f32 v253, v253, v249
    v_accvgpr_write_b32 a18, v253
    v_accvgpr_read_b32 v254, a19
    v_ldexp_f32 v254, v254, v249
    v_accvgpr_write_b32 a19, v254
    v_accvgpr_read_b32 v253, a32
    v_ldexp_f32 v253, v253, v249
    v_accvgpr_write_b32 a32, v253
    v_accvgpr_read_b32 v254, a33
    v_ldexp_f32 v254, v254, v249
    v_accvgpr_write_b32 a33, v254
    v_accvgpr_read_b32 v253, a34
    v_ldexp_f32 v253, v253, v249
    v_accvgpr_write_b32 a34, v253
    v_accvgpr_read_b32 v254, a35
    v_ldexp_f32 v254, v254, v249
    v_accvgpr_write_b32 a35, v254
    v_accvgpr_read_b32 v253, a48
    v_ldexp_f32 v253, v253, v249
    v_accvgpr_write_b32 a48, v253
    v_accvgpr_read_b32 v254, a49
    v_ldexp_f32 v254, v254, v249
    v_accvgpr_write_b32 a49, v254
    v_accvgpr_read_b32 v253, a50
    v_ldexp_f32 v253, v253, v249
    v_accvgpr_write_b32 a50, v253
    v_accvgpr_read_b32 v254, a51
    v_ldexp_f32 v254, v254, v249
    v_accvgpr_write_b32 a51, v254
    v_accvgpr_read_b32 v253, a64
    v_ldexp_f32 v253, v253, v249
    v_accvgpr_write_b32 a64, v253
    v_accvgpr_read_b32 v254, a65
    v_ldexp_f32 v254, v254, v249
    v_accvgpr_write_b32 a65, v254
    v_accvgpr_read_b32 v253, a66
    v_ldexp_f32 v253, v253, v249
    v_accvgpr_write_b32 a66, v253
    v_accvgpr_read_b32 v254, a67
    v_ldexp_f32 v254, v254, v249
    v_accvgpr_write_b32 a67, v254
    v_accvgpr_read_b32 v253, a80
    v_ldexp_f32 v253, v253, v249
    v_accvgpr_write_b32 a80, v253
    v_accvgpr_read_b32 v254, a81
    v_ldexp_f32 v254, v254, v249
    v_accvgpr_write_b32 a81, v254
    v_accvgpr_read_b32 v253, a82
    v_ldexp_f32 v253, v253, v249
    v_accvgpr_write_b32 a82, v253
    v_accvgpr_read_b32 v254, a83
    v_ldexp_f32 v254, v254, v249
    v_accvgpr_write_b32 a83, v254
    v_accvgpr_read_b32 v253, a96
    v_ldexp_f32 v253, v253, v249
    v_accvgpr_write_b32 a96, v253
    v_accvgpr_read_b32 v254, a97
    v_ldexp_f32 v254, v254, v249
    v_accvgpr_write_b32 a97, v254
    v_accvgpr_read_b32 v253, a98
    v_ldexp_f32 v253, v253, v249
    v_accvgpr_write_b32 a98, v253
    v_accvgpr_read_b32 v254, a99
    v_ldexp_f32 v254, v254, v249
    v_accvgpr_write_b32 a99, v254
    v_accvgpr_read_b32 v253, a112
    v_ldexp_f32 v253, v253, v249
    v_accvgpr_write_b32 a112, v253
    v_accvgpr_read_b32 v254, a113
    v_ldexp_f32 v254, v254, v249
    v_accvgpr_write_b32 a113, v254
    v_accvgpr_read_b32 v253, a114
    v_ldexp_f32 v253, v253, v249
    v_accvgpr_write_b32 a114, v253
    v_accvgpr_read_b32 v254, a115
    v_ldexp_f32 v254, v254, v249
    v_accvgpr_write_b32 a115, v254
    v_sub_f32 v96, v96, v248
    v_sub_f32 v97, v97, v248
    v_sub_f32 v98, v98, v248
    v_sub_f32 v99, v99, v248
    v_sub_f32 v0, v0, v248
    v_sub_f32 v32, v32, v248
    v_sub_f32 v1, v1, v248
    v_sub_f32 v33, v33, v248
    v_sub_f32 v2, v2, v248
    v_sub_f32 v34, v34, v248
    v_sub_f32 v3, v3, v248
    v_sub_f32 v35, v35, v248
    v_sub_f32 v4, v4, v248
    v_sub_f32 v36, v36, v248
    v_sub_f32 v5, v5, v248
    v_sub_f32 v37, v37, v248
    v_sub_f32 v6, v6, v248
    v_sub_f32 v38, v38, v248
    v_sub_f32 v7, v7, v248
    v_sub_f32 v39, v39, v248
    v_exp_f32 v253, v0
    v_exp_f32 v254, v1
    s_nop 0
    v_cvt_pk_bf16_f32 v64, v253, v254
    v_exp_f32 v253, v2
    v_exp_f32 v254, v3
    s_nop 0
    v_cvt_pk_bf16_f32 v65, v253, v254
    v_exp_f32 v253, v4
    v_exp_f32 v254, v5
    s_nop 0
    v_cvt_pk_bf16_f32 v66, v253, v254
    v_exp_f32 v253, v6
    v_exp_f32 v254, v7
    s_nop 0
    v_cvt_pk_bf16_f32 v67, v253, v254
    s_nop 1
    v_mfma_f32_16x16x32_bf16 v[112:115], a[216:219], v[64:67], v[208:211]
    v_max3_f32 v246, v8, v9, v10
    v_max3_f32 v246, v246, v11, v12
    v_max3_f32 v246, v246, v13, v14
    v_max_f32 v246, v246, v15
    v_mov_b32 v247, v246
    s_nop 1
    v_permlane32_swap_b32 v247, v246
    s_nop 1
    v_max_f32 v246, v246, v247
    v_mov_b32 v247, v246
    s_nop 1
    v_permlane16_swap_b32 v247, v246
    s_nop 1
    v_max_f32 v246, v246, v247
    v_add_f32 v246, 0x42c80000, v246
    v_ceil_f32 v246, v246
    v_max_f32 v248, 0, v246
    v_min_f32 v246, 0x46000000, v248
    v_cvt_i32_f32 v249, v246
    v_sub_u32 v249, 0, v249
    v_ldexp_f32 v212, v212, v249
    v_ldexp_f32 v213, v213, v249
    v_ldexp_f32 v214, v214, v249
    v_ldexp_f32 v215, v215, v249
    v_accvgpr_read_b32 v253, a4
    v_ldexp_f32 v253, v253, v249
    v_accvgpr_write_b32 a4, v253
    v_accvgpr_read_b32 v254, a5
    v_ldexp_f32 v254, v254, v249
    v_accvgpr_write_b32 a5, v254
    v_accvgpr_read_b32 v253, a6
    v_ldexp_f32 v253, v253, v249
    v_accvgpr_write_b32 a6, v253
    v_accvgpr_read_b32 v254, a7
    v_ldexp_f32 v254, v254, v249
    v_accvgpr_write_b32 a7, v254
    v_accvgpr_read_b32 v253, a20
    v_ldexp_f32 v253, v253, v249
    v_accvgpr_write_b32 a20, v253
    v_accvgpr_read_b32 v254, a21
    v_ldexp_f32 v254, v254, v249
    v_accvgpr_write_b32 a21, v254
    v_accvgpr_read_b32 v253, a22
    v_ldexp_f32 v253, v253, v249
    v_accvgpr_write_b32 a22, v253
    v_accvgpr_read_b32 v254, a23
    v_ldexp_f32 v254, v254, v249
    v_accvgpr_write_b32 a23, v254
    v_accvgpr_read_b32 v253, a36
    v_ldexp_f32 v253, v253, v249
    v_accvgpr_write_b32 a36, v253
    v_accvgpr_read_b32 v254, a37
    v_ldexp_f32 v254, v254, v249
    v_accvgpr_write_b32 a37, v254
    v_accvgpr_read_b32 v253, a38
    v_ldexp_f32 v253, v253, v249
    v_accvgpr_write_b32 a38, v253
    v_accvgpr_read_b32 v254, a39
    v_ldexp_f32 v254, v254, v249
    v_accvgpr_write_b32 a39, v254
    v_accvgpr_read_b32 v253, a52
    v_ldexp_f32 v253, v253, v249
    v_accvgpr_write_b32 a52, v253
    v_accvgpr_read_b32 v254, a53
    v_ldexp_f32 v254, v254, v249
    v_accvgpr_write_b32 a53, v254
    v_accvgpr_read_b32 v253, a54
    v_ldexp_f32 v253, v253, v249
    v_accvgpr_write_b32 a54, v253
    v_accvgpr_read_b32 v254, a55
    v_ldexp_f32 v254, v254, v249
    v_accvgpr_write_b32 a55, v254
    v_accvgpr_read_b32 v253, a68
    v_ldexp_f32 v253, v253, v249
    v_accvgpr_write_b32 a68, v253
    v_accvgpr_read_b32 v254, a69
    v_ldexp_f32 v254, v254, v249
    v_accvgpr_write_b32 a69, v254
    v_accvgpr_read_b32 v253, a70
    v_ldexp_f32 v253, v253, v249
    v_accvgpr_write_b32 a70, v253
    v_accvgpr_read_b32 v254, a71
    v_ldexp_f32 v254, v254, v249
    v_accvgpr_write_b32 a71, v254
    v_accvgpr_read_b32 v253, a84
    v_ldexp_f32 v253, v253, v249
    v_accvgpr_write_b32 a84, v253
    v_accvgpr_read_b32 v254, a85
    v_ldexp_f32 v254, v254, v249
    v_accvgpr_write_b32 a85, v254
    v_accvgpr_read_b32 v253, a86
    v_ldexp_f32 v253, v253, v249
    v_accvgpr_write_b32 a86, v253
    v_accvgpr_read_b32 v254, a87
    v_ldexp_f32 v254, v254, v249
    v_accvgpr_write_b32 a87, v254
    v_accvgpr_read_b32 v253, a100
    v_ldexp_f32 v253, v253, v249
    v_accvgpr_write_b32 a100, v253
    v_accvgpr_read_b32 v254, a101
    v_ldexp_f32 v254, v254, v249
    v_accvgpr_write_b32 a101, v254
    v_accvgpr_read_b32 v253, a102
    v_ldexp_f32 v253, v253, v249
    v_accvgpr_write_b32 a102, v253
    v_accvgpr_read_b32 v254, a103
    v_ldexp_f32 v254, v254, v249
    v_accvgpr_write_b32 a103, v254
    v_accvgpr_read_b32 v253, a116
    v_ldexp_f32 v253, v253, v249
    v_accvgpr_write_b32 a116, v253
    v_accvgpr_read_b32 v254, a117
    v_ldexp_f32 v254, v254, v249
    v_accvgpr_write_b32 a117, v254
    v_accvgpr_read_b32 v253, a118
    v_ldexp_f32 v253, v253, v249
    v_accvgpr_write_b32 a118, v253
    v_accvgpr_read_b32 v254, a119
    v_ldexp_f32 v254, v254, v249
    v_accvgpr_write_b32 a119, v254
    v_sub_f32 v100, v100, v248
    v_sub_f32 v101, v101, v248
    v_sub_f32 v102, v102, v248
    v_sub_f32 v103, v103, v248
    v_sub_f32 v8, v8, v248
    v_sub_f32 v40, v40, v248
    v_sub_f32 v9, v9, v248
    v_sub_f32 v41, v41, v248
    v_sub_f32 v10, v10, v248
    v_sub_f32 v42, v42, v248
    v_sub_f32 v11, v11, v248
    v_sub_f32 v43, v43, v248
    v_sub_f32 v12, v12, v248
    v_sub_f32 v44, v44, v248
    v_sub_f32 v13, v13, v248
    v_sub_f32 v45, v45, v248
    v_sub_f32 v14, v14, v248
    v_sub_f32 v46, v46, v248
    v_sub_f32 v15, v15, v248
    v_sub_f32 v47, v47, v248
    v_exp_f32 v253, v8
    v_exp_f32 v254, v9
    s_nop 0
    v_cvt_pk_bf16_f32 v68, v253, v254
    v_exp_f32 v253, v10
    v_exp_f32 v254, v11
    s_nop 0
    v_cvt_pk_bf16_f32 v69, v253, v254
    v_exp_f32 v253, v12
    v_exp_f32 v254, v13
    s_nop 0
    v_cvt_pk_bf16_f32 v70, v253, v254
    v_exp_f32 v253, v14
    v_exp_f32 v254, v15
    s_nop 0
    v_cvt_pk_bf16_f32 v71, v253, v254
    s_nop 1
    v_mfma_f32_16x16x32_bf16 v[116:119], a[216:219], v[68:71], v[212:215]
    v_max3_f32 v246, v16, v17, v18
    v_max3_f32 v246, v246, v19, v20
    v_max3_f32 v246, v246, v21, v22
    v_max_f32 v246, v246, v23
    v_mov_b32 v247, v246
    s_nop 1
    v_permlane32_swap_b32 v247, v246
    s_nop 1
    v_max_f32 v246, v246, v247
    v_mov_b32 v247, v246
    s_nop 1
    v_permlane16_swap_b32 v247, v246
    s_nop 1
    v_max_f32 v246, v246, v247
    v_add_f32 v246, 0x42c80000, v246
    v_ceil_f32 v246, v246
    v_max_f32 v248, 0, v246
    v_min_f32 v246, 0x46000000, v248
    v_cvt_i32_f32 v249, v246
    v_sub_u32 v249, 0, v249
    v_ldexp_f32 v216, v216, v249
    v_ldexp_f32 v217, v217, v249
    v_ldexp_f32 v218, v218, v249
    v_ldexp_f32 v219, v219, v249
    v_accvgpr_read_b32 v253, a8
    v_ldexp_f32 v253, v253, v249
    v_accvgpr_write_b32 a8, v253
    v_accvgpr_read_b32 v254, a9
    v_ldexp_f32 v254, v254, v249
    v_accvgpr_write_b32 a9, v254
    v_accvgpr_read_b32 v253, a10
    v_ldexp_f32 v253, v253, v249
    v_accvgpr_write_b32 a10, v253
    v_accvgpr_read_b32 v254, a11
    v_ldexp_f32 v254, v254, v249
    v_accvgpr_write_b32 a11, v254
    v_accvgpr_read_b32 v253, a24
    v_ldexp_f32 v253, v253, v249
    v_accvgpr_write_b32 a24, v253
    v_accvgpr_read_b32 v254, a25
    v_ldexp_f32 v254, v254, v249
    v_accvgpr_write_b32 a25, v254
    v_accvgpr_read_b32 v253, a26
    v_ldexp_f32 v253, v253, v249
    v_accvgpr_write_b32 a26, v253
    v_accvgpr_read_b32 v254, a27
    v_ldexp_f32 v254, v254, v249
    v_accvgpr_write_b32 a27, v254
    v_accvgpr_read_b32 v253, a40
    v_ldexp_f32 v253, v253, v249
    v_accvgpr_write_b32 a40, v253
    v_accvgpr_read_b32 v254, a41
    v_ldexp_f32 v254, v254, v249
    v_accvgpr_write_b32 a41, v254
    v_accvgpr_read_b32 v253, a42
    v_ldexp_f32 v253, v253, v249
    v_accvgpr_write_b32 a42, v253
    v_accvgpr_read_b32 v254, a43
    v_ldexp_f32 v254, v254, v249
    v_accvgpr_write_b32 a43, v254
    v_accvgpr_read_b32 v253, a56
    v_ldexp_f32 v253, v253, v249
    v_accvgpr_write_b32 a56, v253
    v_accvgpr_read_b32 v254, a57
    v_ldexp_f32 v254, v254, v249
    v_accvgpr_write_b32 a57, v254
    v_accvgpr_read_b32 v253, a58
    v_ldexp_f32 v253, v253, v249
    v_accvgpr_write_b32 a58, v253
    v_accvgpr_read_b32 v254, a59
    v_ldexp_f32 v254, v254, v249
    v_accvgpr_write_b32 a59, v254
    v_accvgpr_read_b32 v253, a72
    v_ldexp_f32 v253, v253, v249
    v_accvgpr_write_b32 a72, v253
    v_accvgpr_read_b32 v254, a73
    v_ldexp_f32 v254, v254, v249
    v_accvgpr_write_b32 a73, v254
    v_accvgpr_read_b32 v253, a74
    v_ldexp_f32 v253, v253, v249
    v_accvgpr_write_b32 a74, v253
    v_accvgpr_read_b32 v254, a75
    v_ldexp_f32 v254, v254, v249
    v_accvgpr_write_b32 a75, v254
    v_accvgpr_read_b32 v253, a88
    v_ldexp_f32 v253, v253, v249
    v_accvgpr_write_b32 a88, v253
    v_accvgpr_read_b32 v254, a89
    v_ldexp_f32 v254, v254, v249
    v_accvgpr_write_b32 a89, v254
    v_accvgpr_read_b32 v253, a90
    v_ldexp_f32 v253, v253, v249
    v_accvgpr_write_b32 a90, v253
    v_accvgpr_read_b32 v254, a91
    v_ldexp_f32 v254, v254, v249
    v_accvgpr_write_b32 a91, v254
    v_accvgpr_read_b32 v253, a104
    v_ldexp_f32 v253, v253, v249
    v_accvgpr_write_b32 a104, v253
    v_accvgpr_read_b32 v254, a105
    v_ldexp_f32 v254, v254, v249
    v_accvgpr_write_b32 a105, v254
    v_accvgpr_read_b32 v253, a106
    v_ldexp_f32 v253, v253, v249
    v_accvgpr_write_b32 a106, v253
    v_accvgpr_read_b32 v254, a107
    v_ldexp_f32 v254, v254, v249
    v_accvgpr_write_b32 a107, v254
    v_accvgpr_read_b32 v253, a120
    v_ldexp_f32 v253, v253, v249
    v_accvgpr_write_b32 a120, v253
    v_accvgpr_read_b32 v254, a121
    v_ldexp_f32 v254, v254, v249
    v_accvgpr_write_b32 a121, v254
    v_accvgpr_read_b32 v253, a122
    v_ldexp_f32 v253, v253, v249
    v_accvgpr_write_b32 a122, v253
    v_accvgpr_read_b32 v254, a123
    v_ldexp_f32 v254, v254, v249
    v_accvgpr_write_b32 a123, v254
    v_sub_f32 v104, v104, v248
    v_sub_f32 v105, v105, v248
    v_sub_f32 v106, v106, v248
    v_sub_f32 v107, v107, v248
    v_sub_f32 v16, v16, v248
    v_sub_f32 v48, v48, v248
    v_sub_f32 v17, v17, v248
    v_sub_f32 v49, v49, v248
    v_sub_f32 v18, v18, v248
    v_sub_f32 v50, v50, v248
    v_sub_f32 v19, v19, v248
    v_sub_f32 v51, v51, v248
    v_sub_f32 v20, v20, v248
    v_sub_f32 v52, v52, v248
    v_sub_f32 v21, v21, v248
    v_sub_f32 v53, v53, v248
    v_sub_f32 v22, v22, v248
    v_sub_f32 v54, v54, v248
    v_sub_f32 v23, v23, v248
    v_sub_f32 v55, v55, v248
    v_exp_f32 v253, v16
    v_exp_f32 v254, v17
    s_nop 0
    v_cvt_pk_bf16_f32 v72, v253, v254
    v_exp_f32 v253, v18
    v_exp_f32 v254, v19
    s_nop 0
    v_cvt_pk_bf16_f32 v73, v253, v254
    v_exp_f32 v253, v20
    v_exp_f32 v254, v21
    s_nop 0
    v_cvt_pk_bf16_f32 v74, v253, v254
    v_exp_f32 v253, v22
    v_exp_f32 v254, v23
    s_nop 0
    v_cvt_pk_bf16_f32 v75, v253, v254
    s_nop 1
    v_mfma_f32_16x16x32_bf16 v[120:123], a[216:219], v[72:75], v[216:219]
    v_max3_f32 v246, v24, v25, v26
    v_max3_f32 v246, v246, v27, v28
    v_max3_f32 v246, v246, v29, v30
    v_max_f32 v246, v246, v31
    v_mov_b32 v247, v246
    s_nop 1
    v_permlane32_swap_b32 v247, v246
    s_nop 1
    v_max_f32 v246, v246, v247
    v_mov_b32 v247, v246
    s_nop 1
    v_permlane16_swap_b32 v247, v246
    s_nop 1
    v_max_f32 v246, v246, v247
    v_add_f32 v246, 0x42c80000, v246
    v_ceil_f32 v246, v246
    v_max_f32 v248, 0, v246
    v_min_f32 v246, 0x46000000, v248
    v_cvt_i32_f32 v249, v246
    v_sub_u32 v249, 0, v249
    v_ldexp_f32 v220, v220, v249
    v_ldexp_f32 v221, v221, v249
    v_ldexp_f32 v222, v222, v249
    v_ldexp_f32 v223, v223, v249
    v_accvgpr_read_b32 v253, a12
    v_ldexp_f32 v253, v253, v249
    v_accvgpr_write_b32 a12, v253
    v_accvgpr_read_b32 v254, a13
    v_ldexp_f32 v254, v254, v249
    v_accvgpr_write_b32 a13, v254
    v_accvgpr_read_b32 v253, a14
    v_ldexp_f32 v253, v253, v249
    v_accvgpr_write_b32 a14, v253
    v_accvgpr_read_b32 v254, a15
    v_ldexp_f32 v254, v254, v249
    v_accvgpr_write_b32 a15, v254
    v_accvgpr_read_b32 v253, a28
    v_ldexp_f32 v253, v253, v249
    v_accvgpr_write_b32 a28, v253
    v_accvgpr_read_b32 v254, a29
    v_ldexp_f32 v254, v254, v249
    v_accvgpr_write_b32 a29, v254
    v_accvgpr_read_b32 v253, a30
    v_ldexp_f32 v253, v253, v249
    v_accvgpr_write_b32 a30, v253
    v_accvgpr_read_b32 v254, a31
    v_ldexp_f32 v254, v254, v249
    v_accvgpr_write_b32 a31, v254
    v_accvgpr_read_b32 v253, a44
    v_ldexp_f32 v253, v253, v249
    v_accvgpr_write_b32 a44, v253
    v_accvgpr_read_b32 v254, a45
    v_ldexp_f32 v254, v254, v249
    v_accvgpr_write_b32 a45, v254
    v_accvgpr_read_b32 v253, a46
    v_ldexp_f32 v253, v253, v249
    v_accvgpr_write_b32 a46, v253
    v_accvgpr_read_b32 v254, a47
    v_ldexp_f32 v254, v254, v249
    v_accvgpr_write_b32 a47, v254
    v_accvgpr_read_b32 v253, a60
    v_ldexp_f32 v253, v253, v249
    v_accvgpr_write_b32 a60, v253
    v_accvgpr_read_b32 v254, a61
    v_ldexp_f32 v254, v254, v249
    v_accvgpr_write_b32 a61, v254
    v_accvgpr_read_b32 v253, a62
    v_ldexp_f32 v253, v253, v249
    v_accvgpr_write_b32 a62, v253
    v_accvgpr_read_b32 v254, a63
    v_ldexp_f32 v254, v254, v249
    v_accvgpr_write_b32 a63, v254
    v_accvgpr_read_b32 v253, a76
    v_ldexp_f32 v253, v253, v249
    v_accvgpr_write_b32 a76, v253
    v_accvgpr_read_b32 v254, a77
    v_ldexp_f32 v254, v254, v249
    v_accvgpr_write_b32 a77, v254
    v_accvgpr_read_b32 v253, a78
    v_ldexp_f32 v253, v253, v249
    v_accvgpr_write_b32 a78, v253
    v_accvgpr_read_b32 v254, a79
    v_ldexp_f32 v254, v254, v249
    v_accvgpr_write_b32 a79, v254
    v_accvgpr_read_b32 v253, a92
    v_ldexp_f32 v253, v253, v249
    v_accvgpr_write_b32 a92, v253
    v_accvgpr_read_b32 v254, a93
    v_ldexp_f32 v254, v254, v249
    v_accvgpr_write_b32 a93, v254
    v_accvgpr_read_b32 v253, a94
    v_ldexp_f32 v253, v253, v249
    v_accvgpr_write_b32 a94, v253
    v_accvgpr_read_b32 v254, a95
    v_ldexp_f32 v254, v254, v249
    v_accvgpr_write_b32 a95, v254
    v_accvgpr_read_b32 v253, a108
    v_ldexp_f32 v253, v253, v249
    v_accvgpr_write_b32 a108, v253
    v_accvgpr_read_b32 v254, a109
    v_ldexp_f32 v254, v254, v249
    v_accvgpr_write_b32 a109, v254
    v_accvgpr_read_b32 v253, a110
    v_ldexp_f32 v253, v253, v249
    v_accvgpr_write_b32 a110, v253
    v_accvgpr_read_b32 v254, a111
    v_ldexp_f32 v254, v254, v249
    v_accvgpr_write_b32 a111, v254
    v_accvgpr_read_b32 v253, a124
    v_ldexp_f32 v253, v253, v249
    v_accvgpr_write_b32 a124, v253
    v_accvgpr_read_b32 v254, a125
    v_ldexp_f32 v254, v254, v249
    v_accvgpr_write_b32 a125, v254
    v_accvgpr_read_b32 v253, a126
    v_ldexp_f32 v253, v253, v249
    v_accvgpr_write_b32 a126, v253
    v_accvgpr_read_b32 v254, a127
    v_ldexp_f32 v254, v254, v249
    v_accvgpr_write_b32 a127, v254
    v_sub_f32 v108, v108, v248
    v_sub_f32 v109, v109, v248
    v_sub_f32 v110, v110, v248
    v_sub_f32 v111, v111, v248
    v_sub_f32 v24, v24, v248
    v_sub_f32 v56, v56, v248
    v_sub_f32 v25, v25, v248
    v_sub_f32 v57, v57, v248
    v_sub_f32 v26, v26, v248
    v_sub_f32 v58, v58, v248
    v_sub_f32 v27, v27, v248
    v_sub_f32 v59, v59, v248
    v_sub_f32 v28, v28, v248
    v_sub_f32 v60, v60, v248
    v_sub_f32 v29, v29, v248
    v_sub_f32 v61, v61, v248
    v_sub_f32 v30, v30, v248
    v_sub_f32 v62, v62, v248
    v_sub_f32 v31, v31, v248
    v_sub_f32 v63, v63, v248
    v_exp_f32 v253, v24
    v_exp_f32 v254, v25
    s_nop 0
    v_cvt_pk_bf16_f32 v76, v253, v254
    v_exp_f32 v253, v26
    v_exp_f32 v254, v27
    s_nop 0
    v_cvt_pk_bf16_f32 v77, v253, v254
    v_exp_f32 v253, v28
    v_exp_f32 v254, v29
    s_nop 0
    v_cvt_pk_bf16_f32 v78, v253, v254
    v_exp_f32 v253, v30
    v_exp_f32 v254, v31
    s_nop 0
    v_cvt_pk_bf16_f32 v79, v253, v254
    s_nop 1
    v_mfma_f32_16x16x32_bf16 v[124:127], a[216:219], v[76:79], v[220:223]
    s_nop 15
    s_setpc_b64 s[30:31]
SLOW_1:
    s_nop 15
    s_nop 7
    v_max3_f32 v246, v32, v33, v34
    v_max3_f32 v246, v246, v35, v36
    v_max3_f32 v246, v246, v37, v38
    v_max_f32 v246, v246, v39
    v_mov_b32 v247, v246
    s_nop 1
    v_permlane32_swap_b32 v247, v246
    s_nop 1
    v_max_f32 v246, v246, v247
    v_mov_b32 v247, v246
    s_nop 1
    v_permlane16_swap_b32 v247, v246
    s_nop 1
    v_max_f32 v246, v246, v247
    v_add_f32 v246, 0x42c80000, v246
    v_ceil_f32 v246, v246
    v_max_f32 v248, 0, v246
    v_min_f32 v246, 0x46000000, v248
    v_cvt_i32_f32 v249, v246
    v_sub_u32 v249, 0, v249
    v_ldexp_f32 v112, v112, v249
    v_ldexp_f32 v113, v113, v249
    v_ldexp_f32 v114, v114, v249
    v_ldexp_f32 v115, v115, v249
    v_accvgpr_read_b32 v253, a0
    v_ldexp_f32 v253, v253, v249
    v_accvgpr_write_b32 a0, v253
    v_accvgpr_read_b32 v254, a1
    v_ldexp_f32 v254, v254, v249
    v_accvgpr_write_b32 a1, v254
    v_accvgpr_read_b32 v253, a2
    v_ldexp_f32 v253, v253, v249
    v_accvgpr_write_b32 a2, v253
    v_accvgpr_read_b32 v254, a3
    v_ldexp_f32 v254, v254, v249
    v_accvgpr_write_b32 a3, v254
    v_accvgpr_read_b32 v253, a16
    v_ldexp_f32 v253, v253, v249
    v_accvgpr_write_b32 a16, v253
    v_accvgpr_read_b32 v254, a17
    v_ldexp_f32 v254, v254, v249
    v_accvgpr_write_b32 a17, v254
    v_accvgpr_read_b32 v253, a18
    v_ldexp_f32 v253, v253, v249
    v_accvgpr_write_b32 a18, v253
    v_accvgpr_read_b32 v254, a19
    v_ldexp_f32 v254, v254, v249
    v_accvgpr_write_b32 a19, v254
    v_accvgpr_read_b32 v253, a32
    v_ldexp_f32 v253, v253, v249
    v_accvgpr_write_b32 a32, v253
    v_accvgpr_read_b32 v254, a33
    v_ldexp_f32 v254, v254, v249
    v_accvgpr_write_b32 a33, v254
    v_accvgpr_read_b32 v253, a34
    v_ldexp_f32 v253, v253, v249
    v_accvgpr_write_b32 a34, v253
    v_accvgpr_read_b32 v254, a35
    v_ldexp_f32 v254, v254, v249
    v_accvgpr_write_b32 a35, v254
    v_accvgpr_read_b32 v253, a48
    v_ldexp_f32 v253, v253, v249
    v_accvgpr_write_b32 a48, v253
    v_accvgpr_read_b32 v254, a49
    v_ldexp_f32 v254, v254, v249
    v_accvgpr_write_b32 a49, v254
    v_accvgpr_read_b32 v253, a50
    v_ldexp_f32 v253, v253, v249
    v_accvgpr_write_b32 a50, v253
    v_accvgpr_read_b32 v254, a51
    v_ldexp_f32 v254, v254, v249
    v_accvgpr_write_b32 a51, v254
    v_accvgpr_read_b32 v253, a64
    v_ldexp_f32 v253, v253, v249
    v_accvgpr_write_b32 a64, v253
    v_accvgpr_read_b32 v254, a65
    v_ldexp_f32 v254, v254, v249
    v_accvgpr_write_b32 a65, v254
    v_accvgpr_read_b32 v253, a66
    v_ldexp_f32 v253, v253, v249
    v_accvgpr_write_b32 a66, v253
    v_accvgpr_read_b32 v254, a67
    v_ldexp_f32 v254, v254, v249
    v_accvgpr_write_b32 a67, v254
    v_accvgpr_read_b32 v253, a80
    v_ldexp_f32 v253, v253, v249
    v_accvgpr_write_b32 a80, v253
    v_accvgpr_read_b32 v254, a81
    v_ldexp_f32 v254, v254, v249
    v_accvgpr_write_b32 a81, v254
    v_accvgpr_read_b32 v253, a82
    v_ldexp_f32 v253, v253, v249
    v_accvgpr_write_b32 a82, v253
    v_accvgpr_read_b32 v254, a83
    v_ldexp_f32 v254, v254, v249
    v_accvgpr_write_b32 a83, v254
    v_accvgpr_read_b32 v253, a96
    v_ldexp_f32 v253, v253, v249
    v_accvgpr_write_b32 a96, v253
    v_accvgpr_read_b32 v254, a97
    v_ldexp_f32 v254, v254, v249
    v_accvgpr_write_b32 a97, v254
    v_accvgpr_read_b32 v253, a98
    v_ldexp_f32 v253, v253, v249
    v_accvgpr_write_b32 a98, v253
    v_accvgpr_read_b32 v254, a99
    v_ldexp_f32 v254, v254, v249
    v_accvgpr_write_b32 a99, v254
    v_accvgpr_read_b32 v253, a112
    v_ldexp_f32 v253, v253, v249
    v_accvgpr_write_b32 a112, v253
    v_accvgpr_read_b32 v254, a113
    v_ldexp_f32 v254, v254, v249
    v_accvgpr_write_b32 a113, v254
    v_accvgpr_read_b32 v253, a114
    v_ldexp_f32 v253, v253, v249
    v_accvgpr_write_b32 a114, v253
    v_accvgpr_read_b32 v254, a115
    v_ldexp_f32 v254, v254, v249
    v_accvgpr_write_b32 a115, v254
    v_sub_f32 v96, v96, v248
    v_sub_f32 v97, v97, v248
    v_sub_f32 v98, v98, v248
    v_sub_f32 v99, v99, v248
    v_sub_f32 v32, v32, v248
    v_sub_f32 v0, v0, v248
    v_sub_f32 v33, v33, v248
    v_sub_f32 v1, v1, v248
    v_sub_f32 v34, v34, v248
    v_sub_f32 v2, v2, v248
    v_sub_f32 v35, v35, v248
    v_sub_f32 v3, v3, v248
    v_sub_f32 v36, v36, v248
    v_sub_f32 v4, v4, v248
    v_sub_f32 v37, v37, v248
    v_sub_f32 v5, v5, v248
    v_sub_f32 v38, v38, v248
    v_sub_f32 v6, v6, v248
    v_sub_f32 v39, v39, v248
    v_sub_f32 v7, v7, v248
    v_exp_f32 v253, v32
    v_exp_f32 v254, v33
    s_nop 0
    v_cvt_pk_bf16_f32 v80, v253, v254
    v_exp_f32 v253, v34
    v_exp_f32 v254, v35
    s_nop 0
    v_cvt_pk_bf16_f32 v81, v253, v254
    v_exp_f32 v253, v36
    v_exp_f32 v254, v37
    s_nop 0
    v_cvt_pk_bf16_f32 v82, v253, v254
    v_exp_f32 v253, v38
    v_exp_f32 v254, v39
    s_nop 0
    v_cvt_pk_bf16_f32 v83, v253, v254
    s_nop 1
    v_mfma_f32_16x16x32_bf16 v[208:211], a[216:219], v[80:83], v[112:115]
    v_max3_f32 v246, v40, v41, v42
    v_max3_f32 v246, v246, v43, v44
    v_max3_f32 v246, v246, v45, v46
    v_max_f32 v246, v246, v47
    v_mov_b32 v247, v246
    s_nop 1
    v_permlane32_swap_b32 v247, v246
    s_nop 1
    v_max_f32 v246, v246, v247
    v_mov_b32 v247, v246
    s_nop 1
    v_permlane16_swap_b32 v247, v246
    s_nop 1
    v_max_f32 v246, v246, v247
    v_add_f32 v246, 0x42c80000, v246
    v_ceil_f32 v246, v246
    v_max_f32 v248, 0, v246
    v_min_f32 v246, 0x46000000, v248
    v_cvt_i32_f32 v249, v246
    v_sub_u32 v249, 0, v249
    v_ldexp_f32 v116, v116, v249
    v_ldexp_f32 v117, v117, v249
    v_ldexp_f32 v118, v118, v249
    v_ldexp_f32 v119, v119, v249
    v_accvgpr_read_b32 v253, a4
    v_ldexp_f32 v253, v253, v249
    v_accvgpr_write_b32 a4, v253
    v_accvgpr_read_b32 v254, a5
    v_ldexp_f32 v254, v254, v249
    v_accvgpr_write_b32 a5, v254
    v_accvgpr_read_b32 v253, a6
    v_ldexp_f32 v253, v253, v249
    v_accvgpr_write_b32 a6, v253
    v_accvgpr_read_b32 v254, a7
    v_ldexp_f32 v254, v254, v249
    v_accvgpr_write_b32 a7, v254
    v_accvgpr_read_b32 v253, a20
    v_ldexp_f32 v253, v253, v249
    v_accvgpr_write_b32 a20, v253
    v_accvgpr_read_b32 v254, a21
    v_ldexp_f32 v254, v254, v249
    v_accvgpr_write_b32 a21, v254
    v_accvgpr_read_b32 v253, a22
    v_ldexp_f32 v253, v253, v249
    v_accvgpr_write_b32 a22, v253
    v_accvgpr_read_b32 v254, a23
    v_ldexp_f32 v254, v254, v249
    v_accvgpr_write_b32 a23, v254
    v_accvgpr_read_b32 v253, a36
    v_ldexp_f32 v253, v253, v249
    v_accvgpr_write_b32 a36, v253
    v_accvgpr_read_b32 v254, a37
    v_ldexp_f32 v254, v254, v249
    v_accvgpr_write_b32 a37, v254
    v_accvgpr_read_b32 v253, a38
    v_ldexp_f32 v253, v253, v249
    v_accvgpr_write_b32 a38, v253
    v_accvgpr_read_b32 v254, a39
    v_ldexp_f32 v254, v254, v249
    v_accvgpr_write_b32 a39, v254
    v_accvgpr_read_b32 v253, a52
    v_ldexp_f32 v253, v253, v249
    v_accvgpr_write_b32 a52, v253
    v_accvgpr_read_b32 v254, a53
    v_ldexp_f32 v254, v254, v249
    v_accvgpr_write_b32 a53, v254
    v_accvgpr_read_b32 v253, a54
    v_ldexp_f32 v253, v253, v249
    v_accvgpr_write_b32 a54, v253
    v_accvgpr_read_b32 v254, a55
    v_ldexp_f32 v254, v254, v249
    v_accvgpr_write_b32 a55, v254
    v_accvgpr_read_b32 v253, a68
    v_ldexp_f32 v253, v253, v249
    v_accvgpr_write_b32 a68, v253
    v_accvgpr_read_b32 v254, a69
    v_ldexp_f32 v254, v254, v249
    v_accvgpr_write_b32 a69, v254
    v_accvgpr_read_b32 v253, a70
    v_ldexp_f32 v253, v253, v249
    v_accvgpr_write_b32 a70, v253
    v_accvgpr_read_b32 v254, a71
    v_ldexp_f32 v254, v254, v249
    v_accvgpr_write_b32 a71, v254
    v_accvgpr_read_b32 v253, a84
    v_ldexp_f32 v253, v253, v249
    v_accvgpr_write_b32 a84, v253
    v_accvgpr_read_b32 v254, a85
    v_ldexp_f32 v254, v254, v249
    v_accvgpr_write_b32 a85, v254
    v_accvgpr_read_b32 v253, a86
    v_ldexp_f32 v253, v253, v249
    v_accvgpr_write_b32 a86, v253
    v_accvgpr_read_b32 v254, a87
    v_ldexp_f32 v254, v254, v249
    v_accvgpr_write_b32 a87, v254
    v_accvgpr_read_b32 v253, a100
    v_ldexp_f32 v253, v253, v249
    v_accvgpr_write_b32 a100, v253
    v_accvgpr_read_b32 v254, a101
    v_ldexp_f32 v254, v254, v249
    v_accvgpr_write_b32 a101, v254
    v_accvgpr_read_b32 v253, a102
    v_ldexp_f32 v253, v253, v249
    v_accvgpr_write_b32 a102, v253
    v_accvgpr_read_b32 v254, a103
    v_ldexp_f32 v254, v254, v249
    v_accvgpr_write_b32 a103, v254
    v_accvgpr_read_b32 v253, a116
    v_ldexp_f32 v253, v253, v249
    v_accvgpr_write_b32 a116, v253
    v_accvgpr_read_b32 v254, a117
    v_ldexp_f32 v254, v254, v249
    v_accvgpr_write_b32 a117, v254
    v_accvgpr_read_b32 v253, a118
    v_ldexp_f32 v253, v253, v249
    v_accvgpr_write_b32 a118, v253
    v_accvgpr_read_b32 v254, a119
    v_ldexp_f32 v254, v254, v249
    v_accvgpr_write_b32 a119, v254
    v_sub_f32 v100, v100, v248
    v_sub_f32 v101, v101, v248
    v_sub_f32 v102, v102, v248
    v_sub_f32 v103, v103, v248
    v_sub_f32 v40, v40, v248
    v_sub_f32 v8, v8, v248
    v_sub_f32 v41, v41, v248
    v_sub_f32 v9, v9, v248
    v_sub_f32 v42, v42, v248
    v_sub_f32 v10, v10, v248
    v_sub_f32 v43, v43, v248
    v_sub_f32 v11, v11, v248
    v_sub_f32 v44, v44, v248
    v_sub_f32 v12, v12, v248
    v_sub_f32 v45, v45, v248
    v_sub_f32 v13, v13, v248
    v_sub_f32 v46, v46, v248
    v_sub_f32 v14, v14, v248
    v_sub_f32 v47, v47, v248
    v_sub_f32 v15, v15, v248
    v_exp_f32 v253, v40
    v_exp_f32 v254, v41
    s_nop 0
    v_cvt_pk_bf16_f32 v84, v253, v254
    v_exp_f32 v253, v42
    v_exp_f32 v254, v43
    s_nop 0
    v_cvt_pk_bf16_f32 v85, v253, v254
    v_exp_f32 v253, v44
    v_exp_f32 v254, v45
    s_nop 0
    v_cvt_pk_bf16_f32 v86, v253, v254
    v_exp_f32 v253, v46
    v_exp_f32 v254, v47
    s_nop 0
    v_cvt_pk_bf16_f32 v87, v253, v254
    s_nop 1
    v_mfma_f32_16x16x32_bf16 v[212:215], a[216:219], v[84:87], v[116:119]
    v_max3_f32 v246, v48, v49, v50
    v_max3_f32 v246, v246, v51, v52
    v_max3_f32 v246, v246, v53, v54
    v_max_f32 v246, v246, v55
    v_mov_b32 v247, v246
    s_nop 1
    v_permlane32_swap_b32 v247, v246
    s_nop 1
    v_max_f32 v246, v246, v247
    v_mov_b32 v247, v246
    s_nop 1
    v_permlane16_swap_b32 v247, v246
    s_nop 1
    v_max_f32 v246, v246, v247
    v_add_f32 v246, 0x42c80000, v246
    v_ceil_f32 v246, v246
    v_max_f32 v248, 0, v246
    v_min_f32 v246, 0x46000000, v248
    v_cvt_i32_f32 v249, v246
    v_sub_u32 v249, 0, v249
    v_ldexp_f32 v120, v120, v249
    v_ldexp_f32 v121, v121, v249
    v_ldexp_f32 v122, v122, v249
    v_ldexp_f32 v123, v123, v249
    v_accvgpr_read_b32 v253, a8
    v_ldexp_f32 v253, v253, v249
    v_accvgpr_write_b32 a8, v253
    v_accvgpr_read_b32 v254, a9
    v_ldexp_f32 v254, v254, v249
    v_accvgpr_write_b32 a9, v254
    v_accvgpr_read_b32 v253, a10
    v_ldexp_f32 v253, v253, v249
    v_accvgpr_write_b32 a10, v253
    v_accvgpr_read_b32 v254, a11
    v_ldexp_f32 v254, v254, v249
    v_accvgpr_write_b32 a11, v254
    v_accvgpr_read_b32 v253, a24
    v_ldexp_f32 v253, v253, v249
    v_accvgpr_write_b32 a24, v253
    v_accvgpr_read_b32 v254, a25
    v_ldexp_f32 v254, v254, v249
    v_accvgpr_write_b32 a25, v254
    v_accvgpr_read_b32 v253, a26
    v_ldexp_f32 v253, v253, v249
    v_accvgpr_write_b32 a26, v253
    v_accvgpr_read_b32 v254, a27
    v_ldexp_f32 v254, v254, v249
    v_accvgpr_write_b32 a27, v254
    v_accvgpr_read_b32 v253, a40
    v_ldexp_f32 v253, v253, v249
    v_accvgpr_write_b32 a40, v253
    v_accvgpr_read_b32 v254, a41
    v_ldexp_f32 v254, v254, v249
    v_accvgpr_write_b32 a41, v254
    v_accvgpr_read_b32 v253, a42
    v_ldexp_f32 v253, v253, v249
    v_accvgpr_write_b32 a42, v253
    v_accvgpr_read_b32 v254, a43
    v_ldexp_f32 v254, v254, v249
    v_accvgpr_write_b32 a43, v254
    v_accvgpr_read_b32 v253, a56
    v_ldexp_f32 v253, v253, v249
    v_accvgpr_write_b32 a56, v253
    v_accvgpr_read_b32 v254, a57
    v_ldexp_f32 v254, v254, v249
    v_accvgpr_write_b32 a57, v254
    v_accvgpr_read_b32 v253, a58
    v_ldexp_f32 v253, v253, v249
    v_accvgpr_write_b32 a58, v253
    v_accvgpr_read_b32 v254, a59
    v_ldexp_f32 v254, v254, v249
    v_accvgpr_write_b32 a59, v254
    v_accvgpr_read_b32 v253, a72
    v_ldexp_f32 v253, v253, v249
    v_accvgpr_write_b32 a72, v253
    v_accvgpr_read_b32 v254, a73
    v_ldexp_f32 v254, v254, v249
    v_accvgpr_write_b32 a73, v254
    v_accvgpr_read_b32 v253, a74
    v_ldexp_f32 v253, v253, v249
    v_accvgpr_write_b32 a74, v253
    v_accvgpr_read_b32 v254, a75
    v_ldexp_f32 v254, v254, v249
    v_accvgpr_write_b32 a75, v254
    v_accvgpr_read_b32 v253, a88
    v_ldexp_f32 v253, v253, v249
    v_accvgpr_write_b32 a88, v253
    v_accvgpr_read_b32 v254, a89
    v_ldexp_f32 v254, v254, v249
    v_accvgpr_write_b32 a89, v254
    v_accvgpr_read_b32 v253, a90
    v_ldexp_f32 v253, v253, v249
    v_accvgpr_write_b32 a90, v253
    v_accvgpr_read_b32 v254, a91
    v_ldexp_f32 v254, v254, v249
    v_accvgpr_write_b32 a91, v254
    v_accvgpr_read_b32 v253, a104
    v_ldexp_f32 v253, v253, v249
    v_accvgpr_write_b32 a104, v253
    v_accvgpr_read_b32 v254, a105
    v_ldexp_f32 v254, v254, v249
    v_accvgpr_write_b32 a105, v254
    v_accvgpr_read_b32 v253, a106
    v_ldexp_f32 v253, v253, v249
    v_accvgpr_write_b32 a106, v253
    v_accvgpr_read_b32 v254, a107
    v_ldexp_f32 v254, v254, v249
    v_accvgpr_write_b32 a107, v254
    v_accvgpr_read_b32 v253, a120
    v_ldexp_f32 v253, v253, v249
    v_accvgpr_write_b32 a120, v253
    v_accvgpr_read_b32 v254, a121
    v_ldexp_f32 v254, v254, v249
    v_accvgpr_write_b32 a121, v254
    v_accvgpr_read_b32 v253, a122
    v_ldexp_f32 v253, v253, v249
    v_accvgpr_write_b32 a122, v253
    v_accvgpr_read_b32 v254, a123
    v_ldexp_f32 v254, v254, v249
    v_accvgpr_write_b32 a123, v254
    v_sub_f32 v104, v104, v248
    v_sub_f32 v105, v105, v248
    v_sub_f32 v106, v106, v248
    v_sub_f32 v107, v107, v248
    v_sub_f32 v48, v48, v248
    v_sub_f32 v16, v16, v248
    v_sub_f32 v49, v49, v248
    v_sub_f32 v17, v17, v248
    v_sub_f32 v50, v50, v248
    v_sub_f32 v18, v18, v248
    v_sub_f32 v51, v51, v248
    v_sub_f32 v19, v19, v248
    v_sub_f32 v52, v52, v248
    v_sub_f32 v20, v20, v248
    v_sub_f32 v53, v53, v248
    v_sub_f32 v21, v21, v248
    v_sub_f32 v54, v54, v248
    v_sub_f32 v22, v22, v248
    v_sub_f32 v55, v55, v248
    v_sub_f32 v23, v23, v248
    v_exp_f32 v253, v48
    v_exp_f32 v254, v49
    s_nop 0
    v_cvt_pk_bf16_f32 v88, v253, v254
    v_exp_f32 v253, v50
    v_exp_f32 v254, v51
    s_nop 0
    v_cvt_pk_bf16_f32 v89, v253, v254
    v_exp_f32 v253, v52
    v_exp_f32 v254, v53
    s_nop 0
    v_cvt_pk_bf16_f32 v90, v253, v254
    v_exp_f32 v253, v54
    v_exp_f32 v254, v55
    s_nop 0
    v_cvt_pk_bf16_f32 v91, v253, v254
    s_nop 1
    v_mfma_f32_16x16x32_bf16 v[216:219], a[216:219], v[88:91], v[120:123]
    v_max3_f32 v246, v56, v57, v58
    v_max3_f32 v246, v246, v59, v60
    v_max3_f32 v246, v246, v61, v62
    v_max_f32 v246, v246, v63
    v_mov_b32 v247, v246
    s_nop 1
    v_permlane32_swap_b32 v247, v246
    s_nop 1
    v_max_f32 v246, v246, v247
    v_mov_b32 v247, v246
    s_nop 1
    v_permlane16_swap_b32 v247, v246
    s_nop 1
    v_max_f32 v246, v246, v247
    v_add_f32 v246, 0x42c80000, v246
    v_ceil_f32 v246, v246
    v_max_f32 v248, 0, v246
    v_min_f32 v246, 0x46000000, v248
    v_cvt_i32_f32 v249, v246
    v_sub_u32 v249, 0, v249
    v_ldexp_f32 v124, v124, v249
    v_ldexp_f32 v125, v125, v249
    v_ldexp_f32 v126, v126, v249
    v_ldexp_f32 v127, v127, v249
    v_accvgpr_read_b32 v253, a12
    v_ldexp_f32 v253, v253, v249
    v_accvgpr_write_b32 a12, v253
    v_accvgpr_read_b32 v254, a13
    v_ldexp_f32 v254, v254, v249
    v_accvgpr_write_b32 a13, v254
    v_accvgpr_read_b32 v253, a14
    v_ldexp_f32 v253, v253, v249
    v_accvgpr_write_b32 a14, v253
    v_accvgpr_read_b32 v254, a15
    v_ldexp_f32 v254, v254, v249
    v_accvgpr_write_b32 a15, v254
    v_accvgpr_read_b32 v253, a28
    v_ldexp_f32 v253, v253, v249
    v_accvgpr_write_b32 a28, v253
    v_accvgpr_read_b32 v254, a29
    v_ldexp_f32 v254, v254, v249
    v_accvgpr_write_b32 a29, v254
    v_accvgpr_read_b32 v253, a30
    v_ldexp_f32 v253, v253, v249
    v_accvgpr_write_b32 a30, v253
    v_accvgpr_read_b32 v254, a31
    v_ldexp_f32 v254, v254, v249
    v_accvgpr_write_b32 a31, v254
    v_accvgpr_read_b32 v253, a44
    v_ldexp_f32 v253, v253, v249
    v_accvgpr_write_b32 a44, v253
    v_accvgpr_read_b32 v254, a45
    v_ldexp_f32 v254, v254, v249
    v_accvgpr_write_b32 a45, v254
    v_accvgpr_read_b32 v253, a46
    v_ldexp_f32 v253, v253, v249
    v_accvgpr_write_b32 a46, v253
    v_accvgpr_read_b32 v254, a47
    v_ldexp_f32 v254, v254, v249
    v_accvgpr_write_b32 a47, v254
    v_accvgpr_read_b32 v253, a60
    v_ldexp_f32 v253, v253, v249
    v_accvgpr_write_b32 a60, v253
    v_accvgpr_read_b32 v254, a61
    v_ldexp_f32 v254, v254, v249
    v_accvgpr_write_b32 a61, v254
    v_accvgpr_read_b32 v253, a62
    v_ldexp_f32 v253, v253, v249
    v_accvgpr_write_b32 a62, v253
    v_accvgpr_read_b32 v254, a63
    v_ldexp_f32 v254, v254, v249
    v_accvgpr_write_b32 a63, v254
    v_accvgpr_read_b32 v253, a76
    v_ldexp_f32 v253, v253, v249
    v_accvgpr_write_b32 a76, v253
    v_accvgpr_read_b32 v254, a77
    v_ldexp_f32 v254, v254, v249
    v_accvgpr_write_b32 a77, v254
    v_accvgpr_read_b32 v253, a78
    v_ldexp_f32 v253, v253, v249
    v_accvgpr_write_b32 a78, v253
    v_accvgpr_read_b32 v254, a79
    v_ldexp_f32 v254, v254, v249
    v_accvgpr_write_b32 a79, v254
    v_accvgpr_read_b32 v253, a92
    v_ldexp_f32 v253, v253, v249
    v_accvgpr_write_b32 a92, v253
    v_accvgpr_read_b32 v254, a93
    v_ldexp_f32 v254, v254, v249
    v_accvgpr_write_b32 a93, v254
    v_accvgpr_read_b32 v253, a94
    v_ldexp_f32 v253, v253, v249
    v_accvgpr_write_b32 a94, v253
    v_accvgpr_read_b32 v254, a95
    v_ldexp_f32 v254, v254, v249
    v_accvgpr_write_b32 a95, v254
    v_accvgpr_read_b32 v253, a108
    v_ldexp_f32 v253, v253, v249
    v_accvgpr_write_b32 a108, v253
    v_accvgpr_read_b32 v254, a109
    v_ldexp_f32 v254, v254, v249
    v_accvgpr_write_b32 a109, v254
    v_accvgpr_read_b32 v253, a110
    v_ldexp_f32 v253, v253, v249
    v_accvgpr_write_b32 a110, v253
    v_accvgpr_read_b32 v254, a111
    v_ldexp_f32 v254, v254, v249
    v_accvgpr_write_b32 a111, v254
    v_accvgpr_read_b32 v253, a124
    v_ldexp_f32 v253, v253, v249
    v_accvgpr_write_b32 a124, v253
    v_accvgpr_read_b32 v254, a125
    v_ldexp_f32 v254, v254, v249
    v_accvgpr_write_b32 a125, v254
    v_accvgpr_read_b32 v253, a126
    v_ldexp_f32 v253, v253, v249
    v_accvgpr_write_b32 a126, v253
    v_accvgpr_read_b32 v254, a127
    v_ldexp_f32 v254, v254, v249
    v_accvgpr_write_b32 a127, v254
    v_sub_f32 v108, v108, v248
    v_sub_f32 v109, v109, v248
    v_sub_f32 v110, v110, v248
    v_sub_f32 v111, v111, v248
    v_sub_f32 v56, v56, v248
    v_sub_f32 v24, v24, v248
    v_sub_f32 v57, v57, v248
    v_sub_f32 v25, v25, v248
    v_sub_f32 v58, v58, v248
    v_sub_f32 v26, v26, v248
    v_sub_f32 v59, v59, v248
    v_sub_f32 v27, v27, v248
    v_sub_f32 v60, v60, v248
    v_sub_f32 v28, v28, v248
    v_sub_f32 v61, v61, v248
    v_sub_f32 v29, v29, v248
    v_sub_f32 v62, v62, v248
    v_sub_f32 v30, v30, v248
    v_sub_f32 v63, v63, v248
    v_sub_f32 v31, v31, v248
    v_exp_f32 v253, v56
    v_exp_f32 v254, v57
    s_nop 0
    v_cvt_pk_bf16_f32 v92, v253, v254
    v_exp_f32 v253, v58
    v_exp_f32 v254, v59
    s_nop 0
    v_cvt_pk_bf16_f32 v93, v253, v254
    v_exp_f32 v253, v60
    v_exp_f32 v254, v61
    s_nop 0
    v_cvt_pk_bf16_f32 v94, v253, v254
    v_exp_f32 v253, v62
    v_exp_f32 v254, v63
    s_nop 0
    v_cvt_pk_bf16_f32 v95, v253, v254
    s_nop 1
    v_mfma_f32_16x16x32_bf16 v[220:223], a[216:219], v[92:95], v[124:127]
    s_nop 15
    s_setpc_b64 s[30:31]
after_slow:
    s_mov_b32 s46, s39
    s_lshl_b32 s36, s46, 18
    s_add_u32 s36, s36, 0x400000
    s_add_u32 s16, s34, s36
    s_addc_u32 s17, s35, 0
    s_and_b32 s17, s17, 0xffff
    s_mov_b32 s18, 0x80000
    v_mbcnt_lo_u32_b32 v0, -1, 0
    v_mbcnt_hi_u32_b32 v0, -1, v0
    v_lshlrev_b32 v0, 4, v0
    v_add_u32 v1, 0x40000, v0
    s_lshl_b32 s36, s29, 13
    v_rcp_f32 v112, v208
    v_rcp_f32 v114, v212
    v_rcp_f32 v116, v216
    v_rcp_f32 v118, v220
    s_nop 7
    v_accvgpr_read_b32 v8, a0
    v_accvgpr_read_b32 v12, a4
    v_accvgpr_read_b32 v9, a1
    v_accvgpr_read_b32 v13, a5
    v_accvgpr_read_b32 v10, a2
    v_accvgpr_read_b32 v14, a6
    v_accvgpr_read_b32 v11, a3
    v_accvgpr_read_b32 v15, a7
    v_pk_mul_f32 v[8:9], v[8:9], v[112:113] op_sel_hi:[1,0]
    v_pk_mul_f32 v[12:13], v[12:13], v[114:115] op_sel_hi:[1,0]
    v_pk_mul_f32 v[10:11], v[10:11], v[112:113] op_sel_hi:[1,0]
    v_pk_mul_f32 v[14:15], v[14:15], v[114:115] op_sel_hi:[1,0]
    v_cvt_pk_bf16_f32 v16, v8, v9
    v_cvt_pk_bf16_f32 v17, v10, v11
    v_cvt_pk_bf16_f32 v18, v12, v13
    v_cvt_pk_bf16_f32 v19, v14, v15
    s_nop 0
    v_permlane16_swap_b32 v16, v18
    v_permlane16_swap_b32 v17, v19
    s_add_u32 s37, s36, 0x0
    buffer_store_dwordx4 v[16:19], v0, s[16:19], s37 offen offset:0 sc1
    v_accvgpr_read_b32 v20, a16
    v_accvgpr_read_b32 v24, a20
    v_accvgpr_read_b32 v21, a17
    v_accvgpr_read_b32 v25, a21
    v_accvgpr_read_b32 v22, a18
    v_accvgpr_read_b32 v26, a22
    v_accvgpr_read_b32 v23, a19
    v_accvgpr_read_b32 v27, a23
    v_pk_mul_f32 v[20:21], v[20:21], v[112:113] op_sel_hi:[1,0]
    v_pk_mul_f32 v[24:25], v[24:25], v[114:115] op_sel_hi:[1,0]
    v_pk_mul_f32 v[22:23], v[22:23], v[112:113] op_sel_hi:[1,0]
    v_pk_mul_f32 v[26:27], v[26:27], v[114:115] op_sel_hi:[1,0]
    v_cvt_pk_bf16_f32 v28, v20, v21
    v_cvt_pk_bf16_f32 v29, v22, v23
    v_cvt_pk_bf16_f32 v30, v24, v25
    v_cvt_pk_bf16_f32 v31, v26, v27
    s_nop 0
    v_permlane16_swap_b32 v28, v30
    v_permlane16_swap_b32 v29, v31
    s_add_u32 s37, s36, 0x0
    buffer_store_dwordx4 v[28:31], v0, s[16:19], s37 offen offset:1024 sc1
    v_accvgpr_read_b32 v32, a32
    v_accvgpr_read_b32 v36, a36
    v_accvgpr_read_b32 v33, a33
    v_accvgpr_read_b32 v37, a37
    v_accvgpr_read_b32 v34, a34
    v_accvgpr_read_b32 v38, a38
    v_accvgpr_read_b32 v35, a35
    v_accvgpr_read_b32 v39, a39
    v_pk_mul_f32 v[32:33], v[32:33], v[112:113] op_sel_hi:[1,0]
    v_pk_mul_f32 v[36:37], v[36:37], v[114:115] op_sel_hi:[1,0]
    v_pk_mul_f32 v[34:35], v[34:35], v[112:113] op_sel_hi:[1,0]
    v_pk_mul_f32 v[38:39], v[38:39], v[114:115] op_sel_hi:[1,0]
    v_cvt_pk_bf16_f32 v40, v32, v33
    v_cvt_pk_bf16_f32 v41, v34, v35
    v_cvt_pk_bf16_f32 v42, v36, v37
    v_cvt_pk_bf16_f32 v43, v38, v39
    s_nop 0
    v_permlane16_swap_b32 v40, v42
    v_permlane16_swap_b32 v41, v43
    s_add_u32 s37, s36, 0x0
    buffer_store_dwordx4 v[40:43], v0, s[16:19], s37 offen offset:2048 sc1
    v_accvgpr_read_b32 v44, a48
    v_accvgpr_read_b32 v48, a52
    v_accvgpr_read_b32 v45, a49
    v_accvgpr_read_b32 v49, a53
    v_accvgpr_read_b32 v46, a50
    v_accvgpr_read_b32 v50, a54
    v_accvgpr_read_b32 v47, a51
    v_accvgpr_read_b32 v51, a55
    v_pk_mul_f32 v[44:45], v[44:45], v[112:113] op_sel_hi:[1,0]
    v_pk_mul_f32 v[48:49], v[48:49], v[114:115] op_sel_hi:[1,0]
    v_pk_mul_f32 v[46:47], v[46:47], v[112:113] op_sel_hi:[1,0]
    v_pk_mul_f32 v[50:51], v[50:51], v[114:115] op_sel_hi:[1,0]
    v_cvt_pk_bf16_f32 v52, v44, v45
    v_cvt_pk_bf16_f32 v53, v46, v47
    v_cvt_pk_bf16_f32 v54, v48, v49
    v_cvt_pk_bf16_f32 v55, v50, v51
    s_nop 0
    v_permlane16_swap_b32 v52, v54
    v_permlane16_swap_b32 v53, v55
    s_add_u32 s37, s36, 0x0
    buffer_store_dwordx4 v[52:55], v0, s[16:19], s37 offen offset:3072 sc1
    v_accvgpr_read_b32 v8, a64
    v_accvgpr_read_b32 v12, a68
    v_accvgpr_read_b32 v9, a65
    v_accvgpr_read_b32 v13, a69
    v_accvgpr_read_b32 v10, a66
    v_accvgpr_read_b32 v14, a70
    v_accvgpr_read_b32 v11, a67
    v_accvgpr_read_b32 v15, a71
    v_pk_mul_f32 v[8:9], v[8:9], v[112:113] op_sel_hi:[1,0]
    v_pk_mul_f32 v[12:13], v[12:13], v[114:115] op_sel_hi:[1,0]
    v_pk_mul_f32 v[10:11], v[10:11], v[112:113] op_sel_hi:[1,0]
    v_pk_mul_f32 v[14:15], v[14:15], v[114:115] op_sel_hi:[1,0]
    v_cvt_pk_bf16_f32 v16, v8, v9
    v_cvt_pk_bf16_f32 v17, v10, v11
    v_cvt_pk_bf16_f32 v18, v12, v13
    v_cvt_pk_bf16_f32 v19, v14, v15
    s_nop 0
    v_permlane16_swap_b32 v16, v18
    v_permlane16_swap_b32 v17, v19
    s_add_u32 s37, s36, 0x1000
    buffer_store_dwordx4 v[16:19], v0, s[16:19], s37 offen offset:0 sc1
    v_accvgpr_read_b32 v20, a80
    v_accvgpr_read_b32 v24, a84
    v_accvgpr_read_b32 v21, a81
    v_accvgpr_read_b32 v25, a85
    v_accvgpr_read_b32 v22, a82
    v_accvgpr_read_b32 v26, a86
    v_accvgpr_read_b32 v23, a83
    v_accvgpr_read_b32 v27, a87
    v_pk_mul_f32 v[20:21], v[20:21], v[112:113] op_sel_hi:[1,0]
    v_pk_mul_f32 v[24:25], v[24:25], v[114:115] op_sel_hi:[1,0]
    v_pk_mul_f32 v[22:23], v[22:23], v[112:113] op_sel_hi:[1,0]
    v_pk_mul_f32 v[26:27], v[26:27], v[114:115] op_sel_hi:[1,0]
    v_cvt_pk_bf16_f32 v28, v20, v21
    v_cvt_pk_bf16_f32 v29, v22, v23
    v_cvt_pk_bf16_f32 v30, v24, v25
    v_cvt_pk_bf16_f32 v31, v26, v27
    s_nop 0
    v_permlane16_swap_b32 v28, v30
    v_permlane16_swap_b32 v29, v31
    s_add_u32 s37, s36, 0x1000
    buffer_store_dwordx4 v[28:31], v0, s[16:19], s37 offen offset:1024 sc1
    v_accvgpr_read_b32 v32, a96
    v_accvgpr_read_b32 v36, a100
    v_accvgpr_read_b32 v33, a97
    v_accvgpr_read_b32 v37, a101
    v_accvgpr_read_b32 v34, a98
    v_accvgpr_read_b32 v38, a102
    v_accvgpr_read_b32 v35, a99
    v_accvgpr_read_b32 v39, a103
    v_pk_mul_f32 v[32:33], v[32:33], v[112:113] op_sel_hi:[1,0]
    v_pk_mul_f32 v[36:37], v[36:37], v[114:115] op_sel_hi:[1,0]
    v_pk_mul_f32 v[34:35], v[34:35], v[112:113] op_sel_hi:[1,0]
    v_pk_mul_f32 v[38:39], v[38:39], v[114:115] op_sel_hi:[1,0]
    v_cvt_pk_bf16_f32 v40, v32, v33
    v_cvt_pk_bf16_f32 v41, v34, v35
    v_cvt_pk_bf16_f32 v42, v36, v37
    v_cvt_pk_bf16_f32 v43, v38, v39
    s_nop 0
    v_permlane16_swap_b32 v40, v42
    v_permlane16_swap_b32 v41, v43
    s_add_u32 s37, s36, 0x1000
    buffer_store_dwordx4 v[40:43], v0, s[16:19], s37 offen offset:2048 sc1
    v_accvgpr_read_b32 v44, a112
    v_accvgpr_read_b32 v48, a116
    v_accvgpr_read_b32 v45, a113
    v_accvgpr_read_b32 v49, a117
    v_accvgpr_read_b32 v46, a114
    v_accvgpr_read_b32 v50, a118
    v_accvgpr_read_b32 v47, a115
    v_accvgpr_read_b32 v51, a119
    v_pk_mul_f32 v[44:45], v[44:45], v[112:113] op_sel_hi:[1,0]
    v_pk_mul_f32 v[48:49], v[48:49], v[114:115] op_sel_hi:[1,0]
    v_pk_mul_f32 v[46:47], v[46:47], v[112:113] op_sel_hi:[1,0]
    v_pk_mul_f32 v[50:51], v[50:51], v[114:115] op_sel_hi:[1,0]
    v_cvt_pk_bf16_f32 v52, v44, v45
    v_cvt_pk_bf16_f32 v53, v46, v47
    v_cvt_pk_bf16_f32 v54, v48, v49
    v_cvt_pk_bf16_f32 v55, v50, v51
    s_nop 0
    v_permlane16_swap_b32 v52, v54
    v_permlane16_swap_b32 v53, v55
    s_add_u32 s37, s36, 0x1000
    buffer_store_dwordx4 v[52:55], v0, s[16:19], s37 offen offset:3072 sc1
    v_accvgpr_read_b32 v8, a8
    v_accvgpr_read_b32 v12, a12
    v_accvgpr_read_b32 v9, a9
    v_accvgpr_read_b32 v13, a13
    v_accvgpr_read_b32 v10, a10
    v_accvgpr_read_b32 v14, a14
    v_accvgpr_read_b32 v11, a11
    v_accvgpr_read_b32 v15, a15
    v_pk_mul_f32 v[8:9], v[8:9], v[116:117] op_sel_hi:[1,0]
    v_pk_mul_f32 v[12:13], v[12:13], v[118:119] op_sel_hi:[1,0]
    v_pk_mul_f32 v[10:11], v[10:11], v[116:117] op_sel_hi:[1,0]
    v_pk_mul_f32 v[14:15], v[14:15], v[118:119] op_sel_hi:[1,0]
    v_cvt_pk_bf16_f32 v16, v8, v9
    v_cvt_pk_bf16_f32 v17, v10, v11
    v_cvt_pk_bf16_f32 v18, v12, v13
    v_cvt_pk_bf16_f32 v19, v14, v15
    s_nop 0
    v_permlane16_swap_b32 v16, v18
    v_permlane16_swap_b32 v17, v19
    s_add_u32 s37, s36, 0x0
    buffer_store_dwordx4 v[16:19], v1, s[16:19], s37 offen offset:0 sc1
    v_accvgpr_read_b32 v20, a24
    v_accvgpr_read_b32 v24, a28
    v_accvgpr_read_b32 v21, a25
    v_accvgpr_read_b32 v25, a29
    v_accvgpr_read_b32 v22, a26
    v_accvgpr_read_b32 v26, a30
    v_accvgpr_read_b32 v23, a27
    v_accvgpr_read_b32 v27, a31
    v_pk_mul_f32 v[20:21], v[20:21], v[116:117] op_sel_hi:[1,0]
    v_pk_mul_f32 v[24:25], v[24:25], v[118:119] op_sel_hi:[1,0]
    v_pk_mul_f32 v[22:23], v[22:23], v[116:117] op_sel_hi:[1,0]
    v_pk_mul_f32 v[26:27], v[26:27], v[118:119] op_sel_hi:[1,0]
    v_cvt_pk_bf16_f32 v28, v20, v21
    v_cvt_pk_bf16_f32 v29, v22, v23
    v_cvt_pk_bf16_f32 v30, v24, v25
    v_cvt_pk_bf16_f32 v31, v26, v27
    s_nop 0
    v_permlane16_swap_b32 v28, v30
    v_permlane16_swap_b32 v29, v31
    s_add_u32 s37, s36, 0x0
    buffer_store_dwordx4 v[28:31], v1, s[16:19], s37 offen offset:1024 sc1
    v_accvgpr_read_b32 v32, a40
    v_accvgpr_read_b32 v36, a44
    v_accvgpr_read_b32 v33, a41
    v_accvgpr_read_b32 v37, a45
    v_accvgpr_read_b32 v34, a42
    v_accvgpr_read_b32 v38, a46
    v_accvgpr_read_b32 v35, a43
    v_accvgpr_read_b32 v39, a47
    v_pk_mul_f32 v[32:33], v[32:33], v[116:117] op_sel_hi:[1,0]
    v_pk_mul_f32 v[36:37], v[36:37], v[118:119] op_sel_hi:[1,0]
    v_pk_mul_f32 v[34:35], v[34:35], v[116:117] op_sel_hi:[1,0]
    v_pk_mul_f32 v[38:39], v[38:39], v[118:119] op_sel_hi:[1,0]
    v_cvt_pk_bf16_f32 v40, v32, v33
    v_cvt_pk_bf16_f32 v41, v34, v35
    v_cvt_pk_bf16_f32 v42, v36, v37
    v_cvt_pk_bf16_f32 v43, v38, v39
    s_nop 0
    v_permlane16_swap_b32 v40, v42
    v_permlane16_swap_b32 v41, v43
    s_add_u32 s37, s36, 0x0
    buffer_store_dwordx4 v[40:43], v1, s[16:19], s37 offen offset:2048 sc1
    v_accvgpr_read_b32 v44, a56
    v_accvgpr_read_b32 v48, a60
    v_accvgpr_read_b32 v45, a57
    v_accvgpr_read_b32 v49, a61
    v_accvgpr_read_b32 v46, a58
    v_accvgpr_read_b32 v50, a62
    v_accvgpr_read_b32 v47, a59
    v_accvgpr_read_b32 v51, a63
    v_pk_mul_f32 v[44:45], v[44:45], v[116:117] op_sel_hi:[1,0]
    v_pk_mul_f32 v[48:49], v[48:49], v[118:119] op_sel_hi:[1,0]
    v_pk_mul_f32 v[46:47], v[46:47], v[116:117] op_sel_hi:[1,0]
    v_pk_mul_f32 v[50:51], v[50:51], v[118:119] op_sel_hi:[1,0]
    v_cvt_pk_bf16_f32 v52, v44, v45
    v_cvt_pk_bf16_f32 v53, v46, v47
    v_cvt_pk_bf16_f32 v54, v48, v49
    v_cvt_pk_bf16_f32 v55, v50, v51
    s_nop 0
    v_permlane16_swap_b32 v52, v54
    v_permlane16_swap_b32 v53, v55
    s_add_u32 s37, s36, 0x0
    buffer_store_dwordx4 v[52:55], v1, s[16:19], s37 offen offset:3072 sc1
    v_accvgpr_read_b32 v8, a72
    v_accvgpr_read_b32 v12, a76
    v_accvgpr_read_b32 v9, a73
    v_accvgpr_read_b32 v13, a77
    v_accvgpr_read_b32 v10, a74
    v_accvgpr_read_b32 v14, a78
    v_accvgpr_read_b32 v11, a75
    v_accvgpr_read_b32 v15, a79
    v_pk_mul_f32 v[8:9], v[8:9], v[116:117] op_sel_hi:[1,0]
    v_pk_mul_f32 v[12:13], v[12:13], v[118:119] op_sel_hi:[1,0]
    v_pk_mul_f32 v[10:11], v[10:11], v[116:117] op_sel_hi:[1,0]
    v_pk_mul_f32 v[14:15], v[14:15], v[118:119] op_sel_hi:[1,0]
    v_cvt_pk_bf16_f32 v16, v8, v9
    v_cvt_pk_bf16_f32 v17, v10, v11
    v_cvt_pk_bf16_f32 v18, v12, v13
    v_cvt_pk_bf16_f32 v19, v14, v15
    s_nop 0
    v_permlane16_swap_b32 v16, v18
    v_permlane16_swap_b32 v17, v19
    s_add_u32 s37, s36, 0x1000
    buffer_store_dwordx4 v[16:19], v1, s[16:19], s37 offen offset:0 sc1
    v_accvgpr_read_b32 v20, a88
    v_accvgpr_read_b32 v24, a92
    v_accvgpr_read_b32 v21, a89
    v_accvgpr_read_b32 v25, a93
    v_accvgpr_read_b32 v22, a90
    v_accvgpr_read_b32 v26, a94
    v_accvgpr_read_b32 v23, a91
    v_accvgpr_read_b32 v27, a95
    v_pk_mul_f32 v[20:21], v[20:21], v[116:117] op_sel_hi:[1,0]
    v_pk_mul_f32 v[24:25], v[24:25], v[118:119] op_sel_hi:[1,0]
    v_pk_mul_f32 v[22:23], v[22:23], v[116:117] op_sel_hi:[1,0]
    v_pk_mul_f32 v[26:27], v[26:27], v[118:119] op_sel_hi:[1,0]
    v_cvt_pk_bf16_f32 v28, v20, v21
    v_cvt_pk_bf16_f32 v29, v22, v23
    v_cvt_pk_bf16_f32 v30, v24, v25
    v_cvt_pk_bf16_f32 v31, v26, v27
    s_nop 0
    v_permlane16_swap_b32 v28, v30
    v_permlane16_swap_b32 v29, v31
    s_add_u32 s37, s36, 0x1000
    buffer_store_dwordx4 v[28:31], v1, s[16:19], s37 offen offset:1024 sc1
    v_accvgpr_read_b32 v32, a104
    v_accvgpr_read_b32 v36, a108
    v_accvgpr_read_b32 v33, a105
    v_accvgpr_read_b32 v37, a109
    v_accvgpr_read_b32 v34, a106
    v_accvgpr_read_b32 v38, a110
    v_accvgpr_read_b32 v35, a107
    v_accvgpr_read_b32 v39, a111
    v_pk_mul_f32 v[32:33], v[32:33], v[116:117] op_sel_hi:[1,0]
    v_pk_mul_f32 v[36:37], v[36:37], v[118:119] op_sel_hi:[1,0]
    v_pk_mul_f32 v[34:35], v[34:35], v[116:117] op_sel_hi:[1,0]
    v_pk_mul_f32 v[38:39], v[38:39], v[118:119] op_sel_hi:[1,0]
    v_cvt_pk_bf16_f32 v40, v32, v33
    v_cvt_pk_bf16_f32 v41, v34, v35
    v_cvt_pk_bf16_f32 v42, v36, v37
    v_cvt_pk_bf16_f32 v43, v38, v39
    s_nop 0
    v_permlane16_swap_b32 v40, v42
    v_permlane16_swap_b32 v41, v43
    s_add_u32 s37, s36, 0x1000
    buffer_store_dwordx4 v[40:43], v1, s[16:19], s37 offen offset:2048 sc1
    v_accvgpr_read_b32 v44, a120
    v_accvgpr_read_b32 v48, a124
    v_accvgpr_read_b32 v45, a121
    v_accvgpr_read_b32 v49, a125
    v_accvgpr_read_b32 v46, a122
    v_accvgpr_read_b32 v50, a126
    v_accvgpr_read_b32 v47, a123
    v_accvgpr_read_b32 v51, a127
    v_pk_mul_f32 v[44:45], v[44:45], v[116:117] op_sel_hi:[1,0]
    v_pk_mul_f32 v[48:49], v[48:49], v[118:119] op_sel_hi:[1,0]
    v_pk_mul_f32 v[46:47], v[46:47], v[116:117] op_sel_hi:[1,0]
    v_pk_mul_f32 v[50:51], v[50:51], v[118:119] op_sel_hi:[1,0]
    v_cvt_pk_bf16_f32 v52, v44, v45
    v_cvt_pk_bf16_f32 v53, v46, v47
    v_cvt_pk_bf16_f32 v54, v48, v49
    v_cvt_pk_bf16_f32 v55, v50, v51
    s_nop 0
    v_permlane16_swap_b32 v52, v54
    v_permlane16_swap_b32 v53, v55
    s_add_u32 s37, s36, 0x1000
    buffer_store_dwordx4 v[52:55], v1, s[16:19], s37 offen offset:3072 sc1
    s_and_b32 s50, s2, 7
    s_lshr_b32 s51, s2, 3
    s_lshr_b32 s22, s51, 3
    s_lshl_b32 s50, s50, 2
    s_add_u32 s50, s50, s22
    s_and_b32 s51, s51, 7
    v_mbcnt_lo_u32_b32 v248, -1, 0
    v_mbcnt_hi_u32_b32 v248, -1, v248
    v_lshrrev_b32 v249, 3, v248
    v_and_b32 v250, 7, v248
    v_and_b32 v251, 2, v249
    v_lshlrev_b32 v251, 1, v251
    v_xor_b32 v250, v250, v251
    s_load_dwordx2 s[4:5], s[0:1], 32
    v_lshlrev_b32 v249, 10, v249
    v_lshl_add_u32 v242, v250, 4, v249
    v_add_u32 v243, 7168, v242
    v_lshrrev_b32 v249, 4, v248
    v_and_b32 v250, 15, v248
    v_lshrrev_b32 v251, 2, v250
    v_and_b32 v250, 3, v250
    v_lshrrev_b32 v252, 1, v249
    v_and_b32 v249, 1, v249
    v_lshl_add_u32 v252, v252, 3, v251
    v_lshlrev_b32 v252, 7, v252
    v_and_b32 v253, 1, v250
    v_lshl_add_u32 v253, v249, 1, v253
    v_lshl_add_u32 v252, v253, 4, v252
    v_lshrrev_b32 v253, 1, v250
    v_lshl_add_u32 v252, v253, 3, v252
    v_lshrrev_b32 v251, 1, v251
    s_mul_i32 s25, s24, 32768
    v_add_u32 v252, s25, v252
    v_xor_b32 v253, 0, v251
    v_lshl_add_u32 v240, v253, 6, v252
    v_xor_b32 v253, 1, v251
    v_lshl_add_u32 v241, v253, 6, v252
    v_lshlrev_b32 v244, 4, v248
    v_add_u32 v245, 0x40000, v244
    s_and_b32 s22, s50, 3
    v_lshlrev_b32 v246, 2, v248
    v_add_u32 v246, s22, v246
    v_lshlrev_b32 v246, 10, v246
    v_lshrrev_b32 v247, 4, v248
    v_and_b32 v247, 1, v247
    s_mov_b32 s22, 262144
    v_mul_lo_u32 v247, v247, s22
    v_and_b32 v249, 15, v248
    v_lshl_add_u32 v247, v249, 10, v247
    s_lshl_b32 s22, s51, 7
    v_add_u32 v247, s22, v247
    s_waitcnt lgkmcnt(0)
    s_lshr_b32 s28, s4, 7
    s_sub_u32 s28, 3, s28
    s_and_b32 s28, s28, 7
    s_lshl_b32 s23, s51, 7
    s_add_u32 s4, s4, s23
    s_addc_u32 s5, s5, 0
    s_and_b32 s5, s5, 0xffff
    s_sub_u32 s6, 0x400000, s23
    s_mov_b32 s7, 0x00020000
    s_mov_b32 s30, 16384
    s_mov_b32 s65, 0x3fffff
    s_and_b32 s22, s2, 7
    s_lshl_b32 s22, s22, 2
    s_add_u32 s64, s22, s24
    s_lshl_b32 s26, s64, 17
    s_cmp_lg_u32 s28, s51
    s_cbranch_scc1 nothot_9
    s_add_u32 s4, s34, 0x3600000
    s_addc_u32 s5, s35, 0
    s_and_b32 s5, s5, 0xffff
    s_mov_b32 s6, 0x80000
    s_mov_b32 s30, 2048
    s_mov_b32 s65, 0x7ffff
    s_lshl_b32 s26, s64, 14
    v_lshrrev_b32 v249, 10, v242
    v_and_b32 v250, 0x3ff, v242
    v_lshl_add_u32 v242, v249, 7, v250
    v_mov_b32 v243, v242
nothot_9:
    s_mul_i32 s31, s30, 24
    s_mul_i32 s22, s50, 524288
    s_add_u32 s22, s22, 0x400000
    s_add_u32 s8, s34, s22
    s_addc_u32 s9, s35, 0
    s_and_b32 s9, s9, 0xffff
    s_mov_b32 s10, 0x80000
    s_mov_b32 s11, 0x00020000
    s_lshl_b32 s27, s64, 13
    s_load_dwordx2 s[16:17], s[0:1], 48
    s_load_dwordx2 s[38:39], s[0:1], 56
    s_and_b32 s40, s2, 7
    s_lshr_b32 s41, s2, 3
    s_lshl_b32 s40, s40, 1
    s_and_b32 s42, s41, 1
    s_add_u32 s62, s40, s42
    s_lshr_b32 s63, s41, 1
    v_mbcnt_lo_u32_b32 v238, -1, 0
    v_mbcnt_hi_u32_b32 v238, -1, v238
    s_lshl_b32 s42, s42, 8
    s_and_b32 s40, s24, 1
    s_lshl_b32 s40, s40, 7
    s_add_u32 s42, s42, s40
    v_lshrrev_b32 v239, 1, v238
    v_add_u32 v239, s42, v239
    v_mul_u32_u24 v239, 3584, v239
    v_and_b32 v238, 1, v238
    v_lshl_add_u32 v239, v238, 7, v239
    s_waitcnt lgkmcnt(0)
    s_cmp_ge_u32 s24, 2
    s_cselect_b32 s16, s38, s16
    s_cselect_b32 s17, s39, s17
    s_mul_i32 s40, s62, 224
    s_add_u32 s16, s16, s40
    s_addc_u32 s17, s17, 0
    s_and_b32 s17, s17, 0xffff
    s_sub_u32 s18, 1835008, s40
    s_mov_b32 s19, 0x00020000
    s_add_u32 s12, s34, 0
    s_addc_u32 s13, s35, 0
    s_and_b32 s13, s13, 0xffff
    s_mov_b32 s14, 49152
    s_mov_b32 s15, 0x00020000
    s_lshl_b32 s22, s32, 7
    s_lshl_b32 s23, s29, 2
    s_add_u32 s22, s22, s23
    s_add_u32 s45, s22, 0x3000800
    v_mbcnt_lo_u32_b32 v58, -1, 0
    v_mbcnt_hi_u32_b32 v58, -1, v58
    v_and_b32 v58, 31, v58
    v_lshlrev_b32 v58, 2, v58
    s_lshr_b32 s22, s50, 2
    s_lshl_b32 s22, s22, 7
    s_add_u32 s22, s22, 0x3000800
    v_add_u32 v58, s22, v58
    v_mbcnt_lo_u32_b32 v60, -1, 0
    v_mbcnt_hi_u32_b32 v60, -1, v60
    v_lshlrev_b32 v60, 2, v60
    s_lshl_b32 s22, s51, 8
    s_add_u32 s22, s22, 4096
    s_add_u32 s23, s22, 0
    buffer_load_dword v61, v60, s[12:15], s23 offen sc1
    s_add_u32 s23, s22, 12288
    buffer_load_dword v62, v60, s[12:15], s23 offen sc1
    s_add_u32 s23, s22, 24576
    buffer_load_dword v63, v60, s[12:15], s23 offen sc1
    s_add_u32 s23, s22, 36864
    buffer_load_dword v64, v60, s[12:15], s23 offen sc1
    v_mbcnt_lo_u32_b32 v66, -1, 0
    v_mbcnt_hi_u32_b32 v66, -1, v66
    v_lshlrev_b32 v66, 2, v66
    s_lshl_b32 s22, s51, 8
    s_add_u32 s22, s22, 10240
    s_add_u32 s23, s22, 0
    buffer_load_dword v67, v66, s[12:15], s23 offen sc1
    s_add_u32 s23, s22, 12288
    buffer_load_dword v68, v66, s[12:15], s23 offen sc1
    s_add_u32 s23, s22, 24576
    buffer_load_dword v69, v66, s[12:15], s23 offen sc1
    s_add_u32 s23, s22, 36864
    buffer_load_dword v70, v66, s[12:15], s23 offen sc1
    v_mbcnt_lo_u32_b32 v76, -1, 0
    v_mbcnt_hi_u32_b32 v76, -1, v76
    v_lshlrev_b32 v76, 2, v76
    s_lshl_b32 s22, s51, 8
    s_add_u32 s22, s22, 8192
    s_add_u32 s23, s22, 0
    buffer_load_dword v77, v76, s[12:15], s23 offen sc1
    s_add_u32 s23, s22, 12288
    buffer_load_dword v78, v76, s[12:15], s23 offen sc1
    s_add_u32 s23, s22, 24576
    buffer_load_dword v79, v76, s[12:15], s23 offen sc1
    s_add_u32 s23, s22, 36864
    buffer_load_dword v80, v76, s[12:15], s23 offen sc1
    s_load_dwordx2 s[36:37], s[0:1], 0
    s_lshr_b32 s22, s24, 1
    s_and_b32 s23, s24, 1
    s_lshl_b32 s28, s50, 1
    s_add_u32 s28, s28, s23
    s_lshl_b32 s29, s51, 1
    s_add_u32 s29, s29, s22
    s_lshl_b32 s28, s28, 15
    s_lshl_b32 s29, s29, 6
    s_add_u32 s28, s28, s29
    v_mbcnt_lo_u32_b32 v72, -1, 0
    v_mbcnt_hi_u32_b32 v72, -1, v72
    v_and_b32 v73, 31, v72
    v_lshrrev_b32 v72, 5, v72
    v_lshlrev_b32 v73, 10, v73
    v_lshl_add_u32 v73, v72, 4, v73
    v_add_u32 v73, s28, v73
    s_waitcnt lgkmcnt(0)
    global_load_dwordx4 v[120:123], v73, s[36:37] offset:0
    global_load_dwordx4 v[124:127], v73, s[36:37] offset:32
    s_waitcnt vmcnt(0)
    s_barrier
    s_cmp_lg_u32 s24, 0
    s_cbranch_scc1 fskip_o_10
    v_mov_b32 v56, s33
    v_mov_b32 v57, s45
    s_mov_b64 exec, 1
    global_store_dword v57, v56, s[34:35] sc1
    s_mov_b64 exec, -1
fskip_o_10:
    v_add_f32 v61, v61, v62
    v_add_f32 v63, v63, v64
    v_add_f32 v61, v61, v63
    v_cvt_pk_bf16_f32 v61, v61, v61
    v_and_b32 v61, 0xffff0000, v61
    v_add_u32 v60, 154624, v60
    ds_write_b32 v60, v61
    v_add_f32 v67, v67, v68
    v_add_f32 v69, v69, v70
    v_add_f32 v67, v67, v69
    v_cvt_pk_bf16_f32 v67, v67, v67
    v_and_b32 v67, 0xffff0000, v67
    v_add_u32 v66, 154880, v66
    ds_write_b32 v66, v67
    v_add_f32 v77, v77, v78
    v_add_f32 v79, v79, v80
    v_add_f32 v77, v77, v79
    v_cvt_pk_bf16_f32 v77, v77, v77
    v_and_b32 v77, 0xffff0000, v77
    v_add_f32 v77, 1.0, v77
    v_cvt_pk_bf16_f32 v77, v77, v77
    v_and_b32 v77, 0xffff0000, v77
    v_add_u32 v76, 155136, v76
    ds_write_b32 v76, v77
    v_accvgpr_read_b32 v61, a212
    v_accvgpr_read_b32 v62, a213
    v_accvgpr_read_b32 v63, a214
    v_cmp_ne_u32 vcc, s33, v61
    v_cmp_ne_u32 s[42:43], s33, v62
    s_or_b64 vcc, vcc, s[42:43]
    v_cmp_ne_u32 s[42:43], s33, v63
    s_or_b64 vcc, vcc, s[42:43]
    s_cmp_eq_u64 vcc, 0
    s_cbranch_scc1 wtok_11
    v_mbcnt_lo_u32_b32 v59, -1, 0
    v_mbcnt_hi_u32_b32 v59, -1, v59
    v_lshlrev_b32 v59, 2, v59
    v_add_u32 v59, 0x3005000, v59
    v_min_u32 v60, 0x30050dc, v59
    s_mov_b32 s47, 400000
wtsp_11:
    global_load_dword v61, v59, s[34:35] sc1
    global_load_dword v62, v59, s[34:35] offset:256 sc1
    global_load_dword v63, v60, s[34:35] offset:512 sc1
    s_waitcnt vmcnt(0)
    v_cmp_ne_u32 vcc, s33, v61
    v_cmp_ne_u32 s[42:43], s33, v62
    s_or_b64 vcc, vcc, s[42:43]
    v_cmp_ne_u32 s[42:43], s33, v63
    s_or_b64 vcc, vcc, s[42:43]
    s_cmp_eq_u64 vcc, 0
    s_cbranch_scc1 wtok_11
    s_sub_u32 s47, s47, 1
    s_cmp_lg_u32 s47, 0
    s_cbranch_scc1 wtsp_11
wtok_11:
    s_add_u32 m0, s25, 0
    s_nop 0
    buffer_load_dwordx4 v242, s[4:7], s26 offen lds
    buffer_load_dwordx4 v243, s[4:7], s26 offen offset:1024 lds
    s_add_u32 s26, s26, s30
    s_add_u32 m0, s25, 2048
    s_nop 0
    buffer_load_dwordx4 v242, s[4:7], s26 offen lds
    buffer_load_dwordx4 v243, s[4:7], s26 offen offset:1024 lds
    s_add_u32 s26, s26, s30
    s_add_u32 m0, s25, 4096
    s_nop 0
    buffer_load_dwordx4 v242, s[4:7], s26 offen lds
    buffer_load_dwordx4 v243, s[4:7], s26 offen offset:1024 lds
    s_add_u32 s26, s26, s30
    s_add_u32 m0, s25, 6144
    s_nop 0
    buffer_load_dwordx4 v242, s[4:7], s26 offen lds
    buffer_load_dwordx4 v243, s[4:7], s26 offen offset:1024 lds
    s_add_u32 s26, s26, s30
    s_add_u32 m0, s25, 8192
    s_nop 0
    buffer_load_dwordx4 v242, s[4:7], s26 offen lds
    buffer_load_dwordx4 v243, s[4:7], s26 offen offset:1024 lds
    s_add_u32 s26, s26, s30
    s_add_u32 m0, s25, 10240
    s_nop 0
    buffer_load_dwordx4 v242, s[4:7], s26 offen lds
    buffer_load_dwordx4 v243, s[4:7], s26 offen offset:1024 lds
    s_add_u32 s26, s26, s30
    s_add_u32 m0, s25, 12288
    s_nop 0
    buffer_load_dwordx4 v242, s[4:7], s26 offen lds
    buffer_load_dwordx4 v243, s[4:7], s26 offen offset:1024 lds
    s_add_u32 s26, s26, s30
    s_add_u32 m0, s25, 14336
    s_nop 0
    buffer_load_dwordx4 v242, s[4:7], s26 offen lds
    buffer_load_dwordx4 v243, s[4:7], s26 offen offset:1024 lds
    s_add_u32 s26, s26, s30
    s_add_u32 s26, s26, s31
    s_and_b32 s26, s26, s65
    s_add_u32 m0, s25, 16384
    s_nop 0
    buffer_load_dwordx4 v242, s[4:7], s26 offen lds
    buffer_load_dwordx4 v243, s[4:7], s26 offen offset:1024 lds
    s_add_u32 s26, s26, s30
    s_add_u32 m0, s25, 18432
    s_nop 0
    buffer_load_dwordx4 v242, s[4:7], s26 offen lds
    buffer_load_dwordx4 v243, s[4:7], s26 offen offset:1024 lds
    s_add_u32 s26, s26, s30
    s_add_u32 m0, s25, 20480
    s_nop 0
    buffer_load_dwordx4 v242, s[4:7], s26 offen lds
    buffer_load_dwordx4 v243, s[4:7], s26 offen offset:1024 lds
    s_add_u32 s26, s26, s30
    s_add_u32 m0, s25, 22528
    s_nop 0
    buffer_load_dwordx4 v242, s[4:7], s26 offen lds
    buffer_load_dwordx4 v243, s[4:7], s26 offen offset:1024 lds
    s_add_u32 s26, s26, s30
    s_add_u32 m0, s25, 24576
    s_nop 0
    buffer_load_dwordx4 v242, s[4:7], s26 offen lds
    buffer_load_dwordx4 v243, s[4:7], s26 offen offset:1024 lds
    s_add_u32 s26, s26, s30
    s_add_u32 m0, s25, 26624
    s_nop 0
    buffer_load_dwordx4 v242, s[4:7], s26 offen lds
    buffer_load_dwordx4 v243, s[4:7], s26 offen offset:1024 lds
    s_add_u32 s26, s26, s30
    s_add_u32 m0, s25, 28672
    s_nop 0
    buffer_load_dwordx4 v242, s[4:7], s26 offen lds
    buffer_load_dwordx4 v243, s[4:7], s26 offen offset:1024 lds
    s_add_u32 s26, s26, s30
    v_mbcnt_lo_u32_b32 v117, -1, 0
    v_mbcnt_hi_u32_b32 v117, -1, v117
    v_and_b32 v117, 31, v117
    v_lshlrev_b32 v117, 2, v117
    s_lshr_b32 s22, s50, 2
    s_lshl_b32 s22, s22, 7
    s_add_u32 s22, s22, 0x3000800
    v_add_u32 v117, s22, v117
    s_nop 4
    s_mov_b32 s47, 400000
hsp_12:
    global_load_dword v116, v117, s[34:35] sc1
    s_waitcnt vmcnt(0)
    v_readlane_b32 s44, v116, s64
    s_cmp_eq_u32 s44, s33
    s_cbranch_scc1 hok_12
    s_sub_u32 s47, s47, 1
    s_cmp_lg_u32 s47, 0
    s_cbranch_scc1 hsp_12
hok_12:
    s_add_u32 s64, s64, 4
    s_and_b32 s64, s64, 31
    buffer_load_dwordx4 v[0:3], v244, s[8:11], s27 offen sc1
    buffer_load_dwordx4 v[4:7], v245, s[8:11], s27 offen sc1
    s_add_u32 s27, s27, 1024
    buffer_load_dwordx4 v[8:11], v244, s[8:11], s27 offen sc1
    buffer_load_dwordx4 v[12:15], v245, s[8:11], s27 offen sc1
    s_add_u32 s27, s27, 1024
    buffer_load_dwordx4 v[16:19], v244, s[8:11], s27 offen sc1
    buffer_load_dwordx4 v[20:23], v245, s[8:11], s27 offen sc1
    s_add_u32 s27, s27, 1024
    buffer_load_dwordx4 v[24:27], v244, s[8:11], s27 offen sc1
    buffer_load_dwordx4 v[28:31], v245, s[8:11], s27 offen sc1
    s_add_u32 s27, s27, 1024
    buffer_load_dwordx4 v[32:35], v244, s[8:11], s27 offen sc1
    buffer_load_dwordx4 v[36:39], v245, s[8:11], s27 offen sc1
    s_add_u32 s27, s27, 1024
    buffer_load_dwordx4 v[40:43], v244, s[8:11], s27 offen sc1
    buffer_load_dwordx4 v[44:47], v245, s[8:11], s27 offen sc1
    s_add_u32 s27, s27, 1024
    buffer_load_dwordx4 v[48:51], v244, s[8:11], s27 offen sc1
    buffer_load_dwordx4 v[52:55], v245, s[8:11], s27 offen sc1
    s_add_u32 s27, s27, 1024
    buffer_load_dwordx4 v[56:59], v244, s[8:11], s27 offen sc1
    buffer_load_dwordx4 v[60:63], v245, s[8:11], s27 offen sc1
    s_add_u32 s27, s27, 1024
    s_add_u32 s27, s27, 24576
    s_and_b32 s27, s27, 0x3ffff
    v_readlane_b32 s44, v116, s64
    s_cmp_eq_u32 s44, s33
    s_cbranch_scc1 hok_13
    s_mov_b32 s47, 400000
hsp_13:
    global_load_dword v116, v117, s[34:35] sc1
    s_waitcnt vmcnt(0)
    v_readlane_b32 s44, v116, s64
    s_cmp_eq_u32 s44, s33
    s_cbranch_scc1 hok_13
    s_sub_u32 s47, s47, 1
    s_cmp_lg_u32 s47, 0
    s_cbranch_scc1 hsp_13
hok_13:
    s_add_u32 s64, s64, 4
    s_and_b32 s64, s64, 31
    buffer_load_dwordx4 v[64:67], v244, s[8:11], s27 offen sc1
    buffer_load_dwordx4 v[68:71], v245, s[8:11], s27 offen sc1
    s_add_u32 s27, s27, 1024
    s_cmp_ge_u32 s2, 224
    s_cbranch_scc1 uw_done
    s_mul_hi_u32 s36, s2, 0x4924925
    s_mul_i32 s37, s36, 56
    s_sub_u32 s37, s2, s37
    s_cmp_ge_u32 s37, 28
    s_cselect_b32 s38, 1, 0
    s_mul_i32 s39, s38, 28
    s_sub_u32 s39, s37, s39
    v_mbcnt_lo_u32_b32 v130, -1, 0
    v_mbcnt_hi_u32_b32 v130, -1, v130
    v_and_b32 v132, 7, v130
    v_accvgpr_read_b32 v136, a160
    v_accvgpr_read_b32 v137, a161
    v_accvgpr_read_b32 v138, a162
    v_accvgpr_read_b32 v139, a163
    v_accvgpr_read_b32 v140, a164
    v_accvgpr_read_b32 v141, a165
    v_accvgpr_read_b32 v142, a166
    v_accvgpr_read_b32 v143, a167
    v_accvgpr_read_b32 v144, a168
    v_accvgpr_read_b32 v145, a169
    v_accvgpr_read_b32 v146, a170
    v_accvgpr_read_b32 v147, a171
    v_accvgpr_read_b32 v148, a172
    v_accvgpr_read_b32 v149, a173
    v_accvgpr_read_b32 v150, a174
    v_accvgpr_read_b32 v151, a175
    v_accvgpr_read_b32 v152, a176
    v_accvgpr_read_b32 v153, a177
    v_accvgpr_read_b32 v154, a178
    v_accvgpr_read_b32 v155, a179
    v_accvgpr_read_b32 v156, a180
    v_accvgpr_read_b32 v157, a181
    v_accvgpr_read_b32 v158, a182
    v_accvgpr_read_b32 v159, a183
    v_accvgpr_read_b32 v160, a184
    v_accvgpr_read_b32 v161, a185
    v_accvgpr_read_b32 v162, a186
    v_accvgpr_read_b32 v163, a187
    v_accvgpr_read_b32 v164, a188
    v_accvgpr_read_b32 v165, a189
    v_accvgpr_read_b32 v166, a190
    v_accvgpr_read_b32 v167, a191
    v_accvgpr_read_b32 v168, a192
    v_accvgpr_read_b32 v169, a193
    v_accvgpr_read_b32 v170, a194
    v_accvgpr_read_b32 v171, a195
    v_accvgpr_read_b32 v172, a196
    v_accvgpr_read_b32 v173, a197
    v_accvgpr_read_b32 v174, a198
    v_accvgpr_read_b32 v175, a199
    v_accvgpr_read_b32 v176, a200
    v_accvgpr_read_b32 v177, a201
    v_accvgpr_read_b32 v178, a202
    v_accvgpr_read_b32 v179, a203
    v_accvgpr_read_b32 v180, a204
    v_accvgpr_read_b32 v181, a205
    v_accvgpr_read_b32 v182, a206
    v_accvgpr_read_b32 v183, a207
    v_add_f32 v152, v152, v153
    v_add_f32 v154, v154, v155
    v_add_f32 v152, v152, v154
    v_cvt_pk_bf16_f32 v152, v152, v152
    v_and_b32 v152, 0xffff0000, v152
    v_add_f32 v168, v168, v169
    v_add_f32 v170, v170, v171
    v_add_f32 v168, v168, v170
    v_cvt_pk_bf16_f32 v168, v168, v168
    v_and_b32 v168, 0xffff0000, v168
    v_add_f32 v168, 1.0, v168
    v_cvt_pk_bf16_f32 v168, v168, v168
    v_and_b32 v168, 0xffff0000, v168
    v_add_f32 v156, v156, v157
    v_add_f32 v158, v158, v159
    v_add_f32 v156, v156, v158
    v_cvt_pk_bf16_f32 v156, v156, v156
    v_and_b32 v156, 0xffff0000, v156
    v_add_f32 v172, v172, v173
    v_add_f32 v174, v174, v175
    v_add_f32 v172, v172, v174
    v_cvt_pk_bf16_f32 v172, v172, v172
    v_and_b32 v172, 0xffff0000, v172
    v_add_f32 v172, 1.0, v172
    v_cvt_pk_bf16_f32 v172, v172, v172
    v_and_b32 v172, 0xffff0000, v172
    v_add_f32 v160, v160, v161
    v_add_f32 v162, v162, v163
    v_add_f32 v160, v160, v162
    v_cvt_pk_bf16_f32 v160, v160, v160
    v_and_b32 v160, 0xffff0000, v160
    v_add_f32 v176, v176, v177
    v_add_f32 v178, v178, v179
    v_add_f32 v176, v176, v178
    v_cvt_pk_bf16_f32 v176, v176, v176
    v_and_b32 v176, 0xffff0000, v176
    v_add_f32 v176, 1.0, v176
    v_cvt_pk_bf16_f32 v176, v176, v176
    v_and_b32 v176, 0xffff0000, v176
    v_add_f32 v164, v164, v165
    v_add_f32 v166, v166, v167
    v_add_f32 v164, v164, v166
    v_cvt_pk_bf16_f32 v164, v164, v164
    v_and_b32 v164, 0xffff0000, v164
    v_add_f32 v180, v180, v181
    v_add_f32 v182, v182, v183
    v_add_f32 v180, v180, v182
    v_cvt_pk_bf16_f32 v180, v180, v180
    v_and_b32 v180, 0xffff0000, v180
    v_add_f32 v180, 1.0, v180
    v_cvt_pk_bf16_f32 v180, v180, v180
    v_and_b32 v180, 0xffff0000, v180
    v_mov_b32 v192, 0
    v_mov_b32 v193, 0
    v_mov_b32 v194, 0
    v_mov_b32 v195, 0
    v_mov_b32 v196, 0
    v_mov_b32 v197, 0
    v_mov_b32 v198, 0
    v_mov_b32 v199, 0
    v_mov_b32 v200, 0
    v_mov_b32 v201, 0
    v_mov_b32 v202, 0
    v_mov_b32 v203, 0
    v_mov_b32 v204, 0
    v_mov_b32 v205, 0
    v_mov_b32 v206, 0
    v_mov_b32 v207, 0
    v_lshlrev_b32 v208, 16, v136
    v_and_b32 v209, 0xffff0000, v136
    v_fmac_f32 v192, v208, v168
    v_fmac_f32 v193, v209, v168
    v_fmac_f32 v200, v208, v152
    v_fmac_f32 v201, v209, v152
    v_lshlrev_b32 v208, 16, v137
    v_and_b32 v209, 0xffff0000, v137
    v_fmac_f32 v194, v208, v168
    v_fmac_f32 v195, v209, v168
    v_fmac_f32 v202, v208, v152
    v_fmac_f32 v203, v209, v152
    v_lshlrev_b32 v208, 16, v138
    v_and_b32 v209, 0xffff0000, v138
    v_fmac_f32 v196, v208, v168
    v_fmac_f32 v197, v209, v168
    v_fmac_f32 v204, v208, v152
    v_fmac_f32 v205, v209, v152
    v_lshlrev_b32 v208, 16, v139
    v_and_b32 v209, 0xffff0000, v139
    v_fmac_f32 v198, v208, v168
    v_fmac_f32 v199, v209, v168
    v_fmac_f32 v206, v208, v152
    v_fmac_f32 v207, v209, v152
    v_lshlrev_b32 v208, 16, v140
    v_and_b32 v209, 0xffff0000, v140
    v_fmac_f32 v192, v208, v172
    v_fmac_f32 v193, v209, v172
    v_fmac_f32 v200, v208, v156
    v_fmac_f32 v201, v209, v156
    v_lshlrev_b32 v208, 16, v141
    v_and_b32 v209, 0xffff0000, v141
    v_fmac_f32 v194, v208, v172
    v_fmac_f32 v195, v209, v172
    v_fmac_f32 v202, v208, v156
    v_fmac_f32 v203, v209, v156
    v_lshlrev_b32 v208, 16, v142
    v_and_b32 v209, 0xffff0000, v142
    v_fmac_f32 v196, v208, v172
    v_fmac_f32 v197, v209, v172
    v_fmac_f32 v204, v208, v156
    v_fmac_f32 v205, v209, v156
    v_lshlrev_b32 v208, 16, v143
    v_and_b32 v209, 0xffff0000, v143
    v_fmac_f32 v198, v208, v172
    v_fmac_f32 v199, v209, v172
    v_fmac_f32 v206, v208, v156
    v_fmac_f32 v207, v209, v156
    v_lshlrev_b32 v208, 16, v144
    v_and_b32 v209, 0xffff0000, v144
    v_fmac_f32 v192, v208, v176
    v_fmac_f32 v193, v209, v176
    v_fmac_f32 v200, v208, v160
    v_fmac_f32 v201, v209, v160
    v_lshlrev_b32 v208, 16, v145
    v_and_b32 v209, 0xffff0000, v145
    v_fmac_f32 v194, v208, v176
    v_fmac_f32 v195, v209, v176
    v_fmac_f32 v202, v208, v160
    v_fmac_f32 v203, v209, v160
    v_lshlrev_b32 v208, 16, v146
    v_and_b32 v209, 0xffff0000, v146
    v_fmac_f32 v196, v208, v176
    v_fmac_f32 v197, v209, v176
    v_fmac_f32 v204, v208, v160
    v_fmac_f32 v205, v209, v160
    v_lshlrev_b32 v208, 16, v147
    v_and_b32 v209, 0xffff0000, v147
    v_fmac_f32 v198, v208, v176
    v_fmac_f32 v199, v209, v176
    v_fmac_f32 v206, v208, v160
    v_fmac_f32 v207, v209, v160
    v_lshlrev_b32 v208, 16, v148
    v_and_b32 v209, 0xffff0000, v148
    v_fmac_f32 v192, v208, v180
    v_fmac_f32 v193, v209, v180
    v_fmac_f32 v200, v208, v164
    v_fmac_f32 v201, v209, v164
    v_lshlrev_b32 v208, 16, v149
    v_and_b32 v209, 0xffff0000, v149
    v_fmac_f32 v194, v208, v180
    v_fmac_f32 v195, v209, v180
    v_fmac_f32 v202, v208, v164
    v_fmac_f32 v203, v209, v164
    v_lshlrev_b32 v208, 16, v150
    v_and_b32 v209, 0xffff0000, v150
    v_fmac_f32 v196, v208, v180
    v_fmac_f32 v197, v209, v180
    v_fmac_f32 v204, v208, v164
    v_fmac_f32 v205, v209, v164
    v_lshlrev_b32 v208, 16, v151
    v_and_b32 v209, 0xffff0000, v151
    v_fmac_f32 v198, v208, v180
    v_fmac_f32 v199, v209, v180
    v_fmac_f32 v206, v208, v164
    v_fmac_f32 v207, v209, v164
    v_lshrrev_b32 v131, 3, v130
    s_lshl_b32 s41, s24, 3
    v_add_u32 v131, s41, v131
    v_lshlrev_b32 v131, 8, v131
    v_lshl_add_u32 v131, v132, 5, v131
    v_add_u32 v131, 131072, v131
    ds_write_b128 v131, v[192:195]
    ds_write_b128 v131, v[196:199] offset:16
    ds_write_b128 v131, v[200:203] offset:8192
    ds_write_b128 v131, v[204:207] offset:8208
    s_waitcnt lgkmcnt(0)
    s_barrier
    s_cmp_lg_u32 s24, 0
    s_cbranch_scc1 uw_done
    v_lshlrev_b32 v131, 2, v130
    v_add_u32 v135, 131072, v131
    s_lshl_b32 s41, s36, 1
    s_mul_i32 s41, s41, 14336
    s_mul_i32 s42, s38, 7168
    s_add_u32 s41, s41, s42
    s_lshl_b32 s42, s39, 8
    s_add_u32 s41, s41, s42
    s_add_u32 s41, s41, 524288
    v_add_u32 v131, s41, v131
    ds_read_b32 v136, v135 offset:0
    ds_read_b32 v137, v135 offset:256
    ds_read_b32 v138, v135 offset:512
    ds_read_b32 v139, v135 offset:768
    ds_read_b32 v140, v135 offset:1024
    ds_read_b32 v141, v135 offset:1280
    ds_read_b32 v142, v135 offset:1536
    ds_read_b32 v143, v135 offset:1792
    ds_read_b32 v144, v135 offset:2048
    ds_read_b32 v145, v135 offset:2304
    ds_read_b32 v146, v135 offset:2560
    ds_read_b32 v147, v135 offset:2816
    ds_read_b32 v148, v135 offset:3072
    ds_read_b32 v149, v135 offset:3328
    ds_read_b32 v150, v135 offset:3584
    ds_read_b32 v151, v135 offset:3840
    v_mov_b32 v168, 0
    v_mov_b32 v169, 0
    s_waitcnt lgkmcnt(15)
    v_add_f32 v168, v168, v136
    s_waitcnt lgkmcnt(14)
    v_add_f32 v169, v169, v137
    s_waitcnt lgkmcnt(13)
    v_add_f32 v168, v168, v138
    s_waitcnt lgkmcnt(12)
    v_add_f32 v169, v169, v139
    s_waitcnt lgkmcnt(11)
    v_add_f32 v168, v168, v140
    s_waitcnt lgkmcnt(10)
    v_add_f32 v169, v169, v141
    s_waitcnt lgkmcnt(9)
    v_add_f32 v168, v168, v142
    s_waitcnt lgkmcnt(8)
    v_add_f32 v169, v169, v143
    s_waitcnt lgkmcnt(7)
    v_add_f32 v168, v168, v144
    s_waitcnt lgkmcnt(6)
    v_add_f32 v169, v169, v145
    s_waitcnt lgkmcnt(5)
    v_add_f32 v168, v168, v146
    s_waitcnt lgkmcnt(4)
    v_add_f32 v169, v169, v147
    s_waitcnt lgkmcnt(3)
    v_add_f32 v168, v168, v148
    s_waitcnt lgkmcnt(2)
    v_add_f32 v169, v169, v149
    s_waitcnt lgkmcnt(1)
    v_add_f32 v168, v168, v150
    s_waitcnt lgkmcnt(0)
    v_add_f32 v169, v169, v151
    ds_read_b32 v136, v135 offset:4096
    ds_read_b32 v137, v135 offset:4352
    ds_read_b32 v138, v135 offset:4608
    ds_read_b32 v139, v135 offset:4864
    ds_read_b32 v140, v135 offset:5120
    ds_read_b32 v141, v135 offset:5376
    ds_read_b32 v142, v135 offset:5632
    ds_read_b32 v143, v135 offset:5888
    ds_read_b32 v144, v135 offset:6144
    ds_read_b32 v145, v135 offset:6400
    ds_read_b32 v146, v135 offset:6656
    ds_read_b32 v147, v135 offset:6912
    ds_read_b32 v148, v135 offset:7168
    ds_read_b32 v149, v135 offset:7424
    ds_read_b32 v150, v135 offset:7680
    ds_read_b32 v151, v135 offset:7936
    s_waitcnt lgkmcnt(15)
    v_add_f32 v168, v168, v136
    s_waitcnt lgkmcnt(14)
    v_add_f32 v169, v169, v137
    s_waitcnt lgkmcnt(13)
    v_add_f32 v168, v168, v138
    s_waitcnt lgkmcnt(12)
    v_add_f32 v169, v169, v139
    s_waitcnt lgkmcnt(11)
    v_add_f32 v168, v168, v140
    s_waitcnt lgkmcnt(10)
    v_add_f32 v169, v169, v141
    s_waitcnt lgkmcnt(9)
    v_add_f32 v168, v168, v142
    s_waitcnt lgkmcnt(8)
    v_add_f32 v169, v169, v143
    s_waitcnt lgkmcnt(7)
    v_add_f32 v168, v168, v144
    s_waitcnt lgkmcnt(6)
    v_add_f32 v169, v169, v145
    s_waitcnt lgkmcnt(5)
    v_add_f32 v168, v168, v146
    s_waitcnt lgkmcnt(4)
    v_add_f32 v169, v169, v147
    s_waitcnt lgkmcnt(3)
    v_add_f32 v168, v168, v148
    s_waitcnt lgkmcnt(2)
    v_add_f32 v169, v169, v149
    s_waitcnt lgkmcnt(1)
    v_add_f32 v168, v168, v150
    s_waitcnt lgkmcnt(0)
    v_add_f32 v169, v169, v151
    v_add_f32 v170, v168, v169
    global_store_dword v131, v170, s[34:35] sc1
    ds_read_b32 v136, v135 offset:8192
    ds_read_b32 v137, v135 offset:8448
    ds_read_b32 v138, v135 offset:8704
    ds_read_b32 v139, v135 offset:8960
    ds_read_b32 v140, v135 offset:9216
    ds_read_b32 v141, v135 offset:9472
    ds_read_b32 v142, v135 offset:9728
    ds_read_b32 v143, v135 offset:9984
    ds_read_b32 v144, v135 offset:10240
    ds_read_b32 v145, v135 offset:10496
    ds_read_b32 v146, v135 offset:10752
    ds_read_b32 v147, v135 offset:11008
    ds_read_b32 v148, v135 offset:11264
    ds_read_b32 v149, v135 offset:11520
    ds_read_b32 v150, v135 offset:11776
    ds_read_b32 v151, v135 offset:12032
    v_mov_b32 v168, 0
    v_mov_b32 v169, 0
    s_waitcnt lgkmcnt(15)
    v_add_f32 v168, v168, v136
    s_waitcnt lgkmcnt(14)
    v_add_f32 v169, v169, v137
    s_waitcnt lgkmcnt(13)
    v_add_f32 v168, v168, v138
    s_waitcnt lgkmcnt(12)
    v_add_f32 v169, v169, v139
    s_waitcnt lgkmcnt(11)
    v_add_f32 v168, v168, v140
    s_waitcnt lgkmcnt(10)
    v_add_f32 v169, v169, v141
    s_waitcnt lgkmcnt(9)
    v_add_f32 v168, v168, v142
    s_waitcnt lgkmcnt(8)
    v_add_f32 v169, v169, v143
    s_waitcnt lgkmcnt(7)
    v_add_f32 v168, v168, v144
    s_waitcnt lgkmcnt(6)
    v_add_f32 v169, v169, v145
    s_waitcnt lgkmcnt(5)
    v_add_f32 v168, v168, v146
    s_waitcnt lgkmcnt(4)
    v_add_f32 v169, v169, v147
    s_waitcnt lgkmcnt(3)
    v_add_f32 v168, v168, v148
    s_waitcnt lgkmcnt(2)
    v_add_f32 v169, v169, v149
    s_waitcnt lgkmcnt(1)
    v_add_f32 v168, v168, v150
    s_waitcnt lgkmcnt(0)
    v_add_f32 v169, v169, v151
    ds_read_b32 v136, v135 offset:12288
    ds_read_b32 v137, v135 offset:12544
    ds_read_b32 v138, v135 offset:12800
    ds_read_b32 v139, v135 offset:13056
    ds_read_b32 v140, v135 offset:13312
    ds_read_b32 v141, v135 offset:13568
    ds_read_b32 v142, v135 offset:13824
    ds_read_b32 v143, v135 offset:14080
    ds_read_b32 v144, v135 offset:14336
    ds_read_b32 v145, v135 offset:14592
    ds_read_b32 v146, v135 offset:14848
    ds_read_b32 v147, v135 offset:15104
    ds_read_b32 v148, v135 offset:15360
    ds_read_b32 v149, v135 offset:15616
    ds_read_b32 v150, v135 offset:15872
    ds_read_b32 v151, v135 offset:16128
    s_waitcnt lgkmcnt(15)
    v_add_f32 v168, v168, v136
    s_waitcnt lgkmcnt(14)
    v_add_f32 v169, v169, v137
    s_waitcnt lgkmcnt(13)
    v_add_f32 v168, v168, v138
    s_waitcnt lgkmcnt(12)
    v_add_f32 v169, v169, v139
    s_waitcnt lgkmcnt(11)
    v_add_f32 v168, v168, v140
    s_waitcnt lgkmcnt(10)
    v_add_f32 v169, v169, v141
    s_waitcnt lgkmcnt(9)
    v_add_f32 v168, v168, v142
    s_waitcnt lgkmcnt(8)
    v_add_f32 v169, v169, v143
    s_waitcnt lgkmcnt(7)
    v_add_f32 v168, v168, v144
    s_waitcnt lgkmcnt(6)
    v_add_f32 v169, v169, v145
    s_waitcnt lgkmcnt(5)
    v_add_f32 v168, v168, v146
    s_waitcnt lgkmcnt(4)
    v_add_f32 v169, v169, v147
    s_waitcnt lgkmcnt(3)
    v_add_f32 v168, v168, v148
    s_waitcnt lgkmcnt(2)
    v_add_f32 v169, v169, v149
    s_waitcnt lgkmcnt(1)
    v_add_f32 v168, v168, v150
    s_waitcnt lgkmcnt(0)
    v_add_f32 v169, v169, v151
    v_add_f32 v171, v168, v169
    v_add_u32 v132, 14336, v131
    global_store_dword v132, v171, s[34:35] sc1
uw_done:
    v_accvgpr_write_b32 a0, 0
    v_accvgpr_write_b32 a1, 0
    v_accvgpr_write_b32 a2, 0
    v_accvgpr_write_b32 a3, 0
    v_accvgpr_write_b32 a4, 0
    v_accvgpr_write_b32 a5, 0
    v_accvgpr_write_b32 a6, 0
    v_accvgpr_write_b32 a7, 0
    v_accvgpr_write_b32 a8, 0
    v_accvgpr_write_b32 a9, 0
    v_accvgpr_write_b32 a10, 0
    v_accvgpr_write_b32 a11, 0
    v_accvgpr_write_b32 a12, 0
    v_accvgpr_write_b32 a13, 0
    v_accvgpr_write_b32 a14, 0
    v_accvgpr_write_b32 a15, 0
    v_accvgpr_write_b32 a16, 0
    v_accvgpr_write_b32 a17, 0
    v_accvgpr_write_b32 a18, 0
    v_accvgpr_write_b32 a19, 0
    v_accvgpr_write_b32 a20, 0
    v_accvgpr_write_b32 a21, 0
    v_accvgpr_write_b32 a22, 0
    v_accvgpr_write_b32 a23, 0
    v_accvgpr_write_b32 a24, 0
    v_accvgpr_write_b32 a25, 0
    v_accvgpr_write_b32 a26, 0
    v_accvgpr_write_b32 a27, 0
    v_accvgpr_write_b32 a28, 0
    v_accvgpr_write_b32 a29, 0
    v_accvgpr_write_b32 a30, 0
    v_accvgpr_write_b32 a31, 0
    v_accvgpr_write_b32 a32, 0
    v_accvgpr_write_b32 a33, 0
    v_accvgpr_write_b32 a34, 0
    v_accvgpr_write_b32 a35, 0
    v_accvgpr_write_b32 a36, 0
    v_accvgpr_write_b32 a37, 0
    v_accvgpr_write_b32 a38, 0
    v_accvgpr_write_b32 a39, 0
    v_accvgpr_write_b32 a40, 0
    v_accvgpr_write_b32 a41, 0
    v_accvgpr_write_b32 a42, 0
    v_accvgpr_write_b32 a43, 0
    v_accvgpr_write_b32 a44, 0
    v_accvgpr_write_b32 a45, 0
    v_accvgpr_write_b32 a46, 0
    v_accvgpr_write_b32 a47, 0
    v_accvgpr_write_b32 a48, 0
    v_accvgpr_write_b32 a49, 0
    v_accvgpr_write_b32 a50, 0
    v_accvgpr_write_b32 a51, 0
    v_accvgpr_write_b32 a52, 0
    v_accvgpr_write_b32 a53, 0
    v_accvgpr_write_b32 a54, 0
    v_accvgpr_write_b32 a55, 0
    v_accvgpr_write_b32 a56, 0
    v_accvgpr_write_b32 a57, 0
    v_accvgpr_write_b32 a58, 0
    v_accvgpr_write_b32 a59, 0
    v_accvgpr_write_b32 a60, 0
    v_accvgpr_write_b32 a61, 0
    v_accvgpr_write_b32 a62, 0
    v_accvgpr_write_b32 a63, 0
    s_waitcnt vmcnt(46)
    ds_read_b64_tr_b16 a[64:65], v240 offset:0
    ds_read_b64_tr_b16 a[66:67], v240 offset:512
    ds_read_b64_tr_b16 a[68:69], v241 offset:0
    ds_read_b64_tr_b16 a[70:71], v241 offset:512
    s_waitcnt vmcnt(17) lgkmcnt(2)
    v_mfma_f32_32x32x16_bf16 a[0:15], a[64:67], v[0:3], a[0:15]
    ds_read_b64_tr_b16 a[72:73], v240 offset:2048
    ds_read_b64_tr_b16 a[74:75], v240 offset:2560
    ds_read_b64_tr_b16 a[76:77], v241 offset:2048
    ds_read_b64_tr_b16 a[78:79], v241 offset:2560
    s_waitcnt vmcnt(16)
    v_mfma_f32_32x32x16_bf16 a[16:31], a[64:67], v[4:7], a[16:31]
    s_waitcnt lgkmcnt(4)
    v_mfma_f32_32x32x16_bf16 a[32:47], a[68:71], v[0:3], a[32:47]
    s_add_u32 m0, s25, 30720
    v_mfma_f32_32x32x16_bf16 a[48:63], a[68:71], v[4:7], a[48:63]
    buffer_load_dwordx4 v242, s[4:7], s26 offen lds
    buffer_load_dwordx4 v243, s[4:7], s26 offen offset:1024 lds
    s_add_u32 s26, s26, s30
    s_add_u32 s26, s26, s31
    s_and_b32 s26, s26, s65
    buffer_load_dwordx4 v[72:75], v244, s[8:11], s27 offen sc1
    buffer_load_dwordx4 v[76:79], v245, s[8:11], s27 offen sc1
    s_add_u32 s27, s27, 1024
    s_waitcnt vmcnt(19) lgkmcnt(2)
    v_mfma_f32_32x32x16_bf16 a[0:15], a[72:75], v[8:11], a[0:15]
    ds_read_b64_tr_b16 a[80:81], v240 offset:4096
    ds_read_b64_tr_b16 a[82:83], v240 offset:4608
    ds_read_b64_tr_b16 a[84:85], v241 offset:4096
    ds_read_b64_tr_b16 a[86:87], v241 offset:4608
    s_waitcnt vmcnt(18)
    v_mfma_f32_32x32x16_bf16 a[16:31], a[72:75], v[12:15], a[16:31]
    s_waitcnt lgkmcnt(4)
    v_mfma_f32_32x32x16_bf16 a[32:47], a[76:79], v[8:11], a[32:47]
    s_add_u32 m0, s25, 0
    v_mfma_f32_32x32x16_bf16 a[48:63], a[76:79], v[12:15], a[48:63]
    buffer_load_dwordx4 v242, s[4:7], s26 offen lds
    buffer_load_dwordx4 v243, s[4:7], s26 offen offset:1024 lds
    s_add_u32 s26, s26, s30
    global_load_dword v116, v117, s[34:35] sc1
    buffer_load_dwordx4 v[0:3], v244, s[8:11], s27 offen sc1
    buffer_load_dwordx4 v[4:7], v245, s[8:11], s27 offen sc1
    s_add_u32 s27, s27, 1024
    s_waitcnt vmcnt(22) lgkmcnt(2)
    v_mfma_f32_32x32x16_bf16 a[0:15], a[80:83], v[16:19], a[0:15]
    ds_read_b64_tr_b16 a[64:65], v240 offset:6144
    ds_read_b64_tr_b16 a[66:67], v240 offset:6656
    ds_read_b64_tr_b16 a[68:69], v241 offset:6144
    ds_read_b64_tr_b16 a[70:71], v241 offset:6656
    s_waitcnt vmcnt(21)
    v_mfma_f32_32x32x16_bf16 a[16:31], a[80:83], v[20:23], a[16:31]
    s_waitcnt lgkmcnt(4)
    v_mfma_f32_32x32x16_bf16 a[32:47], a[84:87], v[16:19], a[32:47]
    s_add_u32 m0, s25, 2048
    v_mfma_f32_32x32x16_bf16 a[48:63], a[84:87], v[20:23], a[48:63]
    buffer_load_dwordx4 v242, s[4:7], s26 offen lds
    buffer_load_dwordx4 v243, s[4:7], s26 offen offset:1024 lds
    s_add_u32 s26, s26, s30
    buffer_load_dwordx4 v[8:11], v244, s[8:11], s27 offen sc1
    buffer_load_dwordx4 v[12:15], v245, s[8:11], s27 offen sc1
    s_add_u32 s27, s27, 1024
    s_waitcnt vmcnt(24) lgkmcnt(2)
    v_mfma_f32_32x32x16_bf16 a[0:15], a[64:67], v[24:27], a[0:15]
    ds_read_b64_tr_b16 a[72:73], v240 offset:8192
    ds_read_b64_tr_b16 a[74:75], v240 offset:8704
    ds_read_b64_tr_b16 a[76:77], v241 offset:8192
    ds_read_b64_tr_b16 a[78:79], v241 offset:8704
    s_waitcnt vmcnt(23)
    v_mfma_f32_32x32x16_bf16 a[16:31], a[64:67], v[28:31], a[16:31]
    s_waitcnt lgkmcnt(4)
    v_mfma_f32_32x32x16_bf16 a[32:47], a[68:71], v[24:27], a[32:47]
    s_add_u32 m0, s25, 4096
    v_mfma_f32_32x32x16_bf16 a[48:63], a[68:71], v[28:31], a[48:63]
    buffer_load_dwordx4 v242, s[4:7], s26 offen lds
    buffer_load_dwordx4 v243, s[4:7], s26 offen offset:1024 lds
    s_add_u32 s26, s26, s30
    buffer_load_dwordx4 v[16:19], v244, s[8:11], s27 offen sc1
    buffer_load_dwordx4 v[20:23], v245, s[8:11], s27 offen sc1
    s_add_u32 s27, s27, 1024
    s_waitcnt vmcnt(26) lgkmcnt(2)
    v_mfma_f32_32x32x16_bf16 a[0:15], a[72:75], v[32:35], a[0:15]
    ds_read_b64_tr_b16 a[80:81], v240 offset:10240
    ds_read_b64_tr_b16 a[82:83], v240 offset:10752
    ds_read_b64_tr_b16 a[84:85], v241 offset:10240
    ds_read_b64_tr_b16 a[86:87], v241 offset:10752
    s_waitcnt vmcnt(25)
    v_mfma_f32_32x32x16_bf16 a[16:31], a[72:75], v[36:39], a[16:31]
    s_waitcnt lgkmcnt(4)
    v_mfma_f32_32x32x16_bf16 a[32:47], a[76:79], v[32:35], a[32:47]
    s_add_u32 m0, s25, 6144
    v_mfma_f32_32x32x16_bf16 a[48:63], a[76:79], v[36:39], a[48:63]
    buffer_load_dwordx4 v242, s[4:7], s26 offen lds
    buffer_load_dwordx4 v243, s[4:7], s26 offen offset:1024 lds
    s_add_u32 s26, s26, s30
    buffer_load_dwordx4 v[24:27], v244, s[8:11], s27 offen sc1
    buffer_load_dwordx4 v[28:31], v245, s[8:11], s27 offen sc1
    s_add_u32 s27, s27, 1024
    s_waitcnt vmcnt(28) lgkmcnt(2)
    v_mfma_f32_32x32x16_bf16 a[0:15], a[80:83], v[40:43], a[0:15]
    ds_read_b64_tr_b16 a[64:65], v240 offset:12288
    ds_read_b64_tr_b16 a[66:67], v240 offset:12800
    ds_read_b64_tr_b16 a[68:69], v241 offset:12288
    ds_read_b64_tr_b16 a[70:71], v241 offset:12800
    s_waitcnt vmcnt(27)
    v_mfma_f32_32x32x16_bf16 a[16:31], a[80:83], v[44:47], a[16:31]
    s_waitcnt lgkmcnt(4)
    v_mfma_f32_32x32x16_bf16 a[32:47], a[84:87], v[40:43], a[32:47]
    s_add_u32 m0, s25, 8192
    v_mfma_f32_32x32x16_bf16 a[48:63], a[84:87], v[44:47], a[48:63]
    buffer_load_dwordx4 v242, s[4:7], s26 offen lds
    buffer_load_dwordx4 v243, s[4:7], s26 offen offset:1024 lds
    s_add_u32 s26, s26, s30
    buffer_load_dwordx4 v[32:35], v244, s[8:11], s27 offen sc1
    buffer_load_dwordx4 v[36:39], v245, s[8:11], s27 offen sc1
    s_add_u32 s27, s27, 1024
    s_waitcnt vmcnt(30) lgkmcnt(2)
    v_mfma_f32_32x32x16_bf16 a[0:15], a[64:67], v[48:51], a[0:15]
    ds_read_b64_tr_b16 a[72:73], v240 offset:14336
    ds_read_b64_tr_b16 a[74:75], v240 offset:14848
    ds_read_b64_tr_b16 a[76:77], v241 offset:14336
    ds_read_b64_tr_b16 a[78:79], v241 offset:14848
    s_waitcnt vmcnt(29)
    v_mfma_f32_32x32x16_bf16 a[16:31], a[64:67], v[52:55], a[16:31]
    s_waitcnt lgkmcnt(4)
    v_mfma_f32_32x32x16_bf16 a[32:47], a[68:71], v[48:51], a[32:47]
    s_add_u32 m0, s25, 10240
    v_mfma_f32_32x32x16_bf16 a[48:63], a[68:71], v[52:55], a[48:63]
    buffer_load_dwordx4 v242, s[4:7], s26 offen lds
    buffer_load_dwordx4 v243, s[4:7], s26 offen offset:1024 lds
    s_add_u32 s26, s26, s30
    buffer_load_dwordx4 v[40:43], v244, s[8:11], s27 offen sc1
    buffer_load_dwordx4 v[44:47], v245, s[8:11], s27 offen sc1
    s_add_u32 s27, s27, 1024
    s_add_u32 s27, s27, 24576
    s_and_b32 s27, s27, 0x3ffff
    s_waitcnt vmcnt(32) lgkmcnt(2)
    v_mfma_f32_32x32x16_bf16 a[0:15], a[72:75], v[56:59], a[0:15]
    ds_read_b64_tr_b16 a[80:81], v240 offset:16384
    ds_read_b64_tr_b16 a[82:83], v240 offset:16896
    ds_read_b64_tr_b16 a[84:85], v241 offset:16384
    ds_read_b64_tr_b16 a[86:87], v241 offset:16896
    s_waitcnt vmcnt(31)
    v_mfma_f32_32x32x16_bf16 a[16:31], a[72:75], v[60:63], a[16:31]
    s_waitcnt lgkmcnt(4)
    v_mfma_f32_32x32x16_bf16 a[32:47], a[76:79], v[56:59], a[32:47]
    s_add_u32 m0, s25, 12288
    v_mfma_f32_32x32x16_bf16 a[48:63], a[76:79], v[60:63], a[48:63]
    buffer_load_dwordx4 v242, s[4:7], s26 offen lds
    buffer_load_dwordx4 v243, s[4:7], s26 offen offset:1024 lds
    s_add_u32 s26, s26, s30
    s_waitcnt vmcnt(24)
    v_readlane_b32 s44, v116, s64
    s_cmp_eq_u32 s44, s33
    s_cbranch_scc1 hok_14
    s_mov_b32 s47, 400000
hsp_14:
    global_load_dword v116, v117, s[34:35] sc1
    s_waitcnt vmcnt(0)
    v_readlane_b32 s44, v116, s64
    s_cmp_eq_u32 s44, s33
    s_cbranch_scc1 hok_14
    s_sub_u32 s47, s47, 1
    s_cmp_lg_u32 s47, 0
    s_cbranch_scc1 hsp_14
hok_14:
    s_add_u32 s64, s64, 4
    s_and_b32 s64, s64, 31
    buffer_load_dwordx4 v[48:51], v244, s[8:11], s27 offen sc1
    buffer_load_dwordx4 v[52:55], v245, s[8:11], s27 offen sc1
    s_add_u32 s27, s27, 1024
    s_waitcnt lgkmcnt(2)
    v_mfma_f32_32x32x16_bf16 a[0:15], a[80:83], v[64:67], a[0:15]
    ds_read_b64_tr_b16 a[64:65], v240 offset:18432
    ds_read_b64_tr_b16 a[66:67], v240 offset:18944
    ds_read_b64_tr_b16 a[68:69], v241 offset:18432
    ds_read_b64_tr_b16 a[70:71], v241 offset:18944
    v_mfma_f32_32x32x16_bf16 a[16:31], a[80:83], v[68:71], a[16:31]
    s_waitcnt lgkmcnt(4)
    v_mfma_f32_32x32x16_bf16 a[32:47], a[84:87], v[64:67], a[32:47]
    s_add_u32 m0, s25, 14336
    v_mfma_f32_32x32x16_bf16 a[48:63], a[84:87], v[68:71], a[48:63]
    buffer_load_dwordx4 v242, s[4:7], s26 offen lds
    buffer_load_dwordx4 v243, s[4:7], s26 offen offset:1024 lds
    s_add_u32 s26, s26, s30
    s_add_u32 s26, s26, s31
    s_and_b32 s26, s26, s65
    buffer_load_dwordx4 v[56:59], v244, s[8:11], s27 offen sc1
    buffer_load_dwordx4 v[60:63], v245, s[8:11], s27 offen sc1
    s_add_u32 s27, s27, 1024
    s_waitcnt lgkmcnt(2)
    v_mfma_f32_32x32x16_bf16 a[0:15], a[64:67], v[72:75], a[0:15]
    ds_read_b64_tr_b16 a[72:73], v240 offset:20480
    ds_read_b64_tr_b16 a[74:75], v240 offset:20992
    ds_read_b64_tr_b16 a[76:77], v241 offset:20480
    ds_read_b64_tr_b16 a[78:79], v241 offset:20992
    v_mfma_f32_32x32x16_bf16 a[16:31], a[64:67], v[76:79], a[16:31]
    s_waitcnt lgkmcnt(4)
    v_mfma_f32_32x32x16_bf16 a[32:47], a[68:71], v[72:75], a[32:47]
    s_add_u32 m0, s25, 16384
    v_mfma_f32_32x32x16_bf16 a[48:63], a[68:71], v[76:79], a[48:63]
    buffer_load_dwordx4 v242, s[4:7], s26 offen lds
    buffer_load_dwordx4 v243, s[4:7], s26 offen offset:1024 lds
    s_add_u32 s26, s26, s30
    global_load_dword v116, v117, s[34:35] sc1
    buffer_load_dwordx4 v[64:67], v244, s[8:11], s27 offen sc1
    buffer_load_dwordx4 v[68:71], v245, s[8:11], s27 offen sc1
    s_add_u32 s27, s27, 1024
    s_waitcnt vmcnt(34) lgkmcnt(2)
    v_mfma_f32_32x32x16_bf16 a[0:15], a[72:75], v[0:3], a[0:15]
    ds_read_b64_tr_b16 a[80:81], v240 offset:22528
    ds_read_b64_tr_b16 a[82:83], v240 offset:23040
    ds_read_b64_tr_b16 a[84:85], v241 offset:22528
    ds_read_b64_tr_b16 a[86:87], v241 offset:23040
    s_waitcnt vmcnt(33)
    v_mfma_f32_32x32x16_bf16 a[16:31], a[72:75], v[4:7], a[16:31]
    s_waitcnt lgkmcnt(4)
    v_mfma_f32_32x32x16_bf16 a[32:47], a[76:79], v[0:3], a[32:47]
    s_add_u32 m0, s25, 18432
    v_mfma_f32_32x32x16_bf16 a[48:63], a[76:79], v[4:7], a[48:63]
    buffer_load_dwordx4 v242, s[4:7], s26 offen lds
    buffer_load_dwordx4 v243, s[4:7], s26 offen offset:1024 lds
    s_add_u32 s26, s26, s30
    buffer_load_dwordx4 v[72:75], v244, s[8:11], s27 offen sc1
    buffer_load_dwordx4 v[76:79], v245, s[8:11], s27 offen sc1
    s_add_u32 s27, s27, 1024
    s_waitcnt vmcnt(34) lgkmcnt(2)
    v_mfma_f32_32x32x16_bf16 a[0:15], a[80:83], v[8:11], a[0:15]
    ds_read_b64_tr_b16 a[64:65], v240 offset:24576
    ds_read_b64_tr_b16 a[66:67], v240 offset:25088
    ds_read_b64_tr_b16 a[68:69], v241 offset:24576
    ds_read_b64_tr_b16 a[70:71], v241 offset:25088
    s_waitcnt vmcnt(33)
    v_mfma_f32_32x32x16_bf16 a[16:31], a[80:83], v[12:15], a[16:31]
    s_waitcnt lgkmcnt(4)
    v_mfma_f32_32x32x16_bf16 a[32:47], a[84:87], v[8:11], a[32:47]
    s_add_u32 m0, s25, 20480
    v_mfma_f32_32x32x16_bf16 a[48:63], a[84:87], v[12:15], a[48:63]
    buffer_load_dwordx4 v242, s[4:7], s26 offen lds
    buffer_load_dwordx4 v243, s[4:7], s26 offen offset:1024 lds
    s_add_u32 s26, s26, s30
    s_cmp_ge_u32 s2, 224
    s_cbranch_scc1 fn_uw_15
    s_cmp_lg_u32 s24, 0
    s_cbranch_scc1 fn_uw_15
    s_lshl_b32 s40, s2, 2
    s_add_u32 s40, s40, 0x3004000
    v_mov_b32 v118, s33
    v_mov_b32 v119, s40
    s_mov_b64 exec, 1
    global_store_dword v119, v118, s[34:35] sc1
    s_mov_b64 exec, -1
fn_uw_15:
    buffer_load_dwordx4 v[0:3], v244, s[8:11], s27 offen sc1
    buffer_load_dwordx4 v[4:7], v245, s[8:11], s27 offen sc1
    s_add_u32 s27, s27, 1024
    s_waitcnt vmcnt(34) lgkmcnt(2)
    v_mfma_f32_32x32x16_bf16 a[0:15], a[64:67], v[16:19], a[0:15]
    ds_read_b64_tr_b16 a[72:73], v240 offset:26624
    ds_read_b64_tr_b16 a[74:75], v240 offset:27136
    ds_read_b64_tr_b16 a[76:77], v241 offset:26624
    ds_read_b64_tr_b16 a[78:79], v241 offset:27136
    s_waitcnt vmcnt(33)
    v_mfma_f32_32x32x16_bf16 a[16:31], a[64:67], v[20:23], a[16:31]
    s_waitcnt lgkmcnt(4)
    v_mfma_f32_32x32x16_bf16 a[32:47], a[68:71], v[16:19], a[32:47]
    s_add_u32 m0, s25, 22528
    v_mfma_f32_32x32x16_bf16 a[48:63], a[68:71], v[20:23], a[48:63]
    buffer_load_dwordx4 v242, s[4:7], s26 offen lds
    buffer_load_dwordx4 v243, s[4:7], s26 offen offset:1024 lds
    s_add_u32 s26, s26, s30
    buffer_load_dwordx4 v[8:11], v244, s[8:11], s27 offen sc1
    buffer_load_dwordx4 v[12:15], v245, s[8:11], s27 offen sc1
    s_add_u32 s27, s27, 1024
    s_waitcnt vmcnt(34) lgkmcnt(2)
    v_mfma_f32_32x32x16_bf16 a[0:15], a[72:75], v[24:27], a[0:15]
    ds_read_b64_tr_b16 a[80:81], v240 offset:28672
    ds_read_b64_tr_b16 a[82:83], v240 offset:29184
    ds_read_b64_tr_b16 a[84:85], v241 offset:28672
    ds_read_b64_tr_b16 a[86:87], v241 offset:29184
    s_waitcnt vmcnt(33)
    v_mfma_f32_32x32x16_bf16 a[16:31], a[72:75], v[28:31], a[16:31]
    s_waitcnt lgkmcnt(4)
    v_mfma_f32_32x32x16_bf16 a[32:47], a[76:79], v[24:27], a[32:47]
    s_add_u32 m0, s25, 24576
    v_mfma_f32_32x32x16_bf16 a[48:63], a[76:79], v[28:31], a[48:63]
    buffer_load_dwordx4 v242, s[4:7], s26 offen lds
    buffer_load_dwordx4 v243, s[4:7], s26 offen offset:1024 lds
    s_add_u32 s26, s26, s30
    buffer_load_dwordx4 v[16:19], v244, s[8:11], s27 offen sc1
    buffer_load_dwordx4 v[20:23], v245, s[8:11], s27 offen sc1
    s_add_u32 s27, s27, 1024
    s_waitcnt vmcnt(34) lgkmcnt(2)
    v_mfma_f32_32x32x16_bf16 a[0:15], a[80:83], v[32:35], a[0:15]
    ds_read_b64_tr_b16 a[64:65], v240 offset:30720
    ds_read_b64_tr_b16 a[66:67], v240 offset:31232
    ds_read_b64_tr_b16 a[68:69], v241 offset:30720
    ds_read_b64_tr_b16 a[70:71], v241 offset:31232
    s_waitcnt vmcnt(33)
    v_mfma_f32_32x32x16_bf16 a[16:31], a[80:83], v[36:39], a[16:31]
    s_waitcnt lgkmcnt(4)
    v_mfma_f32_32x32x16_bf16 a[32:47], a[84:87], v[32:35], a[32:47]
    s_add_u32 m0, s25, 26624
    v_mfma_f32_32x32x16_bf16 a[48:63], a[84:87], v[36:39], a[48:63]
    buffer_load_dwordx4 v242, s[4:7], s26 offen lds
    buffer_load_dwordx4 v243, s[4:7], s26 offen offset:1024 lds
    s_add_u32 s26, s26, s30
    buffer_load_dwordx4 v[24:27], v244, s[8:11], s27 offen sc1
    buffer_load_dwordx4 v[28:31], v245, s[8:11], s27 offen sc1
    s_add_u32 s27, s27, 1024
    s_add_u32 s27, s27, 24576
    s_and_b32 s27, s27, 0x3ffff
    s_waitcnt vmcnt(34) lgkmcnt(2)
    v_mfma_f32_32x32x16_bf16 a[0:15], a[64:67], v[40:43], a[0:15]
    ds_read_b64_tr_b16 a[72:73], v240 offset:0
    ds_read_b64_tr_b16 a[74:75], v240 offset:512
    ds_read_b64_tr_b16 a[76:77], v241 offset:0
    ds_read_b64_tr_b16 a[78:79], v241 offset:512
    s_waitcnt vmcnt(33)
    v_mfma_f32_32x32x16_bf16 a[16:31], a[64:67], v[44:47], a[16:31]
    s_waitcnt lgkmcnt(4)
    v_mfma_f32_32x32x16_bf16 a[32:47], a[68:71], v[40:43], a[32:47]
    s_add_u32 m0, s25, 28672
    v_mfma_f32_32x32x16_bf16 a[48:63], a[68:71], v[44:47], a[48:63]
    buffer_load_dwordx4 v242, s[4:7], s26 offen lds
    buffer_load_dwordx4 v243, s[4:7], s26 offen offset:1024 lds
    s_add_u32 s26, s26, s30
    s_waitcnt vmcnt(24)
    v_readlane_b32 s44, v116, s64
    s_cmp_eq_u32 s44, s33
    s_cbranch_scc1 hok_16
    s_mov_b32 s47, 400000
hsp_16:
    global_load_dword v116, v117, s[34:35] sc1
    s_waitcnt vmcnt(0)
    v_readlane_b32 s44, v116, s64
    s_cmp_eq_u32 s44, s33
    s_cbranch_scc1 hok_16
    s_sub_u32 s47, s47, 1
    s_cmp_lg_u32 s47, 0
    s_cbranch_scc1 hsp_16
hok_16:
    s_add_u32 s64, s64, 4
    s_and_b32 s64, s64, 31
    buffer_load_dwordx4 v[32:35], v244, s[8:11], s27 offen sc1
    buffer_load_dwordx4 v[36:39], v245, s[8:11], s27 offen sc1
    s_add_u32 s27, s27, 1024
    s_waitcnt lgkmcnt(2)
    v_mfma_f32_32x32x16_bf16 a[0:15], a[72:75], v[48:51], a[0:15]
    ds_read_b64_tr_b16 a[80:81], v240 offset:2048
    ds_read_b64_tr_b16 a[82:83], v240 offset:2560
    ds_read_b64_tr_b16 a[84:85], v241 offset:2048
    ds_read_b64_tr_b16 a[86:87], v241 offset:2560
    v_mfma_f32_32x32x16_bf16 a[16:31], a[72:75], v[52:55], a[16:31]
    s_waitcnt lgkmcnt(4)
    v_mfma_f32_32x32x16_bf16 a[32:47], a[76:79], v[48:51], a[32:47]
    s_add_u32 m0, s25, 30720
    v_mfma_f32_32x32x16_bf16 a[48:63], a[76:79], v[52:55], a[48:63]
    buffer_load_dwordx4 v242, s[4:7], s26 offen lds
    buffer_load_dwordx4 v243, s[4:7], s26 offen offset:1024 lds
    s_add_u32 s26, s26, s30
    s_add_u32 s26, s26, s31
    s_and_b32 s26, s26, s65
    buffer_load_dwordx4 v[40:43], v244, s[8:11], s27 offen sc1
    buffer_load_dwordx4 v[44:47], v245, s[8:11], s27 offen sc1
    s_add_u32 s27, s27, 1024
    s_waitcnt lgkmcnt(2)
    v_mfma_f32_32x32x16_bf16 a[0:15], a[80:83], v[56:59], a[0:15]
    ds_read_b64_tr_b16 a[64:65], v240 offset:4096
    ds_read_b64_tr_b16 a[66:67], v240 offset:4608
    ds_read_b64_tr_b16 a[68:69], v241 offset:4096
    ds_read_b64_tr_b16 a[70:71], v241 offset:4608
    v_mfma_f32_32x32x16_bf16 a[16:31], a[80:83], v[60:63], a[16:31]
    s_waitcnt lgkmcnt(4)
    v_mfma_f32_32x32x16_bf16 a[32:47], a[84:87], v[56:59], a[32:47]
    s_add_u32 m0, s25, 0
    v_mfma_f32_32x32x16_bf16 a[48:63], a[84:87], v[60:63], a[48:63]
    buffer_load_dwordx4 v242, s[4:7], s26 offen lds
    buffer_load_dwordx4 v243, s[4:7], s26 offen offset:1024 lds
    s_add_u32 s26, s26, s30
    global_load_dword v116, v117, s[34:35] sc1
    buffer_load_dwordx4 v[48:51], v244, s[8:11], s27 offen sc1
    buffer_load_dwordx4 v[52:55], v245, s[8:11], s27 offen sc1
    s_add_u32 s27, s27, 1024
    s_waitcnt vmcnt(34) lgkmcnt(2)
    v_mfma_f32_32x32x16_bf16 a[0:15], a[64:67], v[64:67], a[0:15]
    ds_read_b64_tr_b16 a[72:73], v240 offset:6144
    ds_read_b64_tr_b16 a[74:75], v240 offset:6656
    ds_read_b64_tr_b16 a[76:77], v241 offset:6144
    ds_read_b64_tr_b16 a[78:79], v241 offset:6656
    s_waitcnt vmcnt(33)
    v_mfma_f32_32x32x16_bf16 a[16:31], a[64:67], v[68:71], a[16:31]
    s_waitcnt lgkmcnt(4)
    v_mfma_f32_32x32x16_bf16 a[32:47], a[68:71], v[64:67], a[32:47]
    s_add_u32 m0, s25, 2048
    v_mfma_f32_32x32x16_bf16 a[48:63], a[68:71], v[68:71], a[48:63]
    buffer_load_dwordx4 v242, s[4:7], s26 offen lds
    buffer_load_dwordx4 v243, s[4:7], s26 offen offset:1024 lds
    s_add_u32 s26, s26, s30
    buffer_load_dwordx4 v[56:59], v244, s[8:11], s27 offen sc1
    buffer_load_dwordx4 v[60:63], v245, s[8:11], s27 offen sc1
    s_add_u32 s27, s27, 1024
    s_waitcnt vmcnt(34) lgkmcnt(2)
    v_mfma_f32_32x32x16_bf16 a[0:15], a[72:75], v[72:75], a[0:15]
    ds_read_b64_tr_b16 a[80:81], v240 offset:8192
    ds_read_b64_tr_b16 a[82:83], v240 offset:8704
    ds_read_b64_tr_b16 a[84:85], v241 offset:8192
    ds_read_b64_tr_b16 a[86:87], v241 offset:8704
    s_waitcnt vmcnt(33)
    v_mfma_f32_32x32x16_bf16 a[16:31], a[72:75], v[76:79], a[16:31]
    s_waitcnt lgkmcnt(4)
    v_mfma_f32_32x32x16_bf16 a[32:47], a[76:79], v[72:75], a[32:47]
    s_add_u32 m0, s25, 4096
    v_mfma_f32_32x32x16_bf16 a[48:63], a[76:79], v[76:79], a[48:63]
    buffer_load_dwordx4 v242, s[4:7], s26 offen lds
    buffer_load_dwordx4 v243, s[4:7], s26 offen offset:1024 lds
    s_add_u32 s26, s26, s30
    buffer_load_dwordx4 v[64:67], v244, s[8:11], s27 offen sc1
    buffer_load_dwordx4 v[68:71], v245, s[8:11], s27 offen sc1
    s_add_u32 s27, s27, 1024
    s_waitcnt vmcnt(34) lgkmcnt(2)
    v_mfma_f32_32x32x16_bf16 a[0:15], a[80:83], v[0:3], a[0:15]
    ds_read_b64_tr_b16 a[64:65], v240 offset:10240
    ds_read_b64_tr_b16 a[66:67], v240 offset:10752
    ds_read_b64_tr_b16 a[68:69], v241 offset:10240
    ds_read_b64_tr_b16 a[70:71], v241 offset:10752
    s_waitcnt vmcnt(33)
    v_mfma_f32_32x32x16_bf16 a[16:31], a[80:83], v[4:7], a[16:31]
    s_waitcnt lgkmcnt(4)
    v_mfma_f32_32x32x16_bf16 a[32:47], a[84:87], v[0:3], a[32:47]
    s_add_u32 m0, s25, 6144
    v_mfma_f32_32x32x16_bf16 a[48:63], a[84:87], v[4:7], a[48:63]
    buffer_load_dwordx4 v242, s[4:7], s26 offen lds
    buffer_load_dwordx4 v243, s[4:7], s26 offen offset:1024 lds
    s_add_u32 s26, s26, s30
    buffer_load_dwordx4 v[72:75], v244, s[8:11], s27 offen sc1
    buffer_load_dwordx4 v[76:79], v245, s[8:11], s27 offen sc1
    s_add_u32 s27, s27, 1024
    s_waitcnt vmcnt(34) lgkmcnt(2)
    v_mfma_f32_32x32x16_bf16 a[0:15], a[64:67], v[8:11], a[0:15]
    ds_read_b64_tr_b16 a[72:73], v240 offset:12288
    ds_read_b64_tr_b16 a[74:75], v240 offset:12800
    ds_read_b64_tr_b16 a[76:77], v241 offset:12288
    ds_read_b64_tr_b16 a[78:79], v241 offset:12800
    s_waitcnt vmcnt(33)
    v_mfma_f32_32x32x16_bf16 a[16:31], a[64:67], v[12:15], a[16:31]
    s_waitcnt lgkmcnt(4)
    v_mfma_f32_32x32x16_bf16 a[32:47], a[68:71], v[8:11], a[32:47]
    s_add_u32 m0, s25, 8192
    v_mfma_f32_32x32x16_bf16 a[48:63], a[68:71], v[12:15], a[48:63]
    buffer_load_dwordx4 v242, s[4:7], s26 offen lds
    buffer_load_dwordx4 v243, s[4:7], s26 offen offset:1024 lds
    s_add_u32 s26, s26, s30
    buffer_load_dwordx4 v[0:3], v244, s[8:11], s27 offen sc1
    buffer_load_dwordx4 v[4:7], v245, s[8:11], s27 offen sc1
    s_add_u32 s27, s27, 1024
    s_waitcnt vmcnt(34) lgkmcnt(2)
    v_mfma_f32_32x32x16_bf16 a[0:15], a[72:75], v[16:19], a[0:15]
    ds_read_b64_tr_b16 a[80:81], v240 offset:14336
    ds_read_b64_tr_b16 a[82:83], v240 offset:14848
    ds_read_b64_tr_b16 a[84:85], v241 offset:14336
    ds_read_b64_tr_b16 a[86:87], v241 offset:14848
    s_waitcnt vmcnt(33)
    v_mfma_f32_32x32x16_bf16 a[16:31], a[72:75], v[20:23], a[16:31]
    s_waitcnt lgkmcnt(4)
    v_mfma_f32_32x32x16_bf16 a[32:47], a[76:79], v[16:19], a[32:47]
    s_add_u32 m0, s25, 10240
    v_mfma_f32_32x32x16_bf16 a[48:63], a[76:79], v[20:23], a[48:63]
    buffer_load_dwordx4 v242, s[4:7], s26 offen lds
    buffer_load_dwordx4 v243, s[4:7], s26 offen offset:1024 lds
    s_add_u32 s26, s26, s30
    buffer_load_dwordx4 v[8:11], v244, s[8:11], s27 offen sc1
    buffer_load_dwordx4 v[12:15], v245, s[8:11], s27 offen sc1
    s_add_u32 s27, s27, 1024
    s_add_u32 s27, s27, 24576
    s_and_b32 s27, s27, 0x3ffff
    s_waitcnt vmcnt(34) lgkmcnt(2)
    v_mfma_f32_32x32x16_bf16 a[0:15], a[80:83], v[24:27], a[0:15]
    ds_read_b64_tr_b16 a[64:65], v240 offset:16384
    ds_read_b64_tr_b16 a[66:67], v240 offset:16896
    ds_read_b64_tr_b16 a[68:69], v241 offset:16384
    ds_read_b64_tr_b16 a[70:71], v241 offset:16896
    s_waitcnt vmcnt(33)
    v_mfma_f32_32x32x16_bf16 a[16:31], a[80:83], v[28:31], a[16:31]
    s_waitcnt lgkmcnt(4)
    v_mfma_f32_32x32x16_bf16 a[32:47], a[84:87], v[24:27], a[32:47]
    s_add_u32 m0, s25, 12288
    v_mfma_f32_32x32x16_bf16 a[48:63], a[84:87], v[28:31], a[48:63]
    buffer_load_dwordx4 v242, s[4:7], s26 offen lds
    buffer_load_dwordx4 v243, s[4:7], s26 offen offset:1024 lds
    s_add_u32 s26, s26, s30
    s_waitcnt vmcnt(24)
    v_readlane_b32 s44, v116, s64
    s_cmp_eq_u32 s44, s33
    s_cbranch_scc1 hok_17
    s_mov_b32 s47, 400000
hsp_17:
    global_load_dword v116, v117, s[34:35] sc1
    s_waitcnt vmcnt(0)
    v_readlane_b32 s44, v116, s64
    s_cmp_eq_u32 s44, s33
    s_cbranch_scc1 hok_17
    s_sub_u32 s47, s47, 1
    s_cmp_lg_u32 s47, 0
    s_cbranch_scc1 hsp_17
hok_17:
    s_add_u32 s64, s64, 4
    s_and_b32 s64, s64, 31
    buffer_load_dwordx4 v[16:19], v244, s[8:11], s27 offen sc1
    buffer_load_dwordx4 v[20:23], v245, s[8:11], s27 offen sc1
    s_add_u32 s27, s27, 1024
    s_waitcnt lgkmcnt(2)
    v_mfma_f32_32x32x16_bf16 a[0:15], a[64:67], v[32:35], a[0:15]
    ds_read_b64_tr_b16 a[72:73], v240 offset:18432
    ds_read_b64_tr_b16 a[74:75], v240 offset:18944
    ds_read_b64_tr_b16 a[76:77], v241 offset:18432
    ds_read_b64_tr_b16 a[78:79], v241 offset:18944
    v_mfma_f32_32x32x16_bf16 a[16:31], a[64:67], v[36:39], a[16:31]
    s_waitcnt lgkmcnt(4)
    v_mfma_f32_32x32x16_bf16 a[32:47], a[68:71], v[32:35], a[32:47]
    s_add_u32 m0, s25, 14336
    v_mfma_f32_32x32x16_bf16 a[48:63], a[68:71], v[36:39], a[48:63]
    buffer_load_dwordx4 v242, s[4:7], s26 offen lds
    buffer_load_dwordx4 v243, s[4:7], s26 offen offset:1024 lds
    s_add_u32 s26, s26, s30
    s_add_u32 s26, s26, s31
    s_and_b32 s26, s26, s65
    buffer_load_dwordx4 v[24:27], v244, s[8:11], s27 offen sc1
    buffer_load_dwordx4 v[28:31], v245, s[8:11], s27 offen sc1
    s_add_u32 s27, s27, 1024
    s_waitcnt lgkmcnt(2)
    v_mfma_f32_32x32x16_bf16 a[0:15], a[72:75], v[40:43], a[0:15]
    ds_read_b64_tr_b16 a[80:81], v240 offset:20480
    ds_read_b64_tr_b16 a[82:83], v240 offset:20992
    ds_read_b64_tr_b16 a[84:85], v241 offset:20480
    ds_read_b64_tr_b16 a[86:87], v241 offset:20992
    v_mfma_f32_32x32x16_bf16 a[16:31], a[72:75], v[44:47], a[16:31]
    s_waitcnt lgkmcnt(4)
    v_mfma_f32_32x32x16_bf16 a[32:47], a[76:79], v[40:43], a[32:47]
    s_add_u32 m0, s25, 16384
    v_mfma_f32_32x32x16_bf16 a[48:63], a[76:79], v[44:47], a[48:63]
    buffer_load_dwordx4 v242, s[4:7], s26 offen lds
    buffer_load_dwordx4 v243, s[4:7], s26 offen offset:1024 lds
    s_add_u32 s26, s26, s30
    global_load_dword v116, v117, s[34:35] sc1
    buffer_load_dwordx4 v[32:35], v244, s[8:11], s27 offen sc1
    buffer_load_dwordx4 v[36:39], v245, s[8:11], s27 offen sc1
    s_add_u32 s27, s27, 1024
    s_waitcnt vmcnt(34) lgkmcnt(2)
    v_mfma_f32_32x32x16_bf16 a[0:15], a[80:83], v[48:51], a[0:15]
    ds_read_b64_tr_b16 a[64:65], v240 offset:22528
    ds_read_b64_tr_b16 a[66:67], v240 offset:23040
    ds_read_b64_tr_b16 a[68:69], v241 offset:22528
    ds_read_b64_tr_b16 a[70:71], v241 offset:23040
    s_waitcnt vmcnt(33)
    v_mfma_f32_32x32x16_bf16 a[16:31], a[80:83], v[52:55], a[16:31]
    s_waitcnt lgkmcnt(4)
    v_mfma_f32_32x32x16_bf16 a[32:47], a[84:87], v[48:51], a[32:47]
    s_add_u32 m0, s25, 18432
    v_mfma_f32_32x32x16_bf16 a[48:63], a[84:87], v[52:55], a[48:63]
    buffer_load_dwordx4 v242, s[4:7], s26 offen lds
    buffer_load_dwordx4 v243, s[4:7], s26 offen offset:1024 lds
    s_add_u32 s26, s26, s30
    buffer_load_dwordx4 v[40:43], v244, s[8:11], s27 offen sc1
    buffer_load_dwordx4 v[44:47], v245, s[8:11], s27 offen sc1
    s_add_u32 s27, s27, 1024
    s_waitcnt vmcnt(34) lgkmcnt(2)
    v_mfma_f32_32x32x16_bf16 a[0:15], a[64:67], v[56:59], a[0:15]
    ds_read_b64_tr_b16 a[72:73], v240 offset:24576
    ds_read_b64_tr_b16 a[74:75], v240 offset:25088
    ds_read_b64_tr_b16 a[76:77], v241 offset:24576
    ds_read_b64_tr_b16 a[78:79], v241 offset:25088
    s_waitcnt vmcnt(33)
    v_mfma_f32_32x32x16_bf16 a[16:31], a[64:67], v[60:63], a[16:31]
    s_waitcnt lgkmcnt(4)
    v_mfma_f32_32x32x16_bf16 a[32:47], a[68:71], v[56:59], a[32:47]
    s_add_u32 m0, s25, 20480
    v_mfma_f32_32x32x16_bf16 a[48:63], a[68:71], v[60:63], a[48:63]
    buffer_load_dwordx4 v242, s[4:7], s26 offen lds
    buffer_load_dwordx4 v243, s[4:7], s26 offen offset:1024 lds
    s_add_u32 s26, s26, s30
    buffer_load_dwordx4 v[48:51], v244, s[8:11], s27 offen sc1
    buffer_load_dwordx4 v[52:55], v245, s[8:11], s27 offen sc1
    s_add_u32 s27, s27, 1024
    s_waitcnt vmcnt(34) lgkmcnt(2)
    v_mfma_f32_32x32x16_bf16 a[0:15], a[72:75], v[64:67], a[0:15]
    ds_read_b64_tr_b16 a[80:81], v240 offset:26624
    ds_read_b64_tr_b16 a[82:83], v240 offset:27136
    ds_read_b64_tr_b16 a[84:85], v241 offset:26624
    ds_read_b64_tr_b16 a[86:87], v241 offset:27136
    s_waitcnt vmcnt(33)
    v_mfma_f32_32x32x16_bf16 a[16:31], a[72:75], v[68:71], a[16:31]
    s_waitcnt lgkmcnt(4)
    v_mfma_f32_32x32x16_bf16 a[32:47], a[76:79], v[64:67], a[32:47]
    s_add_u32 m0, s25, 22528
    v_mfma_f32_32x32x16_bf16 a[48:63], a[76:79], v[68:71], a[48:63]
    buffer_load_dwordx4 v242, s[4:7], s26 offen lds
    buffer_load_dwordx4 v243, s[4:7], s26 offen offset:1024 lds
    s_add_u32 s26, s26, s30
    buffer_load_dwordx4 v[56:59], v244, s[8:11], s27 offen sc1
    buffer_load_dwordx4 v[60:63], v245, s[8:11], s27 offen sc1
    s_add_u32 s27, s27, 1024
    s_waitcnt vmcnt(34) lgkmcnt(2)
    v_mfma_f32_32x32x16_bf16 a[0:15], a[80:83], v[72:75], a[0:15]
    ds_read_b64_tr_b16 a[64:65], v240 offset:28672
    ds_read_b64_tr_b16 a[66:67], v240 offset:29184
    ds_read_b64_tr_b16 a[68:69], v241 offset:28672
    ds_read_b64_tr_b16 a[70:71], v241 offset:29184
    s_waitcnt vmcnt(33)
    v_mfma_f32_32x32x16_bf16 a[16:31], a[80:83], v[76:79], a[16:31]
    s_waitcnt lgkmcnt(4)
    v_mfma_f32_32x32x16_bf16 a[32:47], a[84:87], v[72:75], a[32:47]
    s_add_u32 m0, s25, 24576
    v_mfma_f32_32x32x16_bf16 a[48:63], a[84:87], v[76:79], a[48:63]
    buffer_load_dwordx4 v242, s[4:7], s26 offen lds
    buffer_load_dwordx4 v243, s[4:7], s26 offen offset:1024 lds
    s_add_u32 s26, s26, s30
    buffer_load_dwordx4 v[64:67], v244, s[8:11], s27 offen sc1
    buffer_load_dwordx4 v[68:71], v245, s[8:11], s27 offen sc1
    s_add_u32 s27, s27, 1024
    s_waitcnt vmcnt(34) lgkmcnt(2)
    v_mfma_f32_32x32x16_bf16 a[0:15], a[64:67], v[0:3], a[0:15]
    ds_read_b64_tr_b16 a[72:73], v240 offset:30720
    ds_read_b64_tr_b16 a[74:75], v240 offset:31232
    ds_read_b64_tr_b16 a[76:77], v241 offset:30720
    ds_read_b64_tr_b16 a[78:79], v241 offset:31232
    s_waitcnt vmcnt(33)
    v_mfma_f32_32x32x16_bf16 a[16:31], a[64:67], v[4:7], a[16:31]
    s_waitcnt lgkmcnt(4)
    v_mfma_f32_32x32x16_bf16 a[32:47], a[68:71], v[0:3], a[32:47]
    s_add_u32 m0, s25, 26624
    v_mfma_f32_32x32x16_bf16 a[48:63], a[68:71], v[4:7], a[48:63]
    buffer_load_dwordx4 v242, s[4:7], s26 offen lds
    buffer_load_dwordx4 v243, s[4:7], s26 offen offset:1024 lds
    s_add_u32 s26, s26, s30
    buffer_load_dwordx4 v[72:75], v244, s[8:11], s27 offen sc1
    buffer_load_dwordx4 v[76:79], v245, s[8:11], s27 offen sc1
    s_add_u32 s27, s27, 1024
    s_add_u32 s27, s27, 24576
    s_and_b32 s27, s27, 0x3ffff
    s_waitcnt vmcnt(34) lgkmcnt(2)
    v_mfma_f32_32x32x16_bf16 a[0:15], a[72:75], v[8:11], a[0:15]
    ds_read_b64_tr_b16 a[80:81], v240 offset:0
    ds_read_b64_tr_b16 a[82:83], v240 offset:512
    ds_read_b64_tr_b16 a[84:85], v241 offset:0
    ds_read_b64_tr_b16 a[86:87], v241 offset:512
    s_waitcnt vmcnt(33)
    v_mfma_f32_32x32x16_bf16 a[16:31], a[72:75], v[12:15], a[16:31]
    s_waitcnt lgkmcnt(4)
    v_mfma_f32_32x32x16_bf16 a[32:47], a[76:79], v[8:11], a[32:47]
    s_add_u32 m0, s25, 28672
    v_mfma_f32_32x32x16_bf16 a[48:63], a[76:79], v[12:15], a[48:63]
    buffer_load_dwordx4 v242, s[4:7], s26 offen lds
    buffer_load_dwordx4 v243, s[4:7], s26 offen offset:1024 lds
    s_add_u32 s26, s26, s30
    s_waitcnt vmcnt(24)
    v_readlane_b32 s44, v116, s64
    s_cmp_eq_u32 s44, s33
    s_cbranch_scc1 hok_18
    s_mov_b32 s47, 400000
hsp_18:
    global_load_dword v116, v117, s[34:35] sc1
    s_waitcnt vmcnt(0)
    v_readlane_b32 s44, v116, s64
    s_cmp_eq_u32 s44, s33
    s_cbranch_scc1 hok_18
    s_sub_u32 s47, s47, 1
    s_cmp_lg_u32 s47, 0
    s_cbranch_scc1 hsp_18
hok_18:
    s_add_u32 s64, s64, 4
    s_and_b32 s64, s64, 31
    buffer_load_dwordx4 v[0:3], v244, s[8:11], s27 offen sc1
    buffer_load_dwordx4 v[4:7], v245, s[8:11], s27 offen sc1
    s_add_u32 s27, s27, 1024
    s_waitcnt lgkmcnt(2)
    v_mfma_f32_32x32x16_bf16 a[0:15], a[80:83], v[16:19], a[0:15]
    ds_read_b64_tr_b16 a[64:65], v240 offset:2048
    ds_read_b64_tr_b16 a[66:67], v240 offset:2560
    ds_read_b64_tr_b16 a[68:69], v241 offset:2048
    ds_read_b64_tr_b16 a[70:71], v241 offset:2560
    v_mfma_f32_32x32x16_bf16 a[16:31], a[80:83], v[20:23], a[16:31]
    s_waitcnt lgkmcnt(4)
    v_mfma_f32_32x32x16_bf16 a[32:47], a[84:87], v[16:19], a[32:47]
    s_add_u32 m0, s25, 30720
    v_mfma_f32_32x32x16_bf16 a[48:63], a[84:87], v[20:23], a[48:63]
    buffer_load_dwordx4 v242, s[4:7], s26 offen lds
    buffer_load_dwordx4 v243, s[4:7], s26 offen offset:1024 lds
    s_add_u32 s26, s26, s30
    s_add_u32 s26, s26, s31
    s_and_b32 s26, s26, s65
    buffer_load_dwordx4 v[8:11], v244, s[8:11], s27 offen sc1
    buffer_load_dwordx4 v[12:15], v245, s[8:11], s27 offen sc1
    s_add_u32 s27, s27, 1024
    s_waitcnt lgkmcnt(2)
    v_mfma_f32_32x32x16_bf16 a[0:15], a[64:67], v[24:27], a[0:15]
    ds_read_b64_tr_b16 a[72:73], v240 offset:4096
    ds_read_b64_tr_b16 a[74:75], v240 offset:4608
    ds_read_b64_tr_b16 a[76:77], v241 offset:4096
    ds_read_b64_tr_b16 a[78:79], v241 offset:4608
    v_mfma_f32_32x32x16_bf16 a[16:31], a[64:67], v[28:31], a[16:31]
    s_waitcnt lgkmcnt(4)
    v_mfma_f32_32x32x16_bf16 a[32:47], a[68:71], v[24:27], a[32:47]
    s_add_u32 m0, s25, 0
    v_mfma_f32_32x32x16_bf16 a[48:63], a[68:71], v[28:31], a[48:63]
    buffer_load_dwordx4 v242, s[4:7], s26 offen lds
    buffer_load_dwordx4 v243, s[4:7], s26 offen offset:1024 lds
    s_add_u32 s26, s26, s30
    global_load_dword v116, v117, s[34:35] sc1
    buffer_load_dwordx4 v[16:19], v244, s[8:11], s27 offen sc1
    buffer_load_dwordx4 v[20:23], v245, s[8:11], s27 offen sc1
    s_add_u32 s27, s27, 1024
    s_waitcnt vmcnt(34) lgkmcnt(2)
    v_mfma_f32_32x32x16_bf16 a[0:15], a[72:75], v[32:35], a[0:15]
    ds_read_b64_tr_b16 a[80:81], v240 offset:6144
    ds_read_b64_tr_b16 a[82:83], v240 offset:6656
    ds_read_b64_tr_b16 a[84:85], v241 offset:6144
    ds_read_b64_tr_b16 a[86:87], v241 offset:6656
    s_waitcnt vmcnt(33)
    v_mfma_f32_32x32x16_bf16 a[16:31], a[72:75], v[36:39], a[16:31]
    s_waitcnt lgkmcnt(4)
    v_mfma_f32_32x32x16_bf16 a[32:47], a[76:79], v[32:35], a[32:47]
    s_add_u32 m0, s25, 2048
    v_mfma_f32_32x32x16_bf16 a[48:63], a[76:79], v[36:39], a[48:63]
    buffer_load_dwordx4 v242, s[4:7], s26 offen lds
    buffer_load_dwordx4 v243, s[4:7], s26 offen offset:1024 lds
    s_add_u32 s26, s26, s30
    buffer_load_dwordx4 v[24:27], v244, s[8:11], s27 offen sc1
    buffer_load_dwordx4 v[28:31], v245, s[8:11], s27 offen sc1
    s_add_u32 s27, s27, 1024
    s_waitcnt vmcnt(34) lgkmcnt(2)
    v_mfma_f32_32x32x16_bf16 a[0:15], a[80:83], v[40:43], a[0:15]
    ds_read_b64_tr_b16 a[64:65], v240 offset:8192
    ds_read_b64_tr_b16 a[66:67], v240 offset:8704
    ds_read_b64_tr_b16 a[68:69], v241 offset:8192
    ds_read_b64_tr_b16 a[70:71], v241 offset:8704
    s_waitcnt vmcnt(33)
    v_mfma_f32_32x32x16_bf16 a[16:31], a[80:83], v[44:47], a[16:31]
    s_waitcnt lgkmcnt(4)
    v_mfma_f32_32x32x16_bf16 a[32:47], a[84:87], v[40:43], a[32:47]
    s_add_u32 m0, s25, 4096
    v_mfma_f32_32x32x16_bf16 a[48:63], a[84:87], v[44:47], a[48:63]
    buffer_load_dwordx4 v242, s[4:7], s26 offen lds
    buffer_load_dwordx4 v243, s[4:7], s26 offen offset:1024 lds
    s_add_u32 s26, s26, s30
    buffer_load_dwordx4 v[32:35], v244, s[8:11], s27 offen sc1
    buffer_load_dwordx4 v[36:39], v245, s[8:11], s27 offen sc1
    s_add_u32 s27, s27, 1024
    s_waitcnt vmcnt(34) lgkmcnt(2)
    v_mfma_f32_32x32x16_bf16 a[0:15], a[64:67], v[48:51], a[0:15]
    ds_read_b64_tr_b16 a[72:73], v240 offset:10240
    ds_read_b64_tr_b16 a[74:75], v240 offset:10752
    ds_read_b64_tr_b16 a[76:77], v241 offset:10240
    ds_read_b64_tr_b16 a[78:79], v241 offset:10752
    s_waitcnt vmcnt(33)
    v_mfma_f32_32x32x16_bf16 a[16:31], a[64:67], v[52:55], a[16:31]
    s_waitcnt lgkmcnt(4)
    v_mfma_f32_32x32x16_bf16 a[32:47], a[68:71], v[48:51], a[32:47]
    s_add_u32 m0, s25, 6144
    v_mfma_f32_32x32x16_bf16 a[48:63], a[68:71], v[52:55], a[48:63]
    buffer_load_dwordx4 v242, s[4:7], s26 offen lds
    buffer_load_dwordx4 v243, s[4:7], s26 offen offset:1024 lds
    s_add_u32 s26, s26, s30
    buffer_load_dwordx4 v[40:43], v244, s[8:11], s27 offen sc1
    buffer_load_dwordx4 v[44:47], v245, s[8:11], s27 offen sc1
    s_add_u32 s27, s27, 1024
    s_waitcnt vmcnt(34) lgkmcnt(2)
    v_mfma_f32_32x32x16_bf16 a[0:15], a[72:75], v[56:59], a[0:15]
    ds_read_b64_tr_b16 a[80:81], v240 offset:12288
    ds_read_b64_tr_b16 a[82:83], v240 offset:12800
    ds_read_b64_tr_b16 a[84:85], v241 offset:12288
    ds_read_b64_tr_b16 a[86:87], v241 offset:12800
    s_waitcnt vmcnt(33)
    v_mfma_f32_32x32x16_bf16 a[16:31], a[72:75], v[60:63], a[16:31]
    s_waitcnt lgkmcnt(4)
    v_mfma_f32_32x32x16_bf16 a[32:47], a[76:79], v[56:59], a[32:47]
    s_add_u32 m0, s25, 8192
    v_mfma_f32_32x32x16_bf16 a[48:63], a[76:79], v[60:63], a[48:63]
    buffer_load_dwordx4 v242, s[4:7], s26 offen lds
    buffer_load_dwordx4 v243, s[4:7], s26 offen offset:1024 lds
    s_add_u32 s26, s26, s30
    buffer_load_dwordx4 v[48:51], v244, s[8:11], s27 offen sc1
    buffer_load_dwordx4 v[52:55], v245, s[8:11], s27 offen sc1
    s_add_u32 s27, s27, 1024
    s_waitcnt vmcnt(34) lgkmcnt(2)
    v_mfma_f32_32x32x16_bf16 a[0:15], a[80:83], v[64:67], a[0:15]
    ds_read_b64_tr_b16 a[64:65], v240 offset:14336
    ds_read_b64_tr_b16 a[66:67], v240 offset:14848
    ds_read_b64_tr_b16 a[68:69], v241 offset:14336
    ds_read_b64_tr_b16 a[70:71], v241 offset:14848
    s_waitcnt vmcnt(33)
    v_mfma_f32_32x32x16_bf16 a[16:31], a[80:83], v[68:71], a[16:31]
    s_waitcnt lgkmcnt(4)
    v_mfma_f32_32x32x16_bf16 a[32:47], a[84:87], v[64:67], a[32:47]
    s_add_u32 m0, s25, 10240
    v_mfma_f32_32x32x16_bf16 a[48:63], a[84:87], v[68:71], a[48:63]
    buffer_load_dwordx4 v242, s[4:7], s26 offen lds
    buffer_load_dwordx4 v243, s[4:7], s26 offen offset:1024 lds
    s_add_u32 s26, s26, s30
    buffer_load_dwordx4 v[56:59], v244, s[8:11], s27 offen sc1
    buffer_load_dwordx4 v[60:63], v245, s[8:11], s27 offen sc1
    s_add_u32 s27, s27, 1024
    s_add_u32 s27, s27, 24576
    s_and_b32 s27, s27, 0x3ffff
    s_waitcnt vmcnt(34) lgkmcnt(2)
    v_mfma_f32_32x32x16_bf16 a[0:15], a[64:67], v[72:75], a[0:15]
    ds_read_b64_tr_b16 a[72:73], v240 offset:16384
    ds_read_b64_tr_b16 a[74:75], v240 offset:16896
    ds_read_b64_tr_b16 a[76:77], v241 offset:16384
    ds_read_b64_tr_b16 a[78:79], v241 offset:16896
    s_waitcnt vmcnt(33)
    v_mfma_f32_32x32x16_bf16 a[16:31], a[64:67], v[76:79], a[16:31]
    s_waitcnt lgkmcnt(4)
    v_mfma_f32_32x32x16_bf16 a[32:47], a[68:71], v[72:75], a[32:47]
    s_add_u32 m0, s25, 12288
    v_mfma_f32_32x32x16_bf16 a[48:63], a[68:71], v[76:79], a[48:63]
    buffer_load_dwordx4 v242, s[4:7], s26 offen lds
    buffer_load_dwordx4 v243, s[4:7], s26 offen offset:1024 lds
    s_add_u32 s26, s26, s30
    s_waitcnt vmcnt(24)
    v_readlane_b32 s44, v116, s64
    s_cmp_eq_u32 s44, s33
    s_cbranch_scc1 hok_19
    s_mov_b32 s47, 400000
hsp_19:
    global_load_dword v116, v117, s[34:35] sc1
    s_waitcnt vmcnt(0)
    v_readlane_b32 s44, v116, s64
    s_cmp_eq_u32 s44, s33
    s_cbranch_scc1 hok_19
    s_sub_u32 s47, s47, 1
    s_cmp_lg_u32 s47, 0
    s_cbranch_scc1 hsp_19
hok_19:
    s_add_u32 s64, s64, 4
    s_and_b32 s64, s64, 31
    buffer_load_dwordx4 v[64:67], v244, s[8:11], s27 offen sc1
    buffer_load_dwordx4 v[68:71], v245, s[8:11], s27 offen sc1
    s_add_u32 s27, s27, 1024
    s_waitcnt lgkmcnt(2)
    v_mfma_f32_32x32x16_bf16 a[0:15], a[72:75], v[0:3], a[0:15]
    ds_read_b64_tr_b16 a[80:81], v240 offset:18432
    ds_read_b64_tr_b16 a[82:83], v240 offset:18944
    ds_read_b64_tr_b16 a[84:85], v241 offset:18432
    ds_read_b64_tr_b16 a[86:87], v241 offset:18944
    v_mfma_f32_32x32x16_bf16 a[16:31], a[72:75], v[4:7], a[16:31]
    s_waitcnt lgkmcnt(4)
    v_mfma_f32_32x32x16_bf16 a[32:47], a[76:79], v[0:3], a[32:47]
    s_add_u32 m0, s25, 14336
    v_mfma_f32_32x32x16_bf16 a[48:63], a[76:79], v[4:7], a[48:63]
    buffer_load_dwordx4 v242, s[4:7], s26 offen lds
    buffer_load_dwordx4 v243, s[4:7], s26 offen offset:1024 lds
    s_add_u32 s26, s26, s30
    s_add_u32 s26, s26, s31
    s_and_b32 s26, s26, s65
    buffer_load_dwordx4 v[72:75], v244, s[8:11], s27 offen sc1
    buffer_load_dwordx4 v[76:79], v245, s[8:11], s27 offen sc1
    s_add_u32 s27, s27, 1024
    s_waitcnt lgkmcnt(2)
    v_mfma_f32_32x32x16_bf16 a[0:15], a[80:83], v[8:11], a[0:15]
    ds_read_b64_tr_b16 a[64:65], v240 offset:20480
    ds_read_b64_tr_b16 a[66:67], v240 offset:20992
    ds_read_b64_tr_b16 a[68:69], v241 offset:20480
    ds_read_b64_tr_b16 a[70:71], v241 offset:20992
    v_mfma_f32_32x32x16_bf16 a[16:31], a[80:83], v[12:15], a[16:31]
    s_waitcnt lgkmcnt(4)
    v_mfma_f32_32x32x16_bf16 a[32:47], a[84:87], v[8:11], a[32:47]
    s_add_u32 m0, s25, 16384
    v_mfma_f32_32x32x16_bf16 a[48:63], a[84:87], v[12:15], a[48:63]
    buffer_load_dwordx4 v242, s[4:7], s26 offen lds
    buffer_load_dwordx4 v243, s[4:7], s26 offen offset:1024 lds
    s_add_u32 s26, s26, s30
    global_load_dword v116, v117, s[34:35] sc1
    buffer_load_dwordx4 v[0:3], v244, s[8:11], s27 offen sc1
    buffer_load_dwordx4 v[4:7], v245, s[8:11], s27 offen sc1
    s_add_u32 s27, s27, 1024
    s_waitcnt vmcnt(34) lgkmcnt(2)
    v_mfma_f32_32x32x16_bf16 a[0:15], a[64:67], v[16:19], a[0:15]
    ds_read_b64_tr_b16 a[72:73], v240 offset:22528
    ds_read_b64_tr_b16 a[74:75], v240 offset:23040
    ds_read_b64_tr_b16 a[76:77], v241 offset:22528
    ds_read_b64_tr_b16 a[78:79], v241 offset:23040
    s_waitcnt vmcnt(33)
    v_mfma_f32_32x32x16_bf16 a[16:31], a[64:67], v[20:23], a[16:31]
    s_waitcnt lgkmcnt(4)
    v_mfma_f32_32x32x16_bf16 a[32:47], a[68:71], v[16:19], a[32:47]
    s_add_u32 m0, s25, 18432
    v_mfma_f32_32x32x16_bf16 a[48:63], a[68:71], v[20:23], a[48:63]
    buffer_load_dwordx4 v242, s[4:7], s26 offen lds
    buffer_load_dwordx4 v243, s[4:7], s26 offen offset:1024 lds
    s_add_u32 s26, s26, s30
    buffer_load_dwordx4 v[8:11], v244, s[8:11], s27 offen sc1
    buffer_load_dwordx4 v[12:15], v245, s[8:11], s27 offen sc1
    s_add_u32 s27, s27, 1024
    s_waitcnt vmcnt(34) lgkmcnt(2)
    v_mfma_f32_32x32x16_bf16 a[0:15], a[72:75], v[24:27], a[0:15]
    ds_read_b64_tr_b16 a[80:81], v240 offset:24576
    ds_read_b64_tr_b16 a[82:83], v240 offset:25088
    ds_read_b64_tr_b16 a[84:85], v241 offset:24576
    ds_read_b64_tr_b16 a[86:87], v241 offset:25088
    s_waitcnt vmcnt(33)
    v_mfma_f32_32x32x16_bf16 a[16:31], a[72:75], v[28:31], a[16:31]
    s_waitcnt lgkmcnt(4)
    v_mfma_f32_32x32x16_bf16 a[32:47], a[76:79], v[24:27], a[32:47]
    s_add_u32 m0, s25, 20480
    v_mfma_f32_32x32x16_bf16 a[48:63], a[76:79], v[28:31], a[48:63]
    buffer_load_dwordx4 v242, s[4:7], s26 offen lds
    buffer_load_dwordx4 v243, s[4:7], s26 offen offset:1024 lds
    s_add_u32 s26, s26, s30
    buffer_load_dwordx4 v[16:19], v244, s[8:11], s27 offen sc1
    buffer_load_dwordx4 v[20:23], v245, s[8:11], s27 offen sc1
    s_add_u32 s27, s27, 1024
    s_waitcnt vmcnt(34) lgkmcnt(2)
    v_mfma_f32_32x32x16_bf16 a[0:15], a[80:83], v[32:35], a[0:15]
    ds_read_b64_tr_b16 a[64:65], v240 offset:26624
    ds_read_b64_tr_b16 a[66:67], v240 offset:27136
    ds_read_b64_tr_b16 a[68:69], v241 offset:26624
    ds_read_b64_tr_b16 a[70:71], v241 offset:27136
    s_waitcnt vmcnt(33)
    v_mfma_f32_32x32x16_bf16 a[16:31], a[80:83], v[36:39], a[16:31]
    s_waitcnt lgkmcnt(4)
    v_mfma_f32_32x32x16_bf16 a[32:47], a[84:87], v[32:35], a[32:47]
    s_add_u32 m0, s25, 22528
    v_mfma_f32_32x32x16_bf16 a[48:63], a[84:87], v[36:39], a[48:63]
    buffer_load_dwordx4 v242, s[4:7], s26 offen lds
    buffer_load_dwordx4 v243, s[4:7], s26 offen offset:1024 lds
    s_add_u32 s26, s26, s30
    buffer_load_dwordx4 v[24:27], v244, s[8:11], s27 offen sc1
    buffer_load_dwordx4 v[28:31], v245, s[8:11], s27 offen sc1
    s_add_u32 s27, s27, 1024
    s_waitcnt vmcnt(34) lgkmcnt(2)
    v_mfma_f32_32x32x16_bf16 a[0:15], a[64:67], v[40:43], a[0:15]
    ds_read_b64_tr_b16 a[72:73], v240 offset:28672
    ds_read_b64_tr_b16 a[74:75], v240 offset:29184
    ds_read_b64_tr_b16 a[76:77], v241 offset:28672
    ds_read_b64_tr_b16 a[78:79], v241 offset:29184
    s_waitcnt vmcnt(33)
    v_mfma_f32_32x32x16_bf16 a[16:31], a[64:67], v[44:47], a[16:31]
    s_waitcnt lgkmcnt(4)
    v_mfma_f32_32x32x16_bf16 a[32:47], a[68:71], v[40:43], a[32:47]
    s_add_u32 m0, s25, 24576
    v_mfma_f32_32x32x16_bf16 a[48:63], a[68:71], v[44:47], a[48:63]
    buffer_load_dwordx4 v242, s[4:7], s26 offen lds
    buffer_load_dwordx4 v243, s[4:7], s26 offen offset:1024 lds
    s_add_u32 s26, s26, s30
    buffer_load_dwordx4 v[32:35], v244, s[8:11], s27 offen sc1
    buffer_load_dwordx4 v[36:39], v245, s[8:11], s27 offen sc1
    s_add_u32 s27, s27, 1024
    s_waitcnt vmcnt(34) lgkmcnt(2)
    v_mfma_f32_32x32x16_bf16 a[0:15], a[72:75], v[48:51], a[0:15]
    ds_read_b64_tr_b16 a[80:81], v240 offset:30720
    ds_read_b64_tr_b16 a[82:83], v240 offset:31232
    ds_read_b64_tr_b16 a[84:85], v241 offset:30720
    ds_read_b64_tr_b16 a[86:87], v241 offset:31232
    s_waitcnt vmcnt(33)
    v_mfma_f32_32x32x16_bf16 a[16:31], a[72:75], v[52:55], a[16:31]
    s_waitcnt lgkmcnt(4)
    v_mfma_f32_32x32x16_bf16 a[32:47], a[76:79], v[48:51], a[32:47]
    s_add_u32 m0, s25, 26624
    v_mfma_f32_32x32x16_bf16 a[48:63], a[76:79], v[52:55], a[48:63]
    buffer_load_dwordx4 v242, s[4:7], s26 offen lds
    buffer_load_dwordx4 v243, s[4:7], s26 offen offset:1024 lds
    s_add_u32 s26, s26, s30
    buffer_load_dwordx4 v[40:43], v244, s[8:11], s27 offen sc1
    buffer_load_dwordx4 v[44:47], v245, s[8:11], s27 offen sc1
    s_add_u32 s27, s27, 1024
    s_add_u32 s27, s27, 24576
    s_and_b32 s27, s27, 0x3ffff
    s_waitcnt vmcnt(34) lgkmcnt(2)
    v_mfma_f32_32x32x16_bf16 a[0:15], a[80:83], v[56:59], a[0:15]
    ds_read_b64_tr_b16 a[64:65], v240 offset:0
    ds_read_b64_tr_b16 a[66:67], v240 offset:512
    ds_read_b64_tr_b16 a[68:69], v241 offset:0
    ds_read_b64_tr_b16 a[70:71], v241 offset:512
    s_waitcnt vmcnt(33)
    v_mfma_f32_32x32x16_bf16 a[16:31], a[80:83], v[60:63], a[16:31]
    s_waitcnt lgkmcnt(4)
    v_mfma_f32_32x32x16_bf16 a[32:47], a[84:87], v[56:59], a[32:47]
    s_add_u32 m0, s25, 28672
    v_mfma_f32_32x32x16_bf16 a[48:63], a[84:87], v[60:63], a[48:63]
    buffer_load_dwordx4 v242, s[4:7], s26 offen lds
    buffer_load_dwordx4 v243, s[4:7], s26 offen offset:1024 lds
    s_add_u32 s26, s26, s30
    s_waitcnt vmcnt(24)
    v_readlane_b32 s44, v116, s64
    s_cmp_eq_u32 s44, s33
    s_cbranch_scc1 hok_20
    s_mov_b32 s47, 400000
hsp_20:
    global_load_dword v116, v117, s[34:35] sc1
    s_waitcnt vmcnt(0)
    v_readlane_b32 s44, v116, s64
    s_cmp_eq_u32 s44, s33
    s_cbranch_scc1 hok_20
    s_sub_u32 s47, s47, 1
    s_cmp_lg_u32 s47, 0
    s_cbranch_scc1 hsp_20
hok_20:
    s_add_u32 s64, s64, 4
    s_and_b32 s64, s64, 31
    buffer_load_dwordx4 v[48:51], v244, s[8:11], s27 offen sc1
    buffer_load_dwordx4 v[52:55], v245, s[8:11], s27 offen sc1
    s_add_u32 s27, s27, 1024
    s_waitcnt lgkmcnt(2)
    v_mfma_f32_32x32x16_bf16 a[0:15], a[64:67], v[64:67], a[0:15]
    ds_read_b64_tr_b16 a[72:73], v240 offset:2048
    ds_read_b64_tr_b16 a[74:75], v240 offset:2560
    ds_read_b64_tr_b16 a[76:77], v241 offset:2048
    ds_read_b64_tr_b16 a[78:79], v241 offset:2560
    v_mfma_f32_32x32x16_bf16 a[16:31], a[64:67], v[68:71], a[16:31]
    s_waitcnt lgkmcnt(4)
    v_mfma_f32_32x32x16_bf16 a[32:47], a[68:71], v[64:67], a[32:47]
    s_add_u32 m0, s25, 30720
    v_mfma_f32_32x32x16_bf16 a[48:63], a[68:71], v[68:71], a[48:63]
    buffer_load_dwordx4 v242, s[4:7], s26 offen lds
    buffer_load_dwordx4 v243, s[4:7], s26 offen offset:1024 lds
    s_add_u32 s26, s26, s30
    s_add_u32 s26, s26, s31
    s_and_b32 s26, s26, s65
    buffer_load_dwordx4 v[56:59], v244, s[8:11], s27 offen sc1
    buffer_load_dwordx4 v[60:63], v245, s[8:11], s27 offen sc1
    s_add_u32 s27, s27, 1024
    s_waitcnt lgkmcnt(2)
    v_mfma_f32_32x32x16_bf16 a[0:15], a[72:75], v[72:75], a[0:15]
    ds_read_b64_tr_b16 a[80:81], v240 offset:4096
    ds_read_b64_tr_b16 a[82:83], v240 offset:4608
    ds_read_b64_tr_b16 a[84:85], v241 offset:4096
    ds_read_b64_tr_b16 a[86:87], v241 offset:4608
    v_mfma_f32_32x32x16_bf16 a[16:31], a[72:75], v[76:79], a[16:31]
    s_waitcnt lgkmcnt(4)
    v_mfma_f32_32x32x16_bf16 a[32:47], a[76:79], v[72:75], a[32:47]
    v_mfma_f32_32x32x16_bf16 a[48:63], a[76:79], v[76:79], a[48:63]
    buffer_load_dwordx4 v[64:67], v244, s[8:11], s27 offen sc1
    buffer_load_dwordx4 v[68:71], v245, s[8:11], s27 offen sc1
    s_add_u32 s27, s27, 1024
    s_waitcnt vmcnt(31) lgkmcnt(2)
    v_mfma_f32_32x32x16_bf16 a[0:15], a[80:83], v[0:3], a[0:15]
    ds_read_b64_tr_b16 a[64:65], v240 offset:6144
    ds_read_b64_tr_b16 a[66:67], v240 offset:6656
    ds_read_b64_tr_b16 a[68:69], v241 offset:6144
    ds_read_b64_tr_b16 a[70:71], v241 offset:6656
    s_waitcnt vmcnt(30)
    v_mfma_f32_32x32x16_bf16 a[16:31], a[80:83], v[4:7], a[16:31]
    s_waitcnt lgkmcnt(4)
    v_mfma_f32_32x32x16_bf16 a[32:47], a[84:87], v[0:3], a[32:47]
    v_mfma_f32_32x32x16_bf16 a[48:63], a[84:87], v[4:7], a[48:63]
    buffer_load_dwordx4 v[72:75], v244, s[8:11], s27 offen sc1
    buffer_load_dwordx4 v[76:79], v245, s[8:11], s27 offen sc1
    s_add_u32 s27, s27, 1024
    s_waitcnt vmcnt(29) lgkmcnt(2)
    v_mfma_f32_32x32x16_bf16 a[0:15], a[64:67], v[8:11], a[0:15]
    ds_read_b64_tr_b16 a[72:73], v240 offset:8192
    ds_read_b64_tr_b16 a[74:75], v240 offset:8704
    ds_read_b64_tr_b16 a[76:77], v241 offset:8192
    ds_read_b64_tr_b16 a[78:79], v241 offset:8704
    s_waitcnt vmcnt(28)
    v_mfma_f32_32x32x16_bf16 a[16:31], a[64:67], v[12:15], a[16:31]
    s_waitcnt lgkmcnt(4)
    v_mfma_f32_32x32x16_bf16 a[32:47], a[68:71], v[8:11], a[32:47]
    v_mfma_f32_32x32x16_bf16 a[48:63], a[68:71], v[12:15], a[48:63]
    buffer_load_dwordx4 v[0:3], v244, s[8:11], s27 offen sc1
    buffer_load_dwordx4 v[4:7], v245, s[8:11], s27 offen sc1
    s_add_u32 s27, s27, 1024
    s_waitcnt vmcnt(27) lgkmcnt(2)
    v_mfma_f32_32x32x16_bf16 a[0:15], a[72:75], v[16:19], a[0:15]
    ds_read_b64_tr_b16 a[80:81], v240 offset:10240
    ds_read_b64_tr_b16 a[82:83], v240 offset:10752
    ds_read_b64_tr_b16 a[84:85], v241 offset:10240
    ds_read_b64_tr_b16 a[86:87], v241 offset:10752
    s_waitcnt vmcnt(26)
    v_mfma_f32_32x32x16_bf16 a[16:31], a[72:75], v[20:23], a[16:31]
    s_waitcnt lgkmcnt(4)
    v_mfma_f32_32x32x16_bf16 a[32:47], a[76:79], v[16:19], a[32:47]
    v_mfma_f32_32x32x16_bf16 a[48:63], a[76:79], v[20:23], a[48:63]
    buffer_load_dwordx4 v[8:11], v244, s[8:11], s27 offen sc1
    buffer_load_dwordx4 v[12:15], v245, s[8:11], s27 offen sc1
    s_add_u32 s27, s27, 1024
    s_waitcnt vmcnt(25) lgkmcnt(2)
    v_mfma_f32_32x32x16_bf16 a[0:15], a[80:83], v[24:27], a[0:15]
    ds_read_b64_tr_b16 a[64:65], v240 offset:12288
    ds_read_b64_tr_b16 a[66:67], v240 offset:12800
    ds_read_b64_tr_b16 a[68:69], v241 offset:12288
    ds_read_b64_tr_b16 a[70:71], v241 offset:12800
    s_waitcnt vmcnt(24)
    v_mfma_f32_32x32x16_bf16 a[16:31], a[80:83], v[28:31], a[16:31]
    s_waitcnt lgkmcnt(4)
    v_mfma_f32_32x32x16_bf16 a[32:47], a[84:87], v[24:27], a[32:47]
    v_mfma_f32_32x32x16_bf16 a[48:63], a[84:87], v[28:31], a[48:63]
    buffer_load_dwordx4 v[16:19], v244, s[8:11], s27 offen sc1
    buffer_load_dwordx4 v[20:23], v245, s[8:11], s27 offen sc1
    s_add_u32 s27, s27, 1024
    s_waitcnt vmcnt(23) lgkmcnt(2)
    v_mfma_f32_32x32x16_bf16 a[0:15], a[64:67], v[32:35], a[0:15]
    ds_read_b64_tr_b16 a[72:73], v240 offset:14336
    ds_read_b64_tr_b16 a[74:75], v240 offset:14848
    ds_read_b64_tr_b16 a[76:77], v241 offset:14336
    ds_read_b64_tr_b16 a[78:79], v241 offset:14848
    s_waitcnt vmcnt(22)
    v_mfma_f32_32x32x16_bf16 a[16:31], a[64:67], v[36:39], a[16:31]
    s_waitcnt lgkmcnt(4)
    v_mfma_f32_32x32x16_bf16 a[32:47], a[68:71], v[32:35], a[32:47]
    v_mfma_f32_32x32x16_bf16 a[48:63], a[68:71], v[36:39], a[48:63]
    buffer_load_dwordx4 v[24:27], v244, s[8:11], s27 offen sc1
    buffer_load_dwordx4 v[28:31], v245, s[8:11], s27 offen sc1
    s_add_u32 s27, s27, 1024
    s_add_u32 s27, s27, 24576
    s_and_b32 s27, s27, 0x3ffff
    s_waitcnt vmcnt(21) lgkmcnt(2)
    v_mfma_f32_32x32x16_bf16 a[0:15], a[72:75], v[40:43], a[0:15]
    ds_read_b64_tr_b16 a[80:81], v240 offset:16384
    ds_read_b64_tr_b16 a[82:83], v240 offset:16896
    ds_read_b64_tr_b16 a[84:85], v241 offset:16384
    ds_read_b64_tr_b16 a[86:87], v241 offset:16896
    s_waitcnt vmcnt(20)
    v_mfma_f32_32x32x16_bf16 a[16:31], a[72:75], v[44:47], a[16:31]
    s_waitcnt lgkmcnt(4)
    v_mfma_f32_32x32x16_bf16 a[32:47], a[76:79], v[40:43], a[32:47]
    v_mfma_f32_32x32x16_bf16 a[48:63], a[76:79], v[44:47], a[48:63]
    s_waitcnt vmcnt(17) lgkmcnt(2)
    v_mfma_f32_32x32x16_bf16 a[0:15], a[80:83], v[48:51], a[0:15]
    ds_read_b64_tr_b16 a[64:65], v240 offset:18432
    ds_read_b64_tr_b16 a[66:67], v240 offset:18944
    ds_read_b64_tr_b16 a[68:69], v241 offset:18432
    ds_read_b64_tr_b16 a[70:71], v241 offset:18944
    s_waitcnt vmcnt(16)
    v_mfma_f32_32x32x16_bf16 a[16:31], a[80:83], v[52:55], a[16:31]
    s_waitcnt lgkmcnt(4)
    v_mfma_f32_32x32x16_bf16 a[32:47], a[84:87], v[48:51], a[32:47]
    v_mfma_f32_32x32x16_bf16 a[48:63], a[84:87], v[52:55], a[48:63]
    s_waitcnt vmcnt(13) lgkmcnt(2)
    v_mfma_f32_32x32x16_bf16 a[0:15], a[64:67], v[56:59], a[0:15]
    ds_read_b64_tr_b16 a[72:73], v240 offset:20480
    ds_read_b64_tr_b16 a[74:75], v240 offset:20992
    ds_read_b64_tr_b16 a[76:77], v241 offset:20480
    ds_read_b64_tr_b16 a[78:79], v241 offset:20992
    s_waitcnt vmcnt(12)
    v_mfma_f32_32x32x16_bf16 a[16:31], a[64:67], v[60:63], a[16:31]
    s_waitcnt lgkmcnt(4)
    v_mfma_f32_32x32x16_bf16 a[32:47], a[68:71], v[56:59], a[32:47]
    v_mfma_f32_32x32x16_bf16 a[48:63], a[68:71], v[60:63], a[48:63]
    s_waitcnt vmcnt(11) lgkmcnt(2)
    v_mfma_f32_32x32x16_bf16 a[0:15], a[72:75], v[64:67], a[0:15]
    ds_read_b64_tr_b16 a[80:81], v240 offset:22528
    ds_read_b64_tr_b16 a[82:83], v240 offset:23040
    ds_read_b64_tr_b16 a[84:85], v241 offset:22528
    ds_read_b64_tr_b16 a[86:87], v241 offset:23040
    s_waitcnt vmcnt(10)
    v_mfma_f32_32x32x16_bf16 a[16:31], a[72:75], v[68:71], a[16:31]
    s_waitcnt lgkmcnt(4)
    v_mfma_f32_32x32x16_bf16 a[32:47], a[76:79], v[64:67], a[32:47]
    v_mfma_f32_32x32x16_bf16 a[48:63], a[76:79], v[68:71], a[48:63]
    s_waitcnt vmcnt(9) lgkmcnt(2)
    v_mfma_f32_32x32x16_bf16 a[0:15], a[80:83], v[72:75], a[0:15]
    ds_read_b64_tr_b16 a[64:65], v240 offset:24576
    ds_read_b64_tr_b16 a[66:67], v240 offset:25088
    ds_read_b64_tr_b16 a[68:69], v241 offset:24576
    ds_read_b64_tr_b16 a[70:71], v241 offset:25088
    s_waitcnt vmcnt(8)
    v_mfma_f32_32x32x16_bf16 a[16:31], a[80:83], v[76:79], a[16:31]
    s_waitcnt lgkmcnt(4)
    v_mfma_f32_32x32x16_bf16 a[32:47], a[84:87], v[72:75], a[32:47]
    v_mfma_f32_32x32x16_bf16 a[48:63], a[84:87], v[76:79], a[48:63]
    s_waitcnt vmcnt(7) lgkmcnt(2)
    v_mfma_f32_32x32x16_bf16 a[0:15], a[64:67], v[0:3], a[0:15]
    ds_read_b64_tr_b16 a[72:73], v240 offset:26624
    ds_read_b64_tr_b16 a[74:75], v240 offset:27136
    ds_read_b64_tr_b16 a[76:77], v241 offset:26624
    ds_read_b64_tr_b16 a[78:79], v241 offset:27136
    s_waitcnt vmcnt(6)
    v_mfma_f32_32x32x16_bf16 a[16:31], a[64:67], v[4:7], a[16:31]
    s_waitcnt lgkmcnt(4)
    v_mfma_f32_32x32x16_bf16 a[32:47], a[68:71], v[0:3], a[32:47]
    v_mfma_f32_32x32x16_bf16 a[48:63], a[68:71], v[4:7], a[48:63]
    s_waitcnt vmcnt(5) lgkmcnt(2)
    v_mfma_f32_32x32x16_bf16 a[0:15], a[72:75], v[8:11], a[0:15]
    ds_read_b64_tr_b16 a[80:81], v240 offset:28672
    ds_read_b64_tr_b16 a[82:83], v240 offset:29184
    ds_read_b64_tr_b16 a[84:85], v241 offset:28672
    ds_read_b64_tr_b16 a[86:87], v241 offset:29184
    s_waitcnt vmcnt(4)
    v_mfma_f32_32x32x16_bf16 a[16:31], a[72:75], v[12:15], a[16:31]
    s_waitcnt lgkmcnt(4)
    v_mfma_f32_32x32x16_bf16 a[32:47], a[76:79], v[8:11], a[32:47]
    v_mfma_f32_32x32x16_bf16 a[48:63], a[76:79], v[12:15], a[48:63]
    s_waitcnt vmcnt(3) lgkmcnt(2)
    v_mfma_f32_32x32x16_bf16 a[0:15], a[80:83], v[16:19], a[0:15]
    ds_read_b64_tr_b16 a[64:65], v240 offset:30720
    ds_read_b64_tr_b16 a[66:67], v240 offset:31232
    ds_read_b64_tr_b16 a[68:69], v241 offset:30720
    ds_read_b64_tr_b16 a[70:71], v241 offset:31232
    s_waitcnt vmcnt(2)
    v_mfma_f32_32x32x16_bf16 a[16:31], a[80:83], v[20:23], a[16:31]
    s_waitcnt lgkmcnt(4)
    v_mfma_f32_32x32x16_bf16 a[32:47], a[84:87], v[16:19], a[32:47]
    v_mfma_f32_32x32x16_bf16 a[48:63], a[84:87], v[20:23], a[48:63]
    s_waitcnt vmcnt(1) lgkmcnt(2)
    v_mfma_f32_32x32x16_bf16 a[0:15], a[64:67], v[24:27], a[0:15]
    s_waitcnt vmcnt(0)
    v_mfma_f32_32x32x16_bf16 a[16:31], a[64:67], v[28:31], a[16:31]
    s_waitcnt lgkmcnt(0)
    v_mfma_f32_32x32x16_bf16 a[32:47], a[68:71], v[24:27], a[32:47]
    v_mfma_f32_32x32x16_bf16 a[48:63], a[68:71], v[28:31], a[48:63]
    s_nop 15
    s_barrier
    v_mbcnt_lo_u32_b32 v2, -1, 0
    v_mbcnt_hi_u32_b32 v2, -1, v2
    s_lshl_b32 s22, s24, 14
    v_lshlrev_b32 v3, 4, v2
    v_add_u32 v4, s22, v3
    ds_write_b128 v4, a[0:3] offset:0
    ds_write_b128 v4, a[4:7] offset:1024
    ds_write_b128 v4, a[8:11] offset:2048
    ds_write_b128 v4, a[12:15] offset:3072
    ds_write_b128 v4, a[16:19] offset:4096
    ds_write_b128 v4, a[20:23] offset:5120
    ds_write_b128 v4, a[24:27] offset:6144
    ds_write_b128 v4, a[28:31] offset:7168
    ds_write_b128 v4, a[32:35] offset:8192
    ds_write_b128 v4, a[36:39] offset:9216
    ds_write_b128 v4, a[40:43] offset:10240
    ds_write_b128 v4, a[44:47] offset:11264
    ds_write_b128 v4, a[48:51] offset:12288
    ds_write_b128 v4, a[52:55] offset:13312
    ds_write_b128 v4, a[56:59] offset:14336
    ds_write_b128 v4, a[60:63] offset:15360
    s_waitcnt lgkmcnt(0)
    s_barrier
    s_lshl_b32 s22, s24, 12
    v_add_u32 v4, s22, v3
    ds_read_b128 v[32:35], v4 offset:0
    ds_read_b128 v[36:39], v4 offset:1024
    ds_read_b128 v[40:43], v4 offset:2048
    ds_read_b128 v[44:47], v4 offset:3072
    ds_read_b128 v[48:51], v4 offset:16384
    ds_read_b128 v[52:55], v4 offset:17408
    ds_read_b128 v[56:59], v4 offset:18432
    ds_read_b128 v[60:63], v4 offset:19456
    ds_read_b128 v[64:67], v4 offset:32768
    ds_read_b128 v[68:71], v4 offset:33792
    ds_read_b128 v[72:75], v4 offset:34816
    ds_read_b128 v[76:79], v4 offset:35840
    ds_read_b128 v[80:83], v4 offset:49152
    ds_read_b128 v[84:87], v4 offset:50176
    ds_read_b128 v[88:91], v4 offset:51200
    ds_read_b128 v[92:95], v4 offset:52224
    s_lshr_b32 s22, s24, 1
    s_and_b32 s23, s24, 1
    s_lshl_b32 s26, s50, 1
    s_add_u32 s26, s26, s23
    s_lshl_b32 s27, s51, 1
    s_add_u32 s27, s27, s22
    v_and_b32 v5, 31, v2
    v_lshrrev_b32 v6, 5, v2
    s_lshl_b32 s28, s22, 7
    s_add_u32 s28, s28, 154624
    v_lshlrev_b32 v7, 5, v6
    v_add_u32 v7, s28, v7
    ds_read_b128 v[100:103], v7 offset:0
    ds_read_b128 v[104:107], v7 offset:16
    ds_read_b128 v[108:111], v7 offset:64
    ds_read_b128 v[112:115], v7 offset:80
    s_lshl_b32 s28, s26, 15
    s_lshl_b32 s29, s27, 11
    s_add_u32 s28, s28, s29
    s_add_u32 s28, s28, 20971520
    v_add_u32 v8, s28, v3
    s_lshl_b32 s28, s26, 15
    s_lshl_b32 s29, s27, 6
    s_add_u32 s28, s28, s29
    v_lshlrev_b32 v9, 10, v5
    v_lshl_add_u32 v9, v6, 4, v9
    v_add_u32 v9, s28, v9
    s_waitcnt lgkmcnt(15)
    v_add_f32 v32, v32, v48
    s_waitcnt lgkmcnt(7)
    v_add_f32 v64, v64, v80
    v_add_f32 v33, v33, v49
    v_add_f32 v65, v65, v81
    v_add_f32 v34, v34, v50
    v_add_f32 v66, v66, v82
    v_add_f32 v35, v35, v51
    v_add_f32 v67, v67, v83
    v_add_f32 v36, v36, v52
    s_waitcnt lgkmcnt(6)
    v_add_f32 v68, v68, v84
    v_add_f32 v37, v37, v53
    v_add_f32 v69, v69, v85
    v_add_f32 v38, v38, v54
    v_add_f32 v70, v70, v86
    v_add_f32 v39, v39, v55
    v_add_f32 v71, v71, v87
    v_add_f32 v40, v40, v56
    s_waitcnt lgkmcnt(5)
    v_add_f32 v72, v72, v88
    v_add_f32 v41, v41, v57
    v_add_f32 v73, v73, v89
    v_add_f32 v42, v42, v58
    v_add_f32 v74, v74, v90
    v_add_f32 v43, v43, v59
    v_add_f32 v75, v75, v91
    v_add_f32 v44, v44, v60
    s_waitcnt lgkmcnt(4)
    v_add_f32 v76, v76, v92
    v_add_f32 v45, v45, v61
    v_add_f32 v77, v77, v93
    v_add_f32 v46, v46, v62
    v_add_f32 v78, v78, v94
    v_add_f32 v47, v47, v63
    v_add_f32 v79, v79, v95
    v_add_f32 v32, v32, v64
    v_add_f32 v33, v33, v65
    v_add_f32 v34, v34, v66
    v_add_f32 v35, v35, v67
    v_add_f32 v36, v36, v68
    v_add_f32 v37, v37, v69
    v_add_f32 v38, v38, v70
    v_add_f32 v39, v39, v71
    v_add_f32 v40, v40, v72
    v_add_f32 v41, v41, v73
    v_add_f32 v42, v42, v74
    v_add_f32 v43, v43, v75
    v_add_f32 v44, v44, v76
    v_add_f32 v45, v45, v77
    v_add_f32 v46, v46, v78
    v_add_f32 v47, v47, v79
    v_cvt_pk_bf16_f32 v48, v32, v33
    v_lshlrev_b32 v49, 16, v48
    v_and_b32 v50, 0xffff0000, v48
    s_waitcnt lgkmcnt(3)
    v_mul_f32 v49, v49, v100
    v_mul_f32 v50, v50, v101
    v_cvt_pk_bf16_f32 v48, v49, v50
    v_lshlrev_b32 v49, 16, v48
    v_and_b32 v50, 0xffff0000, v48
    v_lshlrev_b32 v51, 16, v120
    v_and_b32 v52, 0xffff0000, v120
    v_add_f32 v49, v49, v51
    v_add_f32 v50, v50, v52
    v_cvt_pk_bf16_f32 v64, v49, v50
    v_cvt_pk_bf16_f32 v48, v34, v35
    v_lshlrev_b32 v49, 16, v48
    v_and_b32 v50, 0xffff0000, v48
    v_mul_f32 v49, v49, v102
    v_mul_f32 v50, v50, v103
    v_cvt_pk_bf16_f32 v48, v49, v50
    v_lshlrev_b32 v49, 16, v48
    v_and_b32 v50, 0xffff0000, v48
    v_lshlrev_b32 v51, 16, v121
    v_and_b32 v52, 0xffff0000, v121
    v_add_f32 v49, v49, v51
    v_add_f32 v50, v50, v52
    v_cvt_pk_bf16_f32 v65, v49, v50
    v_cvt_pk_bf16_f32 v48, v36, v37
    v_lshlrev_b32 v49, 16, v48
    v_and_b32 v50, 0xffff0000, v48
    s_waitcnt lgkmcnt(2)
    v_mul_f32 v49, v49, v104
    v_mul_f32 v50, v50, v105
    v_cvt_pk_bf16_f32 v48, v49, v50
    v_lshlrev_b32 v49, 16, v48
    v_and_b32 v50, 0xffff0000, v48
    v_lshlrev_b32 v51, 16, v122
    v_and_b32 v52, 0xffff0000, v122
    v_add_f32 v49, v49, v51
    v_add_f32 v50, v50, v52
    v_cvt_pk_bf16_f32 v66, v49, v50
    v_cvt_pk_bf16_f32 v48, v38, v39
    v_lshlrev_b32 v49, 16, v48
    v_and_b32 v50, 0xffff0000, v48
    v_mul_f32 v49, v49, v106
    v_mul_f32 v50, v50, v107
    v_cvt_pk_bf16_f32 v48, v49, v50
    v_lshlrev_b32 v49, 16, v48
    v_and_b32 v50, 0xffff0000, v48
    v_lshlrev_b32 v51, 16, v123
    v_and_b32 v52, 0xffff0000, v123
    v_add_f32 v49, v49, v51
    v_add_f32 v50, v50, v52
    v_cvt_pk_bf16_f32 v67, v49, v50
    v_cvt_pk_bf16_f32 v48, v40, v41
    v_lshlrev_b32 v49, 16, v48
    v_and_b32 v50, 0xffff0000, v48
    s_waitcnt lgkmcnt(1)
    v_mul_f32 v49, v49, v108
    v_mul_f32 v50, v50, v109
    v_cvt_pk_bf16_f32 v48, v49, v50
    v_lshlrev_b32 v49, 16, v48
    v_and_b32 v50, 0xffff0000, v48
    v_lshlrev_b32 v51, 16, v124
    v_and_b32 v52, 0xffff0000, v124
    v_add_f32 v49, v49, v51
    v_add_f32 v50, v50, v52
    v_cvt_pk_bf16_f32 v68, v49, v50
    v_cvt_pk_bf16_f32 v48, v42, v43
    v_lshlrev_b32 v49, 16, v48
    v_and_b32 v50, 0xffff0000, v48
    v_mul_f32 v49, v49, v110
    v_mul_f32 v50, v50, v111
    v_cvt_pk_bf16_f32 v48, v49, v50
    v_lshlrev_b32 v49, 16, v48
    v_and_b32 v50, 0xffff0000, v48
    v_lshlrev_b32 v51, 16, v125
    v_and_b32 v52, 0xffff0000, v125
    v_add_f32 v49, v49, v51
    v_add_f32 v50, v50, v52
    v_cvt_pk_bf16_f32 v69, v49, v50
    v_cvt_pk_bf16_f32 v48, v44, v45
    v_lshlrev_b32 v49, 16, v48
    v_and_b32 v50, 0xffff0000, v48
    s_waitcnt lgkmcnt(0)
    v_mul_f32 v49, v49, v112
    v_mul_f32 v50, v50, v113
    v_cvt_pk_bf16_f32 v48, v49, v50
    v_lshlrev_b32 v49, 16, v48
    v_and_b32 v50, 0xffff0000, v48
    v_lshlrev_b32 v51, 16, v126
    v_and_b32 v52, 0xffff0000, v126
    v_add_f32 v49, v49, v51
    v_add_f32 v50, v50, v52
    v_cvt_pk_bf16_f32 v70, v49, v50
    v_cvt_pk_bf16_f32 v48, v46, v47
    v_lshlrev_b32 v49, 16, v48
    v_and_b32 v50, 0xffff0000, v48
    v_mul_f32 v49, v49, v114
    v_mul_f32 v50, v50, v115
    v_cvt_pk_bf16_f32 v48, v49, v50
    v_lshlrev_b32 v49, 16, v48
    v_and_b32 v50, 0xffff0000, v48
    v_lshlrev_b32 v51, 16, v127
    v_and_b32 v52, 0xffff0000, v127
    v_add_f32 v49, v49, v51
    v_add_f32 v50, v50, v52
    v_cvt_pk_bf16_f32 v71, v49, v50
    v_accvgpr_write_b32 a240, v64
    v_accvgpr_write_b32 a241, v65
    v_accvgpr_write_b32 a242, v66
    v_accvgpr_write_b32 a243, v67
    v_accvgpr_write_b32 a244, v68
    v_accvgpr_write_b32 a245, v69
    v_accvgpr_write_b32 a246, v70
    v_accvgpr_write_b32 a247, v71
    ds_read_b128 v[100:103], v7 offset:512
    ds_read_b128 v[104:107], v7 offset:528
    ds_read_b128 v[108:111], v7 offset:576
    ds_read_b128 v[112:115], v7 offset:592
    v_lshlrev_b32 v32, 16, v64
    v_and_b32 v33, 0xffff0000, v64
    v_lshlrev_b32 v34, 16, v65
    v_and_b32 v35, 0xffff0000, v65
    v_lshlrev_b32 v36, 16, v66
    v_and_b32 v37, 0xffff0000, v66
    v_lshlrev_b32 v38, 16, v67
    v_and_b32 v39, 0xffff0000, v67
    v_lshlrev_b32 v40, 16, v68
    v_and_b32 v41, 0xffff0000, v68
    v_lshlrev_b32 v42, 16, v69
    v_and_b32 v43, 0xffff0000, v69
    v_lshlrev_b32 v44, 16, v70
    v_and_b32 v45, 0xffff0000, v70
    v_lshlrev_b32 v46, 16, v71
    v_and_b32 v47, 0xffff0000, v71
    s_waitcnt lgkmcnt(3)
    v_mul_f32 v80, v32, v100
    v_mul_f32 v81, v33, v101
    v_mul_f32 v82, v34, v102
    v_mul_f32 v83, v35, v103
    s_waitcnt lgkmcnt(2)
    v_mul_f32 v84, v36, v104
    v_mul_f32 v85, v37, v105
    v_mul_f32 v86, v38, v106
    v_mul_f32 v87, v39, v107
    s_waitcnt lgkmcnt(1)
    v_mul_f32 v88, v40, v108
    v_mul_f32 v89, v41, v109
    v_mul_f32 v90, v42, v110
    v_mul_f32 v91, v43, v111
    s_waitcnt lgkmcnt(0)
    v_mul_f32 v92, v44, v112
    v_mul_f32 v93, v45, v113
    v_mul_f32 v94, v46, v114
    v_mul_f32 v95, v47, v115
    v_cvt_pk_bf16_f32 v72, v80, v81
    v_cvt_pk_bf16_f32 v73, v82, v83
    v_cvt_pk_bf16_f32 v74, v84, v85
    v_cvt_pk_bf16_f32 v75, v86, v87
    v_cvt_pk_bf16_f32 v76, v88, v89
    v_cvt_pk_bf16_f32 v77, v90, v91
    v_cvt_pk_bf16_f32 v78, v92, v93
    v_cvt_pk_bf16_f32 v79, v94, v95
    global_store_dwordx4 v8, v[72:75], s[34:35] offset:0 sc1
    global_store_dwordx4 v8, v[76:79], s[34:35] offset:1024 sc1
    v_add_f32 v48, v32, v33
    v_add_f32 v48, v48, v34
    v_add_f32 v48, v48, v35
    v_add_f32 v48, v48, v36
    v_add_f32 v48, v48, v37
    v_add_f32 v48, v48, v38
    v_add_f32 v48, v48, v39
    v_add_f32 v48, v48, v40
    v_add_f32 v48, v48, v41
    v_add_f32 v48, v48, v42
    v_add_f32 v48, v48, v43
    v_add_f32 v48, v48, v44
    v_add_f32 v48, v48, v45
    v_add_f32 v48, v48, v46
    v_add_f32 v48, v48, v47
    v_mov_b32 v49, v48
    s_nop 1
    v_permlane32_swap_b32 v49, v48
    s_nop 1
    v_add_f32 v48, v48, v49
    v_mul_f32 v48, 0x3d000000, v48
    v_sub_f32 v32, v32, v48
    v_sub_f32 v33, v33, v48
    v_sub_f32 v34, v34, v48
    v_sub_f32 v35, v35, v48
    v_sub_f32 v36, v36, v48
    v_sub_f32 v37, v37, v48
    v_sub_f32 v38, v38, v48
    v_sub_f32 v39, v39, v48
    v_sub_f32 v40, v40, v48
    v_sub_f32 v41, v41, v48
    v_sub_f32 v42, v42, v48
    v_sub_f32 v43, v43, v48
    v_sub_f32 v44, v44, v48
    v_sub_f32 v45, v45, v48
    v_sub_f32 v46, v46, v48
    v_sub_f32 v47, v47, v48
    v_mul_f32 v49, v32, v32
    v_fmac_f32 v49, v33, v33
    v_fmac_f32 v49, v34, v34
    v_fmac_f32 v49, v35, v35
    v_fmac_f32 v49, v36, v36
    v_fmac_f32 v49, v37, v37
    v_fmac_f32 v49, v38, v38
    v_fmac_f32 v49, v39, v39
    v_fmac_f32 v49, v40, v40
    v_fmac_f32 v49, v41, v41
    v_fmac_f32 v49, v42, v42
    v_fmac_f32 v49, v43, v43
    v_fmac_f32 v49, v44, v44
    v_fmac_f32 v49, v45, v45
    v_fmac_f32 v49, v46, v46
    v_fmac_f32 v49, v47, v47
    v_mov_b32 v50, v49
    s_nop 1
    v_permlane32_swap_b32 v50, v49
    s_nop 1
    v_add_f32 v49, v49, v50
    s_lshl_b32 s28, s26, 8
    s_lshl_b32 s29, s27, 14
    s_add_u32 s28, s28, s29
    s_add_u32 s28, s28, 24117248
    v_lshlrev_b32 v9, 3, v5
    v_add_u32 v9, s28, v9
    s_mov_b32 exec_hi, 0
    global_store_dwordx2 v9, v[48:49], s[34:35] sc1
    s_mov_b32 exec_hi, -1
    v_mbcnt_lo_u32_b32 v28, -1, 0
    v_mbcnt_hi_u32_b32 v28, -1, v28
    s_and_b32 s40, s24, 1
    s_mul_i32 s40, s40, 448
    s_mov_b32 s41, 0x12492493
    s_mov_b32 s42, 3584
    s_add_u32 s43, s40, 0
    v_add_u32 v29, s43, v28
    v_mul_hi_u32 v30, v29, s41
    v_mul_u32_u24 v31, 14, v30
    v_sub_u32 v31, v29, v31
    v_mul_lo_u32 v30, v30, s42
    v_lshl_add_u32 v16, v31, 4, v30
    s_add_u32 s43, s40, 64
    v_add_u32 v29, s43, v28
    v_mul_hi_u32 v30, v29, s41
    v_mul_u32_u24 v31, 14, v30
    v_sub_u32 v31, v29, v31
    v_mul_lo_u32 v30, v30, s42
    v_lshl_add_u32 v17, v31, 4, v30
    v_subrev_u32 v17, 1024, v17
    s_add_u32 s43, s40, 128
    v_add_u32 v29, s43, v28
    v_mul_hi_u32 v30, v29, s41
    v_mul_u32_u24 v31, 14, v30
    v_sub_u32 v31, v29, v31
    v_mul_lo_u32 v30, v30, s42
    v_lshl_add_u32 v18, v31, 4, v30
    v_subrev_u32 v18, 2048, v18
    s_add_u32 s43, s40, 192
    v_add_u32 v29, s43, v28
    v_mul_hi_u32 v30, v29, s41
    v_mul_u32_u24 v31, 14, v30
    v_sub_u32 v31, v29, v31
    v_mul_lo_u32 v30, v30, s42
    v_lshl_add_u32 v19, v31, 4, v30
    v_subrev_u32 v19, 3072, v19
    s_add_u32 s43, s40, 256
    v_add_u32 v29, s43, v28
    v_mul_hi_u32 v30, v29, s41
    v_mul_u32_u24 v31, 14, v30
    v_sub_u32 v31, v29, v31
    v_mul_lo_u32 v30, v30, s42
    v_lshl_add_u32 v20, v31, 4, v30
    s_add_u32 s43, s40, 320
    v_add_u32 v29, s43, v28
    v_mul_hi_u32 v30, v29, s41
    v_mul_u32_u24 v31, 14, v30
    v_sub_u32 v31, v29, v31
    v_mul_lo_u32 v30, v30, s42
    v_lshl_add_u32 v21, v31, 4, v30
    v_subrev_u32 v21, 1024, v21
    s_add_u32 s43, s40, 384
    v_add_u32 v29, s43, v28
    v_mul_hi_u32 v30, v29, s41
    v_mul_u32_u24 v31, 14, v30
    v_sub_u32 v31, v29, v31
    v_mul_lo_u32 v30, v30, s42
    v_lshl_add_u32 v22, v31, 4, v30
    v_subrev_u32 v22, 2048, v22
    s_mul_i32 s60, s24, 7168
    s_cmp_ge_u32 s24, 2
    s_cselect_b32 s40, 128, 0
    s_add_u32 s60, s60, s40
    s_mov_b32 s61, 0
    s_lshr_b32 s22, s50, 1
    s_lshl_b32 s22, s22, 7
    s_and_b32 s23, s50, 1
    s_lshl_b32 s23, s23, 3
    s_add_u32 s23, s23, s51
    s_lshl_b32 s23, s23, 2
    s_add_u32 s22, s22, s23
    s_add_u32 s45, s22, 0x3001000
    v_mbcnt_lo_u32_b32 v58, -1, 0
    v_mbcnt_hi_u32_b32 v58, -1, v58
    v_and_b32 v58, 15, v58
    v_lshlrev_b32 v58, 2, v58
    s_lshl_b32 s22, s63, 7
    s_add_u32 s22, s22, 0x3001000
    v_add_u32 v58, s22, v58
    s_waitcnt lgkmcnt(0)
    s_waitcnt vmcnt(0)
    s_barrier
    s_cmp_lg_u32 s24, 0
    s_cbranch_scc1 fskip_x1_21
    v_mov_b32 v56, s33
    v_mov_b32 v57, s45
    s_mov_b64 exec, 1
    global_store_dword v57, v56, s[34:35] sc1
    s_mov_b64 exec, -1
fskip_x1_21:
    s_add_u32 m0, s60, 65536
    s_nop 0
    buffer_load_dwordx4 v16, s[16:19], s61 offen offset:0 lds
    buffer_load_dwordx4 v17, s[16:19], s61 offen offset:1024 lds
    buffer_load_dwordx4 v18, s[16:19], s61 offen offset:2048 lds
    buffer_load_dwordx4 v19, s[16:19], s61 offen offset:3072 lds
    s_add_u32 m0, s60, 69632
    s_nop 0
    buffer_load_dwordx4 v20, s[16:19], s61 offen offset:0 lds
    buffer_load_dwordx4 v21, s[16:19], s61 offen offset:1024 lds
    buffer_load_dwordx4 v22, s[16:19], s61 offen offset:2048 lds
    s_add_u32 s61, s61, 229376
    s_add_u32 m0, s60, 94464
    s_nop 0
    buffer_load_dwordx4 v16, s[16:19], s61 offen offset:0 lds
    buffer_load_dwordx4 v17, s[16:19], s61 offen offset:1024 lds
    buffer_load_dwordx4 v18, s[16:19], s61 offen offset:2048 lds
    buffer_load_dwordx4 v19, s[16:19], s61 offen offset:3072 lds
    s_add_u32 m0, s60, 98560
    s_nop 0
    buffer_load_dwordx4 v20, s[16:19], s61 offen offset:0 lds
    buffer_load_dwordx4 v21, s[16:19], s61 offen offset:1024 lds
    buffer_load_dwordx4 v22, s[16:19], s61 offen offset:2048 lds
    s_add_u32 s61, s61, 229376
    s_add_u32 m0, s60, 123392
    s_nop 0
    buffer_load_dwordx4 v16, s[16:19], s61 offen offset:0 lds
    buffer_load_dwordx4 v17, s[16:19], s61 offen offset:1024 lds
    buffer_load_dwordx4 v18, s[16:19], s61 offen offset:2048 lds
    buffer_load_dwordx4 v19, s[16:19], s61 offen offset:3072 lds
    s_add_u32 m0, s60, 127488
    s_nop 0
    buffer_load_dwordx4 v20, s[16:19], s61 offen offset:0 lds
    buffer_load_dwordx4 v21, s[16:19], s61 offen offset:1024 lds
    buffer_load_dwordx4 v22, s[16:19], s61 offen offset:2048 lds
    s_add_u32 s61, s61, 229376
    v_mbcnt_lo_u32_b32 v82, -1, 0
    v_mbcnt_hi_u32_b32 v82, -1, v82
    v_lshlrev_b32 v82, 2, v82
    v_add_u32 v82, 0x3004000, v82
    v_min_u32 v83, 0x300407c, v82
    s_cmp_lg_u32 s24, 0
    s_cbranch_scc1 pskip_uw_22
    s_mov_b32 s47, 400000
ploop_uw_22:
    global_load_dword v84, v82, s[34:35] offset:0 sc1
    global_load_dword v85, v82, s[34:35] offset:256 sc1
    global_load_dword v86, v82, s[34:35] offset:512 sc1
    global_load_dword v87, v83, s[34:35] offset:768 sc1
    s_waitcnt vmcnt(0)
    v_cmp_ne_u32 vcc, s33, v84
    v_cmp_ne_u32 s[42:43], s33, v85
    s_or_b64 vcc, vcc, s[42:43]
    v_cmp_ne_u32 s[42:43], s33, v86
    s_or_b64 vcc, vcc, s[42:43]
    v_cmp_ne_u32 s[42:43], s33, v87
    s_or_b64 vcc, vcc, s[42:43]
    s_cmp_eq_u64 vcc, 0
    s_cbranch_scc1 pskip_uw_22
    s_sub_u32 s47, s47, 1
    s_cmp_lg_u32 s47, 0
    s_cbranch_scc1 ploop_uw_22
pskip_uw_22:
    s_barrier
    v_mbcnt_lo_u32_b32 v2, -1, 0
    v_mbcnt_hi_u32_b32 v2, -1, v2
    s_lshl_b32 s22, s24, 6
    v_add_u32 v3, s22, v2
    v_cmp_le_u32 vcc, 112, v3
    s_nop 1
    v_cndmask_b32 v4, 0, 1, vcc
    v_mul_u32_u24 v5, 112, v4
    v_sub_u32 v5, v3, v5
    s_mul_i32 s22, s62, 448
    s_add_u32 s22, s22, 524288
    v_mul_u32_u24 v6, 7168, v4
    v_lshl_add_u32 v6, v5, 2, v6
    v_add_u32 v6, s22, v6
    v_add_u32 v7, 0, v6
    global_load_dword v40, v7, s[34:35] sc1
    v_add_u32 v7, 14336, v6
    global_load_dword v41, v7, s[34:35] sc1
    v_add_u32 v7, 28672, v6
    global_load_dword v42, v7, s[34:35] sc1
    v_add_u32 v7, 43008, v6
    global_load_dword v43, v7, s[34:35] sc1
    v_add_u32 v7, 57344, v6
    global_load_dword v44, v7, s[34:35] sc1
    v_add_u32 v7, 71680, v6
    global_load_dword v45, v7, s[34:35] sc1
    v_add_u32 v7, 86016, v6
    global_load_dword v46, v7, s[34:35] sc1
    v_add_u32 v7, 100352, v6
    global_load_dword v47, v7, s[34:35] sc1
    v_mul_u32_u24 v7, 896, v4
    v_lshl_add_u32 v7, v5, 2, v7
    v_add_u32 v36, 152320, v7
    s_lshl_b32 s22, s63, 2
    s_add_u32 s64, s22, s24
    s_lshl_b32 s22, s64, 15
    s_add_u32 s22, s22, 0x1400000
    s_add_u32 s20, s34, s22
    s_addc_u32 s21, s35, 0
    s_and_b32 s21, s21, 0xffff
    v_and_b32 v4, 31, v2
    v_lshlrev_b32 v4, 3, v4
    s_lshl_b32 s40, s64, 8
    s_add_u32 s40, s40, 0x1700000
    v_add_u32 v23, s40, v4
    v_lshlrev_b32 v27, 4, v2
    v_lshrrev_b32 v4, 4, v2
    v_and_b32 v5, 15, v2
    v_lshrrev_b32 v6, 2, v5
    v_and_b32 v5, 3, v5
    v_lshrrev_b32 v7, 1, v4
    v_and_b32 v4, 1, v4
    v_lshl_add_u32 v7, v7, 3, v6
    v_mul_u32_u24 v7, 224, v7
    v_mul_u32_u24 v4, 14464, v4
    v_add_u32 v7, v7, v4
    v_and_b32 v4, 1, v5
    v_lshlrev_b32 v4, 1, v4
    v_lshrrev_b32 v5, 1, v5
    v_or_b32 v4, v4, v5
    v_lshl_add_u32 v7, v4, 3, v7
    v_add_u32 v8, 65536, v7
    v_add_u32 v9, 94464, v7
    v_add_u32 v10, 123392, v7
    v_add_u32 v11, 0, v7
    v_add_u32 v12, 28928, v7
    v_lshrrev_b32 v4, 5, v2
    v_lshlrev_b32 v4, 5, v4
    v_add_u32 v24, 152320, v4
    s_waitcnt vmcnt(5)
    v_add_f32 v32, v40, v42
    s_waitcnt vmcnt(1)
    v_add_f32 v34, v44, v46
    v_add_f32 v32, v32, v34
    v_add_f32 v33, v41, v43
    s_waitcnt vmcnt(0)
    v_add_f32 v35, v45, v47
    v_add_f32 v33, v33, v35
    v_cmp_gt_u32 vcc, 224, v3
    s_and_saveexec_b64 s[40:41], vcc
    ds_write_b32 v36, v32
    ds_write_b32 v36, v33 offset:448
    s_mov_b64 exec, s[40:41]
    s_load_dwordx2 s[4:5], s[0:1], 64
    v_mbcnt_lo_u32_b32 v13, -1, 0
    v_mbcnt_hi_u32_b32 v13, -1, v13
    s_and_b32 s22, s50, 3
    v_lshlrev_b32 v13, 2, v13
    v_add_u32 v13, s22, v13
    v_lshlrev_b32 v13, 10, v13
    s_waitcnt lgkmcnt(0)
    s_mul_i32 s22, s24, 458752
    s_lshl_b32 s23, s51, 7
    s_add_u32 s22, s22, s23
    s_add_u32 s4, s4, s22
    s_addc_u32 s5, s5, 0
    s_and_b32 s5, s5, 0xffff
    s_sub_u32 s6, 0x1c0000, s22
    s_mov_b32 s7, 0x00020000
    s_waitcnt vmcnt(0) lgkmcnt(0)
    s_cmp_lg_u32 s24, 0
    s_cbranch_scc1 pskip_x1_23
    s_mov_b32 s47, 400000
ploop_x1_23:
    global_load_dword v56, v58, s[34:35] offset:0 sc1
    s_waitcnt vmcnt(0)
    v_cmp_ne_u32 vcc, s33, v56
    s_cmp_eq_u64 vcc, 0
    s_cbranch_scc1 pskip_x1_23
    s_sub_u32 s47, s47, 1
    s_cmp_lg_u32 s47, 0
    s_cbranch_scc1 ploop_x1_23
pskip_x1_23:
    s_barrier
    s_mov_b32 s22, 32768
    s_mov_b32 s23, 0x00020000
    s_mov_b32 s43, 0
    buffer_load_dwordx4 a[56:59], v27, s[20:23], s43 offen offset:0 sc1
    s_mov_b32 s43, 0
    buffer_load_dwordx4 a[60:63], v27, s[20:23], s43 offen offset:1024 sc1
    s_mov_b32 s43, 0
    buffer_load_dwordx4 a[64:67], v27, s[20:23], s43 offen offset:2048 sc1
    s_mov_b32 s43, 0
    buffer_load_dwordx4 a[68:71], v27, s[20:23], s43 offen offset:3072 sc1
    s_mov_b32 s43, 4096
    buffer_load_dwordx4 a[72:75], v27, s[20:23], s43 offen offset:0 sc1
    s_mov_b32 s43, 4096
    buffer_load_dwordx4 a[76:79], v27, s[20:23], s43 offen offset:1024 sc1
    s_mov_b32 s43, 4096
    buffer_load_dwordx4 a[80:83], v27, s[20:23], s43 offen offset:2048 sc1
    s_mov_b32 s43, 4096
    buffer_load_dwordx4 a[84:87], v27, s[20:23], s43 offen offset:3072 sc1
    ds_read_b64_tr_b16 a[0:1], v8 offset:0
    ds_read_b64_tr_b16 a[2:3], v8 offset:896
    ds_read_b64_tr_b16 a[4:5], v8 offset:32
    ds_read_b64_tr_b16 a[6:7], v8 offset:928
    ds_read_b64_tr_b16 a[8:9], v8 offset:64
    ds_read_b64_tr_b16 a[10:11], v8 offset:960
    ds_read_b64_tr_b16 a[12:13], v8 offset:96
    ds_read_b64_tr_b16 a[14:15], v8 offset:992
    ds_read_b64_tr_b16 a[16:17], v8 offset:128
    ds_read_b64_tr_b16 a[18:19], v8 offset:1024
    s_add_u32 m0, s60, 0
    s_nop 0
    s_waitcnt vmcnt(7) lgkmcnt(8)
    v_mfma_f32_32x32x16_bf16 v[128:143], a[0:3], a[56:59], 0
    buffer_load_dwordx4 v16, s[16:19], s61 offen offset:0 lds
    ds_read_b64_tr_b16 a[20:21], v8 offset:160
    ds_read_b64_tr_b16 a[22:23], v8 offset:1056
    s_waitcnt lgkmcnt(8)
    v_mfma_f32_32x32x16_bf16 v[144:159], a[4:7], a[56:59], 0
    buffer_load_dwordx4 v17, s[16:19], s61 offen offset:1024 lds
    ds_read_b64_tr_b16 a[24:25], v8 offset:192
    ds_read_b64_tr_b16 a[26:27], v8 offset:1088
    s_waitcnt lgkmcnt(6)
    v_mfma_f32_32x32x16_bf16 v[160:175], a[8:11], a[56:59], 0
    buffer_load_dwordx4 v18, s[16:19], s61 offen offset:2048 lds
    ds_read_b64_tr_b16 a[28:29], v8 offset:3584
    ds_read_b64_tr_b16 a[30:31], v8 offset:4480
    v_mfma_f32_32x32x16_bf16 v[176:191], a[12:15], a[56:59], 0
    buffer_load_dwordx4 v19, s[16:19], s61 offen offset:3072 lds
    ds_read_b64_tr_b16 a[32:33], v8 offset:3616
    ds_read_b64_tr_b16 a[34:35], v8 offset:4512
    s_add_u32 m0, s60, 4096
    s_mov_b32 s43, 8192
    s_waitcnt lgkmcnt(6)
    v_mfma_f32_32x32x16_bf16 v[192:207], a[16:19], a[56:59], 0
    buffer_load_dwordx4 v20, s[16:19], s61 offen offset:0 lds
    ds_read_b64_tr_b16 a[36:37], v8 offset:3648
    ds_read_b64_tr_b16 a[38:39], v8 offset:4544
    buffer_load_dwordx4 a[88:91], v27, s[20:23], s43 offen offset:0 sc1
    v_mfma_f32_32x32x16_bf16 v[208:223], a[20:23], a[56:59], 0
    buffer_load_dwordx4 v21, s[16:19], s61 offen offset:1024 lds
    ds_read_b64_tr_b16 a[40:41], v8 offset:3680
    ds_read_b64_tr_b16 a[42:43], v8 offset:4576
    s_waitcnt lgkmcnt(6)
    v_mfma_f32_32x32x16_bf16 v[224:239], a[24:27], a[56:59], 0
    buffer_load_dwordx4 v22, s[16:19], s61 offen offset:2048 lds
    ds_read_b64_tr_b16 a[44:45], v8 offset:3712
    ds_read_b64_tr_b16 a[46:47], v8 offset:4608
    s_add_u32 s61, s61, 229376
    s_waitcnt vmcnt(14)
    v_mfma_f32_32x32x16_bf16 v[128:143], a[28:31], a[60:63], v[128:143]
    ds_read_b64_tr_b16 a[48:49], v8 offset:3744
    ds_read_b64_tr_b16 a[50:51], v8 offset:4640
    s_waitcnt lgkmcnt(6)
    v_mfma_f32_32x32x16_bf16 v[144:159], a[32:35], a[60:63], v[144:159]
    ds_read_b64_tr_b16 a[52:53], v8 offset:3776
    ds_read_b64_tr_b16 a[54:55], v8 offset:4672
    v_mfma_f32_32x32x16_bf16 v[160:175], a[36:39], a[60:63], v[160:175]
    ds_read_b64_tr_b16 a[0:1], v8 offset:7168
    ds_read_b64_tr_b16 a[2:3], v8 offset:8064
    s_waitcnt lgkmcnt(6)
    v_mfma_f32_32x32x16_bf16 v[176:191], a[40:43], a[60:63], v[176:191]
    ds_read_b64_tr_b16 a[4:5], v8 offset:7200
    ds_read_b64_tr_b16 a[6:7], v8 offset:8096
    s_mov_b32 s43, 8192
    v_mfma_f32_32x32x16_bf16 v[192:207], a[44:47], a[60:63], v[192:207]
    ds_read_b64_tr_b16 a[8:9], v8 offset:7232
    ds_read_b64_tr_b16 a[10:11], v8 offset:8128
    buffer_load_dwordx4 a[92:95], v27, s[20:23], s43 offen offset:1024 sc1
    s_waitcnt lgkmcnt(6)
    v_mfma_f32_32x32x16_bf16 v[208:223], a[48:51], a[60:63], v[208:223]
    ds_read_b64_tr_b16 a[12:13], v8 offset:7264
    ds_read_b64_tr_b16 a[14:15], v8 offset:8160
    v_mfma_f32_32x32x16_bf16 v[224:239], a[52:55], a[60:63], v[224:239]
    ds_read_b64_tr_b16 a[16:17], v8 offset:7296
    ds_read_b64_tr_b16 a[18:19], v8 offset:8192
    s_waitcnt lgkmcnt(6)
    s_add_u32 m0, s60, 28928
    s_nop 0
    s_waitcnt vmcnt(14)
    v_mfma_f32_32x32x16_bf16 v[128:143], a[0:3], a[64:67], v[128:143]
    buffer_load_dwordx4 v16, s[16:19], s61 offen offset:0 lds
    ds_read_b64_tr_b16 a[20:21], v8 offset:7328
    ds_read_b64_tr_b16 a[22:23], v8 offset:8224
    v_mfma_f32_32x32x16_bf16 v[144:159], a[4:7], a[64:67], v[144:159]
    buffer_load_dwordx4 v17, s[16:19], s61 offen offset:1024 lds
    ds_read_b64_tr_b16 a[24:25], v8 offset:7360
    ds_read_b64_tr_b16 a[26:27], v8 offset:8256
    s_waitcnt lgkmcnt(6)
    v_mfma_f32_32x32x16_bf16 v[160:175], a[8:11], a[64:67], v[160:175]
    buffer_load_dwordx4 v18, s[16:19], s61 offen offset:2048 lds
    ds_read_b64_tr_b16 a[28:29], v8 offset:10752
    ds_read_b64_tr_b16 a[30:31], v8 offset:11648
    v_mfma_f32_32x32x16_bf16 v[176:191], a[12:15], a[64:67], v[176:191]
    buffer_load_dwordx4 v19, s[16:19], s61 offen offset:3072 lds
    ds_read_b64_tr_b16 a[32:33], v8 offset:10784
    ds_read_b64_tr_b16 a[34:35], v8 offset:11680
    s_add_u32 m0, s60, 33024
    s_mov_b32 s43, 8192
    s_waitcnt lgkmcnt(6)
    v_mfma_f32_32x32x16_bf16 v[192:207], a[16:19], a[64:67], v[192:207]
    buffer_load_dwordx4 v20, s[16:19], s61 offen offset:0 lds
    ds_read_b64_tr_b16 a[36:37], v8 offset:10816
    ds_read_b64_tr_b16 a[38:39], v8 offset:11712
    buffer_load_dwordx4 a[96:99], v27, s[20:23], s43 offen offset:2048 sc1
    v_mfma_f32_32x32x16_bf16 v[208:223], a[20:23], a[64:67], v[208:223]
    buffer_load_dwordx4 v21, s[16:19], s61 offen offset:1024 lds
    ds_read_b64_tr_b16 a[40:41], v8 offset:10848
    ds_read_b64_tr_b16 a[42:43], v8 offset:11744
    s_waitcnt lgkmcnt(6)
    v_mfma_f32_32x32x16_bf16 v[224:239], a[24:27], a[64:67], v[224:239]
    buffer_load_dwordx4 v22, s[16:19], s61 offen offset:2048 lds
    ds_read_b64_tr_b16 a[44:45], v8 offset:10880
    ds_read_b64_tr_b16 a[46:47], v8 offset:11776
    s_add_u32 s61, s61, 229376
    s_waitcnt vmcnt(21)
    v_mfma_f32_32x32x16_bf16 v[128:143], a[28:31], a[68:71], v[128:143]
    ds_read_b64_tr_b16 a[48:49], v8 offset:10912
    ds_read_b64_tr_b16 a[50:51], v8 offset:11808
    s_waitcnt lgkmcnt(6)
    v_mfma_f32_32x32x16_bf16 v[144:159], a[32:35], a[68:71], v[144:159]
    ds_read_b64_tr_b16 a[52:53], v8 offset:10944
    ds_read_b64_tr_b16 a[54:55], v8 offset:11840
    v_mfma_f32_32x32x16_bf16 v[160:175], a[36:39], a[68:71], v[160:175]
    ds_read_b64_tr_b16 a[0:1], v9 offset:0
    ds_read_b64_tr_b16 a[2:3], v9 offset:896
    s_waitcnt lgkmcnt(6)
    v_mfma_f32_32x32x16_bf16 v[176:191], a[40:43], a[68:71], v[176:191]
    ds_read_b64_tr_b16 a[4:5], v9 offset:32
    ds_read_b64_tr_b16 a[6:7], v9 offset:928
    s_mov_b32 s43, 8192
    v_mfma_f32_32x32x16_bf16 v[192:207], a[44:47], a[68:71], v[192:207]
    ds_read_b64_tr_b16 a[8:9], v9 offset:64
    ds_read_b64_tr_b16 a[10:11], v9 offset:960
    buffer_load_dwordx4 a[100:103], v27, s[20:23], s43 offen offset:3072 sc1
    s_waitcnt lgkmcnt(6)
    v_mfma_f32_32x32x16_bf16 v[208:223], a[48:51], a[68:71], v[208:223]
    ds_read_b64_tr_b16 a[12:13], v9 offset:96
    ds_read_b64_tr_b16 a[14:15], v9 offset:992
    v_mfma_f32_32x32x16_bf16 v[224:239], a[52:55], a[68:71], v[224:239]
    ds_read_b64_tr_b16 a[16:17], v9 offset:128
    ds_read_b64_tr_b16 a[18:19], v9 offset:1024
    s_waitcnt lgkmcnt(6)
    s_barrier
    s_add_u32 m0, s60, 65536
    s_nop 0
    s_waitcnt vmcnt(21)
    v_mfma_f32_32x32x16_bf16 v[128:143], a[0:3], a[72:75], v[128:143]
    buffer_load_dwordx4 v16, s[16:19], s61 offen offset:0 lds
    ds_read_b64_tr_b16 a[20:21], v9 offset:160
    ds_read_b64_tr_b16 a[22:23], v9 offset:1056
    v_mfma_f32_32x32x16_bf16 v[144:159], a[4:7], a[72:75], v[144:159]
    buffer_load_dwordx4 v17, s[16:19], s61 offen offset:1024 lds
    ds_read_b64_tr_b16 a[24:25], v9 offset:192
    ds_read_b64_tr_b16 a[26:27], v9 offset:1088
    s_waitcnt lgkmcnt(6)
    v_mfma_f32_32x32x16_bf16 v[160:175], a[8:11], a[72:75], v[160:175]
    buffer_load_dwordx4 v18, s[16:19], s61 offen offset:2048 lds
    ds_read_b64_tr_b16 a[28:29], v9 offset:3584
    ds_read_b64_tr_b16 a[30:31], v9 offset:4480
    v_mfma_f32_32x32x16_bf16 v[176:191], a[12:15], a[72:75], v[176:191]
    buffer_load_dwordx4 v19, s[16:19], s61 offen offset:3072 lds
    ds_read_b64_tr_b16 a[32:33], v9 offset:3616
    ds_read_b64_tr_b16 a[34:35], v9 offset:4512
    s_add_u32 m0, s60, 69632
    s_mov_b32 s43, 12288
    s_waitcnt lgkmcnt(6)
    v_mfma_f32_32x32x16_bf16 v[192:207], a[16:19], a[72:75], v[192:207]
    buffer_load_dwordx4 v20, s[16:19], s61 offen offset:0 lds
    ds_read_b64_tr_b16 a[36:37], v9 offset:3648
    ds_read_b64_tr_b16 a[38:39], v9 offset:4544
    buffer_load_dwordx4 a[104:107], v27, s[20:23], s43 offen offset:0 sc1
    v_mfma_f32_32x32x16_bf16 v[208:223], a[20:23], a[72:75], v[208:223]
    buffer_load_dwordx4 v21, s[16:19], s61 offen offset:1024 lds
    ds_read_b64_tr_b16 a[40:41], v9 offset:3680
    ds_read_b64_tr_b16 a[42:43], v9 offset:4576
    s_waitcnt lgkmcnt(6)
    v_mfma_f32_32x32x16_bf16 v[224:239], a[24:27], a[72:75], v[224:239]
    buffer_load_dwordx4 v22, s[16:19], s61 offen offset:2048 lds
    ds_read_b64_tr_b16 a[44:45], v9 offset:3712
    ds_read_b64_tr_b16 a[46:47], v9 offset:4608
    s_add_u32 s61, s61, 229376
    s_waitcnt vmcnt(28)
    v_mfma_f32_32x32x16_bf16 v[128:143], a[28:31], a[76:79], v[128:143]
    ds_read_b64_tr_b16 a[48:49], v9 offset:3744
    ds_read_b64_tr_b16 a[50:51], v9 offset:4640
    s_waitcnt lgkmcnt(6)
    v_mfma_f32_32x32x16_bf16 v[144:159], a[32:35], a[76:79], v[144:159]
    ds_read_b64_tr_b16 a[52:53], v9 offset:3776
    ds_read_b64_tr_b16 a[54:55], v9 offset:4672
    v_mfma_f32_32x32x16_bf16 v[160:175], a[36:39], a[76:79], v[160:175]
    ds_read_b64_tr_b16 a[0:1], v9 offset:7168
    ds_read_b64_tr_b16 a[2:3], v9 offset:8064
    s_waitcnt lgkmcnt(6)
    v_mfma_f32_32x32x16_bf16 v[176:191], a[40:43], a[76:79], v[176:191]
    ds_read_b64_tr_b16 a[4:5], v9 offset:7200
    ds_read_b64_tr_b16 a[6:7], v9 offset:8096
    s_mov_b32 s43, 12288
    v_mfma_f32_32x32x16_bf16 v[192:207], a[44:47], a[76:79], v[192:207]
    ds_read_b64_tr_b16 a[8:9], v9 offset:7232
    ds_read_b64_tr_b16 a[10:11], v9 offset:8128
    buffer_load_dwordx4 a[108:111], v27, s[20:23], s43 offen offset:1024 sc1
    s_waitcnt lgkmcnt(6)
    v_mfma_f32_32x32x16_bf16 v[208:223], a[48:51], a[76:79], v[208:223]
    ds_read_b64_tr_b16 a[12:13], v9 offset:7264
    ds_read_b64_tr_b16 a[14:15], v9 offset:8160
    v_mfma_f32_32x32x16_bf16 v[224:239], a[52:55], a[76:79], v[224:239]
    ds_read_b64_tr_b16 a[16:17], v9 offset:7296
    ds_read_b64_tr_b16 a[18:19], v9 offset:8192
    s_waitcnt lgkmcnt(6)
    s_waitcnt vmcnt(28)
    v_mfma_f32_32x32x16_bf16 v[128:143], a[0:3], a[80:83], v[128:143]
    ds_read_b64_tr_b16 a[20:21], v9 offset:7328
    ds_read_b64_tr_b16 a[22:23], v9 offset:8224
    v_mfma_f32_32x32x16_bf16 v[144:159], a[4:7], a[80:83], v[144:159]
    ds_read_b64_tr_b16 a[24:25], v9 offset:7360
    ds_read_b64_tr_b16 a[26:27], v9 offset:8256
    s_waitcnt lgkmcnt(6)
    v_mfma_f32_32x32x16_bf16 v[160:175], a[8:11], a[80:83], v[160:175]
    ds_read_b64_tr_b16 a[28:29], v9 offset:10752
    ds_read_b64_tr_b16 a[30:31], v9 offset:11648
    v_mfma_f32_32x32x16_bf16 v[176:191], a[12:15], a[80:83], v[176:191]
    ds_read_b64_tr_b16 a[32:33], v9 offset:10784
    ds_read_b64_tr_b16 a[34:35], v9 offset:11680
    s_mov_b32 s43, 12288
    s_waitcnt lgkmcnt(6)
    v_mfma_f32_32x32x16_bf16 v[192:207], a[16:19], a[80:83], v[192:207]
    ds_read_b64_tr_b16 a[36:37], v9 offset:10816
    ds_read_b64_tr_b16 a[38:39], v9 offset:11712
    buffer_load_dwordx4 a[112:115], v27, s[20:23], s43 offen offset:2048 sc1
    v_mfma_f32_32x32x16_bf16 v[208:223], a[20:23], a[80:83], v[208:223]
    ds_read_b64_tr_b16 a[40:41], v9 offset:10848
    ds_read_b64_tr_b16 a[42:43], v9 offset:11744
    s_waitcnt lgkmcnt(6)
    v_mfma_f32_32x32x16_bf16 v[224:239], a[24:27], a[80:83], v[224:239]
    ds_read_b64_tr_b16 a[44:45], v9 offset:10880
    ds_read_b64_tr_b16 a[46:47], v9 offset:11776
    s_waitcnt vmcnt(28)
    v_mfma_f32_32x32x16_bf16 v[128:143], a[28:31], a[84:87], v[128:143]
    ds_read_b64_tr_b16 a[48:49], v9 offset:10912
    ds_read_b64_tr_b16 a[50:51], v9 offset:11808
    s_waitcnt lgkmcnt(6)
    v_mfma_f32_32x32x16_bf16 v[144:159], a[32:35], a[84:87], v[144:159]
    ds_read_b64_tr_b16 a[52:53], v9 offset:10944
    ds_read_b64_tr_b16 a[54:55], v9 offset:11840
    v_mfma_f32_32x32x16_bf16 v[160:175], a[36:39], a[84:87], v[160:175]
    ds_read_b64_tr_b16 a[0:1], v10 offset:0
    ds_read_b64_tr_b16 a[2:3], v10 offset:896
    s_waitcnt lgkmcnt(6)
    v_mfma_f32_32x32x16_bf16 v[176:191], a[40:43], a[84:87], v[176:191]
    ds_read_b64_tr_b16 a[4:5], v10 offset:32
    ds_read_b64_tr_b16 a[6:7], v10 offset:928
    s_mov_b32 s43, 12288
    v_mfma_f32_32x32x16_bf16 v[192:207], a[44:47], a[84:87], v[192:207]
    ds_read_b64_tr_b16 a[8:9], v10 offset:64
    ds_read_b64_tr_b16 a[10:11], v10 offset:960
    buffer_load_dwordx4 a[116:119], v27, s[20:23], s43 offen offset:3072 sc1
    s_waitcnt lgkmcnt(6)
    v_mfma_f32_32x32x16_bf16 v[208:223], a[48:51], a[84:87], v[208:223]
    ds_read_b64_tr_b16 a[12:13], v10 offset:96
    ds_read_b64_tr_b16 a[14:15], v10 offset:992
    v_mfma_f32_32x32x16_bf16 v[224:239], a[52:55], a[84:87], v[224:239]
    ds_read_b64_tr_b16 a[16:17], v10 offset:128
    ds_read_b64_tr_b16 a[18:19], v10 offset:1024
    s_waitcnt lgkmcnt(6)
    s_barrier
    s_add_u32 m0, s60, 94464
    s_nop 0
    s_waitcnt vmcnt(23)
    v_mfma_f32_32x32x16_bf16 v[128:143], a[0:3], a[88:91], v[128:143]
    buffer_load_dwordx4 v16, s[16:19], s61 offen offset:0 lds
    ds_read_b64_tr_b16 a[20:21], v10 offset:160
    ds_read_b64_tr_b16 a[22:23], v10 offset:1056
    v_mfma_f32_32x32x16_bf16 v[144:159], a[4:7], a[88:91], v[144:159]
    buffer_load_dwordx4 v17, s[16:19], s61 offen offset:1024 lds
    ds_read_b64_tr_b16 a[24:25], v10 offset:192
    ds_read_b64_tr_b16 a[26:27], v10 offset:1088
    s_waitcnt lgkmcnt(6)
    v_mfma_f32_32x32x16_bf16 v[160:175], a[8:11], a[88:91], v[160:175]
    buffer_load_dwordx4 v18, s[16:19], s61 offen offset:2048 lds
    ds_read_b64_tr_b16 a[28:29], v10 offset:3584
    ds_read_b64_tr_b16 a[30:31], v10 offset:4480
    v_mfma_f32_32x32x16_bf16 v[176:191], a[12:15], a[88:91], v[176:191]
    buffer_load_dwordx4 v19, s[16:19], s61 offen offset:3072 lds
    ds_read_b64_tr_b16 a[32:33], v10 offset:3616
    ds_read_b64_tr_b16 a[34:35], v10 offset:4512
    s_add_u32 m0, s60, 98560
    s_mov_b32 s43, 16384
    s_waitcnt lgkmcnt(6)
    v_mfma_f32_32x32x16_bf16 v[192:207], a[16:19], a[88:91], v[192:207]
    buffer_load_dwordx4 v20, s[16:19], s61 offen offset:0 lds
    ds_read_b64_tr_b16 a[36:37], v10 offset:3648
    ds_read_b64_tr_b16 a[38:39], v10 offset:4544
    buffer_load_dwordx4 a[120:123], v27, s[20:23], s43 offen offset:0 sc1
    v_mfma_f32_32x32x16_bf16 v[208:223], a[20:23], a[88:91], v[208:223]
    buffer_load_dwordx4 v21, s[16:19], s61 offen offset:1024 lds
    ds_read_b64_tr_b16 a[40:41], v10 offset:3680
    ds_read_b64_tr_b16 a[42:43], v10 offset:4576
    s_waitcnt lgkmcnt(6)
    v_mfma_f32_32x32x16_bf16 v[224:239], a[24:27], a[88:91], v[224:239]
    buffer_load_dwordx4 v22, s[16:19], s61 offen offset:2048 lds
    ds_read_b64_tr_b16 a[44:45], v10 offset:3712
    ds_read_b64_tr_b16 a[46:47], v10 offset:4608
    s_add_u32 s61, s61, 229376
    s_waitcnt vmcnt(28)
    v_mfma_f32_32x32x16_bf16 v[128:143], a[28:31], a[92:95], v[128:143]
    ds_read_b64_tr_b16 a[48:49], v10 offset:3744
    ds_read_b64_tr_b16 a[50:51], v10 offset:4640
    s_waitcnt lgkmcnt(6)
    v_mfma_f32_32x32x16_bf16 v[144:159], a[32:35], a[92:95], v[144:159]
    ds_read_b64_tr_b16 a[52:53], v10 offset:3776
    ds_read_b64_tr_b16 a[54:55], v10 offset:4672
    v_mfma_f32_32x32x16_bf16 v[160:175], a[36:39], a[92:95], v[160:175]
    ds_read_b64_tr_b16 a[0:1], v10 offset:7168
    ds_read_b64_tr_b16 a[2:3], v10 offset:8064
    s_waitcnt lgkmcnt(6)
    v_mfma_f32_32x32x16_bf16 v[176:191], a[40:43], a[92:95], v[176:191]
    ds_read_b64_tr_b16 a[4:5], v10 offset:7200
    ds_read_b64_tr_b16 a[6:7], v10 offset:8096
    s_mov_b32 s43, 16384
    v_mfma_f32_32x32x16_bf16 v[192:207], a[44:47], a[92:95], v[192:207]
    ds_read_b64_tr_b16 a[8:9], v10 offset:7232
    ds_read_b64_tr_b16 a[10:11], v10 offset:8128
    buffer_load_dwordx4 a[124:127], v27, s[20:23], s43 offen offset:1024 sc1
    s_waitcnt lgkmcnt(6)
    v_mfma_f32_32x32x16_bf16 v[208:223], a[48:51], a[92:95], v[208:223]
    ds_read_b64_tr_b16 a[12:13], v10 offset:7264
    ds_read_b64_tr_b16 a[14:15], v10 offset:8160
    v_mfma_f32_32x32x16_bf16 v[224:239], a[52:55], a[92:95], v[224:239]
    ds_read_b64_tr_b16 a[16:17], v10 offset:7296
    ds_read_b64_tr_b16 a[18:19], v10 offset:8192
    s_waitcnt lgkmcnt(6)
    s_waitcnt vmcnt(23)
    v_mfma_f32_32x32x16_bf16 v[128:143], a[0:3], a[96:99], v[128:143]
    ds_read_b64_tr_b16 a[20:21], v10 offset:7328
    ds_read_b64_tr_b16 a[22:23], v10 offset:8224
    v_mfma_f32_32x32x16_bf16 v[144:159], a[4:7], a[96:99], v[144:159]
    ds_read_b64_tr_b16 a[24:25], v10 offset:7360
    ds_read_b64_tr_b16 a[26:27], v10 offset:8256
    s_waitcnt lgkmcnt(6)
    v_mfma_f32_32x32x16_bf16 v[160:175], a[8:11], a[96:99], v[160:175]
    ds_read_b64_tr_b16 a[28:29], v10 offset:10752
    ds_read_b64_tr_b16 a[30:31], v10 offset:11648
    v_mfma_f32_32x32x16_bf16 v[176:191], a[12:15], a[96:99], v[176:191]
    ds_read_b64_tr_b16 a[32:33], v10 offset:10784
    ds_read_b64_tr_b16 a[34:35], v10 offset:11680
    s_mov_b32 s43, 16384
    s_waitcnt lgkmcnt(6)
    v_mfma_f32_32x32x16_bf16 v[192:207], a[16:19], a[96:99], v[192:207]
    ds_read_b64_tr_b16 a[36:37], v10 offset:10816
    ds_read_b64_tr_b16 a[38:39], v10 offset:11712
    buffer_load_dwordx4 a[128:131], v27, s[20:23], s43 offen offset:2048 sc1
    v_mfma_f32_32x32x16_bf16 v[208:223], a[20:23], a[96:99], v[208:223]
    ds_read_b64_tr_b16 a[40:41], v10 offset:10848
    ds_read_b64_tr_b16 a[42:43], v10 offset:11744
    s_waitcnt lgkmcnt(6)
    v_mfma_f32_32x32x16_bf16 v[224:239], a[24:27], a[96:99], v[224:239]
    ds_read_b64_tr_b16 a[44:45], v10 offset:10880
    ds_read_b64_tr_b16 a[46:47], v10 offset:11776
    s_waitcnt vmcnt(21)
    v_mfma_f32_32x32x16_bf16 v[128:143], a[28:31], a[100:103], v[128:143]
    ds_read_b64_tr_b16 a[48:49], v10 offset:10912
    ds_read_b64_tr_b16 a[50:51], v10 offset:11808
    s_waitcnt lgkmcnt(6)
    v_mfma_f32_32x32x16_bf16 v[144:159], a[32:35], a[100:103], v[144:159]
    ds_read_b64_tr_b16 a[52:53], v10 offset:10944
    ds_read_b64_tr_b16 a[54:55], v10 offset:11840
    s_barrier
    v_mfma_f32_32x32x16_bf16 v[160:175], a[36:39], a[100:103], v[160:175]
    ds_read_b64_tr_b16 a[0:1], v11 offset:0
    ds_read_b64_tr_b16 a[2:3], v11 offset:896
    s_waitcnt lgkmcnt(6)
    v_mfma_f32_32x32x16_bf16 v[176:191], a[40:43], a[100:103], v[176:191]
    ds_read_b64_tr_b16 a[4:5], v11 offset:32
    ds_read_b64_tr_b16 a[6:7], v11 offset:928
    s_mov_b32 s43, 16384
    v_mfma_f32_32x32x16_bf16 v[192:207], a[44:47], a[100:103], v[192:207]
    ds_read_b64_tr_b16 a[8:9], v11 offset:64
    ds_read_b64_tr_b16 a[10:11], v11 offset:960
    buffer_load_dwordx4 a[132:135], v27, s[20:23], s43 offen offset:3072 sc1
    s_waitcnt lgkmcnt(6)
    v_mfma_f32_32x32x16_bf16 v[208:223], a[48:51], a[100:103], v[208:223]
    ds_read_b64_tr_b16 a[12:13], v11 offset:96
    ds_read_b64_tr_b16 a[14:15], v11 offset:992
    v_mfma_f32_32x32x16_bf16 v[224:239], a[52:55], a[100:103], v[224:239]
    ds_read_b64_tr_b16 a[16:17], v11 offset:128
    ds_read_b64_tr_b16 a[18:19], v11 offset:1024
    s_waitcnt lgkmcnt(6)
    s_barrier
    s_add_u32 m0, s60, 123392
    s_nop 0
    s_waitcnt vmcnt(16)
    v_mfma_f32_32x32x16_bf16 v[128:143], a[0:3], a[104:107], v[128:143]
    buffer_load_dwordx4 v16, s[16:19], s61 offen offset:0 lds
    ds_read_b64_tr_b16 a[20:21], v11 offset:160
    ds_read_b64_tr_b16 a[22:23], v11 offset:1056
    v_mfma_f32_32x32x16_bf16 v[144:159], a[4:7], a[104:107], v[144:159]
    buffer_load_dwordx4 v17, s[16:19], s61 offen offset:1024 lds
    ds_read_b64_tr_b16 a[24:25], v11 offset:192
    ds_read_b64_tr_b16 a[26:27], v11 offset:1088
    s_waitcnt lgkmcnt(6)
    v_mfma_f32_32x32x16_bf16 v[160:175], a[8:11], a[104:107], v[160:175]
    buffer_load_dwordx4 v18, s[16:19], s61 offen offset:2048 lds
    ds_read_b64_tr_b16 a[28:29], v11 offset:3584
    ds_read_b64_tr_b16 a[30:31], v11 offset:4480
    v_mfma_f32_32x32x16_bf16 v[176:191], a[12:15], a[104:107], v[176:191]
    buffer_load_dwordx4 v19, s[16:19], s61 offen offset:3072 lds
    ds_read_b64_tr_b16 a[32:33], v11 offset:3616
    ds_read_b64_tr_b16 a[34:35], v11 offset:4512
    s_add_u32 m0, s60, 127488
    s_mov_b32 s43, 20480
    s_waitcnt lgkmcnt(6)
    v_mfma_f32_32x32x16_bf16 v[192:207], a[16:19], a[104:107], v[192:207]
    buffer_load_dwordx4 v20, s[16:19], s61 offen offset:0 lds
    ds_read_b64_tr_b16 a[36:37], v11 offset:3648
    ds_read_b64_tr_b16 a[38:39], v11 offset:4544
    buffer_load_dwordx4 a[136:139], v27, s[20:23], s43 offen offset:0 sc1
    v_mfma_f32_32x32x16_bf16 v[208:223], a[20:23], a[104:107], v[208:223]
    buffer_load_dwordx4 v21, s[16:19], s61 offen offset:1024 lds
    ds_read_b64_tr_b16 a[40:41], v11 offset:3680
    ds_read_b64_tr_b16 a[42:43], v11 offset:4576
    s_waitcnt lgkmcnt(6)
    v_mfma_f32_32x32x16_bf16 v[224:239], a[24:27], a[104:107], v[224:239]
    buffer_load_dwordx4 v22, s[16:19], s61 offen offset:2048 lds
    ds_read_b64_tr_b16 a[44:45], v11 offset:3712
    ds_read_b64_tr_b16 a[46:47], v11 offset:4608
    s_add_u32 s61, s61, 229376
    s_waitcnt vmcnt(21)
    v_mfma_f32_32x32x16_bf16 v[128:143], a[28:31], a[108:111], v[128:143]
    ds_read_b64_tr_b16 a[48:49], v11 offset:3744
    ds_read_b64_tr_b16 a[50:51], v11 offset:4640
    s_waitcnt lgkmcnt(6)
    v_mfma_f32_32x32x16_bf16 v[144:159], a[32:35], a[108:111], v[144:159]
    ds_read_b64_tr_b16 a[52:53], v11 offset:3776
    ds_read_b64_tr_b16 a[54:55], v11 offset:4672
    v_mfma_f32_32x32x16_bf16 v[160:175], a[36:39], a[108:111], v[160:175]
    ds_read_b64_tr_b16 a[0:1], v11 offset:7168
    ds_read_b64_tr_b16 a[2:3], v11 offset:8064
    s_waitcnt lgkmcnt(6)
    v_mfma_f32_32x32x16_bf16 v[176:191], a[40:43], a[108:111], v[176:191]
    ds_read_b64_tr_b16 a[4:5], v11 offset:7200
    ds_read_b64_tr_b16 a[6:7], v11 offset:8096
    s_mov_b32 s43, 20480
    v_mfma_f32_32x32x16_bf16 v[192:207], a[44:47], a[108:111], v[192:207]
    ds_read_b64_tr_b16 a[8:9], v11 offset:7232
    ds_read_b64_tr_b16 a[10:11], v11 offset:8128
    buffer_load_dwordx4 a[140:143], v27, s[20:23], s43 offen offset:1024 sc1
    s_waitcnt lgkmcnt(6)
    v_mfma_f32_32x32x16_bf16 v[208:223], a[48:51], a[108:111], v[208:223]
    ds_read_b64_tr_b16 a[12:13], v11 offset:7264
    ds_read_b64_tr_b16 a[14:15], v11 offset:8160
    v_mfma_f32_32x32x16_bf16 v[224:239], a[52:55], a[108:111], v[224:239]
    ds_read_b64_tr_b16 a[16:17], v11 offset:7296
    ds_read_b64_tr_b16 a[18:19], v11 offset:8192
    s_waitcnt lgkmcnt(6)
    s_waitcnt vmcnt(21)
    v_mfma_f32_32x32x16_bf16 v[128:143], a[0:3], a[112:115], v[128:143]
    ds_read_b64_tr_b16 a[20:21], v11 offset:7328
    ds_read_b64_tr_b16 a[22:23], v11 offset:8224
    v_mfma_f32_32x32x16_bf16 v[144:159], a[4:7], a[112:115], v[144:159]
    ds_read_b64_tr_b16 a[24:25], v11 offset:7360
    ds_read_b64_tr_b16 a[26:27], v11 offset:8256
    s_waitcnt lgkmcnt(6)
    v_mfma_f32_32x32x16_bf16 v[160:175], a[8:11], a[112:115], v[160:175]
    ds_read_b64_tr_b16 a[28:29], v11 offset:10752
    ds_read_b64_tr_b16 a[30:31], v11 offset:11648
    v_mfma_f32_32x32x16_bf16 v[176:191], a[12:15], a[112:115], v[176:191]
    ds_read_b64_tr_b16 a[32:33], v11 offset:10784
    ds_read_b64_tr_b16 a[34:35], v11 offset:11680
    s_mov_b32 s43, 20480
    s_waitcnt lgkmcnt(6)
    v_mfma_f32_32x32x16_bf16 v[192:207], a[16:19], a[112:115], v[192:207]
    ds_read_b64_tr_b16 a[36:37], v11 offset:10816
    ds_read_b64_tr_b16 a[38:39], v11 offset:11712
    buffer_load_dwordx4 a[144:147], v27, s[20:23], s43 offen offset:2048 sc1
    v_mfma_f32_32x32x16_bf16 v[208:223], a[20:23], a[112:115], v[208:223]
    ds_read_b64_tr_b16 a[40:41], v11 offset:10848
    ds_read_b64_tr_b16 a[42:43], v11 offset:11744
    s_waitcnt lgkmcnt(6)
    v_mfma_f32_32x32x16_bf16 v[224:239], a[24:27], a[112:115], v[224:239]
    ds_read_b64_tr_b16 a[44:45], v11 offset:10880
    ds_read_b64_tr_b16 a[46:47], v11 offset:11776
    s_waitcnt vmcnt(21)
    v_mfma_f32_32x32x16_bf16 v[128:143], a[28:31], a[116:119], v[128:143]
    ds_read_b64_tr_b16 a[48:49], v11 offset:10912
    ds_read_b64_tr_b16 a[50:51], v11 offset:11808
    s_waitcnt lgkmcnt(6)
    v_mfma_f32_32x32x16_bf16 v[144:159], a[32:35], a[116:119], v[144:159]
    ds_read_b64_tr_b16 a[52:53], v11 offset:10944
    ds_read_b64_tr_b16 a[54:55], v11 offset:11840
    s_barrier
    v_mfma_f32_32x32x16_bf16 v[160:175], a[36:39], a[116:119], v[160:175]
    ds_read_b64_tr_b16 a[0:1], v12 offset:0
    ds_read_b64_tr_b16 a[2:3], v12 offset:896
    s_waitcnt lgkmcnt(6)
    v_mfma_f32_32x32x16_bf16 v[176:191], a[40:43], a[116:119], v[176:191]
    ds_read_b64_tr_b16 a[4:5], v12 offset:32
    ds_read_b64_tr_b16 a[6:7], v12 offset:928
    s_mov_b32 s43, 20480
    v_mfma_f32_32x32x16_bf16 v[192:207], a[44:47], a[116:119], v[192:207]
    ds_read_b64_tr_b16 a[8:9], v12 offset:64
    ds_read_b64_tr_b16 a[10:11], v12 offset:960
    buffer_load_dwordx4 a[148:151], v27, s[20:23], s43 offen offset:3072 sc1
    s_waitcnt lgkmcnt(6)
    v_mfma_f32_32x32x16_bf16 v[208:223], a[48:51], a[116:119], v[208:223]
    ds_read_b64_tr_b16 a[12:13], v12 offset:96
    ds_read_b64_tr_b16 a[14:15], v12 offset:992
    v_mfma_f32_32x32x16_bf16 v[224:239], a[52:55], a[116:119], v[224:239]
    ds_read_b64_tr_b16 a[16:17], v12 offset:128
    ds_read_b64_tr_b16 a[18:19], v12 offset:1024
    s_waitcnt lgkmcnt(6)
    s_waitcnt vmcnt(16)
    v_mfma_f32_32x32x16_bf16 v[128:143], a[0:3], a[120:123], v[128:143]
    ds_read_b64_tr_b16 a[20:21], v12 offset:160
    ds_read_b64_tr_b16 a[22:23], v12 offset:1056
    v_mfma_f32_32x32x16_bf16 v[144:159], a[4:7], a[120:123], v[144:159]
    ds_read_b64_tr_b16 a[24:25], v12 offset:192
    ds_read_b64_tr_b16 a[26:27], v12 offset:1088
    s_waitcnt lgkmcnt(6)
    v_mfma_f32_32x32x16_bf16 v[160:175], a[8:11], a[120:123], v[160:175]
    ds_read_b64_tr_b16 a[28:29], v12 offset:3584
    ds_read_b64_tr_b16 a[30:31], v12 offset:4480
    v_mfma_f32_32x32x16_bf16 v[176:191], a[12:15], a[120:123], v[176:191]
    ds_read_b64_tr_b16 a[32:33], v12 offset:3616
    ds_read_b64_tr_b16 a[34:35], v12 offset:4512
    s_mov_b32 s43, 24576
    s_waitcnt lgkmcnt(6)
    v_mfma_f32_32x32x16_bf16 v[192:207], a[16:19], a[120:123], v[192:207]
    ds_read_b64_tr_b16 a[36:37], v12 offset:3648
    ds_read_b64_tr_b16 a[38:39], v12 offset:4544
    buffer_load_dwordx4 a[152:155], v27, s[20:23], s43 offen offset:0 sc1
    v_mfma_f32_32x32x16_bf16 v[208:223], a[20:23], a[120:123], v[208:223]
    ds_read_b64_tr_b16 a[40:41], v12 offset:3680
    ds_read_b64_tr_b16 a[42:43], v12 offset:4576
    s_waitcnt lgkmcnt(6)
    v_mfma_f32_32x32x16_bf16 v[224:239], a[24:27], a[120:123], v[224:239]
    ds_read_b64_tr_b16 a[44:45], v12 offset:3712
    ds_read_b64_tr_b16 a[46:47], v12 offset:4608
    s_waitcnt vmcnt(14)
    v_mfma_f32_32x32x16_bf16 v[128:143], a[28:31], a[124:127], v[128:143]
    ds_read_b64_tr_b16 a[48:49], v12 offset:3744
    ds_read_b64_tr_b16 a[50:51], v12 offset:4640
    s_waitcnt lgkmcnt(6)
    v_mfma_f32_32x32x16_bf16 v[144:159], a[32:35], a[124:127], v[144:159]
    ds_read_b64_tr_b16 a[52:53], v12 offset:3776
    ds_read_b64_tr_b16 a[54:55], v12 offset:4672
    v_mfma_f32_32x32x16_bf16 v[160:175], a[36:39], a[124:127], v[160:175]
    ds_read_b64_tr_b16 a[0:1], v12 offset:7168
    ds_read_b64_tr_b16 a[2:3], v12 offset:8064
    s_waitcnt lgkmcnt(6)
    v_mfma_f32_32x32x16_bf16 v[176:191], a[40:43], a[124:127], v[176:191]
    ds_read_b64_tr_b16 a[4:5], v12 offset:7200
    ds_read_b64_tr_b16 a[6:7], v12 offset:8096
    s_mov_b32 s43, 24576
    v_mfma_f32_32x32x16_bf16 v[192:207], a[44:47], a[124:127], v[192:207]
    ds_read_b64_tr_b16 a[8:9], v12 offset:7232
    ds_read_b64_tr_b16 a[10:11], v12 offset:8128
    buffer_load_dwordx4 a[156:159], v27, s[20:23], s43 offen offset:1024 sc1
    s_waitcnt lgkmcnt(6)
    v_mfma_f32_32x32x16_bf16 v[208:223], a[48:51], a[124:127], v[208:223]
    ds_read_b64_tr_b16 a[12:13], v12 offset:7264
    ds_read_b64_tr_b16 a[14:15], v12 offset:8160
    v_mfma_f32_32x32x16_bf16 v[224:239], a[52:55], a[124:127], v[224:239]
    ds_read_b64_tr_b16 a[16:17], v12 offset:7296
    ds_read_b64_tr_b16 a[18:19], v12 offset:8192
    s_waitcnt lgkmcnt(6)
    s_waitcnt vmcnt(14)
    v_mfma_f32_32x32x16_bf16 v[128:143], a[0:3], a[128:131], v[128:143]
    ds_read_b64_tr_b16 a[20:21], v12 offset:7328
    ds_read_b64_tr_b16 a[22:23], v12 offset:8224
    v_mfma_f32_32x32x16_bf16 v[144:159], a[4:7], a[128:131], v[144:159]
    ds_read_b64_tr_b16 a[24:25], v12 offset:7360
    ds_read_b64_tr_b16 a[26:27], v12 offset:8256
    s_waitcnt lgkmcnt(6)
    v_mfma_f32_32x32x16_bf16 v[160:175], a[8:11], a[128:131], v[160:175]
    ds_read_b64_tr_b16 a[28:29], v12 offset:10752
    ds_read_b64_tr_b16 a[30:31], v12 offset:11648
    v_mfma_f32_32x32x16_bf16 v[176:191], a[12:15], a[128:131], v[176:191]
    ds_read_b64_tr_b16 a[32:33], v12 offset:10784
    ds_read_b64_tr_b16 a[34:35], v12 offset:11680
    s_mov_b32 s43, 24576
    s_waitcnt lgkmcnt(6)
    v_mfma_f32_32x32x16_bf16 v[192:207], a[16:19], a[128:131], v[192:207]
    ds_read_b64_tr_b16 a[36:37], v12 offset:10816
    ds_read_b64_tr_b16 a[38:39], v12 offset:11712
    buffer_load_dwordx4 a[160:163], v27, s[20:23], s43 offen offset:2048 sc1
    v_mfma_f32_32x32x16_bf16 v[208:223], a[20:23], a[128:131], v[208:223]
    ds_read_b64_tr_b16 a[40:41], v12 offset:10848
    ds_read_b64_tr_b16 a[42:43], v12 offset:11744
    s_waitcnt lgkmcnt(6)
    v_mfma_f32_32x32x16_bf16 v[224:239], a[24:27], a[128:131], v[224:239]
    ds_read_b64_tr_b16 a[44:45], v12 offset:10880
    ds_read_b64_tr_b16 a[46:47], v12 offset:11776
    s_waitcnt vmcnt(14)
    v_mfma_f32_32x32x16_bf16 v[128:143], a[28:31], a[132:135], v[128:143]
    ds_read_b64_tr_b16 a[48:49], v12 offset:10912
    ds_read_b64_tr_b16 a[50:51], v12 offset:11808
    s_waitcnt lgkmcnt(6)
    v_mfma_f32_32x32x16_bf16 v[144:159], a[32:35], a[132:135], v[144:159]
    ds_read_b64_tr_b16 a[52:53], v12 offset:10944
    ds_read_b64_tr_b16 a[54:55], v12 offset:11840
    s_barrier
    v_mfma_f32_32x32x16_bf16 v[160:175], a[36:39], a[132:135], v[160:175]
    ds_read_b64_tr_b16 a[0:1], v8 offset:0
    ds_read_b64_tr_b16 a[2:3], v8 offset:896
    s_waitcnt lgkmcnt(6)
    v_mfma_f32_32x32x16_bf16 v[176:191], a[40:43], a[132:135], v[176:191]
    ds_read_b64_tr_b16 a[4:5], v8 offset:32
    ds_read_b64_tr_b16 a[6:7], v8 offset:928
    s_mov_b32 s43, 24576
    v_mfma_f32_32x32x16_bf16 v[192:207], a[44:47], a[132:135], v[192:207]
    ds_read_b64_tr_b16 a[8:9], v8 offset:64
    ds_read_b64_tr_b16 a[10:11], v8 offset:960
    buffer_load_dwordx4 a[164:167], v27, s[20:23], s43 offen offset:3072 sc1
    s_waitcnt lgkmcnt(6)
    v_mfma_f32_32x32x16_bf16 v[208:223], a[48:51], a[132:135], v[208:223]
    ds_read_b64_tr_b16 a[12:13], v8 offset:96
    ds_read_b64_tr_b16 a[14:15], v8 offset:992
    v_mfma_f32_32x32x16_bf16 v[224:239], a[52:55], a[132:135], v[224:239]
    ds_read_b64_tr_b16 a[16:17], v8 offset:128
    ds_read_b64_tr_b16 a[18:19], v8 offset:1024
    s_waitcnt lgkmcnt(6)
    s_waitcnt vmcnt(9)
    v_mfma_f32_32x32x16_bf16 v[128:143], a[0:3], a[136:139], v[128:143]
    ds_read_b64_tr_b16 a[20:21], v8 offset:160
    ds_read_b64_tr_b16 a[22:23], v8 offset:1056
    v_add_u32 v15, 0, v23
    v_mfma_f32_32x32x16_bf16 v[144:159], a[4:7], a[136:139], v[144:159]
    ds_read_b64_tr_b16 a[24:25], v8 offset:192
    ds_read_b64_tr_b16 a[26:27], v8 offset:1088
    global_load_dwordx2 v[96:97], v15, s[34:35] sc1
    v_add_u32 v15, 16384, v23
    s_waitcnt lgkmcnt(6)
    v_mfma_f32_32x32x16_bf16 v[160:175], a[8:11], a[136:139], v[160:175]
    ds_read_b64_tr_b16 a[28:29], v8 offset:3584
    ds_read_b64_tr_b16 a[30:31], v8 offset:4480
    global_load_dwordx2 v[98:99], v15, s[34:35] sc1
    v_add_u32 v15, 32768, v23
    v_mfma_f32_32x32x16_bf16 v[176:191], a[12:15], a[136:139], v[176:191]
    ds_read_b64_tr_b16 a[32:33], v8 offset:3616
    ds_read_b64_tr_b16 a[34:35], v8 offset:4512
    global_load_dwordx2 v[100:101], v15, s[34:35] sc1
    s_mov_b32 s43, 28672
    v_add_u32 v15, 49152, v23
    s_waitcnt lgkmcnt(6)
    v_mfma_f32_32x32x16_bf16 v[192:207], a[16:19], a[136:139], v[192:207]
    ds_read_b64_tr_b16 a[36:37], v8 offset:3648
    ds_read_b64_tr_b16 a[38:39], v8 offset:4544
    buffer_load_dwordx4 a[168:171], v27, s[20:23], s43 offen offset:0 sc1
    global_load_dwordx2 v[102:103], v15, s[34:35] sc1
    v_add_u32 v15, 65536, v23
    v_mfma_f32_32x32x16_bf16 v[208:223], a[20:23], a[136:139], v[208:223]
    ds_read_b64_tr_b16 a[40:41], v8 offset:3680
    ds_read_b64_tr_b16 a[42:43], v8 offset:4576
    global_load_dwordx2 v[104:105], v15, s[34:35] sc1
    v_add_u32 v15, 81920, v23
    s_waitcnt lgkmcnt(6)
    v_mfma_f32_32x32x16_bf16 v[224:239], a[24:27], a[136:139], v[224:239]
    ds_read_b64_tr_b16 a[44:45], v8 offset:3712
    ds_read_b64_tr_b16 a[46:47], v8 offset:4608
    global_load_dwordx2 v[106:107], v15, s[34:35] sc1
    s_waitcnt vmcnt(13)
    v_mfma_f32_32x32x16_bf16 v[128:143], a[28:31], a[140:143], v[128:143]
    ds_read_b64_tr_b16 a[48:49], v8 offset:3744
    ds_read_b64_tr_b16 a[50:51], v8 offset:4640
    v_add_u32 v15, 98304, v23
    s_waitcnt lgkmcnt(6)
    v_mfma_f32_32x32x16_bf16 v[144:159], a[32:35], a[140:143], v[144:159]
    ds_read_b64_tr_b16 a[52:53], v8 offset:3776
    ds_read_b64_tr_b16 a[54:55], v8 offset:4672
    global_load_dwordx2 v[108:109], v15, s[34:35] sc1
    v_add_u32 v15, 114688, v23
    v_mfma_f32_32x32x16_bf16 v[160:175], a[36:39], a[140:143], v[160:175]
    ds_read_b64_tr_b16 a[0:1], v8 offset:7168
    ds_read_b64_tr_b16 a[2:3], v8 offset:8064
    global_load_dwordx2 v[110:111], v15, s[34:35] sc1
    v_add_u32 v15, 131072, v23
    s_waitcnt lgkmcnt(6)
    v_mfma_f32_32x32x16_bf16 v[176:191], a[40:43], a[140:143], v[176:191]
    ds_read_b64_tr_b16 a[4:5], v8 offset:7200
    ds_read_b64_tr_b16 a[6:7], v8 offset:8096
    global_load_dwordx2 v[112:113], v15, s[34:35] sc1
    s_mov_b32 s43, 28672
    v_add_u32 v15, 147456, v23
    v_mfma_f32_32x32x16_bf16 v[192:207], a[44:47], a[140:143], v[192:207]
    ds_read_b64_tr_b16 a[8:9], v8 offset:7232
    ds_read_b64_tr_b16 a[10:11], v8 offset:8128
    buffer_load_dwordx4 a[172:175], v27, s[20:23], s43 offen offset:1024 sc1
    global_load_dwordx2 v[114:115], v15, s[34:35] sc1
    v_add_u32 v15, 163840, v23
    s_waitcnt lgkmcnt(6)
    v_mfma_f32_32x32x16_bf16 v[208:223], a[48:51], a[140:143], v[208:223]
    ds_read_b64_tr_b16 a[12:13], v8 offset:7264
    ds_read_b64_tr_b16 a[14:15], v8 offset:8160
    global_load_dwordx2 v[116:117], v15, s[34:35] sc1
    v_add_u32 v15, 180224, v23
    v_mfma_f32_32x32x16_bf16 v[224:239], a[52:55], a[140:143], v[224:239]
    ds_read_b64_tr_b16 a[16:17], v8 offset:7296
    ds_read_b64_tr_b16 a[18:19], v8 offset:8192
    global_load_dwordx2 v[118:119], v15, s[34:35] sc1
    s_waitcnt lgkmcnt(6)
    s_waitcnt vmcnt(19)
    v_mfma_f32_32x32x16_bf16 v[128:143], a[0:3], a[144:147], v[128:143]
    ds_read_b64_tr_b16 a[20:21], v8 offset:7328
    ds_read_b64_tr_b16 a[22:23], v8 offset:8224
    v_add_u32 v15, 196608, v23
    v_mfma_f32_32x32x16_bf16 v[144:159], a[4:7], a[144:147], v[144:159]
    ds_read_b64_tr_b16 a[24:25], v8 offset:7360
    ds_read_b64_tr_b16 a[26:27], v8 offset:8256
    global_load_dwordx2 v[120:121], v15, s[34:35] sc1
    v_add_u32 v15, 212992, v23
    s_waitcnt lgkmcnt(6)
    v_mfma_f32_32x32x16_bf16 v[160:175], a[8:11], a[144:147], v[160:175]
    ds_read_b64_tr_b16 a[28:29], v8 offset:10752
    ds_read_b64_tr_b16 a[30:31], v8 offset:11648
    global_load_dwordx2 v[122:123], v15, s[34:35] sc1
    v_add_u32 v15, 229376, v23
    v_mfma_f32_32x32x16_bf16 v[176:191], a[12:15], a[144:147], v[176:191]
    ds_read_b64_tr_b16 a[32:33], v8 offset:10784
    ds_read_b64_tr_b16 a[34:35], v8 offset:11680
    global_load_dwordx2 v[124:125], v15, s[34:35] sc1
    s_mov_b32 s43, 28672
    v_add_u32 v15, 245760, v23
    s_waitcnt lgkmcnt(6)
    v_mfma_f32_32x32x16_bf16 v[192:207], a[16:19], a[144:147], v[192:207]
    ds_read_b64_tr_b16 a[36:37], v8 offset:10816
    ds_read_b64_tr_b16 a[38:39], v8 offset:11712
    buffer_load_dwordx4 a[176:179], v27, s[20:23], s43 offen offset:2048 sc1
    global_load_dwordx2 v[126:127], v15, s[34:35] sc1
    v_mfma_f32_32x32x16_bf16 v[208:223], a[20:23], a[144:147], v[208:223]
    ds_read_b64_tr_b16 a[40:41], v8 offset:10848
    ds_read_b64_tr_b16 a[42:43], v8 offset:11744
    s_waitcnt lgkmcnt(6)
    v_mfma_f32_32x32x16_bf16 v[224:239], a[24:27], a[144:147], v[224:239]
    ds_read_b64_tr_b16 a[44:45], v8 offset:10880
    ds_read_b64_tr_b16 a[46:47], v8 offset:11776
    s_waitcnt vmcnt(23)
    v_mfma_f32_32x32x16_bf16 v[128:143], a[28:31], a[148:151], v[128:143]
    ds_read_b64_tr_b16 a[48:49], v8 offset:10912
    ds_read_b64_tr_b16 a[50:51], v8 offset:11808
    s_waitcnt lgkmcnt(6)
    v_mfma_f32_32x32x16_bf16 v[144:159], a[32:35], a[148:151], v[144:159]
    ds_read_b64_tr_b16 a[52:53], v8 offset:10944
    ds_read_b64_tr_b16 a[54:55], v8 offset:11840
    s_barrier
    v_mfma_f32_32x32x16_bf16 v[160:175], a[36:39], a[148:151], v[160:175]
    ds_read_b64_tr_b16 a[0:1], v9 offset:0
    ds_read_b64_tr_b16 a[2:3], v9 offset:896
    s_waitcnt lgkmcnt(6)
    v_mfma_f32_32x32x16_bf16 v[176:191], a[40:43], a[148:151], v[176:191]
    ds_read_b64_tr_b16 a[4:5], v9 offset:32
    ds_read_b64_tr_b16 a[6:7], v9 offset:928
    s_mov_b32 s43, 28672
    v_mfma_f32_32x32x16_bf16 v[192:207], a[44:47], a[148:151], v[192:207]
    ds_read_b64_tr_b16 a[8:9], v9 offset:64
    ds_read_b64_tr_b16 a[10:11], v9 offset:960
    buffer_load_dwordx4 a[180:183], v27, s[20:23], s43 offen offset:3072 sc1
    s_waitcnt lgkmcnt(6)
    v_mfma_f32_32x32x16_bf16 v[208:223], a[48:51], a[148:151], v[208:223]
    ds_read_b64_tr_b16 a[12:13], v9 offset:96
    ds_read_b64_tr_b16 a[14:15], v9 offset:992
    v_mfma_f32_32x32x16_bf16 v[224:239], a[52:55], a[148:151], v[224:239]
    ds_read_b64_tr_b16 a[16:17], v9 offset:128
    ds_read_b64_tr_b16 a[18:19], v9 offset:1024
    s_waitcnt lgkmcnt(6)
    s_waitcnt vmcnt(23)
    v_mfma_f32_32x32x16_bf16 v[128:143], a[0:3], a[152:155], v[128:143]
    ds_read_b64_tr_b16 a[20:21], v9 offset:160
    ds_read_b64_tr_b16 a[22:23], v9 offset:1056
    v_mfma_f32_32x32x16_bf16 v[144:159], a[4:7], a[152:155], v[144:159]
    ds_read_b64_tr_b16 a[24:25], v9 offset:192
    ds_read_b64_tr_b16 a[26:27], v9 offset:1088
    s_waitcnt lgkmcnt(6)
    v_mfma_f32_32x32x16_bf16 v[160:175], a[8:11], a[152:155], v[160:175]
    ds_read_b64_tr_b16 a[28:29], v9 offset:3584
    ds_read_b64_tr_b16 a[30:31], v9 offset:4480
    v_mfma_f32_32x32x16_bf16 v[176:191], a[12:15], a[152:155], v[176:191]
    ds_read_b64_tr_b16 a[32:33], v9 offset:3616
    ds_read_b64_tr_b16 a[34:35], v9 offset:4512
    s_waitcnt lgkmcnt(6)
    v_mfma_f32_32x32x16_bf16 v[192:207], a[16:19], a[152:155], v[192:207]
    ds_read_b64_tr_b16 a[36:37], v9 offset:3648
    ds_read_b64_tr_b16 a[38:39], v9 offset:4544
    v_mfma_f32_32x32x16_bf16 v[208:223], a[20:23], a[152:155], v[208:223]
    ds_read_b64_tr_b16 a[40:41], v9 offset:3680
    ds_read_b64_tr_b16 a[42:43], v9 offset:4576
    s_waitcnt lgkmcnt(6)
    v_mfma_f32_32x32x16_bf16 v[224:239], a[24:27], a[152:155], v[224:239]
    ds_read_b64_tr_b16 a[44:45], v9 offset:3712
    ds_read_b64_tr_b16 a[46:47], v9 offset:4608
    s_waitcnt vmcnt(22)
    v_mfma_f32_32x32x16_bf16 v[128:143], a[28:31], a[156:159], v[128:143]
    ds_read_b64_tr_b16 a[48:49], v9 offset:3744
    ds_read_b64_tr_b16 a[50:51], v9 offset:4640
    s_waitcnt lgkmcnt(6)
    v_mfma_f32_32x32x16_bf16 v[144:159], a[32:35], a[156:159], v[144:159]
    ds_read_b64_tr_b16 a[52:53], v9 offset:3776
    ds_read_b64_tr_b16 a[54:55], v9 offset:4672
    v_mfma_f32_32x32x16_bf16 v[160:175], a[36:39], a[156:159], v[160:175]
    ds_read_b64_tr_b16 a[0:1], v9 offset:7168
    ds_read_b64_tr_b16 a[2:3], v9 offset:8064
    s_waitcnt lgkmcnt(6)
    v_mfma_f32_32x32x16_bf16 v[176:191], a[40:43], a[156:159], v[176:191]
    ds_read_b64_tr_b16 a[4:5], v9 offset:7200
    ds_read_b64_tr_b16 a[6:7], v9 offset:8096
    v_mfma_f32_32x32x16_bf16 v[192:207], a[44:47], a[156:159], v[192:207]
    ds_read_b64_tr_b16 a[8:9], v9 offset:7232
    ds_read_b64_tr_b16 a[10:11], v9 offset:8128
    s_waitcnt lgkmcnt(6)
    v_mfma_f32_32x32x16_bf16 v[208:223], a[48:51], a[156:159], v[208:223]
    ds_read_b64_tr_b16 a[12:13], v9 offset:7264
    ds_read_b64_tr_b16 a[14:15], v9 offset:8160
    v_mfma_f32_32x32x16_bf16 v[224:239], a[52:55], a[156:159], v[224:239]
    ds_read_b64_tr_b16 a[16:17], v9 offset:7296
    ds_read_b64_tr_b16 a[18:19], v9 offset:8192
    s_waitcnt lgkmcnt(6)
    s_waitcnt vmcnt(21)
    v_mfma_f32_32x32x16_bf16 v[128:143], a[0:3], a[160:163], v[128:143]
    ds_read_b64_tr_b16 a[20:21], v9 offset:7328
    ds_read_b64_tr_b16 a[22:23], v9 offset:8224
    s_waitcnt vmcnt(1)
    v_add_f32 v28, v96, v98
    v_mfma_f32_32x32x16_bf16 v[144:159], a[4:7], a[160:163], v[144:159]
    ds_read_b64_tr_b16 a[24:25], v9 offset:7360
    ds_read_b64_tr_b16 a[26:27], v9 offset:8256
    v_add_f32 v28, v28, v100
    v_add_f32 v28, v28, v102
    s_waitcnt lgkmcnt(6)
    v_mfma_f32_32x32x16_bf16 v[160:175], a[8:11], a[160:163], v[160:175]
    ds_read_b64_tr_b16 a[28:29], v9 offset:10752
    ds_read_b64_tr_b16 a[30:31], v9 offset:11648
    v_add_f32 v28, v28, v104
    v_add_f32 v28, v28, v106
    v_mfma_f32_32x32x16_bf16 v[176:191], a[12:15], a[160:163], v[176:191]
    ds_read_b64_tr_b16 a[32:33], v9 offset:10784
    ds_read_b64_tr_b16 a[34:35], v9 offset:11680
    v_add_f32 v28, v28, v108
    v_add_f32 v28, v28, v110
    s_waitcnt lgkmcnt(6)
    v_mfma_f32_32x32x16_bf16 v[192:207], a[16:19], a[160:163], v[192:207]
    ds_read_b64_tr_b16 a[36:37], v9 offset:10816
    ds_read_b64_tr_b16 a[38:39], v9 offset:11712
    v_add_f32 v28, v28, v112
    v_add_f32 v28, v28, v114
    v_mfma_f32_32x32x16_bf16 v[208:223], a[20:23], a[160:163], v[208:223]
    ds_read_b64_tr_b16 a[40:41], v9 offset:10848
    ds_read_b64_tr_b16 a[42:43], v9 offset:11744
    v_add_f32 v28, v28, v116
    v_add_f32 v28, v28, v118
    s_waitcnt lgkmcnt(6)
    v_mfma_f32_32x32x16_bf16 v[224:239], a[24:27], a[160:163], v[224:239]
    ds_read_b64_tr_b16 a[44:45], v9 offset:10880
    ds_read_b64_tr_b16 a[46:47], v9 offset:11776
    v_add_f32 v28, v28, v120
    v_add_f32 v28, v28, v122
    v_mfma_f32_32x32x16_bf16 v[128:143], a[28:31], a[164:167], v[128:143]
    ds_read_b64_tr_b16 a[48:49], v9 offset:10912
    ds_read_b64_tr_b16 a[50:51], v9 offset:11808
    v_add_f32 v28, v28, v124
    v_add_f32 v28, v28, v126
    s_waitcnt lgkmcnt(6)
    v_mfma_f32_32x32x16_bf16 v[144:159], a[32:35], a[164:167], v[144:159]
    ds_read_b64_tr_b16 a[52:53], v9 offset:10944
    ds_read_b64_tr_b16 a[54:55], v9 offset:11840
    v_mul_f32 v28, 0x3d800000, v28
    v_add_f32 v29, v97, v99
    s_barrier
    v_mfma_f32_32x32x16_bf16 v[160:175], a[36:39], a[164:167], v[160:175]
    ds_read_b64_tr_b16 a[0:1], v10 offset:0
    ds_read_b64_tr_b16 a[2:3], v10 offset:896
    v_add_f32 v29, v29, v101
    v_add_f32 v29, v29, v103
    s_waitcnt lgkmcnt(6)
    v_mfma_f32_32x32x16_bf16 v[176:191], a[40:43], a[164:167], v[176:191]
    ds_read_b64_tr_b16 a[4:5], v10 offset:32
    ds_read_b64_tr_b16 a[6:7], v10 offset:928
    v_add_f32 v29, v29, v105
    v_add_f32 v29, v29, v107
    v_mfma_f32_32x32x16_bf16 v[192:207], a[44:47], a[164:167], v[192:207]
    ds_read_b64_tr_b16 a[8:9], v10 offset:64
    ds_read_b64_tr_b16 a[10:11], v10 offset:960
    v_add_f32 v29, v29, v109
    v_add_f32 v29, v29, v111
    s_waitcnt lgkmcnt(6)
    v_mfma_f32_32x32x16_bf16 v[208:223], a[48:51], a[164:167], v[208:223]
    ds_read_b64_tr_b16 a[12:13], v10 offset:96
    ds_read_b64_tr_b16 a[14:15], v10 offset:992
    v_add_f32 v29, v29, v113
    v_add_f32 v29, v29, v115
    v_mfma_f32_32x32x16_bf16 v[224:239], a[52:55], a[164:167], v[224:239]
    ds_read_b64_tr_b16 a[16:17], v10 offset:128
    ds_read_b64_tr_b16 a[18:19], v10 offset:1024
    v_add_f32 v29, v29, v117
    v_add_f32 v29, v29, v119
    s_waitcnt lgkmcnt(6)
    v_mfma_f32_32x32x16_bf16 v[128:143], a[0:3], a[168:171], v[128:143]
    ds_read_b64_tr_b16 a[20:21], v10 offset:160
    ds_read_b64_tr_b16 a[22:23], v10 offset:1056
    v_add_f32 v29, v29, v121
    v_add_f32 v29, v29, v123
    v_mfma_f32_32x32x16_bf16 v[144:159], a[4:7], a[168:171], v[144:159]
    ds_read_b64_tr_b16 a[24:25], v10 offset:192
    ds_read_b64_tr_b16 a[26:27], v10 offset:1088
    v_add_f32 v29, v29, v125
    v_add_f32 v29, v29, v127
    s_waitcnt lgkmcnt(6)
    v_mfma_f32_32x32x16_bf16 v[160:175], a[8:11], a[168:171], v[160:175]
    ds_read_b64_tr_b16 a[28:29], v10 offset:3584
    ds_read_b64_tr_b16 a[30:31], v10 offset:4480
    v_mov_b32 v30, 0
    v_sub_f32 v31, v96, v28
    v_mfma_f32_32x32x16_bf16 v[176:191], a[12:15], a[168:171], v[176:191]
    ds_read_b64_tr_b16 a[32:33], v10 offset:3616
    ds_read_b64_tr_b16 a[34:35], v10 offset:4512
    v_fmac_f32 v30, v31, v31
    v_sub_f32 v31, v98, v28
    s_waitcnt lgkmcnt(6)
    v_mfma_f32_32x32x16_bf16 v[192:207], a[16:19], a[168:171], v[192:207]
    ds_read_b64_tr_b16 a[36:37], v10 offset:3648
    ds_read_b64_tr_b16 a[38:39], v10 offset:4544
    v_fmac_f32 v30, v31, v31
    v_sub_f32 v31, v100, v28
    v_mfma_f32_32x32x16_bf16 v[208:223], a[20:23], a[168:171], v[208:223]
    ds_read_b64_tr_b16 a[40:41], v10 offset:3680
    ds_read_b64_tr_b16 a[42:43], v10 offset:4576
    v_fmac_f32 v30, v31, v31
    v_sub_f32 v31, v102, v28
    s_waitcnt lgkmcnt(6)
    v_mfma_f32_32x32x16_bf16 v[224:239], a[24:27], a[168:171], v[224:239]
    ds_read_b64_tr_b16 a[44:45], v10 offset:3712
    ds_read_b64_tr_b16 a[46:47], v10 offset:4608
    v_fmac_f32 v30, v31, v31
    v_sub_f32 v31, v104, v28
    v_mfma_f32_32x32x16_bf16 v[128:143], a[28:31], a[172:175], v[128:143]
    ds_read_b64_tr_b16 a[48:49], v10 offset:3744
    ds_read_b64_tr_b16 a[50:51], v10 offset:4640
    v_fmac_f32 v30, v31, v31
    v_sub_f32 v31, v106, v28
    s_waitcnt lgkmcnt(6)
    v_mfma_f32_32x32x16_bf16 v[144:159], a[32:35], a[172:175], v[144:159]
    ds_read_b64_tr_b16 a[52:53], v10 offset:3776
    ds_read_b64_tr_b16 a[54:55], v10 offset:4672
    v_fmac_f32 v30, v31, v31
    v_sub_f32 v31, v108, v28
    v_mfma_f32_32x32x16_bf16 v[160:175], a[36:39], a[172:175], v[160:175]
    ds_read_b64_tr_b16 a[0:1], v10 offset:7168
    ds_read_b64_tr_b16 a[2:3], v10 offset:8064
    v_fmac_f32 v30, v31, v31
    v_sub_f32 v31, v110, v28
    s_waitcnt lgkmcnt(6)
    v_mfma_f32_32x32x16_bf16 v[176:191], a[40:43], a[172:175], v[176:191]
    ds_read_b64_tr_b16 a[4:5], v10 offset:7200
    ds_read_b64_tr_b16 a[6:7], v10 offset:8096
    v_fmac_f32 v30, v31, v31
    v_sub_f32 v31, v112, v28
    v_mfma_f32_32x32x16_bf16 v[192:207], a[44:47], a[172:175], v[192:207]
    ds_read_b64_tr_b16 a[8:9], v10 offset:7232
    ds_read_b64_tr_b16 a[10:11], v10 offset:8128
    v_fmac_f32 v30, v31, v31
    v_sub_f32 v31, v114, v28
    s_waitcnt lgkmcnt(6)
    v_mfma_f32_32x32x16_bf16 v[208:223], a[48:51], a[172:175], v[208:223]
    ds_read_b64_tr_b16 a[12:13], v10 offset:7264
    ds_read_b64_tr_b16 a[14:15], v10 offset:8160
    v_fmac_f32 v30, v31, v31
    v_sub_f32 v31, v116, v28
    v_mfma_f32_32x32x16_bf16 v[224:239], a[52:55], a[172:175], v[224:239]
    ds_read_b64_tr_b16 a[16:17], v10 offset:7296
    ds_read_b64_tr_b16 a[18:19], v10 offset:8192
    v_fmac_f32 v30, v31, v31
    v_sub_f32 v31, v118, v28
    s_waitcnt lgkmcnt(6)
    v_mfma_f32_32x32x16_bf16 v[128:143], a[0:3], a[176:179], v[128:143]
    ds_read_b64_tr_b16 a[20:21], v10 offset:7328
    ds_read_b64_tr_b16 a[22:23], v10 offset:8224
    v_fmac_f32 v30, v31, v31
    v_sub_f32 v31, v120, v28
    v_mfma_f32_32x32x16_bf16 v[144:159], a[4:7], a[176:179], v[144:159]
    ds_read_b64_tr_b16 a[24:25], v10 offset:7360
    ds_read_b64_tr_b16 a[26:27], v10 offset:8256
    v_fmac_f32 v30, v31, v31
    v_sub_f32 v31, v122, v28
    s_waitcnt lgkmcnt(6)
    v_mfma_f32_32x32x16_bf16 v[160:175], a[8:11], a[176:179], v[160:175]
    ds_read_b64_tr_b16 a[28:29], v10 offset:10752
    ds_read_b64_tr_b16 a[30:31], v10 offset:11648
    v_fmac_f32 v30, v31, v31
    v_sub_f32 v31, v124, v28
    v_mfma_f32_32x32x16_bf16 v[176:191], a[12:15], a[176:179], v[176:191]
    ds_read_b64_tr_b16 a[32:33], v10 offset:10784
    ds_read_b64_tr_b16 a[34:35], v10 offset:11680
    v_fmac_f32 v30, v31, v31
    v_sub_f32 v31, v126, v28
    s_waitcnt lgkmcnt(6)
    v_mfma_f32_32x32x16_bf16 v[192:207], a[16:19], a[176:179], v[192:207]
    ds_read_b64_tr_b16 a[36:37], v10 offset:10816
    ds_read_b64_tr_b16 a[38:39], v10 offset:11712
    v_fmac_f32 v30, v31, v31
    v_fmac_f32 v29, 0x42000000, v30
    v_mfma_f32_32x32x16_bf16 v[208:223], a[20:23], a[176:179], v[208:223]
    ds_read_b64_tr_b16 a[40:41], v10 offset:10848
    ds_read_b64_tr_b16 a[42:43], v10 offset:11744
    v_mov_b32 v30, 0x3727c5ac
    v_fmac_f32 v30, 0x3b000000, v29
    s_waitcnt lgkmcnt(6)
    v_mfma_f32_32x32x16_bf16 v[224:239], a[24:27], a[176:179], v[224:239]
    ds_read_b64_tr_b16 a[44:45], v10 offset:10880
    ds_read_b64_tr_b16 a[46:47], v10 offset:11776
    v_rsq_f32 v25, v30
    v_mov_b32 v31, 0
    s_waitcnt vmcnt(0)
    v_mfma_f32_32x32x16_bf16 v[128:143], a[28:31], a[180:183], v[128:143]
    ds_read_b64_tr_b16 a[48:49], v10 offset:10912
    ds_read_b64_tr_b16 a[50:51], v10 offset:11808
    v_mul_f32 v26, v28, v25
    v_sub_f32 v26, 0, v26
    s_waitcnt lgkmcnt(6)
    v_mfma_f32_32x32x16_bf16 v[144:159], a[32:35], a[180:183], v[144:159]
    ds_read_b64_tr_b16 a[52:53], v10 offset:10944
    ds_read_b64_tr_b16 a[54:55], v10 offset:11840
    v_mfma_f32_32x32x16_bf16 v[160:175], a[36:39], a[180:183], v[160:175]
    s_waitcnt lgkmcnt(4)
    v_mfma_f32_32x32x16_bf16 v[176:191], a[40:43], a[180:183], v[176:191]
    v_mfma_f32_32x32x16_bf16 v[192:207], a[44:47], a[180:183], v[192:207]
    s_waitcnt lgkmcnt(0)
    v_mfma_f32_32x32x16_bf16 v[208:223], a[48:51], a[180:183], v[208:223]
    v_mfma_f32_32x32x16_bf16 v[224:239], a[52:55], a[180:183], v[224:239]
    s_nop 15
    s_mul_i32 s22, s64, 114688
    s_mul_i32 s23, s62, 7168
    s_add_u32 s22, s22, s23
    s_add_u32 s22, s22, 0x1800000
    v_add_u32 v27, s22, v27
    s_mov_b32 s40, 0xbfb8aa3b
    s_mov_b32 s41, 0xbfb8aa3b
    s_mov_b32 s42, 1.0
    s_mov_b32 s43, 1.0
    ds_read_b128 v[32:35], v24 offset:0
    ds_read_b128 v[48:51], v24 offset:448
    ds_read_b128 v[36:39], v24 offset:16
    ds_read_b128 v[52:55], v24 offset:464
    ds_read_b128 v[40:43], v24 offset:896
    ds_read_b128 v[56:59], v24 offset:1344
    ds_read_b128 v[44:47], v24 offset:912
    ds_read_b128 v[60:63], v24 offset:1360
    ds_read_b128 v[64:67], v24 offset:64
    ds_read_b128 v[80:83], v24 offset:512
    ds_read_b128 v[68:71], v24 offset:80
    ds_read_b128 v[84:87], v24 offset:528
    ds_read_b128 v[72:75], v24 offset:960
    ds_read_b128 v[88:91], v24 offset:1408
    ds_read_b128 v[76:79], v24 offset:976
    ds_read_b128 v[92:95], v24 offset:1424
    s_waitcnt lgkmcnt(14)
    v_pk_fma_f32 v[48:49], v[32:33], v[26:27], v[48:49] op_sel_hi:[1,0,1]
    v_pk_fma_f32 v[50:51], v[34:35], v[26:27], v[50:51] op_sel_hi:[1,0,1]
    s_waitcnt lgkmcnt(12)
    v_pk_fma_f32 v[52:53], v[36:37], v[26:27], v[52:53] op_sel_hi:[1,0,1]
    v_pk_fma_f32 v[54:55], v[38:39], v[26:27], v[54:55] op_sel_hi:[1,0,1]
    s_waitcnt lgkmcnt(10)
    v_pk_fma_f32 v[56:57], v[40:41], v[26:27], v[56:57] op_sel_hi:[1,0,1]
    v_pk_fma_f32 v[58:59], v[42:43], v[26:27], v[58:59] op_sel_hi:[1,0,1]
    s_waitcnt lgkmcnt(8)
    v_pk_fma_f32 v[60:61], v[44:45], v[26:27], v[60:61] op_sel_hi:[1,0,1]
    v_pk_fma_f32 v[62:63], v[46:47], v[26:27], v[62:63] op_sel_hi:[1,0,1]
    v_pk_fma_f32 v[128:129], v[128:129], v[24:25], v[48:49] op_sel:[0,1,0] op_sel_hi:[1,1,1]
    v_pk_fma_f32 v[130:131], v[130:131], v[24:25], v[50:51] op_sel:[0,1,0] op_sel_hi:[1,1,1]
    v_pk_fma_f32 v[132:133], v[132:133], v[24:25], v[52:53] op_sel:[0,1,0] op_sel_hi:[1,1,1]
    v_pk_fma_f32 v[134:135], v[134:135], v[24:25], v[54:55] op_sel:[0,1,0] op_sel_hi:[1,1,1]
    v_pk_fma_f32 v[136:137], v[136:137], v[24:25], v[56:57] op_sel:[0,1,0] op_sel_hi:[1,1,1]
    v_pk_fma_f32 v[138:139], v[138:139], v[24:25], v[58:59] op_sel:[0,1,0] op_sel_hi:[1,1,1]
    v_pk_fma_f32 v[140:141], v[140:141], v[24:25], v[60:61] op_sel:[0,1,0] op_sel_hi:[1,1,1]
    v_pk_fma_f32 v[142:143], v[142:143], v[24:25], v[62:63] op_sel:[0,1,0] op_sel_hi:[1,1,1]
    v_pk_mul_f32 v[96:97], v[128:129], s[40:41]
    v_pk_mul_f32 v[98:99], v[130:131], s[40:41]
    v_pk_mul_f32 v[100:101], v[132:133], s[40:41]
    v_pk_mul_f32 v[102:103], v[134:135], s[40:41]
    v_exp_f32 v96, v96
    v_exp_f32 v97, v97
    v_exp_f32 v98, v98
    v_exp_f32 v99, v99
    v_exp_f32 v100, v100
    v_exp_f32 v101, v101
    v_exp_f32 v102, v102
    v_exp_f32 v103, v103
    v_pk_mul_f32 v[128:129], v[128:129], v[136:137]
    v_pk_mul_f32 v[130:131], v[130:131], v[138:139]
    v_pk_mul_f32 v[132:133], v[132:133], v[140:141]
    v_pk_mul_f32 v[134:135], v[134:135], v[142:143]
    v_pk_add_f32 v[96:97], v[96:97], s[42:43]
    v_pk_add_f32 v[98:99], v[98:99], s[42:43]
    v_pk_add_f32 v[100:101], v[100:101], s[42:43]
    v_pk_add_f32 v[102:103], v[102:103], s[42:43]
    v_rcp_f32 v96, v96
    v_rcp_f32 v97, v97
    v_rcp_f32 v98, v98
    v_rcp_f32 v99, v99
    v_rcp_f32 v100, v100
    v_rcp_f32 v101, v101
    v_rcp_f32 v102, v102
    v_rcp_f32 v103, v103
    s_nop 0
    v_pk_mul_f32 v[128:129], v[128:129], v[96:97]
    v_pk_mul_f32 v[130:131], v[130:131], v[98:99]
    v_pk_mul_f32 v[132:133], v[132:133], v[100:101]
    v_pk_mul_f32 v[134:135], v[134:135], v[102:103]
    v_cvt_pk_bf16_f32 v136, v128, v129
    v_cvt_pk_bf16_f32 v137, v130, v131
    v_cvt_pk_bf16_f32 v138, v132, v133
    v_cvt_pk_bf16_f32 v139, v134, v135
    global_store_dwordx4 v27, v[136:139], s[34:35] offset:0 sc1
    ds_read_b128 v[32:35], v24 offset:128
    ds_read_b128 v[48:51], v24 offset:576
    ds_read_b128 v[36:39], v24 offset:144
    ds_read_b128 v[52:55], v24 offset:592
    ds_read_b128 v[40:43], v24 offset:1024
    ds_read_b128 v[56:59], v24 offset:1472
    ds_read_b128 v[44:47], v24 offset:1040
    ds_read_b128 v[60:63], v24 offset:1488
    s_waitcnt lgkmcnt(14)
    v_pk_fma_f32 v[80:81], v[64:65], v[26:27], v[80:81] op_sel_hi:[1,0,1]
    v_pk_fma_f32 v[82:83], v[66:67], v[26:27], v[82:83] op_sel_hi:[1,0,1]
    s_waitcnt lgkmcnt(12)
    v_pk_fma_f32 v[84:85], v[68:69], v[26:27], v[84:85] op_sel_hi:[1,0,1]
    v_pk_fma_f32 v[86:87], v[70:71], v[26:27], v[86:87] op_sel_hi:[1,0,1]
    s_waitcnt lgkmcnt(10)
    v_pk_fma_f32 v[88:89], v[72:73], v[26:27], v[88:89] op_sel_hi:[1,0,1]
    v_pk_fma_f32 v[90:91], v[74:75], v[26:27], v[90:91] op_sel_hi:[1,0,1]
    s_waitcnt lgkmcnt(8)
    v_pk_fma_f32 v[92:93], v[76:77], v[26:27], v[92:93] op_sel_hi:[1,0,1]
    v_pk_fma_f32 v[94:95], v[78:79], v[26:27], v[94:95] op_sel_hi:[1,0,1]
    v_pk_fma_f32 v[144:145], v[144:145], v[24:25], v[80:81] op_sel:[0,1,0] op_sel_hi:[1,1,1]
    v_pk_fma_f32 v[146:147], v[146:147], v[24:25], v[82:83] op_sel:[0,1,0] op_sel_hi:[1,1,1]
    v_pk_fma_f32 v[148:149], v[148:149], v[24:25], v[84:85] op_sel:[0,1,0] op_sel_hi:[1,1,1]
    v_pk_fma_f32 v[150:151], v[150:151], v[24:25], v[86:87] op_sel:[0,1,0] op_sel_hi:[1,1,1]
    v_pk_fma_f32 v[152:153], v[152:153], v[24:25], v[88:89] op_sel:[0,1,0] op_sel_hi:[1,1,1]
    v_pk_fma_f32 v[154:155], v[154:155], v[24:25], v[90:91] op_sel:[0,1,0] op_sel_hi:[1,1,1]
    v_pk_fma_f32 v[156:157], v[156:157], v[24:25], v[92:93] op_sel:[0,1,0] op_sel_hi:[1,1,1]
    v_pk_fma_f32 v[158:159], v[158:159], v[24:25], v[94:95] op_sel:[0,1,0] op_sel_hi:[1,1,1]
    v_pk_mul_f32 v[104:105], v[144:145], s[40:41]
    v_pk_mul_f32 v[106:107], v[146:147], s[40:41]
    v_pk_mul_f32 v[108:109], v[148:149], s[40:41]
    v_pk_mul_f32 v[110:111], v[150:151], s[40:41]
    v_exp_f32 v104, v104
    v_exp_f32 v105, v105
    v_exp_f32 v106, v106
    v_exp_f32 v107, v107
    v_exp_f32 v108, v108
    v_exp_f32 v109, v109
    v_exp_f32 v110, v110
    v_exp_f32 v111, v111
    v_pk_mul_f32 v[144:145], v[144:145], v[152:153]
    v_pk_mul_f32 v[146:147], v[146:147], v[154:155]
    v_pk_mul_f32 v[148:149], v[148:149], v[156:157]
    v_pk_mul_f32 v[150:151], v[150:151], v[158:159]
    v_pk_add_f32 v[104:105], v[104:105], s[42:43]
    v_pk_add_f32 v[106:107], v[106:107], s[42:43]
    v_pk_add_f32 v[108:109], v[108:109], s[42:43]
    v_pk_add_f32 v[110:111], v[110:111], s[42:43]
    v_rcp_f32 v104, v104
    v_rcp_f32 v105, v105
    v_rcp_f32 v106, v106
    v_rcp_f32 v107, v107
    v_rcp_f32 v108, v108
    v_rcp_f32 v109, v109
    v_rcp_f32 v110, v110
    v_rcp_f32 v111, v111
    s_nop 0
    v_pk_mul_f32 v[144:145], v[144:145], v[104:105]
    v_pk_mul_f32 v[146:147], v[146:147], v[106:107]
    v_pk_mul_f32 v[148:149], v[148:149], v[108:109]
    v_pk_mul_f32 v[150:151], v[150:151], v[110:111]
    v_cvt_pk_bf16_f32 v152, v144, v145
    v_cvt_pk_bf16_f32 v153, v146, v147
    v_cvt_pk_bf16_f32 v154, v148, v149
    v_cvt_pk_bf16_f32 v155, v150, v151
    global_store_dwordx4 v27, v[152:155], s[34:35] offset:1024 sc1
    ds_read_b128 v[64:67], v24 offset:192
    ds_read_b128 v[80:83], v24 offset:640
    ds_read_b128 v[68:71], v24 offset:208
    ds_read_b128 v[84:87], v24 offset:656
    ds_read_b128 v[72:75], v24 offset:1088
    ds_read_b128 v[88:91], v24 offset:1536
    ds_read_b128 v[76:79], v24 offset:1104
    ds_read_b128 v[92:95], v24 offset:1552
    s_waitcnt lgkmcnt(14)
    v_pk_fma_f32 v[48:49], v[32:33], v[26:27], v[48:49] op_sel_hi:[1,0,1]
    v_pk_fma_f32 v[50:51], v[34:35], v[26:27], v[50:51] op_sel_hi:[1,0,1]
    s_waitcnt lgkmcnt(12)
    v_pk_fma_f32 v[52:53], v[36:37], v[26:27], v[52:53] op_sel_hi:[1,0,1]
    v_pk_fma_f32 v[54:55], v[38:39], v[26:27], v[54:55] op_sel_hi:[1,0,1]
    s_waitcnt lgkmcnt(10)
    v_pk_fma_f32 v[56:57], v[40:41], v[26:27], v[56:57] op_sel_hi:[1,0,1]
    v_pk_fma_f32 v[58:59], v[42:43], v[26:27], v[58:59] op_sel_hi:[1,0,1]
    s_waitcnt lgkmcnt(8)
    v_pk_fma_f32 v[60:61], v[44:45], v[26:27], v[60:61] op_sel_hi:[1,0,1]
    v_pk_fma_f32 v[62:63], v[46:47], v[26:27], v[62:63] op_sel_hi:[1,0,1]
    v_pk_fma_f32 v[160:161], v[160:161], v[24:25], v[48:49] op_sel:[0,1,0] op_sel_hi:[1,1,1]
    v_pk_fma_f32 v[162:163], v[162:163], v[24:25], v[50:51] op_sel:[0,1,0] op_sel_hi:[1,1,1]
    v_pk_fma_f32 v[164:165], v[164:165], v[24:25], v[52:53] op_sel:[0,1,0] op_sel_hi:[1,1,1]
    v_pk_fma_f32 v[166:167], v[166:167], v[24:25], v[54:55] op_sel:[0,1,0] op_sel_hi:[1,1,1]
    v_pk_fma_f32 v[168:169], v[168:169], v[24:25], v[56:57] op_sel:[0,1,0] op_sel_hi:[1,1,1]
    v_pk_fma_f32 v[170:171], v[170:171], v[24:25], v[58:59] op_sel:[0,1,0] op_sel_hi:[1,1,1]
    v_pk_fma_f32 v[172:173], v[172:173], v[24:25], v[60:61] op_sel:[0,1,0] op_sel_hi:[1,1,1]
    v_pk_fma_f32 v[174:175], v[174:175], v[24:25], v[62:63] op_sel:[0,1,0] op_sel_hi:[1,1,1]
    v_pk_mul_f32 v[96:97], v[160:161], s[40:41]
    v_pk_mul_f32 v[98:99], v[162:163], s[40:41]
    v_pk_mul_f32 v[100:101], v[164:165], s[40:41]
    v_pk_mul_f32 v[102:103], v[166:167], s[40:41]
    v_exp_f32 v96, v96
    v_exp_f32 v97, v97
    v_exp_f32 v98, v98
    v_exp_f32 v99, v99
    v_exp_f32 v100, v100
    v_exp_f32 v101, v101
    v_exp_f32 v102, v102
    v_exp_f32 v103, v103
    v_pk_mul_f32 v[160:161], v[160:161], v[168:169]
    v_pk_mul_f32 v[162:163], v[162:163], v[170:171]
    v_pk_mul_f32 v[164:165], v[164:165], v[172:173]
    v_pk_mul_f32 v[166:167], v[166:167], v[174:175]
    v_pk_add_f32 v[96:97], v[96:97], s[42:43]
    v_pk_add_f32 v[98:99], v[98:99], s[42:43]
    v_pk_add_f32 v[100:101], v[100:101], s[42:43]
    v_pk_add_f32 v[102:103], v[102:103], s[42:43]
    v_rcp_f32 v96, v96
    v_rcp_f32 v97, v97
    v_rcp_f32 v98, v98
    v_rcp_f32 v99, v99
    v_rcp_f32 v100, v100
    v_rcp_f32 v101, v101
    v_rcp_f32 v102, v102
    v_rcp_f32 v103, v103
    s_nop 0
    v_pk_mul_f32 v[160:161], v[160:161], v[96:97]
    v_pk_mul_f32 v[162:163], v[162:163], v[98:99]
    v_pk_mul_f32 v[164:165], v[164:165], v[100:101]
    v_pk_mul_f32 v[166:167], v[166:167], v[102:103]
    v_cvt_pk_bf16_f32 v168, v160, v161
    v_cvt_pk_bf16_f32 v169, v162, v163
    v_cvt_pk_bf16_f32 v170, v164, v165
    v_cvt_pk_bf16_f32 v171, v166, v167
    global_store_dwordx4 v27, v[168:171], s[34:35] offset:2048 sc1
    ds_read_b128 v[32:35], v24 offset:256
    ds_read_b128 v[48:51], v24 offset:704
    ds_read_b128 v[36:39], v24 offset:272
    ds_read_b128 v[52:55], v24 offset:720
    ds_read_b128 v[40:43], v24 offset:1152
    ds_read_b128 v[56:59], v24 offset:1600
    ds_read_b128 v[44:47], v24 offset:1168
    ds_read_b128 v[60:63], v24 offset:1616
    s_waitcnt lgkmcnt(14)
    v_pk_fma_f32 v[80:81], v[64:65], v[26:27], v[80:81] op_sel_hi:[1,0,1]
    v_pk_fma_f32 v[82:83], v[66:67], v[26:27], v[82:83] op_sel_hi:[1,0,1]
    s_waitcnt lgkmcnt(12)
    v_pk_fma_f32 v[84:85], v[68:69], v[26:27], v[84:85] op_sel_hi:[1,0,1]
    v_pk_fma_f32 v[86:87], v[70:71], v[26:27], v[86:87] op_sel_hi:[1,0,1]
    s_waitcnt lgkmcnt(10)
    v_pk_fma_f32 v[88:89], v[72:73], v[26:27], v[88:89] op_sel_hi:[1,0,1]
    v_pk_fma_f32 v[90:91], v[74:75], v[26:27], v[90:91] op_sel_hi:[1,0,1]
    s_waitcnt lgkmcnt(8)
    v_pk_fma_f32 v[92:93], v[76:77], v[26:27], v[92:93] op_sel_hi:[1,0,1]
    v_pk_fma_f32 v[94:95], v[78:79], v[26:27], v[94:95] op_sel_hi:[1,0,1]
    v_pk_fma_f32 v[176:177], v[176:177], v[24:25], v[80:81] op_sel:[0,1,0] op_sel_hi:[1,1,1]
    v_pk_fma_f32 v[178:179], v[178:179], v[24:25], v[82:83] op_sel:[0,1,0] op_sel_hi:[1,1,1]
    v_pk_fma_f32 v[180:181], v[180:181], v[24:25], v[84:85] op_sel:[0,1,0] op_sel_hi:[1,1,1]
    v_pk_fma_f32 v[182:183], v[182:183], v[24:25], v[86:87] op_sel:[0,1,0] op_sel_hi:[1,1,1]
    v_pk_fma_f32 v[184:185], v[184:185], v[24:25], v[88:89] op_sel:[0,1,0] op_sel_hi:[1,1,1]
    v_pk_fma_f32 v[186:187], v[186:187], v[24:25], v[90:91] op_sel:[0,1,0] op_sel_hi:[1,1,1]
    v_pk_fma_f32 v[188:189], v[188:189], v[24:25], v[92:93] op_sel:[0,1,0] op_sel_hi:[1,1,1]
    v_pk_fma_f32 v[190:191], v[190:191], v[24:25], v[94:95] op_sel:[0,1,0] op_sel_hi:[1,1,1]
    v_pk_mul_f32 v[104:105], v[176:177], s[40:41]
    v_pk_mul_f32 v[106:107], v[178:179], s[40:41]
    v_pk_mul_f32 v[108:109], v[180:181], s[40:41]
    v_pk_mul_f32 v[110:111], v[182:183], s[40:41]
    v_exp_f32 v104, v104
    v_exp_f32 v105, v105
    v_exp_f32 v106, v106
    v_exp_f32 v107, v107
    v_exp_f32 v108, v108
    v_exp_f32 v109, v109
    v_exp_f32 v110, v110
    v_exp_f32 v111, v111
    v_pk_mul_f32 v[176:177], v[176:177], v[184:185]
    v_pk_mul_f32 v[178:179], v[178:179], v[186:187]
    v_pk_mul_f32 v[180:181], v[180:181], v[188:189]
    v_pk_mul_f32 v[182:183], v[182:183], v[190:191]
    v_pk_add_f32 v[104:105], v[104:105], s[42:43]
    v_pk_add_f32 v[106:107], v[106:107], s[42:43]
    v_pk_add_f32 v[108:109], v[108:109], s[42:43]
    v_pk_add_f32 v[110:111], v[110:111], s[42:43]
    v_rcp_f32 v104, v104
    v_rcp_f32 v105, v105
    v_rcp_f32 v106, v106
    v_rcp_f32 v107, v107
    v_rcp_f32 v108, v108
    v_rcp_f32 v109, v109
    v_rcp_f32 v110, v110
    v_rcp_f32 v111, v111
    s_nop 0
    v_pk_mul_f32 v[176:177], v[176:177], v[104:105]
    v_pk_mul_f32 v[178:179], v[178:179], v[106:107]
    v_pk_mul_f32 v[180:181], v[180:181], v[108:109]
    v_pk_mul_f32 v[182:183], v[182:183], v[110:111]
    v_cvt_pk_bf16_f32 v184, v176, v177
    v_cvt_pk_bf16_f32 v185, v178, v179
    v_cvt_pk_bf16_f32 v186, v180, v181
    v_cvt_pk_bf16_f32 v187, v182, v183
    global_store_dwordx4 v27, v[184:187], s[34:35] offset:3072 sc1
    ds_read_b128 v[64:67], v24 offset:320
    ds_read_b128 v[80:83], v24 offset:768
    ds_read_b128 v[68:71], v24 offset:336
    ds_read_b128 v[84:87], v24 offset:784
    ds_read_b128 v[72:75], v24 offset:1216
    ds_read_b128 v[88:91], v24 offset:1664
    ds_read_b128 v[76:79], v24 offset:1232
    ds_read_b128 v[92:95], v24 offset:1680
    s_waitcnt lgkmcnt(14)
    v_pk_fma_f32 v[48:49], v[32:33], v[26:27], v[48:49] op_sel_hi:[1,0,1]
    v_pk_fma_f32 v[50:51], v[34:35], v[26:27], v[50:51] op_sel_hi:[1,0,1]
    s_waitcnt lgkmcnt(12)
    v_pk_fma_f32 v[52:53], v[36:37], v[26:27], v[52:53] op_sel_hi:[1,0,1]
    v_pk_fma_f32 v[54:55], v[38:39], v[26:27], v[54:55] op_sel_hi:[1,0,1]
    s_waitcnt lgkmcnt(10)
    v_pk_fma_f32 v[56:57], v[40:41], v[26:27], v[56:57] op_sel_hi:[1,0,1]
    v_pk_fma_f32 v[58:59], v[42:43], v[26:27], v[58:59] op_sel_hi:[1,0,1]
    s_waitcnt lgkmcnt(8)
    v_pk_fma_f32 v[60:61], v[44:45], v[26:27], v[60:61] op_sel_hi:[1,0,1]
    v_pk_fma_f32 v[62:63], v[46:47], v[26:27], v[62:63] op_sel_hi:[1,0,1]
    v_pk_fma_f32 v[192:193], v[192:193], v[24:25], v[48:49] op_sel:[0,1,0] op_sel_hi:[1,1,1]
    v_pk_fma_f32 v[194:195], v[194:195], v[24:25], v[50:51] op_sel:[0,1,0] op_sel_hi:[1,1,1]
    v_pk_fma_f32 v[196:197], v[196:197], v[24:25], v[52:53] op_sel:[0,1,0] op_sel_hi:[1,1,1]
    v_pk_fma_f32 v[198:199], v[198:199], v[24:25], v[54:55] op_sel:[0,1,0] op_sel_hi:[1,1,1]
    v_pk_fma_f32 v[200:201], v[200:201], v[24:25], v[56:57] op_sel:[0,1,0] op_sel_hi:[1,1,1]
    v_pk_fma_f32 v[202:203], v[202:203], v[24:25], v[58:59] op_sel:[0,1,0] op_sel_hi:[1,1,1]
    v_pk_fma_f32 v[204:205], v[204:205], v[24:25], v[60:61] op_sel:[0,1,0] op_sel_hi:[1,1,1]
    v_pk_fma_f32 v[206:207], v[206:207], v[24:25], v[62:63] op_sel:[0,1,0] op_sel_hi:[1,1,1]
    v_pk_mul_f32 v[96:97], v[192:193], s[40:41]
    v_pk_mul_f32 v[98:99], v[194:195], s[40:41]
    v_pk_mul_f32 v[100:101], v[196:197], s[40:41]
    v_pk_mul_f32 v[102:103], v[198:199], s[40:41]
    v_exp_f32 v96, v96
    v_exp_f32 v97, v97
    v_exp_f32 v98, v98
    v_exp_f32 v99, v99
    v_exp_f32 v100, v100
    v_exp_f32 v101, v101
    v_exp_f32 v102, v102
    v_exp_f32 v103, v103
    v_pk_mul_f32 v[192:193], v[192:193], v[200:201]
    v_pk_mul_f32 v[194:195], v[194:195], v[202:203]
    v_pk_mul_f32 v[196:197], v[196:197], v[204:205]
    v_pk_mul_f32 v[198:199], v[198:199], v[206:207]
    v_pk_add_f32 v[96:97], v[96:97], s[42:43]
    v_pk_add_f32 v[98:99], v[98:99], s[42:43]
    v_pk_add_f32 v[100:101], v[100:101], s[42:43]
    v_pk_add_f32 v[102:103], v[102:103], s[42:43]
    v_rcp_f32 v96, v96
    v_rcp_f32 v97, v97
    v_rcp_f32 v98, v98
    v_rcp_f32 v99, v99
    v_rcp_f32 v100, v100
    v_rcp_f32 v101, v101
    v_rcp_f32 v102, v102
    v_rcp_f32 v103, v103
    s_nop 0
    v_pk_mul_f32 v[192:193], v[192:193], v[96:97]
    v_pk_mul_f32 v[194:195], v[194:195], v[98:99]
    v_pk_mul_f32 v[196:197], v[196:197], v[100:101]
    v_pk_mul_f32 v[198:199], v[198:199], v[102:103]
    v_cvt_pk_bf16_f32 v200, v192, v193
    v_cvt_pk_bf16_f32 v201, v194, v195
    v_cvt_pk_bf16_f32 v202, v196, v197
    v_cvt_pk_bf16_f32 v203, v198, v199
    v_add_u32 v27, 0x1000, v27
    global_store_dwordx4 v27, v[200:203], s[34:35] offset:0 sc1
    ds_read_b128 v[32:35], v24 offset:384
    ds_read_b128 v[48:51], v24 offset:832
    ds_read_b128 v[36:39], v24 offset:400
    ds_read_b128 v[52:55], v24 offset:848
    ds_read_b128 v[40:43], v24 offset:1280
    ds_read_b128 v[56:59], v24 offset:1728
    ds_read_b128 v[44:47], v24 offset:1296
    ds_read_b128 v[60:63], v24 offset:1744
    s_waitcnt lgkmcnt(14)
    v_pk_fma_f32 v[80:81], v[64:65], v[26:27], v[80:81] op_sel_hi:[1,0,1]
    v_pk_fma_f32 v[82:83], v[66:67], v[26:27], v[82:83] op_sel_hi:[1,0,1]
    s_waitcnt lgkmcnt(12)
    v_pk_fma_f32 v[84:85], v[68:69], v[26:27], v[84:85] op_sel_hi:[1,0,1]
    v_pk_fma_f32 v[86:87], v[70:71], v[26:27], v[86:87] op_sel_hi:[1,0,1]
    s_waitcnt lgkmcnt(10)
    v_pk_fma_f32 v[88:89], v[72:73], v[26:27], v[88:89] op_sel_hi:[1,0,1]
    v_pk_fma_f32 v[90:91], v[74:75], v[26:27], v[90:91] op_sel_hi:[1,0,1]
    s_waitcnt lgkmcnt(8)
    v_pk_fma_f32 v[92:93], v[76:77], v[26:27], v[92:93] op_sel_hi:[1,0,1]
    v_pk_fma_f32 v[94:95], v[78:79], v[26:27], v[94:95] op_sel_hi:[1,0,1]
    v_pk_fma_f32 v[208:209], v[208:209], v[24:25], v[80:81] op_sel:[0,1,0] op_sel_hi:[1,1,1]
    v_pk_fma_f32 v[210:211], v[210:211], v[24:25], v[82:83] op_sel:[0,1,0] op_sel_hi:[1,1,1]
    v_pk_fma_f32 v[212:213], v[212:213], v[24:25], v[84:85] op_sel:[0,1,0] op_sel_hi:[1,1,1]
    v_pk_fma_f32 v[214:215], v[214:215], v[24:25], v[86:87] op_sel:[0,1,0] op_sel_hi:[1,1,1]
    v_pk_fma_f32 v[216:217], v[216:217], v[24:25], v[88:89] op_sel:[0,1,0] op_sel_hi:[1,1,1]
    v_pk_fma_f32 v[218:219], v[218:219], v[24:25], v[90:91] op_sel:[0,1,0] op_sel_hi:[1,1,1]
    v_pk_fma_f32 v[220:221], v[220:221], v[24:25], v[92:93] op_sel:[0,1,0] op_sel_hi:[1,1,1]
    v_pk_fma_f32 v[222:223], v[222:223], v[24:25], v[94:95] op_sel:[0,1,0] op_sel_hi:[1,1,1]
    v_pk_mul_f32 v[104:105], v[208:209], s[40:41]
    v_pk_mul_f32 v[106:107], v[210:211], s[40:41]
    v_pk_mul_f32 v[108:109], v[212:213], s[40:41]
    v_pk_mul_f32 v[110:111], v[214:215], s[40:41]
    v_exp_f32 v104, v104
    v_exp_f32 v105, v105
    v_exp_f32 v106, v106
    v_exp_f32 v107, v107
    v_exp_f32 v108, v108
    v_exp_f32 v109, v109
    v_exp_f32 v110, v110
    v_exp_f32 v111, v111
    v_pk_mul_f32 v[208:209], v[208:209], v[216:217]
    v_pk_mul_f32 v[210:211], v[210:211], v[218:219]
    v_pk_mul_f32 v[212:213], v[212:213], v[220:221]
    v_pk_mul_f32 v[214:215], v[214:215], v[222:223]
    v_pk_add_f32 v[104:105], v[104:105], s[42:43]
    v_pk_add_f32 v[106:107], v[106:107], s[42:43]
    v_pk_add_f32 v[108:109], v[108:109], s[42:43]
    v_pk_add_f32 v[110:111], v[110:111], s[42:43]
    v_rcp_f32 v104, v104
    v_rcp_f32 v105, v105
    v_rcp_f32 v106, v106
    v_rcp_f32 v107, v107
    v_rcp_f32 v108, v108
    v_rcp_f32 v109, v109
    v_rcp_f32 v110, v110
    v_rcp_f32 v111, v111
    s_nop 0
    v_pk_mul_f32 v[208:209], v[208:209], v[104:105]
    v_pk_mul_f32 v[210:211], v[210:211], v[106:107]
    v_pk_mul_f32 v[212:213], v[212:213], v[108:109]
    v_pk_mul_f32 v[214:215], v[214:215], v[110:111]
    v_cvt_pk_bf16_f32 v216, v208, v209
    v_cvt_pk_bf16_f32 v217, v210, v211
    v_cvt_pk_bf16_f32 v218, v212, v213
    v_cvt_pk_bf16_f32 v219, v214, v215
    global_store_dwordx4 v27, v[216:219], s[34:35] offset:1024 sc1
    s_waitcnt lgkmcnt(6)
    v_pk_fma_f32 v[48:49], v[32:33], v[26:27], v[48:49] op_sel_hi:[1,0,1]
    v_pk_fma_f32 v[50:51], v[34:35], v[26:27], v[50:51] op_sel_hi:[1,0,1]
    s_waitcnt lgkmcnt(4)
    v_pk_fma_f32 v[52:53], v[36:37], v[26:27], v[52:53] op_sel_hi:[1,0,1]
    v_pk_fma_f32 v[54:55], v[38:39], v[26:27], v[54:55] op_sel_hi:[1,0,1]
    s_waitcnt lgkmcnt(2)
    v_pk_fma_f32 v[56:57], v[40:41], v[26:27], v[56:57] op_sel_hi:[1,0,1]
    v_pk_fma_f32 v[58:59], v[42:43], v[26:27], v[58:59] op_sel_hi:[1,0,1]
    s_waitcnt lgkmcnt(0)
    v_pk_fma_f32 v[60:61], v[44:45], v[26:27], v[60:61] op_sel_hi:[1,0,1]
    v_pk_fma_f32 v[62:63], v[46:47], v[26:27], v[62:63] op_sel_hi:[1,0,1]
    v_pk_fma_f32 v[224:225], v[224:225], v[24:25], v[48:49] op_sel:[0,1,0] op_sel_hi:[1,1,1]
    v_pk_fma_f32 v[226:227], v[226:227], v[24:25], v[50:51] op_sel:[0,1,0] op_sel_hi:[1,1,1]
    v_pk_fma_f32 v[228:229], v[228:229], v[24:25], v[52:53] op_sel:[0,1,0] op_sel_hi:[1,1,1]
    v_pk_fma_f32 v[230:231], v[230:231], v[24:25], v[54:55] op_sel:[0,1,0] op_sel_hi:[1,1,1]
    v_pk_fma_f32 v[232:233], v[232:233], v[24:25], v[56:57] op_sel:[0,1,0] op_sel_hi:[1,1,1]
    v_pk_fma_f32 v[234:235], v[234:235], v[24:25], v[58:59] op_sel:[0,1,0] op_sel_hi:[1,1,1]
    v_pk_fma_f32 v[236:237], v[236:237], v[24:25], v[60:61] op_sel:[0,1,0] op_sel_hi:[1,1,1]
    v_pk_fma_f32 v[238:239], v[238:239], v[24:25], v[62:63] op_sel:[0,1,0] op_sel_hi:[1,1,1]
    v_pk_mul_f32 v[96:97], v[224:225], s[40:41]
    v_pk_mul_f32 v[98:99], v[226:227], s[40:41]
    v_pk_mul_f32 v[100:101], v[228:229], s[40:41]
    v_pk_mul_f32 v[102:103], v[230:231], s[40:41]
    v_exp_f32 v96, v96
    v_exp_f32 v97, v97
    v_exp_f32 v98, v98
    v_exp_f32 v99, v99
    v_exp_f32 v100, v100
    v_exp_f32 v101, v101
    v_exp_f32 v102, v102
    v_exp_f32 v103, v103
    v_pk_mul_f32 v[224:225], v[224:225], v[232:233]
    v_pk_mul_f32 v[226:227], v[226:227], v[234:235]
    v_pk_mul_f32 v[228:229], v[228:229], v[236:237]
    v_pk_mul_f32 v[230:231], v[230:231], v[238:239]
    v_pk_add_f32 v[96:97], v[96:97], s[42:43]
    v_pk_add_f32 v[98:99], v[98:99], s[42:43]
    v_pk_add_f32 v[100:101], v[100:101], s[42:43]
    v_pk_add_f32 v[102:103], v[102:103], s[42:43]
    v_rcp_f32 v96, v96
    v_rcp_f32 v97, v97
    v_rcp_f32 v98, v98
    v_rcp_f32 v99, v99
    v_rcp_f32 v100, v100
    v_rcp_f32 v101, v101
    v_rcp_f32 v102, v102
    v_rcp_f32 v103, v103
    s_nop 0
    v_pk_mul_f32 v[224:225], v[224:225], v[96:97]
    v_pk_mul_f32 v[226:227], v[226:227], v[98:99]
    v_pk_mul_f32 v[228:229], v[228:229], v[100:101]
    v_pk_mul_f32 v[230:231], v[230:231], v[102:103]
    v_cvt_pk_bf16_f32 v232, v224, v225
    v_cvt_pk_bf16_f32 v233, v226, v227
    v_cvt_pk_bf16_f32 v234, v228, v229
    v_cvt_pk_bf16_f32 v235, v230, v231
    global_store_dwordx4 v27, v[232:235], s[34:35] offset:2048 sc1
    s_and_b32 s50, s2, 7
    s_lshr_b32 s51, s2, 3
    s_lshr_b32 s22, s51, 3
    s_lshl_b32 s50, s50, 2
    s_add_u32 s50, s50, s22
    s_and_b32 s51, s51, 7
    v_mbcnt_lo_u32_b32 v248, -1, 0
    v_mbcnt_hi_u32_b32 v248, -1, v248
    v_lshrrev_b32 v249, 3, v248
    v_and_b32 v250, 7, v248
    v_and_b32 v251, 2, v249
    v_lshlrev_b32 v251, 1, v251
    v_xor_b32 v250, v250, v251
    s_load_dwordx2 s[4:5], s[0:1], 64
    v_lshlrev_b32 v249, 10, v249
    v_lshl_add_u32 v242, v250, 4, v249
    v_add_u32 v243, 7168, v242
    v_lshrrev_b32 v249, 4, v248
    v_and_b32 v250, 15, v248
    v_lshrrev_b32 v251, 2, v250
    v_and_b32 v250, 3, v250
    v_lshrrev_b32 v252, 1, v249
    v_and_b32 v249, 1, v249
    v_lshl_add_u32 v252, v252, 3, v251
    v_lshlrev_b32 v252, 7, v252
    v_and_b32 v253, 1, v250
    v_lshl_add_u32 v253, v249, 1, v253
    v_lshl_add_u32 v252, v253, 4, v252
    v_lshrrev_b32 v253, 1, v250
    v_lshl_add_u32 v252, v253, 3, v252
    v_lshrrev_b32 v251, 1, v251
    s_mul_i32 s25, s24, 32768
    v_add_u32 v252, s25, v252
    v_xor_b32 v253, 0, v251
    v_lshl_add_u32 v240, v253, 6, v252
    v_xor_b32 v253, 1, v251
    v_lshl_add_u32 v241, v253, 6, v252
    v_lshlrev_b32 v244, 4, v248
    v_add_u32 v245, 0x1c000, v244
    s_and_b32 s22, s50, 3
    v_lshlrev_b32 v246, 2, v248
    v_add_u32 v246, s22, v246
    v_lshlrev_b32 v246, 10, v246
    v_lshrrev_b32 v247, 4, v248
    v_and_b32 v247, 1, v247
    s_mov_b32 s22, 114688
    v_mul_lo_u32 v247, v247, s22
    v_and_b32 v249, 15, v248
    v_lshl_add_u32 v247, v249, 10, v247
    s_lshl_b32 s22, s51, 7
    v_add_u32 v247, s22, v247
    s_waitcnt lgkmcnt(0)
    s_lshr_b32 s28, s4, 7
    s_sub_u32 s28, 3, s28
    s_and_b32 s28, s28, 7
    s_mul_i32 s22, s24, 458752
    s_lshl_b32 s23, s51, 7
    s_add_u32 s22, s22, s23
    s_add_u32 s4, s4, s22
    s_addc_u32 s5, s5, 0
    s_and_b32 s5, s5, 0xffff
    s_sub_u32 s6, 0x1c0000, s22
    s_mov_b32 s7, 0x00020000
    s_mov_b32 s30, 16384
    s_cmp_lg_u32 s28, s51
    s_cbranch_scc1 nothot_24
    s_mul_i32 s22, s24, 57344
    s_add_u32 s23, s22, 0x3680000
    s_add_u32 s4, s34, s23
    s_addc_u32 s5, s35, 0
    s_and_b32 s5, s5, 0xffff
    s_sub_u32 s6, 0x38000, s22
    s_mov_b32 s30, 2048
    v_lshrrev_b32 v249, 10, v242
    v_and_b32 v250, 0x3ff, v242
    v_lshl_add_u32 v242, v249, 7, v250
    v_mov_b32 v243, v242
nothot_24:
    s_mul_i32 s22, s50, 229376
    s_mul_i32 s23, s24, 28672
    s_add_u32 s22, s22, s23
    s_add_u32 s22, s22, 0x1800000
    s_add_u32 s8, s34, s22
    s_addc_u32 s9, s35, 0
    s_and_b32 s9, s9, 0xffff
    s_sub_u32 s10, 0x38000, s23
    s_mov_b32 s11, 0x00020000
    s_mov_b32 s26, 0
    s_mov_b32 s27, 0
    s_lshl_b32 s22, s63, 7
    s_lshl_b32 s23, s62, 2
    s_add_u32 s22, s22, s23
    s_add_u32 s45, s22, 0x3002000
    v_mbcnt_lo_u32_b32 v92, -1, 0
    v_mbcnt_hi_u32_b32 v92, -1, v92
    v_and_b32 v92, 3, v92
    v_lshlrev_b32 v92, 2, v92
    s_lshr_b32 s22, s50, 1
    s_lshl_b32 s22, s22, 7
    s_lshl_b32 s23, s24, 4
    s_add_u32 s22, s22, s23
    s_add_u32 s22, s22, 0x3002000
    v_add_u32 v92, s22, v92
    s_waitcnt vmcnt(0)
    s_barrier
    s_cmp_lg_u32 s24, 0
    s_cbranch_scc1 fskip_g_25
    v_mov_b32 v90, s33
    v_mov_b32 v91, s45
    s_mov_b64 exec, 1
    global_store_dword v91, v90, s[34:35] sc1
    s_mov_b64 exec, -1
fskip_g_25:
    s_add_u32 m0, s25, 0
    s_nop 0
    buffer_load_dwordx4 v242, s[4:7], s26 offen lds
    buffer_load_dwordx4 v243, s[4:7], s26 offen offset:1024 lds
    s_add_u32 s26, s26, s30
    s_add_u32 m0, s25, 2048
    s_nop 0
    buffer_load_dwordx4 v242, s[4:7], s26 offen lds
    buffer_load_dwordx4 v243, s[4:7], s26 offen offset:1024 lds
    s_add_u32 s26, s26, s30
    s_add_u32 m0, s25, 4096
    s_nop 0
    buffer_load_dwordx4 v242, s[4:7], s26 offen lds
    buffer_load_dwordx4 v243, s[4:7], s26 offen offset:1024 lds
    s_add_u32 s26, s26, s30
    s_add_u32 m0, s25, 6144
    s_nop 0
    buffer_load_dwordx4 v242, s[4:7], s26 offen lds
    buffer_load_dwordx4 v243, s[4:7], s26 offen offset:1024 lds
    s_add_u32 s26, s26, s30
    s_add_u32 m0, s25, 8192
    s_nop 0
    buffer_load_dwordx4 v242, s[4:7], s26 offen lds
    buffer_load_dwordx4 v243, s[4:7], s26 offen offset:1024 lds
    s_add_u32 s26, s26, s30
    s_add_u32 m0, s25, 10240
    s_nop 0
    buffer_load_dwordx4 v242, s[4:7], s26 offen lds
    buffer_load_dwordx4 v243, s[4:7], s26 offen offset:1024 lds
    s_add_u32 s26, s26, s30
    s_add_u32 m0, s25, 12288
    s_nop 0
    buffer_load_dwordx4 v242, s[4:7], s26 offen lds
    buffer_load_dwordx4 v243, s[4:7], s26 offen offset:1024 lds
    s_add_u32 s26, s26, s30
    s_add_u32 m0, s25, 14336
    s_nop 0
    buffer_load_dwordx4 v242, s[4:7], s26 offen lds
    buffer_load_dwordx4 v243, s[4:7], s26 offen offset:1024 lds
    s_add_u32 s26, s26, s30
    s_add_u32 m0, s25, 16384
    s_nop 0
    buffer_load_dwordx4 v242, s[4:7], s26 offen lds
    buffer_load_dwordx4 v243, s[4:7], s26 offen offset:1024 lds
    s_add_u32 s26, s26, s30
    s_add_u32 m0, s25, 18432
    s_nop 0
    buffer_load_dwordx4 v242, s[4:7], s26 offen lds
    buffer_load_dwordx4 v243, s[4:7], s26 offen offset:1024 lds
    s_add_u32 s26, s26, s30
    s_add_u32 m0, s25, 20480
    s_nop 0
    buffer_load_dwordx4 v242, s[4:7], s26 offen lds
    buffer_load_dwordx4 v243, s[4:7], s26 offen offset:1024 lds
    s_add_u32 s26, s26, s30
    s_add_u32 m0, s25, 22528
    s_nop 0
    buffer_load_dwordx4 v242, s[4:7], s26 offen lds
    buffer_load_dwordx4 v243, s[4:7], s26 offen offset:1024 lds
    s_add_u32 s26, s26, s30
    s_add_u32 m0, s25, 24576
    s_nop 0
    buffer_load_dwordx4 v242, s[4:7], s26 offen lds
    buffer_load_dwordx4 v243, s[4:7], s26 offen offset:1024 lds
    s_add_u32 s26, s26, s30
    s_add_u32 m0, s25, 26624
    s_nop 0
    buffer_load_dwordx4 v242, s[4:7], s26 offen lds
    buffer_load_dwordx4 v243, s[4:7], s26 offen offset:1024 lds
    s_add_u32 s26, s26, s30
    s_add_u32 m0, s25, 28672
    s_nop 0
    buffer_load_dwordx4 v242, s[4:7], s26 offen lds
    buffer_load_dwordx4 v243, s[4:7], s26 offen offset:1024 lds
    s_add_u32 s26, s26, s30
    s_mov_b32 s47, 400000
gsp_26:
    global_load_dword v90, v92, s[34:35] sc1
    s_waitcnt vmcnt(0)
    v_cmp_ne_u32 vcc, s33, v90
    s_cmp_eq_u64 vcc, 0
    s_cbranch_scc1 gok_26
    s_sub_u32 s47, s47, 1
    s_cmp_lg_u32 s47, 0
    s_cbranch_scc1 gsp_26
gok_26:
    buffer_load_dwordx4 v[0:3], v244, s[8:11], s27 offen sc1
    buffer_load_dwordx4 v[4:7], v245, s[8:11], s27 offen sc1
    s_add_u32 s27, s27, 1024
    buffer_load_dwordx4 v[8:11], v244, s[8:11], s27 offen sc1
    buffer_load_dwordx4 v[12:15], v245, s[8:11], s27 offen sc1
    s_add_u32 s27, s27, 1024
    buffer_load_dwordx4 v[16:19], v244, s[8:11], s27 offen sc1
    buffer_load_dwordx4 v[20:23], v245, s[8:11], s27 offen sc1
    s_add_u32 s27, s27, 1024
    buffer_load_dwordx4 v[24:27], v244, s[8:11], s27 offen sc1
    buffer_load_dwordx4 v[28:31], v245, s[8:11], s27 offen sc1
    s_add_u32 s27, s27, 1024
    buffer_load_dwordx4 v[32:35], v244, s[8:11], s27 offen sc1
    buffer_load_dwordx4 v[36:39], v245, s[8:11], s27 offen sc1
    s_add_u32 s27, s27, 1024
    buffer_load_dwordx4 v[40:43], v244, s[8:11], s27 offen sc1
    buffer_load_dwordx4 v[44:47], v245, s[8:11], s27 offen sc1
    s_add_u32 s27, s27, 1024
    buffer_load_dwordx4 v[48:51], v244, s[8:11], s27 offen sc1
    buffer_load_dwordx4 v[52:55], v245, s[8:11], s27 offen sc1
    s_add_u32 s27, s27, 1024
    buffer_load_dwordx4 v[56:59], v244, s[8:11], s27 offen sc1
    buffer_load_dwordx4 v[60:63], v245, s[8:11], s27 offen sc1
    s_add_u32 s27, s27, 1024
    buffer_load_dwordx4 v[64:67], v244, s[8:11], s27 offen sc1
    buffer_load_dwordx4 v[68:71], v245, s[8:11], s27 offen sc1
    s_add_u32 s27, s27, 1024
    v_accvgpr_write_b32 a0, 0
    v_accvgpr_write_b32 a1, 0
    v_accvgpr_write_b32 a2, 0
    v_accvgpr_write_b32 a3, 0
    v_accvgpr_write_b32 a4, 0
    v_accvgpr_write_b32 a5, 0
    v_accvgpr_write_b32 a6, 0
    v_accvgpr_write_b32 a7, 0
    v_accvgpr_write_b32 a8, 0
    v_accvgpr_write_b32 a9, 0
    v_accvgpr_write_b32 a10, 0
    v_accvgpr_write_b32 a11, 0
    v_accvgpr_write_b32 a12, 0
    v_accvgpr_write_b32 a13, 0
    v_accvgpr_write_b32 a14, 0
    v_accvgpr_write_b32 a15, 0
    v_accvgpr_write_b32 a16, 0
    v_accvgpr_write_b32 a17, 0
    v_accvgpr_write_b32 a18, 0
    v_accvgpr_write_b32 a19, 0
    v_accvgpr_write_b32 a20, 0
    v_accvgpr_write_b32 a21, 0
    v_accvgpr_write_b32 a22, 0
    v_accvgpr_write_b32 a23, 0
    v_accvgpr_write_b32 a24, 0
    v_accvgpr_write_b32 a25, 0
    v_accvgpr_write_b32 a26, 0
    v_accvgpr_write_b32 a27, 0
    v_accvgpr_write_b32 a28, 0
    v_accvgpr_write_b32 a29, 0
    v_accvgpr_write_b32 a30, 0
    v_accvgpr_write_b32 a31, 0
    v_accvgpr_write_b32 a32, 0
    v_accvgpr_write_b32 a33, 0
    v_accvgpr_write_b32 a34, 0
    v_accvgpr_write_b32 a35, 0
    v_accvgpr_write_b32 a36, 0
    v_accvgpr_write_b32 a37, 0
    v_accvgpr_write_b32 a38, 0
    v_accvgpr_write_b32 a39, 0
    v_accvgpr_write_b32 a40, 0
    v_accvgpr_write_b32 a41, 0
    v_accvgpr_write_b32 a42, 0
    v_accvgpr_write_b32 a43, 0
    v_accvgpr_write_b32 a44, 0
    v_accvgpr_write_b32 a45, 0
    v_accvgpr_write_b32 a46, 0
    v_accvgpr_write_b32 a47, 0
    v_accvgpr_write_b32 a48, 0
    v_accvgpr_write_b32 a49, 0
    v_accvgpr_write_b32 a50, 0
    v_accvgpr_write_b32 a51, 0
    v_accvgpr_write_b32 a52, 0
    v_accvgpr_write_b32 a53, 0
    v_accvgpr_write_b32 a54, 0
    v_accvgpr_write_b32 a55, 0
    v_accvgpr_write_b32 a56, 0
    v_accvgpr_write_b32 a57, 0
    v_accvgpr_write_b32 a58, 0
    v_accvgpr_write_b32 a59, 0
    v_accvgpr_write_b32 a60, 0
    v_accvgpr_write_b32 a61, 0
    v_accvgpr_write_b32 a62, 0
    v_accvgpr_write_b32 a63, 0
    s_waitcnt vmcnt(46)
    ds_read_b64_tr_b16 a[64:65], v240 offset:0
    ds_read_b64_tr_b16 a[66:67], v240 offset:512
    ds_read_b64_tr_b16 a[68:69], v241 offset:0
    ds_read_b64_tr_b16 a[70:71], v241 offset:512
    s_waitcnt vmcnt(17) lgkmcnt(2)
    v_mfma_f32_32x32x16_bf16 a[0:15], a[64:67], v[0:3], a[0:15]
    ds_read_b64_tr_b16 a[72:73], v240 offset:2048
    ds_read_b64_tr_b16 a[74:75], v240 offset:2560
    ds_read_b64_tr_b16 a[76:77], v241 offset:2048
    ds_read_b64_tr_b16 a[78:79], v241 offset:2560
    s_waitcnt vmcnt(16)
    v_mfma_f32_32x32x16_bf16 a[16:31], a[64:67], v[4:7], a[16:31]
    s_waitcnt lgkmcnt(4)
    v_mfma_f32_32x32x16_bf16 a[32:47], a[68:71], v[0:3], a[32:47]
    s_add_u32 m0, s25, 30720
    v_mfma_f32_32x32x16_bf16 a[48:63], a[68:71], v[4:7], a[48:63]
    buffer_load_dwordx4 v242, s[4:7], s26 offen lds
    buffer_load_dwordx4 v243, s[4:7], s26 offen offset:1024 lds
    s_add_u32 s26, s26, s30
    buffer_load_dwordx4 v[72:75], v244, s[8:11], s27 offen sc1
    buffer_load_dwordx4 v[76:79], v245, s[8:11], s27 offen sc1
    s_add_u32 s27, s27, 1024
    s_waitcnt vmcnt(19) lgkmcnt(2)
    v_mfma_f32_32x32x16_bf16 a[0:15], a[72:75], v[8:11], a[0:15]
    ds_read_b64_tr_b16 a[80:81], v240 offset:4096
    ds_read_b64_tr_b16 a[82:83], v240 offset:4608
    ds_read_b64_tr_b16 a[84:85], v241 offset:4096
    ds_read_b64_tr_b16 a[86:87], v241 offset:4608
    s_waitcnt vmcnt(18)
    v_mfma_f32_32x32x16_bf16 a[16:31], a[72:75], v[12:15], a[16:31]
    s_waitcnt lgkmcnt(4)
    v_mfma_f32_32x32x16_bf16 a[32:47], a[76:79], v[8:11], a[32:47]
    s_add_u32 m0, s25, 0
    v_mfma_f32_32x32x16_bf16 a[48:63], a[76:79], v[12:15], a[48:63]
    buffer_load_dwordx4 v242, s[4:7], s26 offen lds
    buffer_load_dwordx4 v243, s[4:7], s26 offen offset:1024 lds
    s_add_u32 s26, s26, s30
    buffer_load_dwordx4 v[0:3], v244, s[8:11], s27 offen sc1
    buffer_load_dwordx4 v[4:7], v245, s[8:11], s27 offen sc1
    s_add_u32 s27, s27, 1024
    s_waitcnt vmcnt(21) lgkmcnt(2)
    v_mfma_f32_32x32x16_bf16 a[0:15], a[80:83], v[16:19], a[0:15]
    ds_read_b64_tr_b16 a[64:65], v240 offset:6144
    ds_read_b64_tr_b16 a[66:67], v240 offset:6656
    ds_read_b64_tr_b16 a[68:69], v241 offset:6144
    ds_read_b64_tr_b16 a[70:71], v241 offset:6656
    s_waitcnt vmcnt(20)
    v_mfma_f32_32x32x16_bf16 a[16:31], a[80:83], v[20:23], a[16:31]
    s_waitcnt lgkmcnt(4)
    v_mfma_f32_32x32x16_bf16 a[32:47], a[84:87], v[16:19], a[32:47]
    s_add_u32 m0, s25, 2048
    v_mfma_f32_32x32x16_bf16 a[48:63], a[84:87], v[20:23], a[48:63]
    buffer_load_dwordx4 v242, s[4:7], s26 offen lds
    buffer_load_dwordx4 v243, s[4:7], s26 offen offset:1024 lds
    s_add_u32 s26, s26, s30
    buffer_load_dwordx4 v[8:11], v244, s[8:11], s27 offen sc1
    buffer_load_dwordx4 v[12:15], v245, s[8:11], s27 offen sc1
    s_add_u32 s27, s27, 1024
    s_waitcnt vmcnt(23) lgkmcnt(2)
    v_mfma_f32_32x32x16_bf16 a[0:15], a[64:67], v[24:27], a[0:15]
    ds_read_b64_tr_b16 a[72:73], v240 offset:8192
    ds_read_b64_tr_b16 a[74:75], v240 offset:8704
    ds_read_b64_tr_b16 a[76:77], v241 offset:8192
    ds_read_b64_tr_b16 a[78:79], v241 offset:8704
    s_waitcnt vmcnt(22)
    v_mfma_f32_32x32x16_bf16 a[16:31], a[64:67], v[28:31], a[16:31]
    s_waitcnt lgkmcnt(4)
    v_mfma_f32_32x32x16_bf16 a[32:47], a[68:71], v[24:27], a[32:47]
    s_add_u32 m0, s25, 4096
    v_mfma_f32_32x32x16_bf16 a[48:63], a[68:71], v[28:31], a[48:63]
    buffer_load_dwordx4 v242, s[4:7], s26 offen lds
    buffer_load_dwordx4 v243, s[4:7], s26 offen offset:1024 lds
    s_add_u32 s26, s26, s30
    buffer_load_dwordx4 v[16:19], v244, s[8:11], s27 offen sc1
    buffer_load_dwordx4 v[20:23], v245, s[8:11], s27 offen sc1
    s_add_u32 s27, s27, 1024
    s_waitcnt vmcnt(25) lgkmcnt(2)
    v_mfma_f32_32x32x16_bf16 a[0:15], a[72:75], v[32:35], a[0:15]
    ds_read_b64_tr_b16 a[80:81], v240 offset:10240
    ds_read_b64_tr_b16 a[82:83], v240 offset:10752
    ds_read_b64_tr_b16 a[84:85], v241 offset:10240
    ds_read_b64_tr_b16 a[86:87], v241 offset:10752
    s_waitcnt vmcnt(24)
    v_mfma_f32_32x32x16_bf16 a[16:31], a[72:75], v[36:39], a[16:31]
    s_waitcnt lgkmcnt(4)
    v_mfma_f32_32x32x16_bf16 a[32:47], a[76:79], v[32:35], a[32:47]
    s_add_u32 m0, s25, 6144
    v_mfma_f32_32x32x16_bf16 a[48:63], a[76:79], v[36:39], a[48:63]
    buffer_load_dwordx4 v242, s[4:7], s26 offen lds
    buffer_load_dwordx4 v243, s[4:7], s26 offen offset:1024 lds
    s_add_u32 s26, s26, s30
    buffer_load_dwordx4 v[24:27], v244, s[8:11], s27 offen sc1
    buffer_load_dwordx4 v[28:31], v245, s[8:11], s27 offen sc1
    s_add_u32 s27, s27, 1024
    s_waitcnt vmcnt(27) lgkmcnt(2)
    v_mfma_f32_32x32x16_bf16 a[0:15], a[80:83], v[40:43], a[0:15]
    ds_read_b64_tr_b16 a[64:65], v240 offset:12288
    ds_read_b64_tr_b16 a[66:67], v240 offset:12800
    ds_read_b64_tr_b16 a[68:69], v241 offset:12288
    ds_read_b64_tr_b16 a[70:71], v241 offset:12800
    s_waitcnt vmcnt(26)
    v_mfma_f32_32x32x16_bf16 a[16:31], a[80:83], v[44:47], a[16:31]
    s_waitcnt lgkmcnt(4)
    v_mfma_f32_32x32x16_bf16 a[32:47], a[84:87], v[40:43], a[32:47]
    s_add_u32 m0, s25, 8192
    v_mfma_f32_32x32x16_bf16 a[48:63], a[84:87], v[44:47], a[48:63]
    buffer_load_dwordx4 v242, s[4:7], s26 offen lds
    buffer_load_dwordx4 v243, s[4:7], s26 offen offset:1024 lds
    s_add_u32 s26, s26, s30
    buffer_load_dwordx4 v[32:35], v244, s[8:11], s27 offen sc1
    buffer_load_dwordx4 v[36:39], v245, s[8:11], s27 offen sc1
    s_add_u32 s27, s27, 1024
    s_waitcnt vmcnt(29) lgkmcnt(2)
    v_mfma_f32_32x32x16_bf16 a[0:15], a[64:67], v[48:51], a[0:15]
    ds_read_b64_tr_b16 a[72:73], v240 offset:14336
    ds_read_b64_tr_b16 a[74:75], v240 offset:14848
    ds_read_b64_tr_b16 a[76:77], v241 offset:14336
    ds_read_b64_tr_b16 a[78:79], v241 offset:14848
    s_waitcnt vmcnt(28)
    v_mfma_f32_32x32x16_bf16 a[16:31], a[64:67], v[52:55], a[16:31]
    s_waitcnt lgkmcnt(4)
    v_mfma_f32_32x32x16_bf16 a[32:47], a[68:71], v[48:51], a[32:47]
    s_add_u32 m0, s25, 10240
    v_mfma_f32_32x32x16_bf16 a[48:63], a[68:71], v[52:55], a[48:63]
    buffer_load_dwordx4 v242, s[4:7], s26 offen lds
    buffer_load_dwordx4 v243, s[4:7], s26 offen offset:1024 lds
    s_add_u32 s26, s26, s30
    buffer_load_dwordx4 v[40:43], v244, s[8:11], s27 offen sc1
    buffer_load_dwordx4 v[44:47], v245, s[8:11], s27 offen sc1
    s_add_u32 s27, s27, 1024
    s_waitcnt vmcnt(31) lgkmcnt(2)
    v_mfma_f32_32x32x16_bf16 a[0:15], a[72:75], v[56:59], a[0:15]
    ds_read_b64_tr_b16 a[80:81], v240 offset:16384
    ds_read_b64_tr_b16 a[82:83], v240 offset:16896
    ds_read_b64_tr_b16 a[84:85], v241 offset:16384
    ds_read_b64_tr_b16 a[86:87], v241 offset:16896
    s_waitcnt vmcnt(30)
    v_mfma_f32_32x32x16_bf16 a[16:31], a[72:75], v[60:63], a[16:31]
    s_waitcnt lgkmcnt(4)
    v_mfma_f32_32x32x16_bf16 a[32:47], a[76:79], v[56:59], a[32:47]
    s_add_u32 m0, s25, 12288
    v_mfma_f32_32x32x16_bf16 a[48:63], a[76:79], v[60:63], a[48:63]
    buffer_load_dwordx4 v242, s[4:7], s26 offen lds
    buffer_load_dwordx4 v243, s[4:7], s26 offen offset:1024 lds
    s_add_u32 s26, s26, s30
    buffer_load_dwordx4 v[48:51], v244, s[8:11], s27 offen sc1
    buffer_load_dwordx4 v[52:55], v245, s[8:11], s27 offen sc1
    s_add_u32 s27, s27, 1024
    s_waitcnt vmcnt(33) lgkmcnt(2)
    v_mfma_f32_32x32x16_bf16 a[0:15], a[80:83], v[64:67], a[0:15]
    ds_read_b64_tr_b16 a[64:65], v240 offset:18432
    ds_read_b64_tr_b16 a[66:67], v240 offset:18944
    ds_read_b64_tr_b16 a[68:69], v241 offset:18432
    ds_read_b64_tr_b16 a[70:71], v241 offset:18944
    s_waitcnt vmcnt(32)
    v_mfma_f32_32x32x16_bf16 a[16:31], a[80:83], v[68:71], a[16:31]
    s_waitcnt lgkmcnt(4)
    v_mfma_f32_32x32x16_bf16 a[32:47], a[84:87], v[64:67], a[32:47]
    s_add_u32 m0, s25, 14336
    v_mfma_f32_32x32x16_bf16 a[48:63], a[84:87], v[68:71], a[48:63]
    buffer_load_dwordx4 v242, s[4:7], s26 offen lds
    buffer_load_dwordx4 v243, s[4:7], s26 offen offset:1024 lds
    s_add_u32 s26, s26, s30
    buffer_load_dwordx4 v[56:59], v244, s[8:11], s27 offen sc1
    buffer_load_dwordx4 v[60:63], v245, s[8:11], s27 offen sc1
    s_add_u32 s27, s27, 1024
    s_waitcnt vmcnt(33) lgkmcnt(2)
    v_mfma_f32_32x32x16_bf16 a[0:15], a[64:67], v[72:75], a[0:15]
    ds_read_b64_tr_b16 a[72:73], v240 offset:20480
    ds_read_b64_tr_b16 a[74:75], v240 offset:20992
    ds_read_b64_tr_b16 a[76:77], v241 offset:20480
    ds_read_b64_tr_b16 a[78:79], v241 offset:20992
    s_waitcnt vmcnt(32)
    v_mfma_f32_32x32x16_bf16 a[16:31], a[64:67], v[76:79], a[16:31]
    s_waitcnt lgkmcnt(4)
    v_mfma_f32_32x32x16_bf16 a[32:47], a[68:71], v[72:75], a[32:47]
    s_add_u32 m0, s25, 16384
    v_mfma_f32_32x32x16_bf16 a[48:63], a[68:71], v[76:79], a[48:63]
    buffer_load_dwordx4 v242, s[4:7], s26 offen lds
    buffer_load_dwordx4 v243, s[4:7], s26 offen offset:1024 lds
    s_add_u32 s26, s26, s30
    buffer_load_dwordx4 v[64:67], v244, s[8:11], s27 offen sc1
    buffer_load_dwordx4 v[68:71], v245, s[8:11], s27 offen sc1
    s_add_u32 s27, s27, 1024
    s_waitcnt vmcnt(33) lgkmcnt(2)
    v_mfma_f32_32x32x16_bf16 a[0:15], a[72:75], v[0:3], a[0:15]
    ds_read_b64_tr_b16 a[80:81], v240 offset:22528
    ds_read_b64_tr_b16 a[82:83], v240 offset:23040
    ds_read_b64_tr_b16 a[84:85], v241 offset:22528
    ds_read_b64_tr_b16 a[86:87], v241 offset:23040
    s_waitcnt vmcnt(32)
    v_mfma_f32_32x32x16_bf16 a[16:31], a[72:75], v[4:7], a[16:31]
    s_waitcnt lgkmcnt(4)
    v_mfma_f32_32x32x16_bf16 a[32:47], a[76:79], v[0:3], a[32:47]
    s_add_u32 m0, s25, 18432
    v_mfma_f32_32x32x16_bf16 a[48:63], a[76:79], v[4:7], a[48:63]
    buffer_load_dwordx4 v242, s[4:7], s26 offen lds
    buffer_load_dwordx4 v243, s[4:7], s26 offen offset:1024 lds
    s_add_u32 s26, s26, s30
    buffer_load_dwordx4 v[72:75], v244, s[8:11], s27 offen sc1
    buffer_load_dwordx4 v[76:79], v245, s[8:11], s27 offen sc1
    s_add_u32 s27, s27, 1024
    s_waitcnt vmcnt(33) lgkmcnt(2)
    v_mfma_f32_32x32x16_bf16 a[0:15], a[80:83], v[8:11], a[0:15]
    ds_read_b64_tr_b16 a[64:65], v240 offset:24576
    ds_read_b64_tr_b16 a[66:67], v240 offset:25088
    ds_read_b64_tr_b16 a[68:69], v241 offset:24576
    ds_read_b64_tr_b16 a[70:71], v241 offset:25088
    s_waitcnt vmcnt(32)
    v_mfma_f32_32x32x16_bf16 a[16:31], a[80:83], v[12:15], a[16:31]
    s_waitcnt lgkmcnt(4)
    v_mfma_f32_32x32x16_bf16 a[32:47], a[84:87], v[8:11], a[32:47]
    s_add_u32 m0, s25, 20480
    v_mfma_f32_32x32x16_bf16 a[48:63], a[84:87], v[12:15], a[48:63]
    buffer_load_dwordx4 v242, s[4:7], s26 offen lds
    buffer_load_dwordx4 v243, s[4:7], s26 offen offset:1024 lds
    s_add_u32 s26, s26, s30
    buffer_load_dwordx4 v[0:3], v244, s[8:11], s27 offen sc1
    buffer_load_dwordx4 v[4:7], v245, s[8:11], s27 offen sc1
    s_add_u32 s27, s27, 1024
    s_waitcnt vmcnt(33) lgkmcnt(2)
    v_mfma_f32_32x32x16_bf16 a[0:15], a[64:67], v[16:19], a[0:15]
    ds_read_b64_tr_b16 a[72:73], v240 offset:26624
    ds_read_b64_tr_b16 a[74:75], v240 offset:27136
    ds_read_b64_tr_b16 a[76:77], v241 offset:26624
    ds_read_b64_tr_b16 a[78:79], v241 offset:27136
    s_waitcnt vmcnt(32)
    v_mfma_f32_32x32x16_bf16 a[16:31], a[64:67], v[20:23], a[16:31]
    s_waitcnt lgkmcnt(4)
    v_mfma_f32_32x32x16_bf16 a[32:47], a[68:71], v[16:19], a[32:47]
    s_add_u32 m0, s25, 22528
    v_mfma_f32_32x32x16_bf16 a[48:63], a[68:71], v[20:23], a[48:63]
    buffer_load_dwordx4 v242, s[4:7], s26 offen lds
    buffer_load_dwordx4 v243, s[4:7], s26 offen offset:1024 lds
    s_add_u32 s26, s26, s30
    buffer_load_dwordx4 v[8:11], v244, s[8:11], s27 offen sc1
    buffer_load_dwordx4 v[12:15], v245, s[8:11], s27 offen sc1
    s_add_u32 s27, s27, 1024
    s_waitcnt vmcnt(33) lgkmcnt(2)
    v_mfma_f32_32x32x16_bf16 a[0:15], a[72:75], v[24:27], a[0:15]
    ds_read_b64_tr_b16 a[80:81], v240 offset:28672
    ds_read_b64_tr_b16 a[82:83], v240 offset:29184
    ds_read_b64_tr_b16 a[84:85], v241 offset:28672
    ds_read_b64_tr_b16 a[86:87], v241 offset:29184
    s_waitcnt vmcnt(32)
    v_mfma_f32_32x32x16_bf16 a[16:31], a[72:75], v[28:31], a[16:31]
    s_waitcnt lgkmcnt(4)
    v_mfma_f32_32x32x16_bf16 a[32:47], a[76:79], v[24:27], a[32:47]
    v_mfma_f32_32x32x16_bf16 a[48:63], a[76:79], v[28:31], a[48:63]
    buffer_load_dwordx4 v[16:19], v244, s[8:11], s27 offen sc1
    buffer_load_dwordx4 v[20:23], v245, s[8:11], s27 offen sc1
    s_add_u32 s27, s27, 1024
    s_waitcnt vmcnt(31) lgkmcnt(2)
    v_mfma_f32_32x32x16_bf16 a[0:15], a[80:83], v[32:35], a[0:15]
    ds_read_b64_tr_b16 a[64:65], v240 offset:30720
    ds_read_b64_tr_b16 a[66:67], v240 offset:31232
    ds_read_b64_tr_b16 a[68:69], v241 offset:30720
    ds_read_b64_tr_b16 a[70:71], v241 offset:31232
    s_waitcnt vmcnt(30)
    v_mfma_f32_32x32x16_bf16 a[16:31], a[80:83], v[36:39], a[16:31]
    s_waitcnt lgkmcnt(4)
    v_mfma_f32_32x32x16_bf16 a[32:47], a[84:87], v[32:35], a[32:47]
    v_mfma_f32_32x32x16_bf16 a[48:63], a[84:87], v[36:39], a[48:63]
    buffer_load_dwordx4 v[24:27], v244, s[8:11], s27 offen sc1
    buffer_load_dwordx4 v[28:31], v245, s[8:11], s27 offen sc1
    s_add_u32 s27, s27, 1024
    s_waitcnt vmcnt(29) lgkmcnt(2)
    v_mfma_f32_32x32x16_bf16 a[0:15], a[64:67], v[40:43], a[0:15]
    ds_read_b64_tr_b16 a[72:73], v240 offset:0
    ds_read_b64_tr_b16 a[74:75], v240 offset:512
    ds_read_b64_tr_b16 a[76:77], v241 offset:0
    ds_read_b64_tr_b16 a[78:79], v241 offset:512
    s_waitcnt vmcnt(28)
    v_mfma_f32_32x32x16_bf16 a[16:31], a[64:67], v[44:47], a[16:31]
    s_waitcnt lgkmcnt(4)
    v_mfma_f32_32x32x16_bf16 a[32:47], a[68:71], v[40:43], a[32:47]
    v_mfma_f32_32x32x16_bf16 a[48:63], a[68:71], v[44:47], a[48:63]
    buffer_load_dwordx4 v[32:35], v244, s[8:11], s27 offen sc1
    buffer_load_dwordx4 v[36:39], v245, s[8:11], s27 offen sc1
    s_add_u32 s27, s27, 1024
    s_waitcnt vmcnt(27) lgkmcnt(2)
    v_mfma_f32_32x32x16_bf16 a[0:15], a[72:75], v[48:51], a[0:15]
    ds_read_b64_tr_b16 a[80:81], v240 offset:2048
    ds_read_b64_tr_b16 a[82:83], v240 offset:2560
    ds_read_b64_tr_b16 a[84:85], v241 offset:2048
    ds_read_b64_tr_b16 a[86:87], v241 offset:2560
    s_waitcnt vmcnt(26)
    v_mfma_f32_32x32x16_bf16 a[16:31], a[72:75], v[52:55], a[16:31]
    s_waitcnt lgkmcnt(4)
    v_mfma_f32_32x32x16_bf16 a[32:47], a[76:79], v[48:51], a[32:47]
    v_mfma_f32_32x32x16_bf16 a[48:63], a[76:79], v[52:55], a[48:63]
    buffer_load_dwordx4 v[40:43], v244, s[8:11], s27 offen sc1
    buffer_load_dwordx4 v[44:47], v245, s[8:11], s27 offen sc1
    s_add_u32 s27, s27, 1024
    s_waitcnt vmcnt(25) lgkmcnt(2)
    v_mfma_f32_32x32x16_bf16 a[0:15], a[80:83], v[56:59], a[0:15]
    ds_read_b64_tr_b16 a[64:65], v240 offset:4096
    ds_read_b64_tr_b16 a[66:67], v240 offset:4608
    ds_read_b64_tr_b16 a[68:69], v241 offset:4096
    ds_read_b64_tr_b16 a[70:71], v241 offset:4608
    s_waitcnt vmcnt(24)
    v_mfma_f32_32x32x16_bf16 a[16:31], a[80:83], v[60:63], a[16:31]
    s_waitcnt lgkmcnt(4)
    v_mfma_f32_32x32x16_bf16 a[32:47], a[84:87], v[56:59], a[32:47]
    v_mfma_f32_32x32x16_bf16 a[48:63], a[84:87], v[60:63], a[48:63]
    buffer_load_dwordx4 v[48:51], v244, s[8:11], s27 offen sc1
    buffer_load_dwordx4 v[52:55], v245, s[8:11], s27 offen sc1
    s_add_u32 s27, s27, 1024
    s_waitcnt vmcnt(23) lgkmcnt(2)
    v_mfma_f32_32x32x16_bf16 a[0:15], a[64:67], v[64:67], a[0:15]
    ds_read_b64_tr_b16 a[72:73], v240 offset:6144
    ds_read_b64_tr_b16 a[74:75], v240 offset:6656
    ds_read_b64_tr_b16 a[76:77], v241 offset:6144
    ds_read_b64_tr_b16 a[78:79], v241 offset:6656
    s_waitcnt vmcnt(22)
    v_mfma_f32_32x32x16_bf16 a[16:31], a[64:67], v[68:71], a[16:31]
    s_waitcnt lgkmcnt(4)
    v_mfma_f32_32x32x16_bf16 a[32:47], a[68:71], v[64:67], a[32:47]
    v_mfma_f32_32x32x16_bf16 a[48:63], a[68:71], v[68:71], a[48:63]
    buffer_load_dwordx4 v[56:59], v244, s[8:11], s27 offen sc1
    buffer_load_dwordx4 v[60:63], v245, s[8:11], s27 offen sc1
    s_add_u32 s27, s27, 1024
    s_waitcnt vmcnt(21) lgkmcnt(2)
    v_mfma_f32_32x32x16_bf16 a[0:15], a[72:75], v[72:75], a[0:15]
    ds_read_b64_tr_b16 a[80:81], v240 offset:8192
    ds_read_b64_tr_b16 a[82:83], v240 offset:8704
    ds_read_b64_tr_b16 a[84:85], v241 offset:8192
    ds_read_b64_tr_b16 a[86:87], v241 offset:8704
    s_waitcnt vmcnt(20)
    v_mfma_f32_32x32x16_bf16 a[16:31], a[72:75], v[76:79], a[16:31]
    s_waitcnt lgkmcnt(4)
    v_mfma_f32_32x32x16_bf16 a[32:47], a[76:79], v[72:75], a[32:47]
    v_mfma_f32_32x32x16_bf16 a[48:63], a[76:79], v[76:79], a[48:63]
    s_waitcnt vmcnt(17) lgkmcnt(2)
    v_mfma_f32_32x32x16_bf16 a[0:15], a[80:83], v[0:3], a[0:15]
    ds_read_b64_tr_b16 a[64:65], v240 offset:10240
    ds_read_b64_tr_b16 a[66:67], v240 offset:10752
    ds_read_b64_tr_b16 a[68:69], v241 offset:10240
    ds_read_b64_tr_b16 a[70:71], v241 offset:10752
    s_waitcnt vmcnt(16)
    v_mfma_f32_32x32x16_bf16 a[16:31], a[80:83], v[4:7], a[16:31]
    s_waitcnt lgkmcnt(4)
    v_mfma_f32_32x32x16_bf16 a[32:47], a[84:87], v[0:3], a[32:47]
    v_mfma_f32_32x32x16_bf16 a[48:63], a[84:87], v[4:7], a[48:63]
    s_waitcnt vmcnt(13) lgkmcnt(2)
    v_mfma_f32_32x32x16_bf16 a[0:15], a[64:67], v[8:11], a[0:15]
    ds_read_b64_tr_b16 a[72:73], v240 offset:12288
    ds_read_b64_tr_b16 a[74:75], v240 offset:12800
    ds_read_b64_tr_b16 a[76:77], v241 offset:12288
    ds_read_b64_tr_b16 a[78:79], v241 offset:12800
    s_waitcnt vmcnt(12)
    v_mfma_f32_32x32x16_bf16 a[16:31], a[64:67], v[12:15], a[16:31]
    s_waitcnt lgkmcnt(4)
    v_mfma_f32_32x32x16_bf16 a[32:47], a[68:71], v[8:11], a[32:47]
    v_mfma_f32_32x32x16_bf16 a[48:63], a[68:71], v[12:15], a[48:63]
    s_waitcnt vmcnt(11) lgkmcnt(2)
    v_mfma_f32_32x32x16_bf16 a[0:15], a[72:75], v[16:19], a[0:15]
    ds_read_b64_tr_b16 a[80:81], v240 offset:14336
    ds_read_b64_tr_b16 a[82:83], v240 offset:14848
    ds_read_b64_tr_b16 a[84:85], v241 offset:14336
    ds_read_b64_tr_b16 a[86:87], v241 offset:14848
    s_waitcnt vmcnt(10)
    v_mfma_f32_32x32x16_bf16 a[16:31], a[72:75], v[20:23], a[16:31]
    s_waitcnt lgkmcnt(4)
    v_mfma_f32_32x32x16_bf16 a[32:47], a[76:79], v[16:19], a[32:47]
    v_mfma_f32_32x32x16_bf16 a[48:63], a[76:79], v[20:23], a[48:63]
    s_waitcnt vmcnt(9) lgkmcnt(2)
    v_mfma_f32_32x32x16_bf16 a[0:15], a[80:83], v[24:27], a[0:15]
    ds_read_b64_tr_b16 a[64:65], v240 offset:16384
    ds_read_b64_tr_b16 a[66:67], v240 offset:16896
    ds_read_b64_tr_b16 a[68:69], v241 offset:16384
    ds_read_b64_tr_b16 a[70:71], v241 offset:16896
    s_waitcnt vmcnt(8)
    v_mfma_f32_32x32x16_bf16 a[16:31], a[80:83], v[28:31], a[16:31]
    s_waitcnt lgkmcnt(4)
    v_mfma_f32_32x32x16_bf16 a[32:47], a[84:87], v[24:27], a[32:47]
    v_mfma_f32_32x32x16_bf16 a[48:63], a[84:87], v[28:31], a[48:63]
    s_waitcnt vmcnt(7) lgkmcnt(2)
    v_mfma_f32_32x32x16_bf16 a[0:15], a[64:67], v[32:35], a[0:15]
    ds_read_b64_tr_b16 a[72:73], v240 offset:18432
    ds_read_b64_tr_b16 a[74:75], v240 offset:18944
    ds_read_b64_tr_b16 a[76:77], v241 offset:18432
    ds_read_b64_tr_b16 a[78:79], v241 offset:18944
    s_waitcnt vmcnt(6)
    v_mfma_f32_32x32x16_bf16 a[16:31], a[64:67], v[36:39], a[16:31]
    s_waitcnt lgkmcnt(4)
    v_mfma_f32_32x32x16_bf16 a[32:47], a[68:71], v[32:35], a[32:47]
    v_mfma_f32_32x32x16_bf16 a[48:63], a[68:71], v[36:39], a[48:63]
    s_waitcnt vmcnt(5) lgkmcnt(2)
    v_mfma_f32_32x32x16_bf16 a[0:15], a[72:75], v[40:43], a[0:15]
    ds_read_b64_tr_b16 a[80:81], v240 offset:20480
    ds_read_b64_tr_b16 a[82:83], v240 offset:20992
    ds_read_b64_tr_b16 a[84:85], v241 offset:20480
    ds_read_b64_tr_b16 a[86:87], v241 offset:20992
    s_waitcnt vmcnt(4)
    v_mfma_f32_32x32x16_bf16 a[16:31], a[72:75], v[44:47], a[16:31]
    s_waitcnt lgkmcnt(4)
    v_mfma_f32_32x32x16_bf16 a[32:47], a[76:79], v[40:43], a[32:47]
    v_mfma_f32_32x32x16_bf16 a[48:63], a[76:79], v[44:47], a[48:63]
    s_waitcnt vmcnt(3) lgkmcnt(2)
    v_mfma_f32_32x32x16_bf16 a[0:15], a[80:83], v[48:51], a[0:15]
    ds_read_b64_tr_b16 a[64:65], v240 offset:22528
    ds_read_b64_tr_b16 a[66:67], v240 offset:23040
    ds_read_b64_tr_b16 a[68:69], v241 offset:22528
    ds_read_b64_tr_b16 a[70:71], v241 offset:23040
    s_waitcnt vmcnt(2)
    v_mfma_f32_32x32x16_bf16 a[16:31], a[80:83], v[52:55], a[16:31]
    s_waitcnt lgkmcnt(4)
    v_mfma_f32_32x32x16_bf16 a[32:47], a[84:87], v[48:51], a[32:47]
    v_mfma_f32_32x32x16_bf16 a[48:63], a[84:87], v[52:55], a[48:63]
    s_waitcnt vmcnt(1) lgkmcnt(2)
    v_mfma_f32_32x32x16_bf16 a[0:15], a[64:67], v[56:59], a[0:15]
    s_waitcnt vmcnt(0)
    v_mfma_f32_32x32x16_bf16 a[16:31], a[64:67], v[60:63], a[16:31]
    s_waitcnt lgkmcnt(0)
    v_mfma_f32_32x32x16_bf16 a[32:47], a[68:71], v[56:59], a[32:47]
    v_mfma_f32_32x32x16_bf16 a[48:63], a[68:71], v[60:63], a[48:63]
    s_nop 15
    s_barrier
    v_mbcnt_lo_u32_b32 v2, -1, 0
    v_mbcnt_hi_u32_b32 v2, -1, v2
    s_lshl_b32 s22, s24, 14
    v_lshlrev_b32 v3, 4, v2
    v_add_u32 v4, s22, v3
    ds_write_b128 v4, a[0:3] offset:0
    ds_write_b128 v4, a[4:7] offset:1024
    ds_write_b128 v4, a[8:11] offset:2048
    ds_write_b128 v4, a[12:15] offset:3072
    ds_write_b128 v4, a[16:19] offset:4096
    ds_write_b128 v4, a[20:23] offset:5120
    ds_write_b128 v4, a[24:27] offset:6144
    ds_write_b128 v4, a[28:31] offset:7168
    ds_write_b128 v4, a[32:35] offset:8192
    ds_write_b128 v4, a[36:39] offset:9216
    ds_write_b128 v4, a[40:43] offset:10240
    ds_write_b128 v4, a[44:47] offset:11264
    ds_write_b128 v4, a[48:51] offset:12288
    ds_write_b128 v4, a[52:55] offset:13312
    ds_write_b128 v4, a[56:59] offset:14336
    ds_write_b128 v4, a[60:63] offset:15360
    s_waitcnt lgkmcnt(0)
    s_barrier
    s_lshl_b32 s22, s24, 12
    v_add_u32 v4, s22, v3
    ds_read_b128 v[32:35], v4 offset:0
    ds_read_b128 v[36:39], v4 offset:1024
    ds_read_b128 v[40:43], v4 offset:2048
    ds_read_b128 v[44:47], v4 offset:3072
    ds_read_b128 v[48:51], v4 offset:16384
    ds_read_b128 v[52:55], v4 offset:17408
    ds_read_b128 v[56:59], v4 offset:18432
    ds_read_b128 v[60:63], v4 offset:19456
    ds_read_b128 v[64:67], v4 offset:32768
    ds_read_b128 v[68:71], v4 offset:33792
    ds_read_b128 v[72:75], v4 offset:34816
    ds_read_b128 v[76:79], v4 offset:35840
    ds_read_b128 v[80:83], v4 offset:49152
    ds_read_b128 v[84:87], v4 offset:50176
    ds_read_b128 v[88:91], v4 offset:51200
    ds_read_b128 v[92:95], v4 offset:52224
    s_load_dwordx2 s[36:37], s[0:1], 88
    s_lshr_b32 s22, s24, 1
    s_and_b32 s23, s24, 1
    s_lshl_b32 s26, s50, 1
    s_add_u32 s26, s26, s23
    s_lshl_b32 s27, s51, 1
    s_add_u32 s27, s27, s22
    v_and_b32 v5, 31, v2
    v_lshrrev_b32 v6, 5, v2
    s_lshl_b32 s28, s22, 7
    s_add_u32 s28, s28, 154880
    v_lshlrev_b32 v7, 5, v6
    v_add_u32 v7, s28, v7
    ds_read_b128 v[100:103], v7 offset:0
    ds_read_b128 v[104:107], v7 offset:16
    ds_read_b128 v[108:111], v7 offset:64
    ds_read_b128 v[112:115], v7 offset:80
    s_lshl_b32 s28, s26, 15
    s_lshl_b32 s29, s27, 11
    s_add_u32 s28, s28, s29
    s_add_u32 s28, s28, 20971520
    v_add_u32 v8, s28, v3
    s_lshl_b32 s28, s26, 15
    s_lshl_b32 s29, s27, 6
    s_add_u32 s28, s28, s29
    v_lshlrev_b32 v9, 10, v5
    v_lshl_add_u32 v9, v6, 4, v9
    v_add_u32 v9, s28, v9
    v_accvgpr_read_b32 v120, a240
    v_accvgpr_read_b32 v121, a241
    v_accvgpr_read_b32 v122, a242
    v_accvgpr_read_b32 v123, a243
    v_accvgpr_read_b32 v124, a244
    v_accvgpr_read_b32 v125, a245
    v_accvgpr_read_b32 v126, a246
    v_accvgpr_read_b32 v127, a247
    s_waitcnt lgkmcnt(0)
    v_add_f32 v32, v32, v48
    v_add_f32 v64, v64, v80
    v_add_f32 v33, v33, v49
    v_add_f32 v65, v65, v81
    v_add_f32 v34, v34, v50
    v_add_f32 v66, v66, v82
    v_add_f32 v35, v35, v51
    v_add_f32 v67, v67, v83
    v_add_f32 v36, v36, v52
    v_add_f32 v68, v68, v84
    v_add_f32 v37, v37, v53
    v_add_f32 v69, v69, v85
    v_add_f32 v38, v38, v54
    v_add_f32 v70, v70, v86
    v_add_f32 v39, v39, v55
    v_add_f32 v71, v71, v87
    v_add_f32 v40, v40, v56
    v_add_f32 v72, v72, v88
    v_add_f32 v41, v41, v57
    v_add_f32 v73, v73, v89
    v_add_f32 v42, v42, v58
    v_add_f32 v74, v74, v90
    v_add_f32 v43, v43, v59
    v_add_f32 v75, v75, v91
    v_add_f32 v44, v44, v60
    v_add_f32 v76, v76, v92
    v_add_f32 v45, v45, v61
    v_add_f32 v77, v77, v93
    v_add_f32 v46, v46, v62
    v_add_f32 v78, v78, v94
    v_add_f32 v47, v47, v63
    v_add_f32 v79, v79, v95
    v_add_f32 v32, v32, v64
    v_add_f32 v33, v33, v65
    v_add_f32 v34, v34, v66
    v_add_f32 v35, v35, v67
    v_add_f32 v36, v36, v68
    v_add_f32 v37, v37, v69
    v_add_f32 v38, v38, v70
    v_add_f32 v39, v39, v71
    v_add_f32 v40, v40, v72
    v_add_f32 v41, v41, v73
    v_add_f32 v42, v42, v74
    v_add_f32 v43, v43, v75
    v_add_f32 v44, v44, v76
    v_add_f32 v45, v45, v77
    v_add_f32 v46, v46, v78
    v_add_f32 v47, v47, v79
    v_cvt_pk_bf16_f32 v48, v32, v33
    v_lshlrev_b32 v49, 16, v48
    v_and_b32 v50, 0xffff0000, v48
    v_mul_f32 v49, v49, v100
    v_mul_f32 v50, v50, v101
    v_cvt_pk_bf16_f32 v48, v49, v50
    v_lshlrev_b32 v49, 16, v48
    v_and_b32 v50, 0xffff0000, v48
    v_lshlrev_b32 v51, 16, v120
    v_and_b32 v52, 0xffff0000, v120
    v_add_f32 v49, v49, v51
    v_add_f32 v50, v50, v52
    v_cvt_pk_bf16_f32 v64, v49, v50
    v_cvt_pk_bf16_f32 v48, v34, v35
    v_lshlrev_b32 v49, 16, v48
    v_and_b32 v50, 0xffff0000, v48
    v_mul_f32 v49, v49, v102
    v_mul_f32 v50, v50, v103
    v_cvt_pk_bf16_f32 v48, v49, v50
    v_lshlrev_b32 v49, 16, v48
    v_and_b32 v50, 0xffff0000, v48
    v_lshlrev_b32 v51, 16, v121
    v_and_b32 v52, 0xffff0000, v121
    v_add_f32 v49, v49, v51
    v_add_f32 v50, v50, v52
    v_cvt_pk_bf16_f32 v65, v49, v50
    v_cvt_pk_bf16_f32 v48, v36, v37
    v_lshlrev_b32 v49, 16, v48
    v_and_b32 v50, 0xffff0000, v48
    v_mul_f32 v49, v49, v104
    v_mul_f32 v50, v50, v105
    v_cvt_pk_bf16_f32 v48, v49, v50
    v_lshlrev_b32 v49, 16, v48
    v_and_b32 v50, 0xffff0000, v48
    v_lshlrev_b32 v51, 16, v122
    v_and_b32 v52, 0xffff0000, v122
    v_add_f32 v49, v49, v51
    v_add_f32 v50, v50, v52
    v_cvt_pk_bf16_f32 v66, v49, v50
    v_cvt_pk_bf16_f32 v48, v38, v39
    v_lshlrev_b32 v49, 16, v48
    v_and_b32 v50, 0xffff0000, v48
    v_mul_f32 v49, v49, v106
    v_mul_f32 v50, v50, v107
    v_cvt_pk_bf16_f32 v48, v49, v50
    v_lshlrev_b32 v49, 16, v48
    v_and_b32 v50, 0xffff0000, v48
    v_lshlrev_b32 v51, 16, v123
    v_and_b32 v52, 0xffff0000, v123
    v_add_f32 v49, v49, v51
    v_add_f32 v50, v50, v52
    v_cvt_pk_bf16_f32 v67, v49, v50
    v_cvt_pk_bf16_f32 v48, v40, v41
    v_lshlrev_b32 v49, 16, v48
    v_and_b32 v50, 0xffff0000, v48
    v_mul_f32 v49, v49, v108
    v_mul_f32 v50, v50, v109
    v_cvt_pk_bf16_f32 v48, v49, v50
    v_lshlrev_b32 v49, 16, v48
    v_and_b32 v50, 0xffff0000, v48
    v_lshlrev_b32 v51, 16, v124
    v_and_b32 v52, 0xffff0000, v124
    v_add_f32 v49, v49, v51
    v_add_f32 v50, v50, v52
    v_cvt_pk_bf16_f32 v68, v49, v50
    v_cvt_pk_bf16_f32 v48, v42, v43
    v_lshlrev_b32 v49, 16, v48
    v_and_b32 v50, 0xffff0000, v48
    v_mul_f32 v49, v49, v110
    v_mul_f32 v50, v50, v111
    v_cvt_pk_bf16_f32 v48, v49, v50
    v_lshlrev_b32 v49, 16, v48
    v_and_b32 v50, 0xffff0000, v48
    v_lshlrev_b32 v51, 16, v125
    v_and_b32 v52, 0xffff0000, v125
    v_add_f32 v49, v49, v51
    v_add_f32 v50, v50, v52
    v_cvt_pk_bf16_f32 v69, v49, v50
    v_cvt_pk_bf16_f32 v48, v44, v45
    v_lshlrev_b32 v49, 16, v48
    v_and_b32 v50, 0xffff0000, v48
    v_mul_f32 v49, v49, v112
    v_mul_f32 v50, v50, v113
    v_cvt_pk_bf16_f32 v48, v49, v50
    v_lshlrev_b32 v49, 16, v48
    v_and_b32 v50, 0xffff0000, v48
    v_lshlrev_b32 v51, 16, v126
    v_and_b32 v52, 0xffff0000, v126
    v_add_f32 v49, v49, v51
    v_add_f32 v50, v50, v52
    v_cvt_pk_bf16_f32 v70, v49, v50
    v_cvt_pk_bf16_f32 v48, v46, v47
    v_lshlrev_b32 v49, 16, v48
    v_and_b32 v50, 0xffff0000, v48
    v_mul_f32 v49, v49, v114
    v_mul_f32 v50, v50, v115
    v_cvt_pk_bf16_f32 v48, v49, v50
    v_lshlrev_b32 v49, 16, v48
    v_and_b32 v50, 0xffff0000, v48
    v_lshlrev_b32 v51, 16, v127
    v_and_b32 v52, 0xffff0000, v127
    v_add_f32 v49, v49, v51
    v_add_f32 v50, v50, v52
    v_cvt_pk_bf16_f32 v71, v49, v50
    s_waitcnt lgkmcnt(0)
    global_store_dwordx4 v9, v[64:67], s[36:37] offset:0
    global_store_dwordx4 v9, v[68:71], s[36:37] offset:32
fused_exit:
    s_endpgm
code_end:

.section .rodata,"a"
.p2align 6
.amdhsa_kernel adaLN_cond__mha_block_cached__swiglu_ffn__prompt_kernel
  .amdhsa_next_free_vgpr 512
  .amdhsa_next_free_sgpr 102
  .amdhsa_accum_offset 256
  .amdhsa_group_segment_fixed_size 0
  .amdhsa_kernarg_size 112
  .amdhsa_user_sgpr_count 2
  .amdhsa_user_sgpr_kernarg_segment_ptr 1
  .amdhsa_system_sgpr_workgroup_id_x 1
  .amdhsa_float_denorm_mode_32 0
.end_amdhsa_kernel
.text
```
